```python
import torch

def _softmax(x, axis=-1):
    return torch.softmax(x, dim=axis)
def _gelu(x):
    return torch.nn.functional.gelu(x, approximate="tanh")
def _silu(x):
    return torch.nn.functional.silu(x)
def _sigmoid(x):
    return torch.sigmoid(x)
def _layernorm(x, axis=-1, eps=1e-5):
    m = x.mean(dim=axis, keepdim=True)
    v = x.var(dim=axis, keepdim=True, unbiased=False)
    return (x - m) / torch.sqrt(v + eps)
def _scatter_add(tgt, idx, src, axis=0):
    return tgt.clone().index_add_(axis, idx, src)
def _segment_sum(src, seg, n):
    out = torch.zeros((n,) + src.shape[1:], dtype=src.dtype)
    return out.index_add_(0, seg, src)
def _pad(x, pw):
    flat = tuple(v for pair in reversed(pw) for v in pair)
    return torch.nn.functional.pad(x, flat)

kernel_name = 'sequential_preLN__compressed_kv_cla__glu_gated_glu__prompt'

def setup_inputs():

    _w = (lambda a: (lambda t: t.to(torch.bfloat16) if t.is_floating_point() else t)(torch.as_tensor(a)))
    def _A_setup():
        B, H, Sq, Sk, D, M = 1, 32, 2048, 2048, 128, 512
        Dc = 4 * D
        return {
            "x": _w((lambda *s: torch.randn(*s, dtype=torch.bfloat16) * 0.05)(B, Sq, M)),
            "c_kv": _w((lambda *s: torch.randn(*s, dtype=torch.bfloat16) * 0.4)(B, Sk, Dc)),
            "w_q": _w((lambda *s: torch.randn(*s, dtype=torch.bfloat16) * 3.2)(M, H, D) * (M ** -0.5)),
            "w_uk": _w((lambda *s: torch.randn(*s, dtype=torch.bfloat16) * 3.2)(Dc, H, D) * (Dc ** -0.5)),
            "w_uv": _w((lambda *s: torch.randn(*s, dtype=torch.bfloat16) * 0.4)(Dc, H, D) * (Dc ** -0.5)),
            "w_o": _w((lambda *s: torch.randn(*s, dtype=torch.bfloat16) * 0.4)(H, D, M) * ((H * D) ** -0.5)),
        }
    _A_in = _A_setup()

    def _B_setup():
        B, S, D, F = 1, 2048, 512, 1792
        return {
            "x": _w((lambda *s: torch.randn(*s, dtype=torch.bfloat16) * 0.05)(B, S, D)),
            "w_gate": _w((lambda *s: torch.randn(*s, dtype=torch.bfloat16) * 0.05)(D, F)),
            "w_up": _w((lambda *s: torch.randn(*s, dtype=torch.bfloat16) * 0.05)(D, F)),
            "w_down": _w((lambda *s: torch.randn(*s, dtype=torch.bfloat16) * 0.05)(F, D)),
        }
    _B_in = _B_setup()

    return {
        "A_x": _A_in["x"],
        "A_c_kv": _A_in["c_kv"],
        "A_w_q": _A_in["w_q"],
        "A_w_uk": _A_in["w_uk"],
        "A_w_uv": _A_in["w_uv"],
        "A_w_o": _A_in["w_o"],
        "B_x": _B_in["x"],
        "B_w_gate": _B_in["w_gate"],
        "B_w_up": _B_in["w_up"],
        "B_w_down": _B_in["w_down"],
    }

def reference(A_x, A_c_kv, A_w_q, A_w_uk, A_w_uv, A_w_o, B_x, B_w_gate, B_w_up, B_w_down):
    def _A_ref(x, c_kv, w_q, w_uk, w_uv, w_o):
        B, Sq, M = x.shape[0], x.shape[1], x.shape[2]
        Sk = c_kv.shape[1]
        H, D = w_q.shape[1], w_q.shape[2]
        q = torch.einsum("bqm,mhd->bhqd", x, w_q)
        k = torch.einsum("bkc,chd->bhkd", c_kv, w_uk)
        v = torch.einsum("bkc,chd->bhkd", c_kv, w_uv)
        scores = torch.einsum("bhqd,bhkd->bhqk", q, k) * (D ** -0.5)
        off = Sk - Sq
        qi = torch.arange(Sq)[:, None]
        kj = torch.arange(Sk)[None, :]
        cmask = kj <= (qi + off)
        scores = torch.where(cmask[None, None], scores, -1e9)
        p = _softmax(scores, axis=-1)
        ctx = torch.einsum("bhqk,bhkd->bhqd", p, v)
        return torch.einsum("bhqd,hdm->bqm", ctx, w_o)

    def _B_ref(x, w_gate, w_up, w_down):
        g = torch.einsum("bsd,df->bsf", x, w_gate)
        u = torch.einsum("bsd,df->bsf", x, w_up)
        h = _sigmoid(g) * u
        return torch.einsum("bsf,fd->bsd", h, w_down)

    x = A_x
    h = x + _A_ref(_layernorm(x, axis=-1), A_c_kv, A_w_q, A_w_uk, A_w_uv, A_w_o)
    h2 = h + _B_ref(_layernorm(h, axis=-1), B_w_gate, B_w_up, B_w_down)
    return h2
```

```asm
; @launch kernel=k1_qkv_kernel grid=(256,1,1) block=(512,1,1) lds=153600
; @launch kernel=k2_attn_kernel grid=(256,1,1) block=(512,1,1) lds=140288
; @launch kernel=k3_oproj_kernel grid=(256,1,1) block=(512,1,1) lds=149504
; @launch kernel=k4_glu_kernel grid=(224,1,1) block=(512,1,1) lds=153600
; @launch kernel=k5_down_kernel grid=(256,1,1) block=(512,1,1) lds=149504
.amdgcn_target "amdgcn-amd-amdhsa--gfx950"
.text
.globl k1_qkv_kernel
.p2align 8
.type k1_qkv_kernel,@function
k1_qkv_kernel:
    s_cmp_ge_u32 s2, 256
    s_cbranch_scc1 k1_qkv_kernel_end
    s_load_dwordx2 s[12:13], s[0:1], 0
    s_load_dwordx2 s[16:17], s[0:1], 16
    s_load_dwordx2 s[20:21], s[0:1], 96
    s_load_dwordx2 s[24:25], s[0:1], 8
    s_load_dwordx2 s[28:29], s[0:1], 24
    s_load_dwordx2 s[32:33], s[0:1], 96
    s_load_dwordx2 s[36:37], s[0:1], 8
    s_load_dwordx2 s[40:41], s[0:1], 32
    s_load_dwordx2 s[44:45], s[0:1], 96
    s_and_b32 s6, s2, 31
    s_lshl_b32 s6, s6, 7
    s_lshr_b32 s5, s2, 5
    s_lshl_b32 s5, s5, 8
    v_and_b32 v1, 63, v0
    v_lshrrev_b32 v4, 6, v0
    s_nop 0
    v_readfirstlane_b32 s3, v4
    v_and_b32 v2, 31, v0
    v_bfe_u32 v3, v0, 5, 1
    s_and_b32 s97, s3, 1
    s_lshr_b32 s8, s3, 1
    s_and_b32 s96, s8, 3
    s_lshr_b32 s98, s8, 2
    s_lshl_b32 s7, s3, 10
    s_mov_b32 s93, s5
    v_lshrrev_b32 v4, 3, v1
    s_mul_i32 s8, s3, 8
    v_add_u32 v4, s8, v4
    v_lshrrev_b32 v5, 1, v4
    v_and_b32 v5, 7, v5
    v_and_b32 v6, 7, v1
    v_xor_b32 v5, v5, v6
    v_lshlrev_b32 v5, 4, v5
    v_add_u32 v4, s5, v4
    s_mov_b32 s8, 1024
    v_mul_lo_u32 v4, v4, s8
    v_add_u32 v8, v4, v5
    v_lshrrev_b32 v4, 4, v1
    v_and_b32 v5, 3, v4
    v_lshlrev_b32 v5, 2, v5
    v_and_b32 v6, 15, v1
    v_xor_b32 v5, v5, v6
    v_lshlrev_b32 v5, 4, v5
    s_mul_i32 s8, s3, 4
    v_add_u32 v4, s8, v4
    s_mov_b32 s8, 8192
    v_mul_lo_u32 v4, v4, s8
    v_add_u32 v4, v4, v5
    s_lshl_b32 s8, s6, 1
    v_add_u32 v9, s8, v4
    s_waitcnt lgkmcnt(0)
    s_and_b32 s13, s13, 0xffff
    s_mov_b32 s14, 2097152
    s_mov_b32 s15, 0x00020000
    s_and_b32 s17, s17, 0xffff
    s_mov_b32 s18, 4194304
    s_mov_b32 s19, 0x00020000
    s_and_b32 s21, s21, 0xffff
    s_mov_b32 s22, 16777216
    s_mov_b32 s23, 0x00020000
    s_and_b32 s25, s25, 0xffff
    s_mov_b32 s26, 2097152
    s_mov_b32 s27, 0x00020000
    s_and_b32 s29, s29, 0xffff
    s_mov_b32 s30, 4194304
    s_mov_b32 s31, 0x00020000
    s_add_u32 s32, s32, 16777216
    s_addc_u32 s33, s33, 0
    s_and_b32 s33, s33, 0xffff
    s_mov_b32 s34, 16777216
    s_mov_b32 s35, 0x00020000
    s_and_b32 s37, s37, 0xffff
    s_mov_b32 s38, 2097152
    s_mov_b32 s39, 0x00020000
    s_and_b32 s41, s41, 0xffff
    s_mov_b32 s42, 4194304
    s_mov_b32 s43, 0x00020000
    s_add_u32 s44, s44, 33554432
    s_addc_u32 s45, s45, 0
    s_and_b32 s45, s45, 0xffff
    s_mov_b32 s46, 16777216
    s_mov_b32 s47, 0x00020000
    s_add_u32 m0, s7, 0
    s_mov_b32 s4, 0
    buffer_load_dwordx4 v8, s[12:15], s4 offen lds
    s_add_u32 m0, s7, 8192
    s_mov_b32 s4, 65536
    buffer_load_dwordx4 v8, s[12:15], s4 offen lds
    s_add_u32 m0, s7, 16384
    s_mov_b32 s4, 131072
    buffer_load_dwordx4 v8, s[12:15], s4 offen lds
    s_add_u32 m0, s7, 24576
    s_mov_b32 s4, 196608
    buffer_load_dwordx4 v8, s[12:15], s4 offen lds
    s_add_u32 m0, s7, 32768
    s_mov_b32 s4, 0
    buffer_load_dwordx4 v9, s[16:19], s4 offen lds
    s_add_u32 m0, s7, 40960
    s_mov_b32 s4, 262144
    buffer_load_dwordx4 v9, s[16:19], s4 offen lds
    s_add_u32 m0, s7, 49152
    s_mov_b32 s4, 128
    buffer_load_dwordx4 v8, s[12:15], s4 offen lds
    s_add_u32 m0, s7, 57344
    s_mov_b32 s4, 65664
    buffer_load_dwordx4 v8, s[12:15], s4 offen lds
    s_add_u32 m0, s7, 65536
    s_mov_b32 s4, 131200
    buffer_load_dwordx4 v8, s[12:15], s4 offen lds
    s_add_u32 m0, s7, 73728
    s_mov_b32 s4, 196736
    buffer_load_dwordx4 v8, s[12:15], s4 offen lds
    s_add_u32 m0, s7, 81920
    s_mov_b32 s4, 524288
    buffer_load_dwordx4 v9, s[16:19], s4 offen lds
    s_add_u32 m0, s7, 90112
    s_mov_b32 s4, 786432
    buffer_load_dwordx4 v9, s[16:19], s4 offen lds
    s_add_u32 m0, s7, 98304
    s_mov_b32 s4, 256
    buffer_load_dwordx4 v8, s[12:15], s4 offen lds
    s_add_u32 m0, s7, 106496
    s_mov_b32 s4, 65792
    buffer_load_dwordx4 v8, s[12:15], s4 offen lds
    s_add_u32 m0, s7, 114688
    s_mov_b32 s4, 131328
    buffer_load_dwordx4 v8, s[12:15], s4 offen lds
    s_add_u32 m0, s7, 122880
    s_mov_b32 s4, 196864
    buffer_load_dwordx4 v8, s[12:15], s4 offen lds
    s_add_u32 m0, s7, 131072
    s_mov_b32 s4, 1048576
    buffer_load_dwordx4 v9, s[16:19], s4 offen lds
    s_add_u32 m0, s7, 139264
    s_mov_b32 s4, 1310720
    buffer_load_dwordx4 v9, s[16:19], s4 offen lds
    s_mul_i32 s92, s96, 1
    s_lshl_b32 s8, s96, 6
    v_add_u32 v4, s8, v2
    v_lshrrev_b32 v5, 1, v4
    v_and_b32 v5, 7, v5
    v_mul_u32_u24 v4, 128, v4
    s_xor_b32 s9, s92, 0
    s_mul_i32 s8, s98, 4
    s_add_u32 s8, s8, s9
    s_lshl_b32 s8, s8, 1
    v_add_u32 v7, s8, v3
    v_xor_b32 v7, v7, v5
    v_lshl_add_u32 v7, v7, 4, v4
    s_xor_b32 s8, s97, 0
    s_mul_i32 s8, s8, 4096
    v_add_u32 v10, s8, v7
    s_xor_b32 s8, s97, 1
    s_mul_i32 s8, s8, 4096
    v_add_u32 v11, s8, v7
    s_xor_b32 s9, s92, 1
    s_mul_i32 s8, s98, 4
    s_add_u32 s8, s8, s9
    s_lshl_b32 s8, s8, 1
    v_add_u32 v7, s8, v3
    v_xor_b32 v7, v7, v5
    v_lshl_add_u32 v7, v7, 4, v4
    s_xor_b32 s8, s97, 0
    s_mul_i32 s8, s8, 4096
    v_add_u32 v12, s8, v7
    s_xor_b32 s8, s97, 1
    s_mul_i32 s8, s8, 4096
    v_add_u32 v13, s8, v7
    s_xor_b32 s9, s92, 2
    s_mul_i32 s8, s98, 4
    s_add_u32 s8, s8, s9
    s_lshl_b32 s8, s8, 1
    v_add_u32 v7, s8, v3
    v_xor_b32 v7, v7, v5
    v_lshl_add_u32 v7, v7, 4, v4
    s_xor_b32 s8, s97, 0
    s_mul_i32 s8, s8, 4096
    v_add_u32 v14, s8, v7
    s_xor_b32 s8, s97, 1
    s_mul_i32 s8, s8, 4096
    v_add_u32 v15, s8, v7
    s_xor_b32 s9, s92, 3
    s_mul_i32 s8, s98, 4
    s_add_u32 s8, s8, s9
    s_lshl_b32 s8, s8, 1
    v_add_u32 v7, s8, v3
    v_xor_b32 v7, v7, v5
    v_lshl_add_u32 v7, v7, 4, v4
    s_xor_b32 s8, s97, 0
    s_mul_i32 s8, s8, 4096
    v_add_u32 v16, s8, v7
    s_xor_b32 s8, s97, 1
    s_mul_i32 s8, s8, 4096
    v_add_u32 v17, s8, v7
    v_bfe_u32 v4, v1, 2, 2
    v_lshrrev_b32 v5, 5, v1
    v_lshlrev_b32 v5, 3, v5
    v_add_u32 v5, v5, v4
    s_mul_i32 s8, s98, 64
    v_add_u32 v5, s8, v5
    v_mul_u32_u24 v5, 256, v5
    v_bfe_u32 v6, v1, 4, 1
    v_lshlrev_b32 v6, 4, v6
    v_and_b32 v7, 3, v1
    v_lshl_add_u32 v6, v7, 2, v6
    s_mul_i32 s8, s97, 64
    s_add_u32 s8, s8, 0
    v_add_u32 v6, s8, v6
    v_lshlrev_b32 v6, 1, v6
    v_lshlrev_b32 v7, 6, v4
    v_xor_b32 v6, v6, v7
    v_add_u32 v5, v5, v6
    s_xor_b32 s8, s92, 0
    s_mul_i32 s8, s8, 4096
    s_add_u32 s8, s8, 32768
    v_add_u32 v18, s8, v5
    s_xor_b32 s8, s92, 1
    s_mul_i32 s8, s8, 4096
    s_add_u32 s8, s8, 32768
    v_add_u32 v19, s8, v5
    s_xor_b32 s8, s92, 2
    s_mul_i32 s8, s8, 4096
    s_add_u32 s8, s8, 32768
    v_add_u32 v20, s8, v5
    s_xor_b32 s8, s92, 3
    s_mul_i32 s8, s8, 4096
    s_add_u32 s8, s8, 32768
    v_add_u32 v21, s8, v5
    v_bfe_u32 v4, v1, 2, 2
    v_lshrrev_b32 v5, 5, v1
    v_lshlrev_b32 v5, 3, v5
    v_add_u32 v5, v5, v4
    s_mul_i32 s8, s98, 64
    v_add_u32 v5, s8, v5
    v_mul_u32_u24 v5, 256, v5
    v_bfe_u32 v6, v1, 4, 1
    v_lshlrev_b32 v6, 4, v6
    v_and_b32 v7, 3, v1
    v_lshl_add_u32 v6, v7, 2, v6
    s_mul_i32 s8, s97, 64
    s_add_u32 s8, s8, 32
    v_add_u32 v6, s8, v6
    v_lshlrev_b32 v6, 1, v6
    v_lshlrev_b32 v7, 6, v4
    v_xor_b32 v6, v6, v7
    v_add_u32 v5, v5, v6
    s_xor_b32 s8, s92, 0
    s_mul_i32 s8, s8, 4096
    s_add_u32 s8, s8, 32768
    v_add_u32 v22, s8, v5
    s_xor_b32 s8, s92, 1
    s_mul_i32 s8, s8, 4096
    s_add_u32 s8, s8, 32768
    v_add_u32 v23, s8, v5
    s_xor_b32 s8, s92, 2
    s_mul_i32 s8, s8, 4096
    s_add_u32 s8, s8, 32768
    v_add_u32 v24, s8, v5
    s_xor_b32 s8, s92, 3
    s_mul_i32 s8, s8, 4096
    s_add_u32 s8, s8, 32768
    v_add_u32 v25, s8, v5
    v_mov_b32 v138, 0x3f803f80
    v_lshlrev_b32 v156, 4, v1
    s_lshl_b32 s95, s2, 3
    s_add_u32 s95, s95, s3
    s_waitcnt vmcnt(12) lgkmcnt(0)
    s_barrier
    ds_read_b128 v[92:95], v10
    ds_read_b128 v[96:99], v11
    ds_read_b64_tr_b16 v[108:109], v18 offset:0
    ds_read_b64_tr_b16 v[110:111], v18 offset:1024
    ds_read_b64_tr_b16 v[112:113], v22 offset:0
    ds_read_b64_tr_b16 v[114:115], v22 offset:1024
    v_mov_b32 v140, 0
    v_mov_b32 v142, 0
    v_mov_b32 v141, 0
    v_mov_b32 v143, 0
    v_mov_b32 v144, 0
    v_mov_b32 v146, 0
    v_mov_b32 v145, 0
    v_mov_b32 v147, 0
    v_mov_b32 v148, 0
    v_mov_b32 v149, 0
    v_mov_b32 v150, 0
    v_mov_b32 v151, 0
    v_mov_b32 v152, 0
    v_mov_b32 v153, 0
    v_mov_b32 v154, 0
    v_mov_b32 v155, 0
    ds_read_b128 v[100:103], v12
    ds_read_b128 v[104:107], v13
    ds_read_b64_tr_b16 v[116:117], v19 offset:0
    ds_read_b64_tr_b16 v[118:119], v19 offset:1024
    ds_read_b64_tr_b16 v[120:121], v23 offset:0
    ds_read_b64_tr_b16 v[122:123], v23 offset:1024
    s_waitcnt lgkmcnt(6)
    v_mfma_f32_32x32x16_bf16 v[28:43], v[108:111], v[92:95], 0
    v_lshlrev_b32 v4, 16, v92
    v_and_b32 v5, 0xffff0000, v92
    v_add_f32 v140, v140, v4
    v_add_f32 v141, v141, v5
    v_fma_f32 v144, v4, v4, v144
    v_fma_f32 v145, v5, v5, v145
    v_lshlrev_b32 v4, 16, v93
    v_and_b32 v5, 0xffff0000, v93
    v_add_f32 v142, v142, v4
    v_add_f32 v143, v143, v5
    v_fma_f32 v146, v4, v4, v146
    v_fma_f32 v147, v5, v5, v147
    v_lshlrev_b32 v4, 16, v94
    v_and_b32 v5, 0xffff0000, v94
    v_mfma_f32_32x32x16_bf16 v[44:59], v[112:115], v[92:95], 0
    v_add_f32 v140, v140, v4
    v_add_f32 v141, v141, v5
    v_fma_f32 v144, v4, v4, v144
    v_fma_f32 v145, v5, v5, v145
    v_lshlrev_b32 v4, 16, v95
    v_and_b32 v5, 0xffff0000, v95
    v_add_f32 v142, v142, v4
    v_add_f32 v143, v143, v5
    v_fma_f32 v146, v4, v4, v146
    v_fma_f32 v147, v5, v5, v147
    v_lshlrev_b32 v6, 16, v108
    v_and_b32 v7, 0xffff0000, v108
    v_add_f32 v148, v148, v6
    v_add_f32 v150, v150, v7
    v_mfma_f32_32x32x16_bf16 v[60:75], v[108:111], v[96:99], 0
    v_lshlrev_b32 v6, 16, v112
    v_and_b32 v7, 0xffff0000, v112
    v_add_f32 v152, v152, v6
    v_add_f32 v154, v154, v7
    v_lshlrev_b32 v6, 16, v109
    v_and_b32 v7, 0xffff0000, v109
    v_add_f32 v149, v149, v6
    v_add_f32 v151, v151, v7
    v_lshlrev_b32 v6, 16, v113
    v_and_b32 v7, 0xffff0000, v113
    v_add_f32 v153, v153, v6
    v_add_f32 v155, v155, v7
    v_lshlrev_b32 v6, 16, v110
    v_and_b32 v7, 0xffff0000, v110
    v_mfma_f32_32x32x16_bf16 v[76:91], v[112:115], v[96:99], 0
    v_add_f32 v148, v148, v6
    v_add_f32 v150, v150, v7
    v_lshlrev_b32 v6, 16, v114
    v_and_b32 v7, 0xffff0000, v114
    v_add_f32 v152, v152, v6
    v_add_f32 v154, v154, v7
    v_lshlrev_b32 v6, 16, v111
    v_and_b32 v7, 0xffff0000, v111
    v_add_f32 v149, v149, v6
    v_add_f32 v151, v151, v7
    v_lshlrev_b32 v6, 16, v115
    v_and_b32 v7, 0xffff0000, v115
    v_add_f32 v153, v153, v6
    v_add_f32 v155, v155, v7
    ds_read_b128 v[92:95], v14
    ds_read_b128 v[96:99], v15
    ds_read_b64_tr_b16 v[108:109], v20 offset:0
    ds_read_b64_tr_b16 v[110:111], v20 offset:1024
    ds_read_b64_tr_b16 v[112:113], v24 offset:0
    ds_read_b64_tr_b16 v[114:115], v24 offset:1024
    s_waitcnt lgkmcnt(6)
    v_mfma_f32_32x32x16_bf16 v[28:43], v[116:119], v[100:103], v[28:43]
    v_lshlrev_b32 v4, 16, v100
    v_and_b32 v5, 0xffff0000, v100
    v_add_f32 v140, v140, v4
    v_add_f32 v141, v141, v5
    v_fma_f32 v144, v4, v4, v144
    v_fma_f32 v145, v5, v5, v145
    v_mfma_f32_32x32x16_bf16 v[44:59], v[120:123], v[100:103], v[44:59]
    v_lshlrev_b32 v4, 16, v101
    v_and_b32 v5, 0xffff0000, v101
    v_add_f32 v142, v142, v4
    v_add_f32 v143, v143, v5
    v_fma_f32 v146, v4, v4, v146
    v_fma_f32 v147, v5, v5, v147
    v_mfma_f32_32x32x16_bf16 v[60:75], v[116:119], v[104:107], v[60:75]
    v_lshlrev_b32 v4, 16, v102
    v_and_b32 v5, 0xffff0000, v102
    v_add_f32 v140, v140, v4
    v_add_f32 v141, v141, v5
    v_fma_f32 v144, v4, v4, v144
    v_fma_f32 v145, v5, v5, v145
    v_mfma_f32_32x32x16_bf16 v[76:91], v[120:123], v[104:107], v[76:91]
    v_lshlrev_b32 v4, 16, v103
    v_and_b32 v5, 0xffff0000, v103
    v_add_f32 v142, v142, v4
    v_add_f32 v143, v143, v5
    v_fma_f32 v146, v4, v4, v146
    v_fma_f32 v147, v5, v5, v147
    ds_read_b128 v[100:103], v16
    ds_read_b128 v[104:107], v17
    ds_read_b64_tr_b16 v[116:117], v21 offset:0
    ds_read_b64_tr_b16 v[118:119], v21 offset:1024
    ds_read_b64_tr_b16 v[120:121], v25 offset:0
    ds_read_b64_tr_b16 v[122:123], v25 offset:1024
    s_waitcnt lgkmcnt(6)
    v_mfma_f32_32x32x16_bf16 v[28:43], v[108:111], v[92:95], v[28:43]
    v_lshlrev_b32 v4, 16, v92
    v_and_b32 v5, 0xffff0000, v92
    v_add_f32 v140, v140, v4
    v_add_f32 v141, v141, v5
    v_fma_f32 v144, v4, v4, v144
    v_fma_f32 v145, v5, v5, v145
    v_lshlrev_b32 v4, 16, v93
    v_and_b32 v5, 0xffff0000, v93
    v_add_f32 v142, v142, v4
    v_add_f32 v143, v143, v5
    v_mfma_f32_32x32x16_bf16 v[44:59], v[112:115], v[92:95], v[44:59]
    v_fma_f32 v146, v4, v4, v146
    v_fma_f32 v147, v5, v5, v147
    v_lshlrev_b32 v4, 16, v94
    v_and_b32 v5, 0xffff0000, v94
    v_add_f32 v140, v140, v4
    v_add_f32 v141, v141, v5
    v_fma_f32 v144, v4, v4, v144
    v_fma_f32 v145, v5, v5, v145
    v_lshlrev_b32 v4, 16, v95
    v_and_b32 v5, 0xffff0000, v95
    v_mfma_f32_32x32x16_bf16 v[60:75], v[108:111], v[96:99], v[60:75]
    v_add_f32 v142, v142, v4
    v_add_f32 v143, v143, v5
    v_fma_f32 v146, v4, v4, v146
    v_fma_f32 v147, v5, v5, v147
    v_add_u32 v10, 49152, v10
    v_add_u32 v11, 49152, v11
    v_add_u32 v12, 49152, v12
    v_add_u32 v13, 49152, v13
    v_add_u32 v14, 49152, v14
    v_add_u32 v15, 49152, v15
    v_mfma_f32_32x32x16_bf16 v[76:91], v[112:115], v[96:99], v[76:91]
    v_add_u32 v16, 49152, v16
    v_add_u32 v17, 49152, v17
    v_add_u32 v18, 49152, v18
    v_add_u32 v19, 49152, v19
    v_add_u32 v20, 49152, v20
    v_add_u32 v21, 49152, v21
    v_add_u32 v22, 49152, v22
    v_add_u32 v23, 49152, v23
    v_add_u32 v24, 49152, v24
    v_add_u32 v25, 49152, v25
    s_waitcnt vmcnt(6) lgkmcnt(0)
    s_barrier
    ds_read_b128 v[92:95], v10
    ds_read_b128 v[96:99], v11
    ds_read_b64_tr_b16 v[108:109], v18 offset:0
    ds_read_b64_tr_b16 v[110:111], v18 offset:1024
    ds_read_b64_tr_b16 v[112:113], v22 offset:0
    ds_read_b64_tr_b16 v[114:115], v22 offset:1024
    v_mfma_f32_32x32x16_bf16 v[28:43], v[116:119], v[100:103], v[28:43]
    s_add_u32 m0, s7, 0
    s_mov_b32 s4, 384
    buffer_load_dwordx4 v8, s[12:15], s4 offen lds
    v_lshlrev_b32 v4, 16, v100
    v_and_b32 v5, 0xffff0000, v100
    v_add_f32 v140, v140, v4
    v_add_f32 v141, v141, v5
    v_fma_f32 v144, v4, v4, v144
    v_fma_f32 v145, v5, v5, v145
    v_mfma_f32_32x32x16_bf16 v[44:59], v[120:123], v[100:103], v[44:59]
    s_add_u32 m0, s7, 8192
    s_mov_b32 s4, 65920
    buffer_load_dwordx4 v8, s[12:15], s4 offen lds
    v_lshlrev_b32 v4, 16, v101
    v_and_b32 v5, 0xffff0000, v101
    v_add_f32 v142, v142, v4
    v_add_f32 v143, v143, v5
    v_fma_f32 v146, v4, v4, v146
    v_fma_f32 v147, v5, v5, v147
    v_mfma_f32_32x32x16_bf16 v[60:75], v[116:119], v[104:107], v[60:75]
    s_add_u32 m0, s7, 16384
    s_mov_b32 s4, 131456
    buffer_load_dwordx4 v8, s[12:15], s4 offen lds
    v_lshlrev_b32 v4, 16, v102
    v_and_b32 v5, 0xffff0000, v102
    v_add_f32 v140, v140, v4
    v_add_f32 v141, v141, v5
    v_fma_f32 v144, v4, v4, v144
    v_fma_f32 v145, v5, v5, v145
    v_mfma_f32_32x32x16_bf16 v[76:91], v[120:123], v[104:107], v[76:91]
    s_add_u32 m0, s7, 24576
    s_mov_b32 s4, 196992
    buffer_load_dwordx4 v8, s[12:15], s4 offen lds
    v_lshlrev_b32 v4, 16, v103
    v_and_b32 v5, 0xffff0000, v103
    v_add_f32 v142, v142, v4
    v_add_f32 v143, v143, v5
    v_fma_f32 v146, v4, v4, v146
    v_fma_f32 v147, v5, v5, v147
    ds_read_b128 v[100:103], v12
    ds_read_b128 v[104:107], v13
    ds_read_b64_tr_b16 v[116:117], v19 offset:0
    ds_read_b64_tr_b16 v[118:119], v19 offset:1024
    ds_read_b64_tr_b16 v[120:121], v23 offset:0
    ds_read_b64_tr_b16 v[122:123], v23 offset:1024
    s_waitcnt lgkmcnt(6)
    v_mfma_f32_32x32x16_bf16 v[28:43], v[108:111], v[92:95], v[28:43]
    s_add_u32 m0, s7, 32768
    s_mov_b32 s4, 1572864
    buffer_load_dwordx4 v9, s[16:19], s4 offen lds
    v_lshlrev_b32 v4, 16, v92
    v_and_b32 v5, 0xffff0000, v92
    v_add_f32 v140, v140, v4
    v_add_f32 v141, v141, v5
    v_fma_f32 v144, v4, v4, v144
    v_fma_f32 v145, v5, v5, v145
    v_lshlrev_b32 v4, 16, v93
    v_and_b32 v5, 0xffff0000, v93
    v_add_f32 v142, v142, v4
    v_add_f32 v143, v143, v5
    v_fma_f32 v146, v4, v4, v146
    v_fma_f32 v147, v5, v5, v147
    v_lshlrev_b32 v4, 16, v94
    v_and_b32 v5, 0xffff0000, v94
    v_mfma_f32_32x32x16_bf16 v[44:59], v[112:115], v[92:95], v[44:59]
    s_add_u32 m0, s7, 40960
    s_mov_b32 s4, 1835008
    buffer_load_dwordx4 v9, s[16:19], s4 offen lds
    v_add_f32 v140, v140, v4
    v_add_f32 v141, v141, v5
    v_fma_f32 v144, v4, v4, v144
    v_fma_f32 v145, v5, v5, v145
    v_lshlrev_b32 v4, 16, v95
    v_and_b32 v5, 0xffff0000, v95
    v_add_f32 v142, v142, v4
    v_add_f32 v143, v143, v5
    v_fma_f32 v146, v4, v4, v146
    v_fma_f32 v147, v5, v5, v147
    v_lshlrev_b32 v6, 16, v108
    v_and_b32 v7, 0xffff0000, v108
    v_add_f32 v148, v148, v6
    v_add_f32 v150, v150, v7
    v_mfma_f32_32x32x16_bf16 v[60:75], v[108:111], v[96:99], v[60:75]
    s_mov_b32 m0, 147456
    s_mul_i32 s4, s95, 1024
    s_add_u32 s4, s4, 0
    buffer_load_dwordx4 v156, s[24:27], s4 offen lds
    v_lshlrev_b32 v6, 16, v112
    v_and_b32 v7, 0xffff0000, v112
    v_add_f32 v152, v152, v6
    v_add_f32 v154, v154, v7
    v_lshlrev_b32 v6, 16, v109
    v_and_b32 v7, 0xffff0000, v109
    v_add_f32 v149, v149, v6
    v_add_f32 v151, v151, v7
    v_lshlrev_b32 v6, 16, v113
    v_and_b32 v7, 0xffff0000, v113
    v_add_f32 v153, v153, v6
    v_add_f32 v155, v155, v7
    v_lshlrev_b32 v6, 16, v110
    v_and_b32 v7, 0xffff0000, v110
    v_mfma_f32_32x32x16_bf16 v[76:91], v[112:115], v[96:99], v[76:91]
    v_add_f32 v148, v148, v6
    v_add_f32 v150, v150, v7
    v_lshlrev_b32 v6, 16, v114
    v_and_b32 v7, 0xffff0000, v114
    v_add_f32 v152, v152, v6
    v_add_f32 v154, v154, v7
    v_lshlrev_b32 v6, 16, v111
    v_and_b32 v7, 0xffff0000, v111
    v_add_f32 v149, v149, v6
    v_add_f32 v151, v151, v7
    v_lshlrev_b32 v6, 16, v115
    v_and_b32 v7, 0xffff0000, v115
    v_add_f32 v153, v153, v6
    v_add_f32 v155, v155, v7
    ds_read_b128 v[92:95], v14
    ds_read_b128 v[96:99], v15
    ds_read_b64_tr_b16 v[108:109], v20 offset:0
    ds_read_b64_tr_b16 v[110:111], v20 offset:1024
    ds_read_b64_tr_b16 v[112:113], v24 offset:0
    ds_read_b64_tr_b16 v[114:115], v24 offset:1024
    s_waitcnt lgkmcnt(6)
    v_mfma_f32_32x32x16_bf16 v[28:43], v[116:119], v[100:103], v[28:43]
    v_lshlrev_b32 v4, 16, v100
    v_and_b32 v5, 0xffff0000, v100
    v_add_f32 v140, v140, v4
    v_add_f32 v141, v141, v5
    v_fma_f32 v144, v4, v4, v144
    v_fma_f32 v145, v5, v5, v145
    v_mfma_f32_32x32x16_bf16 v[44:59], v[120:123], v[100:103], v[44:59]
    v_lshlrev_b32 v4, 16, v101
    v_and_b32 v5, 0xffff0000, v101
    v_add_f32 v142, v142, v4
    v_add_f32 v143, v143, v5
    v_fma_f32 v146, v4, v4, v146
    v_fma_f32 v147, v5, v5, v147
    v_mfma_f32_32x32x16_bf16 v[60:75], v[116:119], v[104:107], v[60:75]
    v_lshlrev_b32 v4, 16, v102
    v_and_b32 v5, 0xffff0000, v102
    v_add_f32 v140, v140, v4
    v_add_f32 v141, v141, v5
    v_fma_f32 v144, v4, v4, v144
    v_fma_f32 v145, v5, v5, v145
    v_mfma_f32_32x32x16_bf16 v[76:91], v[120:123], v[104:107], v[76:91]
    v_lshlrev_b32 v4, 16, v103
    v_and_b32 v5, 0xffff0000, v103
    v_add_f32 v142, v142, v4
    v_add_f32 v143, v143, v5
    v_fma_f32 v146, v4, v4, v146
    v_fma_f32 v147, v5, v5, v147
    ds_read_b128 v[100:103], v16
    ds_read_b128 v[104:107], v17
    ds_read_b64_tr_b16 v[116:117], v21 offset:0
    ds_read_b64_tr_b16 v[118:119], v21 offset:1024
    ds_read_b64_tr_b16 v[120:121], v25 offset:0
    ds_read_b64_tr_b16 v[122:123], v25 offset:1024
    s_waitcnt lgkmcnt(6)
    v_mfma_f32_32x32x16_bf16 v[28:43], v[108:111], v[92:95], v[28:43]
    s_mov_b32 m0, 147456
    s_mul_i32 s4, s95, 2048
    s_add_u32 s4, s4, 0
    buffer_load_dwordx4 v156, s[28:31], s4 offen lds
    v_lshlrev_b32 v4, 16, v92
    v_and_b32 v5, 0xffff0000, v92
    v_add_f32 v140, v140, v4
    v_add_f32 v141, v141, v5
    v_fma_f32 v144, v4, v4, v144
    v_fma_f32 v145, v5, v5, v145
    v_lshlrev_b32 v4, 16, v93
    v_and_b32 v5, 0xffff0000, v93
    v_add_f32 v142, v142, v4
    v_add_f32 v143, v143, v5
    v_mfma_f32_32x32x16_bf16 v[44:59], v[112:115], v[92:95], v[44:59]
    v_fma_f32 v146, v4, v4, v146
    v_fma_f32 v147, v5, v5, v147
    v_lshlrev_b32 v4, 16, v94
    v_and_b32 v5, 0xffff0000, v94
    v_add_f32 v140, v140, v4
    v_add_f32 v141, v141, v5
    v_fma_f32 v144, v4, v4, v144
    v_fma_f32 v145, v5, v5, v145
    v_lshlrev_b32 v4, 16, v95
    v_and_b32 v5, 0xffff0000, v95
    v_mfma_f32_32x32x16_bf16 v[60:75], v[108:111], v[96:99], v[60:75]
    v_add_f32 v142, v142, v4
    v_add_f32 v143, v143, v5
    v_fma_f32 v146, v4, v4, v146
    v_fma_f32 v147, v5, v5, v147
    v_add_u32 v10, 49152, v10
    v_add_u32 v11, 49152, v11
    v_add_u32 v12, 49152, v12
    v_add_u32 v13, 49152, v13
    v_add_u32 v14, 49152, v14
    v_add_u32 v15, 49152, v15
    v_mfma_f32_32x32x16_bf16 v[76:91], v[112:115], v[96:99], v[76:91]
    v_add_u32 v16, 49152, v16
    v_add_u32 v17, 49152, v17
    v_add_u32 v18, 49152, v18
    v_add_u32 v19, 49152, v19
    v_add_u32 v20, 49152, v20
    v_add_u32 v21, 49152, v21
    v_add_u32 v22, 49152, v22
    v_add_u32 v23, 49152, v23
    v_add_u32 v24, 49152, v24
    v_add_u32 v25, 49152, v25
    s_waitcnt vmcnt(8) lgkmcnt(0)
    s_barrier
    ds_read_b128 v[92:95], v10
    ds_read_b128 v[96:99], v11
    ds_read_b64_tr_b16 v[108:109], v18 offset:0
    ds_read_b64_tr_b16 v[110:111], v18 offset:1024
    ds_read_b64_tr_b16 v[112:113], v22 offset:0
    ds_read_b64_tr_b16 v[114:115], v22 offset:1024
    v_mfma_f32_32x32x16_bf16 v[28:43], v[116:119], v[100:103], v[28:43]
    s_add_u32 m0, s7, 49152
    s_mov_b32 s4, 512
    buffer_load_dwordx4 v8, s[12:15], s4 offen lds
    v_lshlrev_b32 v4, 16, v100
    v_and_b32 v5, 0xffff0000, v100
    v_add_f32 v140, v140, v4
    v_add_f32 v141, v141, v5
    v_fma_f32 v144, v4, v4, v144
    v_fma_f32 v145, v5, v5, v145
    v_mfma_f32_32x32x16_bf16 v[44:59], v[120:123], v[100:103], v[44:59]
    s_add_u32 m0, s7, 57344
    s_mov_b32 s4, 66048
    buffer_load_dwordx4 v8, s[12:15], s4 offen lds
    v_lshlrev_b32 v4, 16, v101
    v_and_b32 v5, 0xffff0000, v101
    v_add_f32 v142, v142, v4
    v_add_f32 v143, v143, v5
    v_fma_f32 v146, v4, v4, v146
    v_fma_f32 v147, v5, v5, v147
    v_mfma_f32_32x32x16_bf16 v[60:75], v[116:119], v[104:107], v[60:75]
    s_add_u32 m0, s7, 65536
    s_mov_b32 s4, 131584
    buffer_load_dwordx4 v8, s[12:15], s4 offen lds
    v_lshlrev_b32 v4, 16, v102
    v_and_b32 v5, 0xffff0000, v102
    v_add_f32 v140, v140, v4
    v_add_f32 v141, v141, v5
    v_fma_f32 v144, v4, v4, v144
    v_fma_f32 v145, v5, v5, v145
    v_mfma_f32_32x32x16_bf16 v[76:91], v[120:123], v[104:107], v[76:91]
    s_add_u32 m0, s7, 73728
    s_mov_b32 s4, 197120
    buffer_load_dwordx4 v8, s[12:15], s4 offen lds
    v_lshlrev_b32 v4, 16, v103
    v_and_b32 v5, 0xffff0000, v103
    v_add_f32 v142, v142, v4
    v_add_f32 v143, v143, v5
    v_fma_f32 v146, v4, v4, v146
    v_fma_f32 v147, v5, v5, v147
    ds_read_b128 v[100:103], v12
    ds_read_b128 v[104:107], v13
    ds_read_b64_tr_b16 v[116:117], v19 offset:0
    ds_read_b64_tr_b16 v[118:119], v19 offset:1024
    ds_read_b64_tr_b16 v[120:121], v23 offset:0
    ds_read_b64_tr_b16 v[122:123], v23 offset:1024
    s_waitcnt lgkmcnt(6)
    v_mfma_f32_32x32x16_bf16 v[28:43], v[108:111], v[92:95], v[28:43]
    s_add_u32 m0, s7, 81920
    s_mov_b32 s4, 2097152
    buffer_load_dwordx4 v9, s[16:19], s4 offen lds
    v_lshlrev_b32 v4, 16, v92
    v_and_b32 v5, 0xffff0000, v92
    v_add_f32 v140, v140, v4
    v_add_f32 v141, v141, v5
    v_fma_f32 v144, v4, v4, v144
    v_fma_f32 v145, v5, v5, v145
    v_lshlrev_b32 v4, 16, v93
    v_and_b32 v5, 0xffff0000, v93
    v_add_f32 v142, v142, v4
    v_add_f32 v143, v143, v5
    v_fma_f32 v146, v4, v4, v146
    v_fma_f32 v147, v5, v5, v147
    v_lshlrev_b32 v4, 16, v94
    v_and_b32 v5, 0xffff0000, v94
    v_mfma_f32_32x32x16_bf16 v[44:59], v[112:115], v[92:95], v[44:59]
    s_add_u32 m0, s7, 90112
    s_mov_b32 s4, 2359296
    buffer_load_dwordx4 v9, s[16:19], s4 offen lds
    v_add_f32 v140, v140, v4
    v_add_f32 v141, v141, v5
    v_fma_f32 v144, v4, v4, v144
    v_fma_f32 v145, v5, v5, v145
    v_lshlrev_b32 v4, 16, v95
    v_and_b32 v5, 0xffff0000, v95
    v_add_f32 v142, v142, v4
    v_add_f32 v143, v143, v5
    v_fma_f32 v146, v4, v4, v146
    v_fma_f32 v147, v5, v5, v147
    v_lshlrev_b32 v6, 16, v108
    v_and_b32 v7, 0xffff0000, v108
    v_add_f32 v148, v148, v6
    v_add_f32 v150, v150, v7
    v_mfma_f32_32x32x16_bf16 v[60:75], v[108:111], v[96:99], v[60:75]
    v_lshlrev_b32 v6, 16, v112
    v_and_b32 v7, 0xffff0000, v112
    v_add_f32 v152, v152, v6
    v_add_f32 v154, v154, v7
    v_lshlrev_b32 v6, 16, v109
    v_and_b32 v7, 0xffff0000, v109
    v_add_f32 v149, v149, v6
    v_add_f32 v151, v151, v7
    v_lshlrev_b32 v6, 16, v113
    v_and_b32 v7, 0xffff0000, v113
    v_add_f32 v153, v153, v6
    v_add_f32 v155, v155, v7
    v_lshlrev_b32 v6, 16, v110
    v_and_b32 v7, 0xffff0000, v110
    v_mfma_f32_32x32x16_bf16 v[76:91], v[112:115], v[96:99], v[76:91]
    v_add_f32 v148, v148, v6
    v_add_f32 v150, v150, v7
    v_lshlrev_b32 v6, 16, v114
    v_and_b32 v7, 0xffff0000, v114
    v_add_f32 v152, v152, v6
    v_add_f32 v154, v154, v7
    v_lshlrev_b32 v6, 16, v111
    v_and_b32 v7, 0xffff0000, v111
    v_add_f32 v149, v149, v6
    v_add_f32 v151, v151, v7
    v_lshlrev_b32 v6, 16, v115
    v_and_b32 v7, 0xffff0000, v115
    v_add_f32 v153, v153, v6
    v_add_f32 v155, v155, v7
    ds_read_b128 v[92:95], v14
    ds_read_b128 v[96:99], v15
    ds_read_b64_tr_b16 v[108:109], v20 offset:0
    ds_read_b64_tr_b16 v[110:111], v20 offset:1024
    ds_read_b64_tr_b16 v[112:113], v24 offset:0
    ds_read_b64_tr_b16 v[114:115], v24 offset:1024
    s_waitcnt lgkmcnt(6)
    v_mfma_f32_32x32x16_bf16 v[28:43], v[116:119], v[100:103], v[28:43]
    s_mov_b32 m0, 147456
    s_mul_i32 s4, s95, 2048
    s_add_u32 s4, s4, 1024
    buffer_load_dwordx4 v156, s[28:31], s4 offen lds
    v_lshlrev_b32 v4, 16, v100
    v_and_b32 v5, 0xffff0000, v100
    v_add_f32 v140, v140, v4
    v_add_f32 v141, v141, v5
    v_fma_f32 v144, v4, v4, v144
    v_fma_f32 v145, v5, v5, v145
    v_mfma_f32_32x32x16_bf16 v[44:59], v[120:123], v[100:103], v[44:59]
    v_lshlrev_b32 v4, 16, v101
    v_and_b32 v5, 0xffff0000, v101
    v_add_f32 v142, v142, v4
    v_add_f32 v143, v143, v5
    v_fma_f32 v146, v4, v4, v146
    v_fma_f32 v147, v5, v5, v147
    v_mfma_f32_32x32x16_bf16 v[60:75], v[116:119], v[104:107], v[60:75]
    v_lshlrev_b32 v4, 16, v102
    v_and_b32 v5, 0xffff0000, v102
    v_add_f32 v140, v140, v4
    v_add_f32 v141, v141, v5
    v_fma_f32 v144, v4, v4, v144
    v_fma_f32 v145, v5, v5, v145
    v_mfma_f32_32x32x16_bf16 v[76:91], v[120:123], v[104:107], v[76:91]
    v_lshlrev_b32 v4, 16, v103
    v_and_b32 v5, 0xffff0000, v103
    v_add_f32 v142, v142, v4
    v_add_f32 v143, v143, v5
    v_fma_f32 v146, v4, v4, v146
    v_fma_f32 v147, v5, v5, v147
    ds_read_b128 v[100:103], v16
    ds_read_b128 v[104:107], v17
    ds_read_b64_tr_b16 v[116:117], v21 offset:0
    ds_read_b64_tr_b16 v[118:119], v21 offset:1024
    ds_read_b64_tr_b16 v[120:121], v25 offset:0
    ds_read_b64_tr_b16 v[122:123], v25 offset:1024
    s_waitcnt lgkmcnt(6)
    v_mfma_f32_32x32x16_bf16 v[28:43], v[108:111], v[92:95], v[28:43]
    v_lshlrev_b32 v4, 16, v92
    v_and_b32 v5, 0xffff0000, v92
    v_add_f32 v140, v140, v4
    v_add_f32 v141, v141, v5
    v_fma_f32 v144, v4, v4, v144
    v_fma_f32 v145, v5, v5, v145
    v_lshlrev_b32 v4, 16, v93
    v_and_b32 v5, 0xffff0000, v93
    v_add_f32 v142, v142, v4
    v_add_f32 v143, v143, v5
    v_mfma_f32_32x32x16_bf16 v[44:59], v[112:115], v[92:95], v[44:59]
    v_fma_f32 v146, v4, v4, v146
    v_fma_f32 v147, v5, v5, v147
    v_lshlrev_b32 v4, 16, v94
    v_and_b32 v5, 0xffff0000, v94
    v_add_f32 v140, v140, v4
    v_add_f32 v141, v141, v5
    v_fma_f32 v144, v4, v4, v144
    v_fma_f32 v145, v5, v5, v145
    v_lshlrev_b32 v4, 16, v95
    v_and_b32 v5, 0xffff0000, v95
    v_mfma_f32_32x32x16_bf16 v[60:75], v[108:111], v[96:99], v[60:75]
    s_mov_b32 m0, 147456
    s_mul_i32 s4, s95, 2048
    s_add_u32 s4, s4, 0
    buffer_load_dwordx4 v156, s[40:43], s4 offen lds
    v_add_f32 v142, v142, v4
    v_add_f32 v143, v143, v5
    v_fma_f32 v146, v4, v4, v146
    v_fma_f32 v147, v5, v5, v147
    v_subrev_u32 v10, 98304, v10
    v_subrev_u32 v11, 98304, v11
    v_subrev_u32 v12, 98304, v12
    v_subrev_u32 v13, 98304, v13
    v_subrev_u32 v14, 98304, v14
    v_subrev_u32 v15, 98304, v15
    v_mfma_f32_32x32x16_bf16 v[76:91], v[112:115], v[96:99], v[76:91]
    v_subrev_u32 v16, 98304, v16
    v_subrev_u32 v17, 98304, v17
    v_subrev_u32 v18, 98304, v18
    v_subrev_u32 v19, 98304, v19
    v_subrev_u32 v20, 98304, v20
    v_subrev_u32 v21, 98304, v21
    v_subrev_u32 v22, 98304, v22
    v_subrev_u32 v23, 98304, v23
    v_subrev_u32 v24, 98304, v24
    v_subrev_u32 v25, 98304, v25
    s_waitcnt vmcnt(10) lgkmcnt(0)
    s_barrier
    ds_read_b128 v[92:95], v10
    ds_read_b128 v[96:99], v11
    ds_read_b64_tr_b16 v[108:109], v18 offset:0
    ds_read_b64_tr_b16 v[110:111], v18 offset:1024
    ds_read_b64_tr_b16 v[112:113], v22 offset:0
    ds_read_b64_tr_b16 v[114:115], v22 offset:1024
    v_mfma_f32_32x32x16_bf16 v[28:43], v[116:119], v[100:103], v[28:43]
    s_add_u32 m0, s7, 98304
    s_mov_b32 s4, 640
    buffer_load_dwordx4 v8, s[12:15], s4 offen lds
    v_lshlrev_b32 v4, 16, v100
    v_and_b32 v5, 0xffff0000, v100
    v_add_f32 v140, v140, v4
    v_add_f32 v141, v141, v5
    v_fma_f32 v144, v4, v4, v144
    v_fma_f32 v145, v5, v5, v145
    v_mfma_f32_32x32x16_bf16 v[44:59], v[120:123], v[100:103], v[44:59]
    s_add_u32 m0, s7, 106496
    s_mov_b32 s4, 66176
    buffer_load_dwordx4 v8, s[12:15], s4 offen lds
    v_lshlrev_b32 v4, 16, v101
    v_and_b32 v5, 0xffff0000, v101
    v_add_f32 v142, v142, v4
    v_add_f32 v143, v143, v5
    v_fma_f32 v146, v4, v4, v146
    v_fma_f32 v147, v5, v5, v147
    v_mfma_f32_32x32x16_bf16 v[60:75], v[116:119], v[104:107], v[60:75]
    s_add_u32 m0, s7, 114688
    s_mov_b32 s4, 131712
    buffer_load_dwordx4 v8, s[12:15], s4 offen lds
    v_lshlrev_b32 v4, 16, v102
    v_and_b32 v5, 0xffff0000, v102
    v_add_f32 v140, v140, v4
    v_add_f32 v141, v141, v5
    v_fma_f32 v144, v4, v4, v144
    v_fma_f32 v145, v5, v5, v145
    v_mfma_f32_32x32x16_bf16 v[76:91], v[120:123], v[104:107], v[76:91]
    s_add_u32 m0, s7, 122880
    s_mov_b32 s4, 197248
    buffer_load_dwordx4 v8, s[12:15], s4 offen lds
    v_lshlrev_b32 v4, 16, v103
    v_and_b32 v5, 0xffff0000, v103
    v_add_f32 v142, v142, v4
    v_add_f32 v143, v143, v5
    v_fma_f32 v146, v4, v4, v146
    v_fma_f32 v147, v5, v5, v147
    ds_read_b128 v[100:103], v12
    ds_read_b128 v[104:107], v13
    ds_read_b64_tr_b16 v[116:117], v19 offset:0
    ds_read_b64_tr_b16 v[118:119], v19 offset:1024
    ds_read_b64_tr_b16 v[120:121], v23 offset:0
    ds_read_b64_tr_b16 v[122:123], v23 offset:1024
    s_waitcnt lgkmcnt(6)
    v_mfma_f32_32x32x16_bf16 v[28:43], v[108:111], v[92:95], v[28:43]
    s_add_u32 m0, s7, 131072
    s_mov_b32 s4, 2621440
    buffer_load_dwordx4 v9, s[16:19], s4 offen lds
    v_lshlrev_b32 v4, 16, v92
    v_and_b32 v5, 0xffff0000, v92
    v_add_f32 v140, v140, v4
    v_add_f32 v141, v141, v5
    v_fma_f32 v144, v4, v4, v144
    v_fma_f32 v145, v5, v5, v145
    v_lshlrev_b32 v4, 16, v93
    v_and_b32 v5, 0xffff0000, v93
    v_add_f32 v142, v142, v4
    v_add_f32 v143, v143, v5
    v_fma_f32 v146, v4, v4, v146
    v_fma_f32 v147, v5, v5, v147
    v_lshlrev_b32 v4, 16, v94
    v_and_b32 v5, 0xffff0000, v94
    v_mfma_f32_32x32x16_bf16 v[44:59], v[112:115], v[92:95], v[44:59]
    s_add_u32 m0, s7, 139264
    s_mov_b32 s4, 2883584
    buffer_load_dwordx4 v9, s[16:19], s4 offen lds
    v_add_f32 v140, v140, v4
    v_add_f32 v141, v141, v5
    v_fma_f32 v144, v4, v4, v144
    v_fma_f32 v145, v5, v5, v145
    v_lshlrev_b32 v4, 16, v95
    v_and_b32 v5, 0xffff0000, v95
    v_add_f32 v142, v142, v4
    v_add_f32 v143, v143, v5
    v_fma_f32 v146, v4, v4, v146
    v_fma_f32 v147, v5, v5, v147
    v_lshlrev_b32 v6, 16, v108
    v_and_b32 v7, 0xffff0000, v108
    v_add_f32 v148, v148, v6
    v_add_f32 v150, v150, v7
    v_mfma_f32_32x32x16_bf16 v[60:75], v[108:111], v[96:99], v[60:75]
    v_lshlrev_b32 v6, 16, v112
    v_and_b32 v7, 0xffff0000, v112
    v_add_f32 v152, v152, v6
    v_add_f32 v154, v154, v7
    v_lshlrev_b32 v6, 16, v109
    v_and_b32 v7, 0xffff0000, v109
    v_add_f32 v149, v149, v6
    v_add_f32 v151, v151, v7
    v_lshlrev_b32 v6, 16, v113
    v_and_b32 v7, 0xffff0000, v113
    v_add_f32 v153, v153, v6
    v_add_f32 v155, v155, v7
    v_lshlrev_b32 v6, 16, v110
    v_and_b32 v7, 0xffff0000, v110
    v_mfma_f32_32x32x16_bf16 v[76:91], v[112:115], v[96:99], v[76:91]
    v_add_f32 v148, v148, v6
    v_add_f32 v150, v150, v7
    v_lshlrev_b32 v6, 16, v114
    v_and_b32 v7, 0xffff0000, v114
    v_add_f32 v152, v152, v6
    v_add_f32 v154, v154, v7
    v_lshlrev_b32 v6, 16, v111
    v_and_b32 v7, 0xffff0000, v111
    v_add_f32 v149, v149, v6
    v_add_f32 v151, v151, v7
    v_lshlrev_b32 v6, 16, v115
    v_and_b32 v7, 0xffff0000, v115
    v_add_f32 v153, v153, v6
    v_add_f32 v155, v155, v7
    ds_read_b128 v[92:95], v14
    ds_read_b128 v[96:99], v15
    ds_read_b64_tr_b16 v[108:109], v20 offset:0
    ds_read_b64_tr_b16 v[110:111], v20 offset:1024
    ds_read_b64_tr_b16 v[112:113], v24 offset:0
    ds_read_b64_tr_b16 v[114:115], v24 offset:1024
    s_waitcnt lgkmcnt(6)
    v_mfma_f32_32x32x16_bf16 v[28:43], v[116:119], v[100:103], v[28:43]
    v_lshlrev_b32 v4, 16, v100
    v_and_b32 v5, 0xffff0000, v100
    v_add_f32 v140, v140, v4
    v_add_f32 v141, v141, v5
    v_fma_f32 v144, v4, v4, v144
    v_fma_f32 v145, v5, v5, v145
    v_mfma_f32_32x32x16_bf16 v[44:59], v[120:123], v[100:103], v[44:59]
    v_lshlrev_b32 v4, 16, v101
    v_and_b32 v5, 0xffff0000, v101
    v_add_f32 v142, v142, v4
    v_add_f32 v143, v143, v5
    v_fma_f32 v146, v4, v4, v146
    v_fma_f32 v147, v5, v5, v147
    v_mfma_f32_32x32x16_bf16 v[60:75], v[116:119], v[104:107], v[60:75]
    s_mov_b32 m0, 147456
    s_mul_i32 s4, s95, 2048
    s_add_u32 s4, s4, 1024
    buffer_load_dwordx4 v156, s[40:43], s4 offen lds
    v_lshlrev_b32 v4, 16, v102
    v_and_b32 v5, 0xffff0000, v102
    v_add_f32 v140, v140, v4
    v_add_f32 v141, v141, v5
    v_fma_f32 v144, v4, v4, v144
    v_fma_f32 v145, v5, v5, v145
    v_mfma_f32_32x32x16_bf16 v[76:91], v[120:123], v[104:107], v[76:91]
    v_lshlrev_b32 v4, 16, v103
    v_and_b32 v5, 0xffff0000, v103
    v_add_f32 v142, v142, v4
    v_add_f32 v143, v143, v5
    v_fma_f32 v146, v4, v4, v146
    v_fma_f32 v147, v5, v5, v147
    ds_read_b128 v[100:103], v16
    ds_read_b128 v[104:107], v17
    ds_read_b64_tr_b16 v[116:117], v21 offset:0
    ds_read_b64_tr_b16 v[118:119], v21 offset:1024
    ds_read_b64_tr_b16 v[120:121], v25 offset:0
    ds_read_b64_tr_b16 v[122:123], v25 offset:1024
    s_waitcnt lgkmcnt(6)
    v_mfma_f32_32x32x16_bf16 v[28:43], v[108:111], v[92:95], v[28:43]
    v_lshlrev_b32 v4, 16, v92
    v_and_b32 v5, 0xffff0000, v92
    v_add_f32 v140, v140, v4
    v_add_f32 v141, v141, v5
    v_fma_f32 v144, v4, v4, v144
    v_fma_f32 v145, v5, v5, v145
    v_lshlrev_b32 v4, 16, v93
    v_and_b32 v5, 0xffff0000, v93
    v_add_f32 v142, v142, v4
    v_add_f32 v143, v143, v5
    v_mfma_f32_32x32x16_bf16 v[44:59], v[112:115], v[92:95], v[44:59]
    v_fma_f32 v146, v4, v4, v146
    v_fma_f32 v147, v5, v5, v147
    v_lshlrev_b32 v4, 16, v94
    v_and_b32 v5, 0xffff0000, v94
    v_add_f32 v140, v140, v4
    v_add_f32 v141, v141, v5
    v_fma_f32 v144, v4, v4, v144
    v_fma_f32 v145, v5, v5, v145
    v_lshlrev_b32 v4, 16, v95
    v_and_b32 v5, 0xffff0000, v95
    v_mfma_f32_32x32x16_bf16 v[60:75], v[108:111], v[96:99], v[60:75]
    v_add_f32 v142, v142, v4
    v_add_f32 v143, v143, v5
    v_fma_f32 v146, v4, v4, v146
    v_fma_f32 v147, v5, v5, v147
    v_add_u32 v10, 49152, v10
    v_add_u32 v11, 49152, v11
    v_add_u32 v12, 49152, v12
    v_add_u32 v13, 49152, v13
    v_add_u32 v14, 49152, v14
    v_add_u32 v15, 49152, v15
    v_mfma_f32_32x32x16_bf16 v[76:91], v[112:115], v[96:99], v[76:91]
    v_add_u32 v16, 49152, v16
    v_add_u32 v17, 49152, v17
    v_add_u32 v18, 49152, v18
    v_add_u32 v19, 49152, v19
    v_add_u32 v20, 49152, v20
    v_add_u32 v21, 49152, v21
    v_add_u32 v22, 49152, v22
    v_add_u32 v23, 49152, v23
    v_add_u32 v24, 49152, v24
    v_add_u32 v25, 49152, v25
    s_waitcnt vmcnt(9) lgkmcnt(0)
    s_barrier
    ds_read_b128 v[92:95], v10
    ds_read_b128 v[96:99], v11
    ds_read_b64_tr_b16 v[108:109], v18 offset:0
    ds_read_b64_tr_b16 v[110:111], v18 offset:1024
    ds_read_b64_tr_b16 v[112:113], v22 offset:0
    ds_read_b64_tr_b16 v[114:115], v22 offset:1024
    v_mfma_f32_32x32x16_bf16 v[28:43], v[116:119], v[100:103], v[28:43]
    s_add_u32 m0, s7, 0
    s_mov_b32 s4, 768
    buffer_load_dwordx4 v8, s[12:15], s4 offen lds
    v_lshlrev_b32 v4, 16, v100
    v_and_b32 v5, 0xffff0000, v100
    v_add_f32 v140, v140, v4
    v_add_f32 v141, v141, v5
    v_fma_f32 v144, v4, v4, v144
    v_fma_f32 v145, v5, v5, v145
    v_mfma_f32_32x32x16_bf16 v[44:59], v[120:123], v[100:103], v[44:59]
    s_add_u32 m0, s7, 8192
    s_mov_b32 s4, 66304
    buffer_load_dwordx4 v8, s[12:15], s4 offen lds
    v_lshlrev_b32 v4, 16, v101
    v_and_b32 v5, 0xffff0000, v101
    v_add_f32 v142, v142, v4
    v_add_f32 v143, v143, v5
    v_fma_f32 v146, v4, v4, v146
    v_fma_f32 v147, v5, v5, v147
    v_mfma_f32_32x32x16_bf16 v[60:75], v[116:119], v[104:107], v[60:75]
    s_add_u32 m0, s7, 16384
    s_mov_b32 s4, 131840
    buffer_load_dwordx4 v8, s[12:15], s4 offen lds
    v_lshlrev_b32 v4, 16, v102
    v_and_b32 v5, 0xffff0000, v102
    v_add_f32 v140, v140, v4
    v_add_f32 v141, v141, v5
    v_fma_f32 v144, v4, v4, v144
    v_fma_f32 v145, v5, v5, v145
    v_mfma_f32_32x32x16_bf16 v[76:91], v[120:123], v[104:107], v[76:91]
    s_add_u32 m0, s7, 24576
    s_mov_b32 s4, 197376
    buffer_load_dwordx4 v8, s[12:15], s4 offen lds
    v_lshlrev_b32 v4, 16, v103
    v_and_b32 v5, 0xffff0000, v103
    v_add_f32 v142, v142, v4
    v_add_f32 v143, v143, v5
    v_fma_f32 v146, v4, v4, v146
    v_fma_f32 v147, v5, v5, v147
    ds_read_b128 v[100:103], v12
    ds_read_b128 v[104:107], v13
    ds_read_b64_tr_b16 v[116:117], v19 offset:0
    ds_read_b64_tr_b16 v[118:119], v19 offset:1024
    ds_read_b64_tr_b16 v[120:121], v23 offset:0
    ds_read_b64_tr_b16 v[122:123], v23 offset:1024
    s_waitcnt lgkmcnt(6)
    v_mfma_f32_32x32x16_bf16 v[28:43], v[108:111], v[92:95], v[28:43]
    s_add_u32 m0, s7, 32768
    s_mov_b32 s4, 3145728
    buffer_load_dwordx4 v9, s[16:19], s4 offen lds
    v_lshlrev_b32 v4, 16, v92
    v_and_b32 v5, 0xffff0000, v92
    v_add_f32 v140, v140, v4
    v_add_f32 v141, v141, v5
    v_fma_f32 v144, v4, v4, v144
    v_fma_f32 v145, v5, v5, v145
    v_lshlrev_b32 v4, 16, v93
    v_and_b32 v5, 0xffff0000, v93
    v_add_f32 v142, v142, v4
    v_add_f32 v143, v143, v5
    v_fma_f32 v146, v4, v4, v146
    v_fma_f32 v147, v5, v5, v147
    v_lshlrev_b32 v4, 16, v94
    v_and_b32 v5, 0xffff0000, v94
    v_mfma_f32_32x32x16_bf16 v[44:59], v[112:115], v[92:95], v[44:59]
    s_add_u32 m0, s7, 40960
    s_mov_b32 s4, 3407872
    buffer_load_dwordx4 v9, s[16:19], s4 offen lds
    v_add_f32 v140, v140, v4
    v_add_f32 v141, v141, v5
    v_fma_f32 v144, v4, v4, v144
    v_fma_f32 v145, v5, v5, v145
    v_lshlrev_b32 v4, 16, v95
    v_and_b32 v5, 0xffff0000, v95
    v_add_f32 v142, v142, v4
    v_add_f32 v143, v143, v5
    v_fma_f32 v146, v4, v4, v146
    v_fma_f32 v147, v5, v5, v147
    v_lshlrev_b32 v6, 16, v108
    v_and_b32 v7, 0xffff0000, v108
    v_add_f32 v148, v148, v6
    v_add_f32 v150, v150, v7
    v_mfma_f32_32x32x16_bf16 v[60:75], v[108:111], v[96:99], v[60:75]
    v_lshlrev_b32 v6, 16, v112
    v_and_b32 v7, 0xffff0000, v112
    v_add_f32 v152, v152, v6
    v_add_f32 v154, v154, v7
    v_lshlrev_b32 v6, 16, v109
    v_and_b32 v7, 0xffff0000, v109
    v_add_f32 v149, v149, v6
    v_add_f32 v151, v151, v7
    v_lshlrev_b32 v6, 16, v113
    v_and_b32 v7, 0xffff0000, v113
    v_add_f32 v153, v153, v6
    v_add_f32 v155, v155, v7
    v_lshlrev_b32 v6, 16, v110
    v_and_b32 v7, 0xffff0000, v110
    v_mfma_f32_32x32x16_bf16 v[76:91], v[112:115], v[96:99], v[76:91]
    v_add_f32 v148, v148, v6
    v_add_f32 v150, v150, v7
    v_lshlrev_b32 v6, 16, v114
    v_and_b32 v7, 0xffff0000, v114
    v_add_f32 v152, v152, v6
    v_add_f32 v154, v154, v7
    v_lshlrev_b32 v6, 16, v111
    v_and_b32 v7, 0xffff0000, v111
    v_add_f32 v149, v149, v6
    v_add_f32 v151, v151, v7
    v_lshlrev_b32 v6, 16, v115
    v_and_b32 v7, 0xffff0000, v115
    v_add_f32 v153, v153, v6
    v_add_f32 v155, v155, v7
    ds_read_b128 v[92:95], v14
    ds_read_b128 v[96:99], v15
    ds_read_b64_tr_b16 v[108:109], v20 offset:0
    ds_read_b64_tr_b16 v[110:111], v20 offset:1024
    ds_read_b64_tr_b16 v[112:113], v24 offset:0
    ds_read_b64_tr_b16 v[114:115], v24 offset:1024
    s_waitcnt lgkmcnt(6)
    v_mfma_f32_32x32x16_bf16 v[28:43], v[116:119], v[100:103], v[28:43]
    v_lshlrev_b32 v4, 16, v100
    v_and_b32 v5, 0xffff0000, v100
    v_add_f32 v140, v140, v4
    v_add_f32 v141, v141, v5
    v_fma_f32 v144, v4, v4, v144
    v_fma_f32 v145, v5, v5, v145
    v_mfma_f32_32x32x16_bf16 v[44:59], v[120:123], v[100:103], v[44:59]
    v_lshlrev_b32 v4, 16, v101
    v_and_b32 v5, 0xffff0000, v101
    v_add_f32 v142, v142, v4
    v_add_f32 v143, v143, v5
    v_fma_f32 v146, v4, v4, v146
    v_fma_f32 v147, v5, v5, v147
    v_mfma_f32_32x32x16_bf16 v[60:75], v[116:119], v[104:107], v[60:75]
    v_lshlrev_b32 v4, 16, v102
    v_and_b32 v5, 0xffff0000, v102
    v_add_f32 v140, v140, v4
    v_add_f32 v141, v141, v5
    v_fma_f32 v144, v4, v4, v144
    v_fma_f32 v145, v5, v5, v145
    v_mfma_f32_32x32x16_bf16 v[76:91], v[120:123], v[104:107], v[76:91]
    v_lshlrev_b32 v4, 16, v103
    v_and_b32 v5, 0xffff0000, v103
    v_add_f32 v142, v142, v4
    v_add_f32 v143, v143, v5
    v_fma_f32 v146, v4, v4, v146
    v_fma_f32 v147, v5, v5, v147
    ds_read_b128 v[100:103], v16
    ds_read_b128 v[104:107], v17
    ds_read_b64_tr_b16 v[116:117], v21 offset:0
    ds_read_b64_tr_b16 v[118:119], v21 offset:1024
    ds_read_b64_tr_b16 v[120:121], v25 offset:0
    ds_read_b64_tr_b16 v[122:123], v25 offset:1024
    s_waitcnt lgkmcnt(6)
    v_mfma_f32_32x32x16_bf16 v[28:43], v[108:111], v[92:95], v[28:43]
    v_lshlrev_b32 v4, 16, v92
    v_and_b32 v5, 0xffff0000, v92
    v_add_f32 v140, v140, v4
    v_add_f32 v141, v141, v5
    v_fma_f32 v144, v4, v4, v144
    v_fma_f32 v145, v5, v5, v145
    v_lshlrev_b32 v4, 16, v93
    v_and_b32 v5, 0xffff0000, v93
    v_add_f32 v142, v142, v4
    v_add_f32 v143, v143, v5
    v_mfma_f32_32x32x16_bf16 v[44:59], v[112:115], v[92:95], v[44:59]
    v_fma_f32 v146, v4, v4, v146
    v_fma_f32 v147, v5, v5, v147
    v_lshlrev_b32 v4, 16, v94
    v_and_b32 v5, 0xffff0000, v94
    v_add_f32 v140, v140, v4
    v_add_f32 v141, v141, v5
    v_fma_f32 v144, v4, v4, v144
    v_fma_f32 v145, v5, v5, v145
    v_lshlrev_b32 v4, 16, v95
    v_and_b32 v5, 0xffff0000, v95
    v_mfma_f32_32x32x16_bf16 v[60:75], v[108:111], v[96:99], v[60:75]
    v_add_f32 v142, v142, v4
    v_add_f32 v143, v143, v5
    v_fma_f32 v146, v4, v4, v146
    v_fma_f32 v147, v5, v5, v147
    v_add_u32 v10, 49152, v10
    v_add_u32 v11, 49152, v11
    v_add_u32 v12, 49152, v12
    v_add_u32 v13, 49152, v13
    v_add_u32 v14, 49152, v14
    v_add_u32 v15, 49152, v15
    v_mfma_f32_32x32x16_bf16 v[76:91], v[112:115], v[96:99], v[76:91]
    v_add_u32 v16, 49152, v16
    v_add_u32 v17, 49152, v17
    v_add_u32 v18, 49152, v18
    v_add_u32 v19, 49152, v19
    v_add_u32 v20, 49152, v20
    v_add_u32 v21, 49152, v21
    v_add_u32 v22, 49152, v22
    v_add_u32 v23, 49152, v23
    v_add_u32 v24, 49152, v24
    v_add_u32 v25, 49152, v25
    s_waitcnt vmcnt(7) lgkmcnt(0)
    s_barrier
    ds_read_b128 v[92:95], v10
    ds_read_b128 v[96:99], v11
    ds_read_b64_tr_b16 v[108:109], v18 offset:0
    ds_read_b64_tr_b16 v[110:111], v18 offset:1024
    ds_read_b64_tr_b16 v[112:113], v22 offset:0
    ds_read_b64_tr_b16 v[114:115], v22 offset:1024
    v_mfma_f32_32x32x16_bf16 v[28:43], v[116:119], v[100:103], v[28:43]
    s_add_u32 m0, s7, 49152
    s_mov_b32 s4, 896
    buffer_load_dwordx4 v8, s[12:15], s4 offen lds
    v_lshlrev_b32 v4, 16, v100
    v_and_b32 v5, 0xffff0000, v100
    v_add_f32 v140, v140, v4
    v_add_f32 v141, v141, v5
    v_fma_f32 v144, v4, v4, v144
    v_fma_f32 v145, v5, v5, v145
    v_mfma_f32_32x32x16_bf16 v[44:59], v[120:123], v[100:103], v[44:59]
    s_add_u32 m0, s7, 57344
    s_mov_b32 s4, 66432
    buffer_load_dwordx4 v8, s[12:15], s4 offen lds
    v_lshlrev_b32 v4, 16, v101
    v_and_b32 v5, 0xffff0000, v101
    v_add_f32 v142, v142, v4
    v_add_f32 v143, v143, v5
    v_fma_f32 v146, v4, v4, v146
    v_fma_f32 v147, v5, v5, v147
    v_mfma_f32_32x32x16_bf16 v[60:75], v[116:119], v[104:107], v[60:75]
    s_add_u32 m0, s7, 65536
    s_mov_b32 s4, 131968
    buffer_load_dwordx4 v8, s[12:15], s4 offen lds
    v_lshlrev_b32 v4, 16, v102
    v_and_b32 v5, 0xffff0000, v102
    v_add_f32 v140, v140, v4
    v_add_f32 v141, v141, v5
    v_fma_f32 v144, v4, v4, v144
    v_fma_f32 v145, v5, v5, v145
    v_mfma_f32_32x32x16_bf16 v[76:91], v[120:123], v[104:107], v[76:91]
    s_add_u32 m0, s7, 73728
    s_mov_b32 s4, 197504
    buffer_load_dwordx4 v8, s[12:15], s4 offen lds
    v_lshlrev_b32 v4, 16, v103
    v_and_b32 v5, 0xffff0000, v103
    v_add_f32 v142, v142, v4
    v_add_f32 v143, v143, v5
    v_fma_f32 v146, v4, v4, v146
    v_fma_f32 v147, v5, v5, v147
    ds_read_b128 v[100:103], v12
    ds_read_b128 v[104:107], v13
    ds_read_b64_tr_b16 v[116:117], v19 offset:0
    ds_read_b64_tr_b16 v[118:119], v19 offset:1024
    ds_read_b64_tr_b16 v[120:121], v23 offset:0
    ds_read_b64_tr_b16 v[122:123], v23 offset:1024
    s_waitcnt lgkmcnt(6)
    v_mfma_f32_32x32x16_bf16 v[28:43], v[108:111], v[92:95], v[28:43]
    s_add_u32 m0, s7, 81920
    s_mov_b32 s4, 3670016
    buffer_load_dwordx4 v9, s[16:19], s4 offen lds
    v_lshlrev_b32 v4, 16, v92
    v_and_b32 v5, 0xffff0000, v92
    v_add_f32 v140, v140, v4
    v_add_f32 v141, v141, v5
    v_fma_f32 v144, v4, v4, v144
    v_fma_f32 v145, v5, v5, v145
    v_lshlrev_b32 v4, 16, v93
    v_and_b32 v5, 0xffff0000, v93
    v_add_f32 v142, v142, v4
    v_add_f32 v143, v143, v5
    v_fma_f32 v146, v4, v4, v146
    v_fma_f32 v147, v5, v5, v147
    v_lshlrev_b32 v4, 16, v94
    v_and_b32 v5, 0xffff0000, v94
    v_mfma_f32_32x32x16_bf16 v[44:59], v[112:115], v[92:95], v[44:59]
    s_add_u32 m0, s7, 90112
    s_mov_b32 s4, 3932160
    buffer_load_dwordx4 v9, s[16:19], s4 offen lds
    v_add_f32 v140, v140, v4
    v_add_f32 v141, v141, v5
    v_fma_f32 v144, v4, v4, v144
    v_fma_f32 v145, v5, v5, v145
    v_lshlrev_b32 v4, 16, v95
    v_and_b32 v5, 0xffff0000, v95
    v_add_f32 v142, v142, v4
    v_add_f32 v143, v143, v5
    v_fma_f32 v146, v4, v4, v146
    v_fma_f32 v147, v5, v5, v147
    v_lshlrev_b32 v6, 16, v108
    v_and_b32 v7, 0xffff0000, v108
    v_add_f32 v148, v148, v6
    v_add_f32 v150, v150, v7
    v_mfma_f32_32x32x16_bf16 v[60:75], v[108:111], v[96:99], v[60:75]
    v_lshlrev_b32 v6, 16, v112
    v_and_b32 v7, 0xffff0000, v112
    v_add_f32 v152, v152, v6
    v_add_f32 v154, v154, v7
    v_lshlrev_b32 v6, 16, v109
    v_and_b32 v7, 0xffff0000, v109
    v_add_f32 v149, v149, v6
    v_add_f32 v151, v151, v7
    v_lshlrev_b32 v6, 16, v113
    v_and_b32 v7, 0xffff0000, v113
    v_add_f32 v153, v153, v6
    v_add_f32 v155, v155, v7
    v_lshlrev_b32 v6, 16, v110
    v_and_b32 v7, 0xffff0000, v110
    v_mfma_f32_32x32x16_bf16 v[76:91], v[112:115], v[96:99], v[76:91]
    v_add_f32 v148, v148, v6
    v_add_f32 v150, v150, v7
    v_lshlrev_b32 v6, 16, v114
    v_and_b32 v7, 0xffff0000, v114
    v_add_f32 v152, v152, v6
    v_add_f32 v154, v154, v7
    v_lshlrev_b32 v6, 16, v111
    v_and_b32 v7, 0xffff0000, v111
    v_add_f32 v149, v149, v6
    v_add_f32 v151, v151, v7
    v_lshlrev_b32 v6, 16, v115
    v_and_b32 v7, 0xffff0000, v115
    v_add_f32 v153, v153, v6
    v_add_f32 v155, v155, v7
    ds_read_b128 v[92:95], v14
    ds_read_b128 v[96:99], v15
    ds_read_b64_tr_b16 v[108:109], v20 offset:0
    ds_read_b64_tr_b16 v[110:111], v20 offset:1024
    ds_read_b64_tr_b16 v[112:113], v24 offset:0
    ds_read_b64_tr_b16 v[114:115], v24 offset:1024
    s_waitcnt lgkmcnt(6)
    v_mfma_f32_32x32x16_bf16 v[28:43], v[116:119], v[100:103], v[28:43]
    v_lshlrev_b32 v4, 16, v100
    v_and_b32 v5, 0xffff0000, v100
    v_add_f32 v140, v140, v4
    v_add_f32 v141, v141, v5
    v_fma_f32 v144, v4, v4, v144
    v_fma_f32 v145, v5, v5, v145
    v_mfma_f32_32x32x16_bf16 v[44:59], v[120:123], v[100:103], v[44:59]
    v_lshlrev_b32 v4, 16, v101
    v_and_b32 v5, 0xffff0000, v101
    v_add_f32 v142, v142, v4
    v_add_f32 v143, v143, v5
    v_fma_f32 v146, v4, v4, v146
    v_fma_f32 v147, v5, v5, v147
    v_mfma_f32_32x32x16_bf16 v[60:75], v[116:119], v[104:107], v[60:75]
    v_lshlrev_b32 v4, 16, v102
    v_and_b32 v5, 0xffff0000, v102
    v_add_f32 v140, v140, v4
    v_add_f32 v141, v141, v5
    v_fma_f32 v144, v4, v4, v144
    v_fma_f32 v145, v5, v5, v145
    v_mfma_f32_32x32x16_bf16 v[76:91], v[120:123], v[104:107], v[76:91]
    v_lshlrev_b32 v4, 16, v103
    v_and_b32 v5, 0xffff0000, v103
    v_add_f32 v142, v142, v4
    v_add_f32 v143, v143, v5
    v_fma_f32 v146, v4, v4, v146
    v_fma_f32 v147, v5, v5, v147
    ds_read_b128 v[100:103], v16
    ds_read_b128 v[104:107], v17
    ds_read_b64_tr_b16 v[116:117], v21 offset:0
    ds_read_b64_tr_b16 v[118:119], v21 offset:1024
    ds_read_b64_tr_b16 v[120:121], v25 offset:0
    ds_read_b64_tr_b16 v[122:123], v25 offset:1024
    s_waitcnt lgkmcnt(6)
    v_mfma_f32_32x32x16_bf16 v[28:43], v[108:111], v[92:95], v[28:43]
    v_lshlrev_b32 v4, 16, v92
    v_and_b32 v5, 0xffff0000, v92
    v_add_f32 v140, v140, v4
    v_add_f32 v141, v141, v5
    v_fma_f32 v144, v4, v4, v144
    v_fma_f32 v145, v5, v5, v145
    v_lshlrev_b32 v4, 16, v93
    v_and_b32 v5, 0xffff0000, v93
    v_add_f32 v142, v142, v4
    v_add_f32 v143, v143, v5
    v_mfma_f32_32x32x16_bf16 v[44:59], v[112:115], v[92:95], v[44:59]
    v_fma_f32 v146, v4, v4, v146
    v_fma_f32 v147, v5, v5, v147
    v_lshlrev_b32 v4, 16, v94
    v_and_b32 v5, 0xffff0000, v94
    v_add_f32 v140, v140, v4
    v_add_f32 v141, v141, v5
    v_fma_f32 v144, v4, v4, v144
    v_fma_f32 v145, v5, v5, v145
    v_lshlrev_b32 v4, 16, v95
    v_and_b32 v5, 0xffff0000, v95
    v_mfma_f32_32x32x16_bf16 v[60:75], v[108:111], v[96:99], v[60:75]
    v_add_f32 v142, v142, v4
    v_add_f32 v143, v143, v5
    v_fma_f32 v146, v4, v4, v146
    v_fma_f32 v147, v5, v5, v147
    v_subrev_u32 v10, 98304, v10
    v_subrev_u32 v11, 98304, v11
    v_subrev_u32 v12, 98304, v12
    v_subrev_u32 v13, 98304, v13
    v_subrev_u32 v14, 98304, v14
    v_subrev_u32 v15, 98304, v15
    v_mfma_f32_32x32x16_bf16 v[76:91], v[112:115], v[96:99], v[76:91]
    v_subrev_u32 v16, 98304, v16
    v_subrev_u32 v17, 98304, v17
    v_subrev_u32 v18, 98304, v18
    v_subrev_u32 v19, 98304, v19
    v_subrev_u32 v20, 98304, v20
    v_subrev_u32 v21, 98304, v21
    v_subrev_u32 v22, 98304, v22
    v_subrev_u32 v23, 98304, v23
    v_subrev_u32 v24, 98304, v24
    v_subrev_u32 v25, 98304, v25
    s_waitcnt vmcnt(6) lgkmcnt(0)
    s_barrier
    ds_read_b128 v[92:95], v10
    ds_read_b128 v[96:99], v11
    ds_read_b64_tr_b16 v[108:109], v18 offset:0
    ds_read_b64_tr_b16 v[110:111], v18 offset:1024
    ds_read_b64_tr_b16 v[112:113], v22 offset:0
    ds_read_b64_tr_b16 v[114:115], v22 offset:1024
    v_mfma_f32_32x32x16_bf16 v[28:43], v[116:119], v[100:103], v[28:43]
    s_add_u32 m0, s7, 98304
    s_mov_b32 s4, 0
    buffer_load_dwordx4 v8, s[24:27], s4 offen lds
    v_lshlrev_b32 v4, 16, v100
    v_and_b32 v5, 0xffff0000, v100
    v_add_f32 v140, v140, v4
    v_add_f32 v141, v141, v5
    v_fma_f32 v144, v4, v4, v144
    v_fma_f32 v145, v5, v5, v145
    v_mfma_f32_32x32x16_bf16 v[44:59], v[120:123], v[100:103], v[44:59]
    s_add_u32 m0, s7, 106496
    s_mov_b32 s4, 65536
    buffer_load_dwordx4 v8, s[24:27], s4 offen lds
    v_lshlrev_b32 v4, 16, v101
    v_and_b32 v5, 0xffff0000, v101
    v_add_f32 v142, v142, v4
    v_add_f32 v143, v143, v5
    v_fma_f32 v146, v4, v4, v146
    v_fma_f32 v147, v5, v5, v147
    v_mfma_f32_32x32x16_bf16 v[60:75], v[116:119], v[104:107], v[60:75]
    s_add_u32 m0, s7, 114688
    s_mov_b32 s4, 131072
    buffer_load_dwordx4 v8, s[24:27], s4 offen lds
    v_lshlrev_b32 v4, 16, v102
    v_and_b32 v5, 0xffff0000, v102
    v_add_f32 v140, v140, v4
    v_add_f32 v141, v141, v5
    v_fma_f32 v144, v4, v4, v144
    v_fma_f32 v145, v5, v5, v145
    v_mfma_f32_32x32x16_bf16 v[76:91], v[120:123], v[104:107], v[76:91]
    s_add_u32 m0, s7, 122880
    s_mov_b32 s4, 196608
    buffer_load_dwordx4 v8, s[24:27], s4 offen lds
    v_lshlrev_b32 v4, 16, v103
    v_and_b32 v5, 0xffff0000, v103
    v_add_f32 v142, v142, v4
    v_add_f32 v143, v143, v5
    v_fma_f32 v146, v4, v4, v146
    v_fma_f32 v147, v5, v5, v147
    ds_read_b128 v[100:103], v12
    ds_read_b128 v[104:107], v13
    ds_read_b64_tr_b16 v[116:117], v19 offset:0
    ds_read_b64_tr_b16 v[118:119], v19 offset:1024
    ds_read_b64_tr_b16 v[120:121], v23 offset:0
    ds_read_b64_tr_b16 v[122:123], v23 offset:1024
    s_waitcnt lgkmcnt(6)
    v_mfma_f32_32x32x16_bf16 v[28:43], v[108:111], v[92:95], v[28:43]
    s_add_u32 m0, s7, 131072
    s_mov_b32 s4, 0
    buffer_load_dwordx4 v9, s[28:31], s4 offen lds
    v_lshlrev_b32 v4, 16, v92
    v_and_b32 v5, 0xffff0000, v92
    v_add_f32 v140, v140, v4
    v_add_f32 v141, v141, v5
    v_fma_f32 v144, v4, v4, v144
    v_fma_f32 v145, v5, v5, v145
    v_lshlrev_b32 v4, 16, v93
    v_and_b32 v5, 0xffff0000, v93
    v_add_f32 v142, v142, v4
    v_add_f32 v143, v143, v5
    v_fma_f32 v146, v4, v4, v146
    v_fma_f32 v147, v5, v5, v147
    v_lshlrev_b32 v4, 16, v94
    v_and_b32 v5, 0xffff0000, v94
    v_mfma_f32_32x32x16_bf16 v[44:59], v[112:115], v[92:95], v[44:59]
    s_add_u32 m0, s7, 139264
    s_mov_b32 s4, 262144
    buffer_load_dwordx4 v9, s[28:31], s4 offen lds
    v_add_f32 v140, v140, v4
    v_add_f32 v141, v141, v5
    v_fma_f32 v144, v4, v4, v144
    v_fma_f32 v145, v5, v5, v145
    v_lshlrev_b32 v4, 16, v95
    v_and_b32 v5, 0xffff0000, v95
    v_add_f32 v142, v142, v4
    v_add_f32 v143, v143, v5
    v_fma_f32 v146, v4, v4, v146
    v_fma_f32 v147, v5, v5, v147
    v_lshlrev_b32 v6, 16, v108
    v_and_b32 v7, 0xffff0000, v108
    v_add_f32 v148, v148, v6
    v_add_f32 v150, v150, v7
    v_mfma_f32_32x32x16_bf16 v[60:75], v[108:111], v[96:99], v[60:75]
    v_lshlrev_b32 v6, 16, v112
    v_and_b32 v7, 0xffff0000, v112
    v_add_f32 v152, v152, v6
    v_add_f32 v154, v154, v7
    v_lshlrev_b32 v6, 16, v109
    v_and_b32 v7, 0xffff0000, v109
    v_add_f32 v149, v149, v6
    v_add_f32 v151, v151, v7
    v_lshlrev_b32 v6, 16, v113
    v_and_b32 v7, 0xffff0000, v113
    v_add_f32 v153, v153, v6
    v_add_f32 v155, v155, v7
    v_lshlrev_b32 v6, 16, v110
    v_and_b32 v7, 0xffff0000, v110
    v_mfma_f32_32x32x16_bf16 v[76:91], v[112:115], v[96:99], v[76:91]
    v_add_f32 v148, v148, v6
    v_add_f32 v150, v150, v7
    v_lshlrev_b32 v6, 16, v114
    v_and_b32 v7, 0xffff0000, v114
    v_add_f32 v152, v152, v6
    v_add_f32 v154, v154, v7
    v_lshlrev_b32 v6, 16, v111
    v_and_b32 v7, 0xffff0000, v111
    v_add_f32 v149, v149, v6
    v_add_f32 v151, v151, v7
    v_lshlrev_b32 v6, 16, v115
    v_and_b32 v7, 0xffff0000, v115
    v_add_f32 v153, v153, v6
    v_add_f32 v155, v155, v7
    ds_read_b128 v[92:95], v14
    ds_read_b128 v[96:99], v15
    ds_read_b64_tr_b16 v[108:109], v20 offset:0
    ds_read_b64_tr_b16 v[110:111], v20 offset:1024
    ds_read_b64_tr_b16 v[112:113], v24 offset:0
    ds_read_b64_tr_b16 v[114:115], v24 offset:1024
    s_waitcnt lgkmcnt(6)
    v_mfma_f32_32x32x16_bf16 v[28:43], v[116:119], v[100:103], v[28:43]
    v_lshlrev_b32 v4, 16, v100
    v_and_b32 v5, 0xffff0000, v100
    v_add_f32 v140, v140, v4
    v_add_f32 v141, v141, v5
    v_fma_f32 v144, v4, v4, v144
    v_fma_f32 v145, v5, v5, v145
    v_mfma_f32_32x32x16_bf16 v[44:59], v[120:123], v[100:103], v[44:59]
    v_lshlrev_b32 v4, 16, v101
    v_and_b32 v5, 0xffff0000, v101
    v_add_f32 v142, v142, v4
    v_add_f32 v143, v143, v5
    v_fma_f32 v146, v4, v4, v146
    v_fma_f32 v147, v5, v5, v147
    v_mfma_f32_32x32x16_bf16 v[60:75], v[116:119], v[104:107], v[60:75]
    v_lshlrev_b32 v4, 16, v102
    v_and_b32 v5, 0xffff0000, v102
    v_add_f32 v140, v140, v4
    v_add_f32 v141, v141, v5
    v_fma_f32 v144, v4, v4, v144
    v_fma_f32 v145, v5, v5, v145
    v_mfma_f32_32x32x16_bf16 v[76:91], v[120:123], v[104:107], v[76:91]
    v_lshlrev_b32 v4, 16, v103
    v_and_b32 v5, 0xffff0000, v103
    v_add_f32 v142, v142, v4
    v_add_f32 v143, v143, v5
    v_fma_f32 v146, v4, v4, v146
    v_fma_f32 v147, v5, v5, v147
    ds_read_b128 v[100:103], v16
    ds_read_b128 v[104:107], v17
    ds_read_b64_tr_b16 v[116:117], v21 offset:0
    ds_read_b64_tr_b16 v[118:119], v21 offset:1024
    ds_read_b64_tr_b16 v[120:121], v25 offset:0
    ds_read_b64_tr_b16 v[122:123], v25 offset:1024
    s_waitcnt lgkmcnt(6)
    v_mfma_f32_32x32x16_bf16 v[28:43], v[108:111], v[92:95], v[28:43]
    v_lshlrev_b32 v4, 16, v92
    v_and_b32 v5, 0xffff0000, v92
    v_add_f32 v140, v140, v4
    v_add_f32 v141, v141, v5
    v_fma_f32 v144, v4, v4, v144
    v_fma_f32 v145, v5, v5, v145
    v_lshlrev_b32 v4, 16, v93
    v_and_b32 v5, 0xffff0000, v93
    v_add_f32 v142, v142, v4
    v_add_f32 v143, v143, v5
    v_mfma_f32_32x32x16_bf16 v[44:59], v[112:115], v[92:95], v[44:59]
    v_fma_f32 v146, v4, v4, v146
    v_fma_f32 v147, v5, v5, v147
    v_lshlrev_b32 v4, 16, v94
    v_and_b32 v5, 0xffff0000, v94
    v_add_f32 v140, v140, v4
    v_add_f32 v141, v141, v5
    v_fma_f32 v144, v4, v4, v144
    v_fma_f32 v145, v5, v5, v145
    v_lshlrev_b32 v4, 16, v95
    v_and_b32 v5, 0xffff0000, v95
    v_mfma_f32_32x32x16_bf16 v[60:75], v[108:111], v[96:99], v[60:75]
    v_add_f32 v142, v142, v4
    v_add_f32 v143, v143, v5
    v_fma_f32 v146, v4, v4, v146
    v_fma_f32 v147, v5, v5, v147
    v_add_u32 v10, 49152, v10
    v_add_u32 v11, 49152, v11
    v_add_u32 v12, 49152, v12
    v_add_u32 v13, 49152, v13
    v_add_u32 v14, 49152, v14
    v_add_u32 v15, 49152, v15
    v_mfma_f32_32x32x16_bf16 v[76:91], v[112:115], v[96:99], v[76:91]
    v_add_u32 v16, 49152, v16
    v_add_u32 v17, 49152, v17
    v_add_u32 v18, 49152, v18
    v_add_u32 v19, 49152, v19
    v_add_u32 v20, 49152, v20
    v_add_u32 v21, 49152, v21
    v_add_u32 v22, 49152, v22
    v_add_u32 v23, 49152, v23
    v_add_u32 v24, 49152, v24
    v_add_u32 v25, 49152, v25
    s_waitcnt vmcnt(6) lgkmcnt(0)
    s_barrier
    ds_read_b128 v[92:95], v10
    ds_read_b128 v[96:99], v11
    ds_read_b64_tr_b16 v[108:109], v18 offset:0
    ds_read_b64_tr_b16 v[110:111], v18 offset:1024
    ds_read_b64_tr_b16 v[112:113], v22 offset:0
    ds_read_b64_tr_b16 v[114:115], v22 offset:1024
    v_mfma_f32_32x32x16_bf16 v[28:43], v[116:119], v[100:103], v[28:43]
    s_add_u32 m0, s7, 0
    s_mov_b32 s4, 128
    buffer_load_dwordx4 v8, s[24:27], s4 offen lds
    v_lshlrev_b32 v4, 16, v100
    v_and_b32 v5, 0xffff0000, v100
    v_add_f32 v140, v140, v4
    v_add_f32 v141, v141, v5
    v_fma_f32 v144, v4, v4, v144
    v_fma_f32 v145, v5, v5, v145
    v_mfma_f32_32x32x16_bf16 v[44:59], v[120:123], v[100:103], v[44:59]
    s_add_u32 m0, s7, 8192
    s_mov_b32 s4, 65664
    buffer_load_dwordx4 v8, s[24:27], s4 offen lds
    v_lshlrev_b32 v4, 16, v101
    v_and_b32 v5, 0xffff0000, v101
    v_add_f32 v142, v142, v4
    v_add_f32 v143, v143, v5
    v_fma_f32 v146, v4, v4, v146
    v_fma_f32 v147, v5, v5, v147
    v_mfma_f32_32x32x16_bf16 v[60:75], v[116:119], v[104:107], v[60:75]
    s_add_u32 m0, s7, 16384
    s_mov_b32 s4, 131200
    buffer_load_dwordx4 v8, s[24:27], s4 offen lds
    v_lshlrev_b32 v4, 16, v102
    v_and_b32 v5, 0xffff0000, v102
    v_add_f32 v140, v140, v4
    v_add_f32 v141, v141, v5
    v_fma_f32 v144, v4, v4, v144
    v_fma_f32 v145, v5, v5, v145
    v_mfma_f32_32x32x16_bf16 v[76:91], v[120:123], v[104:107], v[76:91]
    s_add_u32 m0, s7, 24576
    s_mov_b32 s4, 196736
    buffer_load_dwordx4 v8, s[24:27], s4 offen lds
    v_lshlrev_b32 v4, 16, v103
    v_and_b32 v5, 0xffff0000, v103
    v_add_f32 v142, v142, v4
    v_add_f32 v143, v143, v5
    v_fma_f32 v146, v4, v4, v146
    v_fma_f32 v147, v5, v5, v147
    ds_read_b128 v[100:103], v12
    ds_read_b128 v[104:107], v13
    ds_read_b64_tr_b16 v[116:117], v19 offset:0
    ds_read_b64_tr_b16 v[118:119], v19 offset:1024
    ds_read_b64_tr_b16 v[120:121], v23 offset:0
    ds_read_b64_tr_b16 v[122:123], v23 offset:1024
    s_waitcnt lgkmcnt(6)
    v_mfma_f32_32x32x16_bf16 v[28:43], v[108:111], v[92:95], v[28:43]
    s_add_u32 m0, s7, 32768
    s_mov_b32 s4, 524288
    buffer_load_dwordx4 v9, s[28:31], s4 offen lds
    v_lshlrev_b32 v4, 16, v92
    v_and_b32 v5, 0xffff0000, v92
    v_add_f32 v140, v140, v4
    v_add_f32 v141, v141, v5
    v_fma_f32 v144, v4, v4, v144
    v_fma_f32 v145, v5, v5, v145
    v_lshlrev_b32 v4, 16, v93
    v_and_b32 v5, 0xffff0000, v93
    v_add_f32 v142, v142, v4
    v_add_f32 v143, v143, v5
    v_fma_f32 v146, v4, v4, v146
    v_fma_f32 v147, v5, v5, v147
    v_lshlrev_b32 v4, 16, v94
    v_and_b32 v5, 0xffff0000, v94
    v_mfma_f32_32x32x16_bf16 v[44:59], v[112:115], v[92:95], v[44:59]
    s_add_u32 m0, s7, 40960
    s_mov_b32 s4, 786432
    buffer_load_dwordx4 v9, s[28:31], s4 offen lds
    v_add_f32 v140, v140, v4
    v_add_f32 v141, v141, v5
    v_fma_f32 v144, v4, v4, v144
    v_fma_f32 v145, v5, v5, v145
    v_lshlrev_b32 v4, 16, v95
    v_and_b32 v5, 0xffff0000, v95
    v_add_f32 v142, v142, v4
    v_add_f32 v143, v143, v5
    v_fma_f32 v146, v4, v4, v146
    v_fma_f32 v147, v5, v5, v147
    v_lshlrev_b32 v6, 16, v108
    v_and_b32 v7, 0xffff0000, v108
    v_add_f32 v148, v148, v6
    v_add_f32 v150, v150, v7
    v_mfma_f32_32x32x16_bf16 v[60:75], v[108:111], v[96:99], v[60:75]
    v_lshlrev_b32 v6, 16, v112
    v_and_b32 v7, 0xffff0000, v112
    v_add_f32 v152, v152, v6
    v_add_f32 v154, v154, v7
    v_lshlrev_b32 v6, 16, v109
    v_and_b32 v7, 0xffff0000, v109
    v_add_f32 v149, v149, v6
    v_add_f32 v151, v151, v7
    v_lshlrev_b32 v6, 16, v113
    v_and_b32 v7, 0xffff0000, v113
    v_add_f32 v153, v153, v6
    v_add_f32 v155, v155, v7
    v_lshlrev_b32 v6, 16, v110
    v_and_b32 v7, 0xffff0000, v110
    v_mfma_f32_32x32x16_bf16 v[76:91], v[112:115], v[96:99], v[76:91]
    v_add_f32 v148, v148, v6
    v_add_f32 v150, v150, v7
    v_lshlrev_b32 v6, 16, v114
    v_and_b32 v7, 0xffff0000, v114
    v_add_f32 v152, v152, v6
    v_add_f32 v154, v154, v7
    v_lshlrev_b32 v6, 16, v111
    v_and_b32 v7, 0xffff0000, v111
    v_add_f32 v149, v149, v6
    v_add_f32 v151, v151, v7
    v_lshlrev_b32 v6, 16, v115
    v_and_b32 v7, 0xffff0000, v115
    v_add_f32 v153, v153, v6
    v_add_f32 v155, v155, v7
    ds_read_b128 v[92:95], v14
    ds_read_b128 v[96:99], v15
    ds_read_b64_tr_b16 v[108:109], v20 offset:0
    ds_read_b64_tr_b16 v[110:111], v20 offset:1024
    ds_read_b64_tr_b16 v[112:113], v24 offset:0
    ds_read_b64_tr_b16 v[114:115], v24 offset:1024
    s_waitcnt lgkmcnt(6)
    v_mfma_f32_32x32x16_bf16 v[28:43], v[116:119], v[100:103], v[28:43]
    v_lshlrev_b32 v4, 16, v100
    v_and_b32 v5, 0xffff0000, v100
    v_add_f32 v140, v140, v4
    v_add_f32 v141, v141, v5
    v_fma_f32 v144, v4, v4, v144
    v_fma_f32 v145, v5, v5, v145
    v_mfma_f32_32x32x16_bf16 v[44:59], v[120:123], v[100:103], v[44:59]
    v_lshlrev_b32 v4, 16, v101
    v_and_b32 v5, 0xffff0000, v101
    v_add_f32 v142, v142, v4
    v_add_f32 v143, v143, v5
    v_fma_f32 v146, v4, v4, v146
    v_fma_f32 v147, v5, v5, v147
    v_mfma_f32_32x32x16_bf16 v[60:75], v[116:119], v[104:107], v[60:75]
    v_lshlrev_b32 v4, 16, v102
    v_and_b32 v5, 0xffff0000, v102
    v_add_f32 v140, v140, v4
    v_add_f32 v141, v141, v5
    v_fma_f32 v144, v4, v4, v144
    v_fma_f32 v145, v5, v5, v145
    v_mfma_f32_32x32x16_bf16 v[76:91], v[120:123], v[104:107], v[76:91]
    v_lshlrev_b32 v4, 16, v103
    v_and_b32 v5, 0xffff0000, v103
    v_add_f32 v142, v142, v4
    v_add_f32 v143, v143, v5
    v_fma_f32 v146, v4, v4, v146
    v_fma_f32 v147, v5, v5, v147
    ds_read_b128 v[100:103], v16
    ds_read_b128 v[104:107], v17
    ds_read_b64_tr_b16 v[116:117], v21 offset:0
    ds_read_b64_tr_b16 v[118:119], v21 offset:1024
    ds_read_b64_tr_b16 v[120:121], v25 offset:0
    ds_read_b64_tr_b16 v[122:123], v25 offset:1024
    s_waitcnt lgkmcnt(6)
    v_mfma_f32_32x32x16_bf16 v[28:43], v[108:111], v[92:95], v[28:43]
    v_lshlrev_b32 v4, 16, v92
    v_and_b32 v5, 0xffff0000, v92
    v_add_f32 v140, v140, v4
    v_add_f32 v141, v141, v5
    v_fma_f32 v144, v4, v4, v144
    v_fma_f32 v145, v5, v5, v145
    v_lshlrev_b32 v4, 16, v93
    v_and_b32 v5, 0xffff0000, v93
    v_add_f32 v142, v142, v4
    v_add_f32 v143, v143, v5
    v_mfma_f32_32x32x16_bf16 v[44:59], v[112:115], v[92:95], v[44:59]
    v_fma_f32 v146, v4, v4, v146
    v_fma_f32 v147, v5, v5, v147
    v_lshlrev_b32 v4, 16, v94
    v_and_b32 v5, 0xffff0000, v94
    v_add_f32 v140, v140, v4
    v_add_f32 v141, v141, v5
    v_fma_f32 v144, v4, v4, v144
    v_fma_f32 v145, v5, v5, v145
    v_lshlrev_b32 v4, 16, v95
    v_and_b32 v5, 0xffff0000, v95
    v_mfma_f32_32x32x16_bf16 v[60:75], v[108:111], v[96:99], v[60:75]
    v_add_f32 v142, v142, v4
    v_add_f32 v143, v143, v5
    v_fma_f32 v146, v4, v4, v146
    v_fma_f32 v147, v5, v5, v147
    v_add_u32 v10, 49152, v10
    v_add_u32 v11, 49152, v11
    v_add_u32 v12, 49152, v12
    v_add_u32 v13, 49152, v13
    v_add_u32 v14, 49152, v14
    v_add_u32 v15, 49152, v15
    v_mfma_f32_32x32x16_bf16 v[76:91], v[112:115], v[96:99], v[76:91]
    v_add_u32 v16, 49152, v16
    v_add_u32 v17, 49152, v17
    v_add_u32 v18, 49152, v18
    v_add_u32 v19, 49152, v19
    v_add_u32 v20, 49152, v20
    v_add_u32 v21, 49152, v21
    v_add_u32 v22, 49152, v22
    v_add_u32 v23, 49152, v23
    v_add_u32 v24, 49152, v24
    v_add_u32 v25, 49152, v25
    s_waitcnt vmcnt(6) lgkmcnt(0)
    s_barrier
    ds_read_b128 v[92:95], v10
    ds_read_b128 v[96:99], v11
    ds_read_b64_tr_b16 v[108:109], v18 offset:0
    ds_read_b64_tr_b16 v[110:111], v18 offset:1024
    ds_read_b64_tr_b16 v[112:113], v22 offset:0
    ds_read_b64_tr_b16 v[114:115], v22 offset:1024
    v_mfma_f32_32x32x16_bf16 v[28:43], v[116:119], v[100:103], v[28:43]
    s_add_u32 m0, s7, 49152
    s_mov_b32 s4, 256
    buffer_load_dwordx4 v8, s[24:27], s4 offen lds
    v_lshlrev_b32 v4, 16, v100
    v_and_b32 v5, 0xffff0000, v100
    v_add_f32 v140, v140, v4
    v_add_f32 v141, v141, v5
    v_fma_f32 v144, v4, v4, v144
    v_fma_f32 v145, v5, v5, v145
    v_mfma_f32_32x32x16_bf16 v[44:59], v[120:123], v[100:103], v[44:59]
    s_add_u32 m0, s7, 57344
    s_mov_b32 s4, 65792
    buffer_load_dwordx4 v8, s[24:27], s4 offen lds
    v_lshlrev_b32 v4, 16, v101
    v_and_b32 v5, 0xffff0000, v101
    v_add_f32 v142, v142, v4
    v_add_f32 v143, v143, v5
    v_fma_f32 v146, v4, v4, v146
    v_fma_f32 v147, v5, v5, v147
    v_mfma_f32_32x32x16_bf16 v[60:75], v[116:119], v[104:107], v[60:75]
    s_add_u32 m0, s7, 65536
    s_mov_b32 s4, 131328
    buffer_load_dwordx4 v8, s[24:27], s4 offen lds
    v_lshlrev_b32 v4, 16, v102
    v_and_b32 v5, 0xffff0000, v102
    v_add_f32 v140, v140, v4
    v_add_f32 v141, v141, v5
    v_fma_f32 v144, v4, v4, v144
    v_fma_f32 v145, v5, v5, v145
    v_mfma_f32_32x32x16_bf16 v[76:91], v[120:123], v[104:107], v[76:91]
    s_add_u32 m0, s7, 73728
    s_mov_b32 s4, 196864
    buffer_load_dwordx4 v8, s[24:27], s4 offen lds
    v_lshlrev_b32 v4, 16, v103
    v_and_b32 v5, 0xffff0000, v103
    v_add_f32 v142, v142, v4
    v_add_f32 v143, v143, v5
    v_fma_f32 v146, v4, v4, v146
    v_fma_f32 v147, v5, v5, v147
    v_add_f32 v140, v140, v142
    v_add_f32 v141, v141, v143
    v_add_f32 v132, v140, v141
    v_add_f32 v144, v144, v146
    v_add_f32 v145, v145, v147
    v_add_f32 v134, v144, v145
    v_add_f32 v148, v148, v149
    v_add_f32 v150, v150, v151
    v_add_f32 v136, v148, v150
    v_add_f32 v152, v152, v153
    v_add_f32 v154, v154, v155
    v_add_f32 v137, v152, v154
    v_mov_b32 v4, v132
    s_nop 1
    v_permlane32_swap_b32 v132, v4
    v_add_f32 v132, v132, v4
    v_mov_b32 v4, v134
    s_nop 1
    v_permlane32_swap_b32 v134, v4
    v_add_f32 v134, v134, v4
    v_mov_b32 v4, v136
    s_nop 1
    v_permlane32_swap_b32 v136, v4
    v_add_f32 v136, v136, v4
    v_mov_b32 v4, v137
    s_nop 1
    v_permlane32_swap_b32 v137, v4
    v_add_f32 v137, v137, v4
    s_lshl_b32 s8, s3, 9
    s_add_u32 s8, s8, 147456
    v_lshlrev_b32 v5, 2, v2
    v_add_u32 v6, s8, v5
    ds_write_b32 v6, v132
    ds_write_b32 v6, v134 offset:128
    ds_write_b32 v6, v136 offset:256
    ds_write_b32 v6, v137 offset:384
    s_waitcnt lgkmcnt(0)
    s_barrier
    s_lshl_b32 s8, s96, 10
    s_add_u32 s8, s8, 147456
    v_add_u32 v6, s8, v5
    s_mul_i32 s8, s97, 512
    s_sub_u32 s9, 512, s8
    v_add_u32 v7, s9, v6
    v_add_u32 v6, s8, v6
    ds_read_b32 v132, v6
    ds_read_b32 v134, v6 offset:128
    ds_read_b32 v133, v7
    ds_read_b32 v135, v7 offset:128
    s_lshl_b32 s8, s97, 9
    s_add_u32 s8, s8, 147712
    v_lshlrev_b32 v5, 2, v1
    v_add_u32 v6, s8, v5
    ds_read_b32 v192, v6 offset:0
    ds_read_b32 v193, v6 offset:1024
    ds_read_b32 v194, v6 offset:2048
    ds_read_b32 v195, v6 offset:3072
    s_waitcnt lgkmcnt(0)
    v_add_f32 v192, v192, v193
    v_add_f32 v192, v192, v194
    v_add_f32 v192, v192, v195
    s_lshl_b32 s8, s3, 8
    s_add_u32 s8, s8, 151552
    v_add_u32 v6, s8, v5
    ds_write_b32 v6, v192
    v_lshlrev_b32 v5, 4, v3
    v_add_u32 v5, s8, v5
    s_waitcnt lgkmcnt(0)
    ds_read_b128 v[160:163], v5 offset:0
    ds_read_b128 v[164:167], v5 offset:32
    ds_read_b128 v[168:171], v5 offset:64
    ds_read_b128 v[172:175], v5 offset:96
    ds_read_b128 v[176:179], v5 offset:128
    ds_read_b128 v[180:183], v5 offset:160
    ds_read_b128 v[184:187], v5 offset:192
    ds_read_b128 v[188:191], v5 offset:224
    s_waitcnt lgkmcnt(0)
    v_mul_f32 v132, 0x3b000000, v132
    v_mul_f32 v134, 0x3b000000, v134
    v_fma_f32 v134, -v132, v132, v134
    v_max_f32 v134, 0, v134
    v_add_f32 v134, 0x3727c5ac, v134
    v_rsq_f32 v134, v134
    s_nop 0
    v_mul_f32 v132, v132, v134
    v_sub_f32 v132, 0, v132
    v_mul_f32 v133, 0x3b000000, v133
    v_mul_f32 v135, 0x3b000000, v135
    v_fma_f32 v135, -v133, v133, v135
    v_max_f32 v135, 0, v135
    v_add_f32 v135, 0x3727c5ac, v135
    v_rsq_f32 v135, v135
    s_nop 0
    v_mul_f32 v133, v133, v135
    v_sub_f32 v133, 0, v133
    v_mul_f32 v134, 0x3e0293ee, v134
    v_mul_f32 v132, 0x3e0293ee, v132
    v_mul_f32 v135, 0x3e0293ee, v135
    v_mul_f32 v133, 0x3e0293ee, v133
    v_mul_f32 v28, v28, v134
    v_fma_f32 v28, v132, v160, v28
    v_mul_f32 v29, v29, v134
    v_fma_f32 v29, v132, v161, v29
    v_mul_f32 v30, v30, v134
    v_fma_f32 v30, v132, v162, v30
    v_mul_f32 v31, v31, v134
    v_fma_f32 v31, v132, v163, v31
    v_mul_f32 v32, v32, v134
    v_fma_f32 v32, v132, v164, v32
    v_mul_f32 v33, v33, v134
    v_fma_f32 v33, v132, v165, v33
    v_mul_f32 v34, v34, v134
    v_fma_f32 v34, v132, v166, v34
    v_mul_f32 v35, v35, v134
    v_fma_f32 v35, v132, v167, v35
    v_mul_f32 v36, v36, v134
    v_fma_f32 v36, v132, v168, v36
    v_mul_f32 v37, v37, v134
    v_fma_f32 v37, v132, v169, v37
    v_mul_f32 v38, v38, v134
    v_fma_f32 v38, v132, v170, v38
    v_mul_f32 v39, v39, v134
    v_fma_f32 v39, v132, v171, v39
    v_mul_f32 v40, v40, v134
    v_fma_f32 v40, v132, v172, v40
    v_mul_f32 v41, v41, v134
    v_fma_f32 v41, v132, v173, v41
    v_mul_f32 v42, v42, v134
    v_fma_f32 v42, v132, v174, v42
    v_mul_f32 v43, v43, v134
    v_fma_f32 v43, v132, v175, v43
    v_mul_f32 v44, v44, v134
    v_fma_f32 v44, v132, v176, v44
    v_mul_f32 v45, v45, v134
    v_fma_f32 v45, v132, v177, v45
    v_mul_f32 v46, v46, v134
    v_fma_f32 v46, v132, v178, v46
    v_mul_f32 v47, v47, v134
    v_fma_f32 v47, v132, v179, v47
    v_mul_f32 v48, v48, v134
    v_fma_f32 v48, v132, v180, v48
    v_mul_f32 v49, v49, v134
    v_fma_f32 v49, v132, v181, v49
    v_mul_f32 v50, v50, v134
    v_fma_f32 v50, v132, v182, v50
    v_mul_f32 v51, v51, v134
    v_fma_f32 v51, v132, v183, v51
    v_mul_f32 v52, v52, v134
    v_fma_f32 v52, v132, v184, v52
    v_mul_f32 v53, v53, v134
    v_fma_f32 v53, v132, v185, v53
    v_mul_f32 v54, v54, v134
    v_fma_f32 v54, v132, v186, v54
    v_mul_f32 v55, v55, v134
    v_fma_f32 v55, v132, v187, v55
    v_mul_f32 v56, v56, v134
    v_fma_f32 v56, v132, v188, v56
    v_mul_f32 v57, v57, v134
    v_fma_f32 v57, v132, v189, v57
    v_mul_f32 v58, v58, v134
    v_fma_f32 v58, v132, v190, v58
    v_mul_f32 v59, v59, v134
    v_fma_f32 v59, v132, v191, v59
    v_mul_f32 v60, v60, v135
    v_fma_f32 v60, v133, v160, v60
    v_mul_f32 v61, v61, v135
    v_fma_f32 v61, v133, v161, v61
    v_mul_f32 v62, v62, v135
    v_fma_f32 v62, v133, v162, v62
    v_mul_f32 v63, v63, v135
    v_fma_f32 v63, v133, v163, v63
    v_mul_f32 v64, v64, v135
    v_fma_f32 v64, v133, v164, v64
    v_mul_f32 v65, v65, v135
    v_fma_f32 v65, v133, v165, v65
    v_mul_f32 v66, v66, v135
    v_fma_f32 v66, v133, v166, v66
    v_mul_f32 v67, v67, v135
    v_fma_f32 v67, v133, v167, v67
    v_mul_f32 v68, v68, v135
    v_fma_f32 v68, v133, v168, v68
    v_mul_f32 v69, v69, v135
    v_fma_f32 v69, v133, v169, v69
    v_mul_f32 v70, v70, v135
    v_fma_f32 v70, v133, v170, v70
    v_mul_f32 v71, v71, v135
    v_fma_f32 v71, v133, v171, v71
    v_mul_f32 v72, v72, v135
    v_fma_f32 v72, v133, v172, v72
    v_mul_f32 v73, v73, v135
    v_fma_f32 v73, v133, v173, v73
    v_mul_f32 v74, v74, v135
    v_fma_f32 v74, v133, v174, v74
    v_mul_f32 v75, v75, v135
    v_fma_f32 v75, v133, v175, v75
    v_mul_f32 v76, v76, v135
    v_fma_f32 v76, v133, v176, v76
    v_mul_f32 v77, v77, v135
    v_fma_f32 v77, v133, v177, v77
    v_mul_f32 v78, v78, v135
    v_fma_f32 v78, v133, v178, v78
    v_mul_f32 v79, v79, v135
    v_fma_f32 v79, v133, v179, v79
    v_mul_f32 v80, v80, v135
    v_fma_f32 v80, v133, v180, v80
    v_mul_f32 v81, v81, v135
    v_fma_f32 v81, v133, v181, v81
    v_mul_f32 v82, v82, v135
    v_fma_f32 v82, v133, v182, v82
    v_mul_f32 v83, v83, v135
    v_fma_f32 v83, v133, v183, v83
    v_mul_f32 v84, v84, v135
    v_fma_f32 v84, v133, v184, v84
    v_mul_f32 v85, v85, v135
    v_fma_f32 v85, v133, v185, v85
    v_mul_f32 v86, v86, v135
    v_fma_f32 v86, v133, v186, v86
    v_mul_f32 v87, v87, v135
    v_fma_f32 v87, v133, v187, v87
    v_mul_f32 v88, v88, v135
    v_fma_f32 v88, v133, v188, v88
    v_mul_f32 v89, v89, v135
    v_fma_f32 v89, v133, v189, v89
    v_mul_f32 v90, v90, v135
    v_fma_f32 v90, v133, v190, v90
    v_mul_f32 v91, v91, v135
    v_fma_f32 v91, v133, v191, v91
    v_lshlrev_b32 v4, 4, v1
    s_lshl_b32 s8, s96, 6
    s_add_u32 s8, s8, s93
    s_lshl_b32 s8, s8, 8
    s_lshl_b32 s9, s6, 12
    s_add_u32 s8, s8, s9
    s_lshl_b32 s9, s97, 12
    s_add_u32 s8, s8, s9
    v_add_u32 v4, s8, v4
    s_mul_i32 s8, s97, 8192
    s_sub_u32 s9, 8192, s8
    v_add_u32 v5, s9, v4
    v_add_u32 v4, s8, v4
    v_mov_b32 v224, v4
    v_cvt_pk_bf16_f32 v192, v28, v29
    v_cvt_pk_bf16_f32 v193, v30, v31
    v_cvt_pk_bf16_f32 v194, v32, v33
    v_cvt_pk_bf16_f32 v195, v34, v35
    v_cvt_pk_bf16_f32 v196, v36, v37
    v_cvt_pk_bf16_f32 v197, v38, v39
    v_cvt_pk_bf16_f32 v198, v40, v41
    v_cvt_pk_bf16_f32 v199, v42, v43
    v_mov_b32 v224, v4
    v_cvt_pk_bf16_f32 v200, v44, v45
    v_cvt_pk_bf16_f32 v201, v46, v47
    v_cvt_pk_bf16_f32 v202, v48, v49
    v_cvt_pk_bf16_f32 v203, v50, v51
    v_cvt_pk_bf16_f32 v204, v52, v53
    v_cvt_pk_bf16_f32 v205, v54, v55
    v_cvt_pk_bf16_f32 v206, v56, v57
    v_cvt_pk_bf16_f32 v207, v58, v59
    v_mov_b32 v225, v5
    v_cvt_pk_bf16_f32 v208, v60, v61
    v_cvt_pk_bf16_f32 v209, v62, v63
    v_cvt_pk_bf16_f32 v210, v64, v65
    v_cvt_pk_bf16_f32 v211, v66, v67
    v_cvt_pk_bf16_f32 v212, v68, v69
    v_cvt_pk_bf16_f32 v213, v70, v71
    v_cvt_pk_bf16_f32 v214, v72, v73
    v_cvt_pk_bf16_f32 v215, v74, v75
    v_mov_b32 v225, v5
    v_cvt_pk_bf16_f32 v216, v76, v77
    v_cvt_pk_bf16_f32 v217, v78, v79
    v_cvt_pk_bf16_f32 v218, v80, v81
    v_cvt_pk_bf16_f32 v219, v82, v83
    v_cvt_pk_bf16_f32 v220, v84, v85
    v_cvt_pk_bf16_f32 v221, v86, v87
    v_cvt_pk_bf16_f32 v222, v88, v89
    v_cvt_pk_bf16_f32 v223, v90, v91
    ds_read_b128 v[100:103], v12
    ds_read_b128 v[104:107], v13
    ds_read_b64_tr_b16 v[116:117], v19 offset:0
    ds_read_b64_tr_b16 v[118:119], v19 offset:1024
    ds_read_b64_tr_b16 v[120:121], v23 offset:0
    ds_read_b64_tr_b16 v[122:123], v23 offset:1024
    s_waitcnt lgkmcnt(6)
    v_mfma_f32_32x32x16_bf16 v[28:43], v[108:111], v[92:95], 0
    s_add_u32 m0, s7, 81920
    s_mov_b32 s4, 1048576
    buffer_load_dwordx4 v9, s[28:31], s4 offen lds
    v_mfma_f32_32x32x16_bf16 v[44:59], v[112:115], v[92:95], 0
    s_add_u32 m0, s7, 90112
    s_mov_b32 s4, 1310720
    buffer_load_dwordx4 v9, s[28:31], s4 offen lds
    v_mfma_f32_32x32x16_bf16 v[60:75], v[108:111], v[96:99], 0
    buffer_store_dwordx4 v[192:195], v224, s[20:23], 0 offen offset:0
    v_mfma_f32_32x32x16_bf16 v[76:91], v[112:115], v[96:99], 0
    buffer_store_dwordx4 v[196:199], v224, s[20:23], 0 offen offset:1024
    ds_read_b128 v[92:95], v14
    ds_read_b128 v[96:99], v15
    ds_read_b64_tr_b16 v[108:109], v20 offset:0
    ds_read_b64_tr_b16 v[110:111], v20 offset:1024
    ds_read_b64_tr_b16 v[112:113], v24 offset:0
    ds_read_b64_tr_b16 v[114:115], v24 offset:1024
    s_waitcnt lgkmcnt(6)
    v_mfma_f32_32x32x16_bf16 v[28:43], v[116:119], v[100:103], v[28:43]
    buffer_store_dwordx4 v[200:203], v224, s[20:23], 0 offen offset:2048
    v_mfma_f32_32x32x16_bf16 v[44:59], v[120:123], v[100:103], v[44:59]
    buffer_store_dwordx4 v[204:207], v224, s[20:23], 0 offen offset:3072
    v_mfma_f32_32x32x16_bf16 v[60:75], v[116:119], v[104:107], v[60:75]
    buffer_store_dwordx4 v[208:211], v225, s[20:23], 0 offen offset:0
    v_mfma_f32_32x32x16_bf16 v[76:91], v[120:123], v[104:107], v[76:91]
    buffer_store_dwordx4 v[212:215], v225, s[20:23], 0 offen offset:1024
    ds_read_b128 v[100:103], v16
    ds_read_b128 v[104:107], v17
    ds_read_b64_tr_b16 v[116:117], v21 offset:0
    ds_read_b64_tr_b16 v[118:119], v21 offset:1024
    ds_read_b64_tr_b16 v[120:121], v25 offset:0
    ds_read_b64_tr_b16 v[122:123], v25 offset:1024
    s_waitcnt lgkmcnt(6)
    v_mfma_f32_32x32x16_bf16 v[28:43], v[108:111], v[92:95], v[28:43]
    buffer_store_dwordx4 v[216:219], v225, s[20:23], 0 offen offset:2048
    v_subrev_u32 v10, 98304, v10
    v_subrev_u32 v11, 98304, v11
    v_subrev_u32 v12, 98304, v12
    v_subrev_u32 v13, 98304, v13
    v_mfma_f32_32x32x16_bf16 v[44:59], v[112:115], v[92:95], v[44:59]
    buffer_store_dwordx4 v[220:223], v225, s[20:23], 0 offen offset:3072
    v_subrev_u32 v14, 98304, v14
    v_subrev_u32 v15, 98304, v15
    v_subrev_u32 v16, 98304, v16
    v_subrev_u32 v17, 98304, v17
    v_mfma_f32_32x32x16_bf16 v[60:75], v[108:111], v[96:99], v[60:75]
    v_subrev_u32 v18, 98304, v18
    v_subrev_u32 v19, 98304, v19
    v_subrev_u32 v20, 98304, v20
    v_subrev_u32 v21, 98304, v21
    v_mfma_f32_32x32x16_bf16 v[76:91], v[112:115], v[96:99], v[76:91]
    v_subrev_u32 v22, 98304, v22
    v_subrev_u32 v23, 98304, v23
    v_subrev_u32 v24, 98304, v24
    v_subrev_u32 v25, 98304, v25
    s_waitcnt vmcnt(14) lgkmcnt(0)
    s_barrier
    ds_read_b128 v[92:95], v10
    ds_read_b128 v[96:99], v11
    ds_read_b64_tr_b16 v[108:109], v18 offset:0
    ds_read_b64_tr_b16 v[110:111], v18 offset:1024
    ds_read_b64_tr_b16 v[112:113], v22 offset:0
    ds_read_b64_tr_b16 v[114:115], v22 offset:1024
    v_mfma_f32_32x32x16_bf16 v[28:43], v[116:119], v[100:103], v[28:43]
    s_add_u32 m0, s7, 98304
    s_mov_b32 s4, 384
    buffer_load_dwordx4 v8, s[24:27], s4 offen lds
    v_mfma_f32_32x32x16_bf16 v[44:59], v[120:123], v[100:103], v[44:59]
    s_add_u32 m0, s7, 106496
    s_mov_b32 s4, 65920
    buffer_load_dwordx4 v8, s[24:27], s4 offen lds
    v_mfma_f32_32x32x16_bf16 v[60:75], v[116:119], v[104:107], v[60:75]
    s_add_u32 m0, s7, 114688
    s_mov_b32 s4, 131456
    buffer_load_dwordx4 v8, s[24:27], s4 offen lds
    v_mfma_f32_32x32x16_bf16 v[76:91], v[120:123], v[104:107], v[76:91]
    s_add_u32 m0, s7, 122880
    s_mov_b32 s4, 196992
    buffer_load_dwordx4 v8, s[24:27], s4 offen lds
    ds_read_b128 v[100:103], v12
    ds_read_b128 v[104:107], v13
    ds_read_b64_tr_b16 v[116:117], v19 offset:0
    ds_read_b64_tr_b16 v[118:119], v19 offset:1024
    ds_read_b64_tr_b16 v[120:121], v23 offset:0
    ds_read_b64_tr_b16 v[122:123], v23 offset:1024
    s_waitcnt lgkmcnt(6)
    v_mfma_f32_32x32x16_bf16 v[28:43], v[108:111], v[92:95], v[28:43]
    s_add_u32 m0, s7, 131072
    s_mov_b32 s4, 1572864
    buffer_load_dwordx4 v9, s[28:31], s4 offen lds
    v_mfma_f32_32x32x16_bf16 v[44:59], v[112:115], v[92:95], v[44:59]
    s_add_u32 m0, s7, 139264
    s_mov_b32 s4, 1835008
    buffer_load_dwordx4 v9, s[28:31], s4 offen lds
    v_mfma_f32_32x32x16_bf16 v[60:75], v[108:111], v[96:99], v[60:75]
    v_mfma_f32_32x32x16_bf16 v[76:91], v[112:115], v[96:99], v[76:91]
    ds_read_b128 v[92:95], v14
    ds_read_b128 v[96:99], v15
    ds_read_b64_tr_b16 v[108:109], v20 offset:0
    ds_read_b64_tr_b16 v[110:111], v20 offset:1024
    ds_read_b64_tr_b16 v[112:113], v24 offset:0
    ds_read_b64_tr_b16 v[114:115], v24 offset:1024
    s_waitcnt lgkmcnt(6)
    v_mfma_f32_32x32x16_bf16 v[28:43], v[116:119], v[100:103], v[28:43]
    v_mfma_f32_32x32x16_bf16 v[44:59], v[120:123], v[100:103], v[44:59]
    v_mfma_f32_32x32x16_bf16 v[60:75], v[116:119], v[104:107], v[60:75]
    v_mfma_f32_32x32x16_bf16 v[76:91], v[120:123], v[104:107], v[76:91]
    ds_read_b128 v[100:103], v16
    ds_read_b128 v[104:107], v17
    ds_read_b64_tr_b16 v[116:117], v21 offset:0
    ds_read_b64_tr_b16 v[118:119], v21 offset:1024
    ds_read_b64_tr_b16 v[120:121], v25 offset:0
    ds_read_b64_tr_b16 v[122:123], v25 offset:1024
    s_waitcnt lgkmcnt(6)
    v_mfma_f32_32x32x16_bf16 v[28:43], v[108:111], v[92:95], v[28:43]
    v_add_u32 v10, 49152, v10
    v_add_u32 v11, 49152, v11
    v_add_u32 v12, 49152, v12
    v_add_u32 v13, 49152, v13
    v_mfma_f32_32x32x16_bf16 v[44:59], v[112:115], v[92:95], v[44:59]
    v_add_u32 v14, 49152, v14
    v_add_u32 v15, 49152, v15
    v_add_u32 v16, 49152, v16
    v_add_u32 v17, 49152, v17
    v_mfma_f32_32x32x16_bf16 v[60:75], v[108:111], v[96:99], v[60:75]
    v_add_u32 v18, 49152, v18
    v_add_u32 v19, 49152, v19
    v_add_u32 v20, 49152, v20
    v_add_u32 v21, 49152, v21
    v_mfma_f32_32x32x16_bf16 v[76:91], v[112:115], v[96:99], v[76:91]
    v_add_u32 v22, 49152, v22
    v_add_u32 v23, 49152, v23
    v_add_u32 v24, 49152, v24
    v_add_u32 v25, 49152, v25
    s_waitcnt vmcnt(14) lgkmcnt(0)
    s_barrier
    ds_read_b128 v[92:95], v10
    ds_read_b128 v[96:99], v11
    ds_read_b64_tr_b16 v[108:109], v18 offset:0
    ds_read_b64_tr_b16 v[110:111], v18 offset:1024
    ds_read_b64_tr_b16 v[112:113], v22 offset:0
    ds_read_b64_tr_b16 v[114:115], v22 offset:1024
    v_mfma_f32_32x32x16_bf16 v[28:43], v[116:119], v[100:103], v[28:43]
    s_add_u32 m0, s7, 0
    s_mov_b32 s4, 512
    buffer_load_dwordx4 v8, s[24:27], s4 offen lds
    v_mfma_f32_32x32x16_bf16 v[44:59], v[120:123], v[100:103], v[44:59]
    s_add_u32 m0, s7, 8192
    s_mov_b32 s4, 66048
    buffer_load_dwordx4 v8, s[24:27], s4 offen lds
    v_mfma_f32_32x32x16_bf16 v[60:75], v[116:119], v[104:107], v[60:75]
    s_add_u32 m0, s7, 16384
    s_mov_b32 s4, 131584
    buffer_load_dwordx4 v8, s[24:27], s4 offen lds
    v_mfma_f32_32x32x16_bf16 v[76:91], v[120:123], v[104:107], v[76:91]
    s_add_u32 m0, s7, 24576
    s_mov_b32 s4, 197120
    buffer_load_dwordx4 v8, s[24:27], s4 offen lds
    ds_read_b128 v[100:103], v12
    ds_read_b128 v[104:107], v13
    ds_read_b64_tr_b16 v[116:117], v19 offset:0
    ds_read_b64_tr_b16 v[118:119], v19 offset:1024
    ds_read_b64_tr_b16 v[120:121], v23 offset:0
    ds_read_b64_tr_b16 v[122:123], v23 offset:1024
    s_waitcnt lgkmcnt(6)
    v_mfma_f32_32x32x16_bf16 v[28:43], v[108:111], v[92:95], v[28:43]
    s_add_u32 m0, s7, 32768
    s_mov_b32 s4, 2097152
    buffer_load_dwordx4 v9, s[28:31], s4 offen lds
    v_mfma_f32_32x32x16_bf16 v[44:59], v[112:115], v[92:95], v[44:59]
    s_add_u32 m0, s7, 40960
    s_mov_b32 s4, 2359296
    buffer_load_dwordx4 v9, s[28:31], s4 offen lds
    v_mfma_f32_32x32x16_bf16 v[60:75], v[108:111], v[96:99], v[60:75]
    v_mfma_f32_32x32x16_bf16 v[76:91], v[112:115], v[96:99], v[76:91]
    ds_read_b128 v[92:95], v14
    ds_read_b128 v[96:99], v15
    ds_read_b64_tr_b16 v[108:109], v20 offset:0
    ds_read_b64_tr_b16 v[110:111], v20 offset:1024
    ds_read_b64_tr_b16 v[112:113], v24 offset:0
    ds_read_b64_tr_b16 v[114:115], v24 offset:1024
    s_waitcnt lgkmcnt(6)
    v_mfma_f32_32x32x16_bf16 v[28:43], v[116:119], v[100:103], v[28:43]
    v_mfma_f32_32x32x16_bf16 v[44:59], v[120:123], v[100:103], v[44:59]
    v_mfma_f32_32x32x16_bf16 v[60:75], v[116:119], v[104:107], v[60:75]
    v_mfma_f32_32x32x16_bf16 v[76:91], v[120:123], v[104:107], v[76:91]
    ds_read_b128 v[100:103], v16
    ds_read_b128 v[104:107], v17
    ds_read_b64_tr_b16 v[116:117], v21 offset:0
    ds_read_b64_tr_b16 v[118:119], v21 offset:1024
    ds_read_b64_tr_b16 v[120:121], v25 offset:0
    ds_read_b64_tr_b16 v[122:123], v25 offset:1024
    s_waitcnt lgkmcnt(6)
    v_mfma_f32_32x32x16_bf16 v[28:43], v[108:111], v[92:95], v[28:43]
    v_add_u32 v10, 49152, v10
    v_add_u32 v11, 49152, v11
    v_add_u32 v12, 49152, v12
    v_add_u32 v13, 49152, v13
    v_mfma_f32_32x32x16_bf16 v[44:59], v[112:115], v[92:95], v[44:59]
    v_add_u32 v14, 49152, v14
    v_add_u32 v15, 49152, v15
    v_add_u32 v16, 49152, v16
    v_add_u32 v17, 49152, v17
    v_mfma_f32_32x32x16_bf16 v[60:75], v[108:111], v[96:99], v[60:75]
    v_add_u32 v18, 49152, v18
    v_add_u32 v19, 49152, v19
    v_add_u32 v20, 49152, v20
    v_add_u32 v21, 49152, v21
    v_mfma_f32_32x32x16_bf16 v[76:91], v[112:115], v[96:99], v[76:91]
    v_add_u32 v22, 49152, v22
    v_add_u32 v23, 49152, v23
    v_add_u32 v24, 49152, v24
    v_add_u32 v25, 49152, v25
    s_waitcnt vmcnt(6) lgkmcnt(0)
    s_barrier
    ds_read_b128 v[92:95], v10
    ds_read_b128 v[96:99], v11
    ds_read_b64_tr_b16 v[108:109], v18 offset:0
    ds_read_b64_tr_b16 v[110:111], v18 offset:1024
    ds_read_b64_tr_b16 v[112:113], v22 offset:0
    ds_read_b64_tr_b16 v[114:115], v22 offset:1024
    v_mfma_f32_32x32x16_bf16 v[28:43], v[116:119], v[100:103], v[28:43]
    s_add_u32 m0, s7, 49152
    s_mov_b32 s4, 640
    buffer_load_dwordx4 v8, s[24:27], s4 offen lds
    v_mfma_f32_32x32x16_bf16 v[44:59], v[120:123], v[100:103], v[44:59]
    s_add_u32 m0, s7, 57344
    s_mov_b32 s4, 66176
    buffer_load_dwordx4 v8, s[24:27], s4 offen lds
    v_mfma_f32_32x32x16_bf16 v[60:75], v[116:119], v[104:107], v[60:75]
    s_add_u32 m0, s7, 65536
    s_mov_b32 s4, 131712
    buffer_load_dwordx4 v8, s[24:27], s4 offen lds
    v_mfma_f32_32x32x16_bf16 v[76:91], v[120:123], v[104:107], v[76:91]
    s_add_u32 m0, s7, 73728
    s_mov_b32 s4, 197248
    buffer_load_dwordx4 v8, s[24:27], s4 offen lds
    ds_read_b128 v[100:103], v12
    ds_read_b128 v[104:107], v13
    ds_read_b64_tr_b16 v[116:117], v19 offset:0
    ds_read_b64_tr_b16 v[118:119], v19 offset:1024
    ds_read_b64_tr_b16 v[120:121], v23 offset:0
    ds_read_b64_tr_b16 v[122:123], v23 offset:1024
    s_waitcnt lgkmcnt(6)
    v_mfma_f32_32x32x16_bf16 v[28:43], v[108:111], v[92:95], v[28:43]
    s_add_u32 m0, s7, 81920
    s_mov_b32 s4, 2621440
    buffer_load_dwordx4 v9, s[28:31], s4 offen lds
    v_mfma_f32_32x32x16_bf16 v[44:59], v[112:115], v[92:95], v[44:59]
    s_add_u32 m0, s7, 90112
    s_mov_b32 s4, 2883584
    buffer_load_dwordx4 v9, s[28:31], s4 offen lds
    v_mfma_f32_32x32x16_bf16 v[60:75], v[108:111], v[96:99], v[60:75]
    v_mfma_f32_32x32x16_bf16 v[76:91], v[112:115], v[96:99], v[76:91]
    ds_read_b128 v[92:95], v14
    ds_read_b128 v[96:99], v15
    ds_read_b64_tr_b16 v[108:109], v20 offset:0
    ds_read_b64_tr_b16 v[110:111], v20 offset:1024
    ds_read_b64_tr_b16 v[112:113], v24 offset:0
    ds_read_b64_tr_b16 v[114:115], v24 offset:1024
    s_waitcnt lgkmcnt(6)
    v_mfma_f32_32x32x16_bf16 v[28:43], v[116:119], v[100:103], v[28:43]
    v_mfma_f32_32x32x16_bf16 v[44:59], v[120:123], v[100:103], v[44:59]
    v_mfma_f32_32x32x16_bf16 v[60:75], v[116:119], v[104:107], v[60:75]
    v_mfma_f32_32x32x16_bf16 v[76:91], v[120:123], v[104:107], v[76:91]
    ds_read_b128 v[100:103], v16
    ds_read_b128 v[104:107], v17
    ds_read_b64_tr_b16 v[116:117], v21 offset:0
    ds_read_b64_tr_b16 v[118:119], v21 offset:1024
    ds_read_b64_tr_b16 v[120:121], v25 offset:0
    ds_read_b64_tr_b16 v[122:123], v25 offset:1024
    s_waitcnt lgkmcnt(6)
    v_mfma_f32_32x32x16_bf16 v[28:43], v[108:111], v[92:95], v[28:43]
    v_subrev_u32 v10, 98304, v10
    v_subrev_u32 v11, 98304, v11
    v_subrev_u32 v12, 98304, v12
    v_subrev_u32 v13, 98304, v13
    v_mfma_f32_32x32x16_bf16 v[44:59], v[112:115], v[92:95], v[44:59]
    v_subrev_u32 v14, 98304, v14
    v_subrev_u32 v15, 98304, v15
    v_subrev_u32 v16, 98304, v16
    v_subrev_u32 v17, 98304, v17
    v_mfma_f32_32x32x16_bf16 v[60:75], v[108:111], v[96:99], v[60:75]
    v_subrev_u32 v18, 98304, v18
    v_subrev_u32 v19, 98304, v19
    v_subrev_u32 v20, 98304, v20
    v_subrev_u32 v21, 98304, v21
    v_mfma_f32_32x32x16_bf16 v[76:91], v[112:115], v[96:99], v[76:91]
    v_subrev_u32 v22, 98304, v22
    v_subrev_u32 v23, 98304, v23
    v_subrev_u32 v24, 98304, v24
    v_subrev_u32 v25, 98304, v25
    s_waitcnt vmcnt(6) lgkmcnt(0)
    s_barrier
    ds_read_b128 v[92:95], v10
    ds_read_b128 v[96:99], v11
    ds_read_b64_tr_b16 v[108:109], v18 offset:0
    ds_read_b64_tr_b16 v[110:111], v18 offset:1024
    ds_read_b64_tr_b16 v[112:113], v22 offset:0
    ds_read_b64_tr_b16 v[114:115], v22 offset:1024
    v_mfma_f32_32x32x16_bf16 v[28:43], v[116:119], v[100:103], v[28:43]
    s_add_u32 m0, s7, 98304
    s_mov_b32 s4, 768
    buffer_load_dwordx4 v8, s[24:27], s4 offen lds
    v_mfma_f32_32x32x16_bf16 v[44:59], v[120:123], v[100:103], v[44:59]
    s_add_u32 m0, s7, 106496
    s_mov_b32 s4, 66304
    buffer_load_dwordx4 v8, s[24:27], s4 offen lds
    v_mfma_f32_32x32x16_bf16 v[60:75], v[116:119], v[104:107], v[60:75]
    s_add_u32 m0, s7, 114688
    s_mov_b32 s4, 131840
    buffer_load_dwordx4 v8, s[24:27], s4 offen lds
    v_mfma_f32_32x32x16_bf16 v[76:91], v[120:123], v[104:107], v[76:91]
    s_add_u32 m0, s7, 122880
    s_mov_b32 s4, 197376
    buffer_load_dwordx4 v8, s[24:27], s4 offen lds
    ds_read_b128 v[100:103], v12
    ds_read_b128 v[104:107], v13
    ds_read_b64_tr_b16 v[116:117], v19 offset:0
    ds_read_b64_tr_b16 v[118:119], v19 offset:1024
    ds_read_b64_tr_b16 v[120:121], v23 offset:0
    ds_read_b64_tr_b16 v[122:123], v23 offset:1024
    s_waitcnt lgkmcnt(6)
    v_mfma_f32_32x32x16_bf16 v[28:43], v[108:111], v[92:95], v[28:43]
    s_add_u32 m0, s7, 131072
    s_mov_b32 s4, 3145728
    buffer_load_dwordx4 v9, s[28:31], s4 offen lds
    v_mfma_f32_32x32x16_bf16 v[44:59], v[112:115], v[92:95], v[44:59]
    s_add_u32 m0, s7, 139264
    s_mov_b32 s4, 3407872
    buffer_load_dwordx4 v9, s[28:31], s4 offen lds
    v_mfma_f32_32x32x16_bf16 v[60:75], v[108:111], v[96:99], v[60:75]
    v_mfma_f32_32x32x16_bf16 v[76:91], v[112:115], v[96:99], v[76:91]
    ds_read_b128 v[92:95], v14
    ds_read_b128 v[96:99], v15
    ds_read_b64_tr_b16 v[108:109], v20 offset:0
    ds_read_b64_tr_b16 v[110:111], v20 offset:1024
    ds_read_b64_tr_b16 v[112:113], v24 offset:0
    ds_read_b64_tr_b16 v[114:115], v24 offset:1024
    s_waitcnt lgkmcnt(6)
    v_mfma_f32_32x32x16_bf16 v[28:43], v[116:119], v[100:103], v[28:43]
    v_mfma_f32_32x32x16_bf16 v[44:59], v[120:123], v[100:103], v[44:59]
    v_mfma_f32_32x32x16_bf16 v[60:75], v[116:119], v[104:107], v[60:75]
    v_mfma_f32_32x32x16_bf16 v[76:91], v[120:123], v[104:107], v[76:91]
    ds_read_b128 v[100:103], v16
    ds_read_b128 v[104:107], v17
    ds_read_b64_tr_b16 v[116:117], v21 offset:0
    ds_read_b64_tr_b16 v[118:119], v21 offset:1024
    ds_read_b64_tr_b16 v[120:121], v25 offset:0
    ds_read_b64_tr_b16 v[122:123], v25 offset:1024
    s_waitcnt lgkmcnt(6)
    v_mfma_f32_32x32x16_bf16 v[28:43], v[108:111], v[92:95], v[28:43]
    v_add_u32 v10, 49152, v10
    v_add_u32 v11, 49152, v11
    v_add_u32 v12, 49152, v12
    v_add_u32 v13, 49152, v13
    v_mfma_f32_32x32x16_bf16 v[44:59], v[112:115], v[92:95], v[44:59]
    v_add_u32 v14, 49152, v14
    v_add_u32 v15, 49152, v15
    v_add_u32 v16, 49152, v16
    v_add_u32 v17, 49152, v17
    v_mfma_f32_32x32x16_bf16 v[60:75], v[108:111], v[96:99], v[60:75]
    v_add_u32 v18, 49152, v18
    v_add_u32 v19, 49152, v19
    v_add_u32 v20, 49152, v20
    v_add_u32 v21, 49152, v21
    v_mfma_f32_32x32x16_bf16 v[76:91], v[112:115], v[96:99], v[76:91]
    v_add_u32 v22, 49152, v22
    v_add_u32 v23, 49152, v23
    v_add_u32 v24, 49152, v24
    v_add_u32 v25, 49152, v25
    s_waitcnt vmcnt(6) lgkmcnt(0)
    s_barrier
    ds_read_b128 v[92:95], v10
    ds_read_b128 v[96:99], v11
    ds_read_b64_tr_b16 v[108:109], v18 offset:0
    ds_read_b64_tr_b16 v[110:111], v18 offset:1024
    ds_read_b64_tr_b16 v[112:113], v22 offset:0
    ds_read_b64_tr_b16 v[114:115], v22 offset:1024
    v_mfma_f32_32x32x16_bf16 v[28:43], v[116:119], v[100:103], v[28:43]
    s_add_u32 m0, s7, 0
    s_mov_b32 s4, 896
    buffer_load_dwordx4 v8, s[24:27], s4 offen lds
    v_mfma_f32_32x32x16_bf16 v[44:59], v[120:123], v[100:103], v[44:59]
    s_add_u32 m0, s7, 8192
    s_mov_b32 s4, 66432
    buffer_load_dwordx4 v8, s[24:27], s4 offen lds
    v_mfma_f32_32x32x16_bf16 v[60:75], v[116:119], v[104:107], v[60:75]
    s_add_u32 m0, s7, 16384
    s_mov_b32 s4, 131968
    buffer_load_dwordx4 v8, s[24:27], s4 offen lds
    v_mfma_f32_32x32x16_bf16 v[76:91], v[120:123], v[104:107], v[76:91]
    s_add_u32 m0, s7, 24576
    s_mov_b32 s4, 197504
    buffer_load_dwordx4 v8, s[24:27], s4 offen lds
    ds_read_b128 v[100:103], v12
    ds_read_b128 v[104:107], v13
    ds_read_b64_tr_b16 v[116:117], v19 offset:0
    ds_read_b64_tr_b16 v[118:119], v19 offset:1024
    ds_read_b64_tr_b16 v[120:121], v23 offset:0
    ds_read_b64_tr_b16 v[122:123], v23 offset:1024
    s_waitcnt lgkmcnt(6)
    v_mfma_f32_32x32x16_bf16 v[28:43], v[108:111], v[92:95], v[28:43]
    s_add_u32 m0, s7, 32768
    s_mov_b32 s4, 3670016
    buffer_load_dwordx4 v9, s[28:31], s4 offen lds
    v_mfma_f32_32x32x16_bf16 v[44:59], v[112:115], v[92:95], v[44:59]
    s_add_u32 m0, s7, 40960
    s_mov_b32 s4, 3932160
    buffer_load_dwordx4 v9, s[28:31], s4 offen lds
    v_mfma_f32_32x32x16_bf16 v[60:75], v[108:111], v[96:99], v[60:75]
    v_mfma_f32_32x32x16_bf16 v[76:91], v[112:115], v[96:99], v[76:91]
    ds_read_b128 v[92:95], v14
    ds_read_b128 v[96:99], v15
    ds_read_b64_tr_b16 v[108:109], v20 offset:0
    ds_read_b64_tr_b16 v[110:111], v20 offset:1024
    ds_read_b64_tr_b16 v[112:113], v24 offset:0
    ds_read_b64_tr_b16 v[114:115], v24 offset:1024
    s_waitcnt lgkmcnt(6)
    v_mfma_f32_32x32x16_bf16 v[28:43], v[116:119], v[100:103], v[28:43]
    v_mfma_f32_32x32x16_bf16 v[44:59], v[120:123], v[100:103], v[44:59]
    v_mfma_f32_32x32x16_bf16 v[60:75], v[116:119], v[104:107], v[60:75]
    v_mfma_f32_32x32x16_bf16 v[76:91], v[120:123], v[104:107], v[76:91]
    ds_read_b128 v[100:103], v16
    ds_read_b128 v[104:107], v17
    ds_read_b64_tr_b16 v[116:117], v21 offset:0
    ds_read_b64_tr_b16 v[118:119], v21 offset:1024
    ds_read_b64_tr_b16 v[120:121], v25 offset:0
    ds_read_b64_tr_b16 v[122:123], v25 offset:1024
    s_waitcnt lgkmcnt(6)
    v_mfma_f32_32x32x16_bf16 v[28:43], v[108:111], v[92:95], v[28:43]
    v_add_u32 v10, 49152, v10
    v_add_u32 v11, 49152, v11
    v_add_u32 v12, 49152, v12
    v_add_u32 v13, 49152, v13
    v_mfma_f32_32x32x16_bf16 v[44:59], v[112:115], v[92:95], v[44:59]
    v_add_u32 v14, 49152, v14
    v_add_u32 v15, 49152, v15
    v_add_u32 v16, 49152, v16
    v_add_u32 v17, 49152, v17
    v_mfma_f32_32x32x16_bf16 v[60:75], v[108:111], v[96:99], v[60:75]
    v_add_u32 v18, 49152, v18
    v_add_u32 v19, 49152, v19
    v_add_u32 v20, 49152, v20
    v_add_u32 v21, 49152, v21
    v_mfma_f32_32x32x16_bf16 v[76:91], v[112:115], v[96:99], v[76:91]
    v_add_u32 v22, 49152, v22
    v_add_u32 v23, 49152, v23
    v_add_u32 v24, 49152, v24
    v_add_u32 v25, 49152, v25
    s_waitcnt vmcnt(6) lgkmcnt(0)
    s_barrier
    ds_read_b128 v[92:95], v10
    ds_read_b128 v[96:99], v11
    ds_read_b64_tr_b16 v[108:109], v18 offset:0
    ds_read_b64_tr_b16 v[110:111], v18 offset:1024
    ds_read_b64_tr_b16 v[112:113], v22 offset:0
    ds_read_b64_tr_b16 v[114:115], v22 offset:1024
    v_mfma_f32_32x32x16_bf16 v[28:43], v[116:119], v[100:103], v[28:43]
    s_add_u32 m0, s7, 49152
    s_mov_b32 s4, 0
    buffer_load_dwordx4 v8, s[36:39], s4 offen lds
    v_mfma_f32_32x32x16_bf16 v[44:59], v[120:123], v[100:103], v[44:59]
    s_add_u32 m0, s7, 57344
    s_mov_b32 s4, 65536
    buffer_load_dwordx4 v8, s[36:39], s4 offen lds
    v_mfma_f32_32x32x16_bf16 v[60:75], v[116:119], v[104:107], v[60:75]
    s_add_u32 m0, s7, 65536
    s_mov_b32 s4, 131072
    buffer_load_dwordx4 v8, s[36:39], s4 offen lds
    v_mfma_f32_32x32x16_bf16 v[76:91], v[120:123], v[104:107], v[76:91]
    s_add_u32 m0, s7, 73728
    s_mov_b32 s4, 196608
    buffer_load_dwordx4 v8, s[36:39], s4 offen lds
    ds_read_b128 v[100:103], v12
    ds_read_b128 v[104:107], v13
    ds_read_b64_tr_b16 v[116:117], v19 offset:0
    ds_read_b64_tr_b16 v[118:119], v19 offset:1024
    ds_read_b64_tr_b16 v[120:121], v23 offset:0
    ds_read_b64_tr_b16 v[122:123], v23 offset:1024
    s_waitcnt lgkmcnt(6)
    v_mfma_f32_32x32x16_bf16 v[28:43], v[108:111], v[92:95], v[28:43]
    s_add_u32 m0, s7, 81920
    s_mov_b32 s4, 0
    buffer_load_dwordx4 v9, s[40:43], s4 offen lds
    v_mfma_f32_32x32x16_bf16 v[44:59], v[112:115], v[92:95], v[44:59]
    s_add_u32 m0, s7, 90112
    s_mov_b32 s4, 262144
    buffer_load_dwordx4 v9, s[40:43], s4 offen lds
    v_mfma_f32_32x32x16_bf16 v[60:75], v[108:111], v[96:99], v[60:75]
    v_mfma_f32_32x32x16_bf16 v[76:91], v[112:115], v[96:99], v[76:91]
    ds_read_b128 v[92:95], v14
    ds_read_b128 v[96:99], v15
    ds_read_b64_tr_b16 v[108:109], v20 offset:0
    ds_read_b64_tr_b16 v[110:111], v20 offset:1024
    ds_read_b64_tr_b16 v[112:113], v24 offset:0
    ds_read_b64_tr_b16 v[114:115], v24 offset:1024
    s_waitcnt lgkmcnt(6)
    v_mfma_f32_32x32x16_bf16 v[28:43], v[116:119], v[100:103], v[28:43]
    v_mfma_f32_32x32x16_bf16 v[44:59], v[120:123], v[100:103], v[44:59]
    v_mfma_f32_32x32x16_bf16 v[60:75], v[116:119], v[104:107], v[60:75]
    v_mfma_f32_32x32x16_bf16 v[76:91], v[120:123], v[104:107], v[76:91]
    ds_read_b128 v[100:103], v16
    ds_read_b128 v[104:107], v17
    ds_read_b64_tr_b16 v[116:117], v21 offset:0
    ds_read_b64_tr_b16 v[118:119], v21 offset:1024
    ds_read_b64_tr_b16 v[120:121], v25 offset:0
    ds_read_b64_tr_b16 v[122:123], v25 offset:1024
    s_waitcnt lgkmcnt(6)
    v_mfma_f32_32x32x16_bf16 v[28:43], v[108:111], v[92:95], v[28:43]
    v_subrev_u32 v10, 98304, v10
    v_subrev_u32 v11, 98304, v11
    v_subrev_u32 v12, 98304, v12
    v_subrev_u32 v13, 98304, v13
    v_mfma_f32_32x32x16_bf16 v[44:59], v[112:115], v[92:95], v[44:59]
    v_subrev_u32 v14, 98304, v14
    v_subrev_u32 v15, 98304, v15
    v_subrev_u32 v16, 98304, v16
    v_subrev_u32 v17, 98304, v17
    v_mfma_f32_32x32x16_bf16 v[60:75], v[108:111], v[96:99], v[60:75]
    v_subrev_u32 v18, 98304, v18
    v_subrev_u32 v19, 98304, v19
    v_subrev_u32 v20, 98304, v20
    v_subrev_u32 v21, 98304, v21
    v_mfma_f32_32x32x16_bf16 v[76:91], v[112:115], v[96:99], v[76:91]
    v_subrev_u32 v22, 98304, v22
    v_subrev_u32 v23, 98304, v23
    v_subrev_u32 v24, 98304, v24
    v_subrev_u32 v25, 98304, v25
    s_waitcnt vmcnt(6) lgkmcnt(0)
    s_barrier
    ds_read_b128 v[92:95], v10
    ds_read_b128 v[96:99], v11
    ds_read_b64_tr_b16 v[108:109], v18 offset:0
    ds_read_b64_tr_b16 v[110:111], v18 offset:1024
    ds_read_b64_tr_b16 v[112:113], v22 offset:0
    ds_read_b64_tr_b16 v[114:115], v22 offset:1024
    v_mfma_f32_32x32x16_bf16 v[28:43], v[116:119], v[100:103], v[28:43]
    s_add_u32 m0, s7, 98304
    s_mov_b32 s4, 128
    buffer_load_dwordx4 v8, s[36:39], s4 offen lds
    v_mfma_f32_32x32x16_bf16 v[44:59], v[120:123], v[100:103], v[44:59]
    s_add_u32 m0, s7, 106496
    s_mov_b32 s4, 65664
    buffer_load_dwordx4 v8, s[36:39], s4 offen lds
    v_mfma_f32_32x32x16_bf16 v[60:75], v[116:119], v[104:107], v[60:75]
    s_add_u32 m0, s7, 114688
    s_mov_b32 s4, 131200
    buffer_load_dwordx4 v8, s[36:39], s4 offen lds
    v_mfma_f32_32x32x16_bf16 v[76:91], v[120:123], v[104:107], v[76:91]
    s_add_u32 m0, s7, 122880
    s_mov_b32 s4, 196736
    buffer_load_dwordx4 v8, s[36:39], s4 offen lds
    ds_read_b128 v[100:103], v12
    ds_read_b128 v[104:107], v13
    ds_read_b64_tr_b16 v[116:117], v19 offset:0
    ds_read_b64_tr_b16 v[118:119], v19 offset:1024
    ds_read_b64_tr_b16 v[120:121], v23 offset:0
    ds_read_b64_tr_b16 v[122:123], v23 offset:1024
    s_waitcnt lgkmcnt(6)
    v_mfma_f32_32x32x16_bf16 v[28:43], v[108:111], v[92:95], v[28:43]
    s_add_u32 m0, s7, 131072
    s_mov_b32 s4, 524288
    buffer_load_dwordx4 v9, s[40:43], s4 offen lds
    v_mfma_f32_32x32x16_bf16 v[44:59], v[112:115], v[92:95], v[44:59]
    s_add_u32 m0, s7, 139264
    s_mov_b32 s4, 786432
    buffer_load_dwordx4 v9, s[40:43], s4 offen lds
    v_mfma_f32_32x32x16_bf16 v[60:75], v[108:111], v[96:99], v[60:75]
    v_mfma_f32_32x32x16_bf16 v[76:91], v[112:115], v[96:99], v[76:91]
    ds_read_b128 v[92:95], v14
    ds_read_b128 v[96:99], v15
    ds_read_b64_tr_b16 v[108:109], v20 offset:0
    ds_read_b64_tr_b16 v[110:111], v20 offset:1024
    ds_read_b64_tr_b16 v[112:113], v24 offset:0
    ds_read_b64_tr_b16 v[114:115], v24 offset:1024
    s_waitcnt lgkmcnt(6)
    v_mfma_f32_32x32x16_bf16 v[28:43], v[116:119], v[100:103], v[28:43]
    v_mfma_f32_32x32x16_bf16 v[44:59], v[120:123], v[100:103], v[44:59]
    v_mfma_f32_32x32x16_bf16 v[60:75], v[116:119], v[104:107], v[60:75]
    v_mfma_f32_32x32x16_bf16 v[76:91], v[120:123], v[104:107], v[76:91]
    ds_read_b128 v[100:103], v16
    ds_read_b128 v[104:107], v17
    ds_read_b64_tr_b16 v[116:117], v21 offset:0
    ds_read_b64_tr_b16 v[118:119], v21 offset:1024
    ds_read_b64_tr_b16 v[120:121], v25 offset:0
    ds_read_b64_tr_b16 v[122:123], v25 offset:1024
    s_waitcnt lgkmcnt(6)
    v_mfma_f32_32x32x16_bf16 v[28:43], v[108:111], v[92:95], v[28:43]
    v_add_u32 v10, 49152, v10
    v_add_u32 v11, 49152, v11
    v_add_u32 v12, 49152, v12
    v_add_u32 v13, 49152, v13
    v_mfma_f32_32x32x16_bf16 v[44:59], v[112:115], v[92:95], v[44:59]
    v_add_u32 v14, 49152, v14
    v_add_u32 v15, 49152, v15
    v_add_u32 v16, 49152, v16
    v_add_u32 v17, 49152, v17
    v_mfma_f32_32x32x16_bf16 v[60:75], v[108:111], v[96:99], v[60:75]
    v_add_u32 v18, 49152, v18
    v_add_u32 v19, 49152, v19
    v_add_u32 v20, 49152, v20
    v_add_u32 v21, 49152, v21
    v_mfma_f32_32x32x16_bf16 v[76:91], v[112:115], v[96:99], v[76:91]
    v_add_u32 v22, 49152, v22
    v_add_u32 v23, 49152, v23
    v_add_u32 v24, 49152, v24
    v_add_u32 v25, 49152, v25
    s_waitcnt vmcnt(6) lgkmcnt(0)
    s_barrier
    ds_read_b128 v[92:95], v10
    ds_read_b128 v[96:99], v11
    ds_read_b64_tr_b16 v[108:109], v18 offset:0
    ds_read_b64_tr_b16 v[110:111], v18 offset:1024
    ds_read_b64_tr_b16 v[112:113], v22 offset:0
    ds_read_b64_tr_b16 v[114:115], v22 offset:1024
    v_mfma_f32_32x32x16_bf16 v[28:43], v[116:119], v[100:103], v[28:43]
    s_add_u32 m0, s7, 0
    s_mov_b32 s4, 256
    buffer_load_dwordx4 v8, s[36:39], s4 offen lds
    v_mfma_f32_32x32x16_bf16 v[44:59], v[120:123], v[100:103], v[44:59]
    s_add_u32 m0, s7, 8192
    s_mov_b32 s4, 65792
    buffer_load_dwordx4 v8, s[36:39], s4 offen lds
    v_mfma_f32_32x32x16_bf16 v[60:75], v[116:119], v[104:107], v[60:75]
    s_add_u32 m0, s7, 16384
    s_mov_b32 s4, 131328
    buffer_load_dwordx4 v8, s[36:39], s4 offen lds
    v_mfma_f32_32x32x16_bf16 v[76:91], v[120:123], v[104:107], v[76:91]
    s_add_u32 m0, s7, 24576
    s_mov_b32 s4, 196864
    buffer_load_dwordx4 v8, s[36:39], s4 offen lds
    v_lshlrev_b32 v4, 4, v1
    s_lshl_b32 s8, s96, 6
    s_add_u32 s8, s8, s93
    s_lshl_b32 s8, s8, 8
    s_lshl_b32 s9, s6, 12
    s_add_u32 s8, s8, s9
    s_lshl_b32 s9, s97, 12
    s_add_u32 s8, s8, s9
    v_add_u32 v4, s8, v4
    s_mul_i32 s8, s97, 8192
    s_sub_u32 s9, 8192, s8
    v_add_u32 v5, s9, v4
    v_add_u32 v4, s8, v4
    v_mov_b32 v224, v4
    v_cvt_pk_bf16_f32 v192, v28, v29
    v_cvt_pk_bf16_f32 v193, v30, v31
    v_cvt_pk_bf16_f32 v194, v32, v33
    v_cvt_pk_bf16_f32 v195, v34, v35
    v_cvt_pk_bf16_f32 v196, v36, v37
    v_cvt_pk_bf16_f32 v197, v38, v39
    v_cvt_pk_bf16_f32 v198, v40, v41
    v_cvt_pk_bf16_f32 v199, v42, v43
    v_mov_b32 v224, v4
    v_cvt_pk_bf16_f32 v200, v44, v45
    v_cvt_pk_bf16_f32 v201, v46, v47
    v_cvt_pk_bf16_f32 v202, v48, v49
    v_cvt_pk_bf16_f32 v203, v50, v51
    v_cvt_pk_bf16_f32 v204, v52, v53
    v_cvt_pk_bf16_f32 v205, v54, v55
    v_cvt_pk_bf16_f32 v206, v56, v57
    v_cvt_pk_bf16_f32 v207, v58, v59
    v_mov_b32 v225, v5
    v_cvt_pk_bf16_f32 v208, v60, v61
    v_cvt_pk_bf16_f32 v209, v62, v63
    v_cvt_pk_bf16_f32 v210, v64, v65
    v_cvt_pk_bf16_f32 v211, v66, v67
    v_cvt_pk_bf16_f32 v212, v68, v69
    v_cvt_pk_bf16_f32 v213, v70, v71
    v_cvt_pk_bf16_f32 v214, v72, v73
    v_cvt_pk_bf16_f32 v215, v74, v75
    v_mov_b32 v225, v5
    v_cvt_pk_bf16_f32 v216, v76, v77
    v_cvt_pk_bf16_f32 v217, v78, v79
    v_cvt_pk_bf16_f32 v218, v80, v81
    v_cvt_pk_bf16_f32 v219, v82, v83
    v_cvt_pk_bf16_f32 v220, v84, v85
    v_cvt_pk_bf16_f32 v221, v86, v87
    v_cvt_pk_bf16_f32 v222, v88, v89
    v_cvt_pk_bf16_f32 v223, v90, v91
    ds_read_b128 v[100:103], v12
    ds_read_b128 v[104:107], v13
    ds_read_b64_tr_b16 v[116:117], v19 offset:0
    ds_read_b64_tr_b16 v[118:119], v19 offset:1024
    ds_read_b64_tr_b16 v[120:121], v23 offset:0
    ds_read_b64_tr_b16 v[122:123], v23 offset:1024
    s_waitcnt lgkmcnt(6)
    v_mfma_f32_32x32x16_bf16 v[28:43], v[92:95], v[108:111], 0
    s_add_u32 m0, s7, 32768
    s_mov_b32 s4, 1048576
    buffer_load_dwordx4 v9, s[40:43], s4 offen lds
    v_mfma_f32_32x32x16_bf16 v[44:59], v[92:95], v[112:115], 0
    s_add_u32 m0, s7, 40960
    s_mov_b32 s4, 1310720
    buffer_load_dwordx4 v9, s[40:43], s4 offen lds
    v_mfma_f32_32x32x16_bf16 v[60:75], v[96:99], v[108:111], 0
    buffer_store_dwordx4 v[192:195], v224, s[32:35], 0 offen offset:0
    v_mfma_f32_32x32x16_bf16 v[76:91], v[96:99], v[112:115], 0
    buffer_store_dwordx4 v[196:199], v224, s[32:35], 0 offen offset:1024
    ds_read_b128 v[92:95], v14
    ds_read_b128 v[96:99], v15
    ds_read_b64_tr_b16 v[108:109], v20 offset:0
    ds_read_b64_tr_b16 v[110:111], v20 offset:1024
    ds_read_b64_tr_b16 v[112:113], v24 offset:0
    ds_read_b64_tr_b16 v[114:115], v24 offset:1024
    s_waitcnt lgkmcnt(6)
    v_mfma_f32_32x32x16_bf16 v[28:43], v[100:103], v[116:119], v[28:43]
    buffer_store_dwordx4 v[200:203], v224, s[32:35], 0 offen offset:2048
    v_mfma_f32_32x32x16_bf16 v[44:59], v[100:103], v[120:123], v[44:59]
    buffer_store_dwordx4 v[204:207], v224, s[32:35], 0 offen offset:3072
    v_mfma_f32_32x32x16_bf16 v[60:75], v[104:107], v[116:119], v[60:75]
    buffer_store_dwordx4 v[208:211], v225, s[32:35], 0 offen offset:0
    v_mfma_f32_32x32x16_bf16 v[76:91], v[104:107], v[120:123], v[76:91]
    buffer_store_dwordx4 v[212:215], v225, s[32:35], 0 offen offset:1024
    ds_read_b128 v[100:103], v16
    ds_read_b128 v[104:107], v17
    ds_read_b64_tr_b16 v[116:117], v21 offset:0
    ds_read_b64_tr_b16 v[118:119], v21 offset:1024
    ds_read_b64_tr_b16 v[120:121], v25 offset:0
    ds_read_b64_tr_b16 v[122:123], v25 offset:1024
    s_waitcnt lgkmcnt(6)
    v_mfma_f32_32x32x16_bf16 v[28:43], v[92:95], v[108:111], v[28:43]
    buffer_store_dwordx4 v[216:219], v225, s[32:35], 0 offen offset:2048
    v_add_u32 v10, 49152, v10
    v_add_u32 v11, 49152, v11
    v_add_u32 v12, 49152, v12
    v_add_u32 v13, 49152, v13
    v_mfma_f32_32x32x16_bf16 v[44:59], v[92:95], v[112:115], v[44:59]
    buffer_store_dwordx4 v[220:223], v225, s[32:35], 0 offen offset:3072
    v_add_u32 v14, 49152, v14
    v_add_u32 v15, 49152, v15
    v_add_u32 v16, 49152, v16
    v_add_u32 v17, 49152, v17
    v_mfma_f32_32x32x16_bf16 v[60:75], v[96:99], v[108:111], v[60:75]
    v_add_u32 v18, 49152, v18
    v_add_u32 v19, 49152, v19
    v_add_u32 v20, 49152, v20
    v_add_u32 v21, 49152, v21
    v_mfma_f32_32x32x16_bf16 v[76:91], v[96:99], v[112:115], v[76:91]
    v_add_u32 v22, 49152, v22
    v_add_u32 v23, 49152, v23
    v_add_u32 v24, 49152, v24
    v_add_u32 v25, 49152, v25
    s_waitcnt vmcnt(14) lgkmcnt(0)
    s_barrier
    ds_read_b128 v[92:95], v10
    ds_read_b128 v[96:99], v11
    ds_read_b64_tr_b16 v[108:109], v18 offset:0
    ds_read_b64_tr_b16 v[110:111], v18 offset:1024
    ds_read_b64_tr_b16 v[112:113], v22 offset:0
    ds_read_b64_tr_b16 v[114:115], v22 offset:1024
    v_mfma_f32_32x32x16_bf16 v[28:43], v[100:103], v[116:119], v[28:43]
    s_add_u32 m0, s7, 49152
    s_mov_b32 s4, 384
    buffer_load_dwordx4 v8, s[36:39], s4 offen lds
    v_mfma_f32_32x32x16_bf16 v[44:59], v[100:103], v[120:123], v[44:59]
    s_add_u32 m0, s7, 57344
    s_mov_b32 s4, 65920
    buffer_load_dwordx4 v8, s[36:39], s4 offen lds
    v_mfma_f32_32x32x16_bf16 v[60:75], v[104:107], v[116:119], v[60:75]
    s_add_u32 m0, s7, 65536
    s_mov_b32 s4, 131456
    buffer_load_dwordx4 v8, s[36:39], s4 offen lds
    v_mfma_f32_32x32x16_bf16 v[76:91], v[104:107], v[120:123], v[76:91]
    s_add_u32 m0, s7, 73728
    s_mov_b32 s4, 196992
    buffer_load_dwordx4 v8, s[36:39], s4 offen lds
    ds_read_b128 v[100:103], v12
    ds_read_b128 v[104:107], v13
    ds_read_b64_tr_b16 v[116:117], v19 offset:0
    ds_read_b64_tr_b16 v[118:119], v19 offset:1024
    ds_read_b64_tr_b16 v[120:121], v23 offset:0
    ds_read_b64_tr_b16 v[122:123], v23 offset:1024
    s_waitcnt lgkmcnt(6)
    v_mfma_f32_32x32x16_bf16 v[28:43], v[92:95], v[108:111], v[28:43]
    s_add_u32 m0, s7, 81920
    s_mov_b32 s4, 1572864
    buffer_load_dwordx4 v9, s[40:43], s4 offen lds
    v_mfma_f32_32x32x16_bf16 v[44:59], v[92:95], v[112:115], v[44:59]
    s_add_u32 m0, s7, 90112
    s_mov_b32 s4, 1835008
    buffer_load_dwordx4 v9, s[40:43], s4 offen lds
    v_mfma_f32_32x32x16_bf16 v[60:75], v[96:99], v[108:111], v[60:75]
    v_mfma_f32_32x32x16_bf16 v[76:91], v[96:99], v[112:115], v[76:91]
    ds_read_b128 v[92:95], v14
    ds_read_b128 v[96:99], v15
    ds_read_b64_tr_b16 v[108:109], v20 offset:0
    ds_read_b64_tr_b16 v[110:111], v20 offset:1024
    ds_read_b64_tr_b16 v[112:113], v24 offset:0
    ds_read_b64_tr_b16 v[114:115], v24 offset:1024
    s_waitcnt lgkmcnt(6)
    v_mfma_f32_32x32x16_bf16 v[28:43], v[100:103], v[116:119], v[28:43]
    v_mfma_f32_32x32x16_bf16 v[44:59], v[100:103], v[120:123], v[44:59]
    v_mfma_f32_32x32x16_bf16 v[60:75], v[104:107], v[116:119], v[60:75]
    v_mfma_f32_32x32x16_bf16 v[76:91], v[104:107], v[120:123], v[76:91]
    ds_read_b128 v[100:103], v16
    ds_read_b128 v[104:107], v17
    ds_read_b64_tr_b16 v[116:117], v21 offset:0
    ds_read_b64_tr_b16 v[118:119], v21 offset:1024
    ds_read_b64_tr_b16 v[120:121], v25 offset:0
    ds_read_b64_tr_b16 v[122:123], v25 offset:1024
    s_waitcnt lgkmcnt(6)
    v_mfma_f32_32x32x16_bf16 v[28:43], v[92:95], v[108:111], v[28:43]
    v_subrev_u32 v10, 98304, v10
    v_subrev_u32 v11, 98304, v11
    v_subrev_u32 v12, 98304, v12
    v_subrev_u32 v13, 98304, v13
    v_mfma_f32_32x32x16_bf16 v[44:59], v[92:95], v[112:115], v[44:59]
    v_subrev_u32 v14, 98304, v14
    v_subrev_u32 v15, 98304, v15
    v_subrev_u32 v16, 98304, v16
    v_subrev_u32 v17, 98304, v17
    v_mfma_f32_32x32x16_bf16 v[60:75], v[96:99], v[108:111], v[60:75]
    v_subrev_u32 v18, 98304, v18
    v_subrev_u32 v19, 98304, v19
    v_subrev_u32 v20, 98304, v20
    v_subrev_u32 v21, 98304, v21
    v_mfma_f32_32x32x16_bf16 v[76:91], v[96:99], v[112:115], v[76:91]
    v_subrev_u32 v22, 98304, v22
    v_subrev_u32 v23, 98304, v23
    v_subrev_u32 v24, 98304, v24
    v_subrev_u32 v25, 98304, v25
    s_waitcnt vmcnt(14) lgkmcnt(0)
    s_barrier
    ds_read_b128 v[92:95], v10
    ds_read_b128 v[96:99], v11
    ds_read_b64_tr_b16 v[108:109], v18 offset:0
    ds_read_b64_tr_b16 v[110:111], v18 offset:1024
    ds_read_b64_tr_b16 v[112:113], v22 offset:0
    ds_read_b64_tr_b16 v[114:115], v22 offset:1024
    v_mfma_f32_32x32x16_bf16 v[28:43], v[100:103], v[116:119], v[28:43]
    s_add_u32 m0, s7, 98304
    s_mov_b32 s4, 512
    buffer_load_dwordx4 v8, s[36:39], s4 offen lds
    v_mfma_f32_32x32x16_bf16 v[44:59], v[100:103], v[120:123], v[44:59]
    s_add_u32 m0, s7, 106496
    s_mov_b32 s4, 66048
    buffer_load_dwordx4 v8, s[36:39], s4 offen lds
    v_mfma_f32_32x32x16_bf16 v[60:75], v[104:107], v[116:119], v[60:75]
    s_add_u32 m0, s7, 114688
    s_mov_b32 s4, 131584
    buffer_load_dwordx4 v8, s[36:39], s4 offen lds
    v_mfma_f32_32x32x16_bf16 v[76:91], v[104:107], v[120:123], v[76:91]
    s_add_u32 m0, s7, 122880
    s_mov_b32 s4, 197120
    buffer_load_dwordx4 v8, s[36:39], s4 offen lds
    ds_read_b128 v[100:103], v12
    ds_read_b128 v[104:107], v13
    ds_read_b64_tr_b16 v[116:117], v19 offset:0
    ds_read_b64_tr_b16 v[118:119], v19 offset:1024
    ds_read_b64_tr_b16 v[120:121], v23 offset:0
    ds_read_b64_tr_b16 v[122:123], v23 offset:1024
    s_waitcnt lgkmcnt(6)
    v_mfma_f32_32x32x16_bf16 v[28:43], v[92:95], v[108:111], v[28:43]
    s_add_u32 m0, s7, 131072
    s_mov_b32 s4, 2097152
    buffer_load_dwordx4 v9, s[40:43], s4 offen lds
    v_mfma_f32_32x32x16_bf16 v[44:59], v[92:95], v[112:115], v[44:59]
    s_add_u32 m0, s7, 139264
    s_mov_b32 s4, 2359296
    buffer_load_dwordx4 v9, s[40:43], s4 offen lds
    v_mfma_f32_32x32x16_bf16 v[60:75], v[96:99], v[108:111], v[60:75]
    v_mfma_f32_32x32x16_bf16 v[76:91], v[96:99], v[112:115], v[76:91]
    ds_read_b128 v[92:95], v14
    ds_read_b128 v[96:99], v15
    ds_read_b64_tr_b16 v[108:109], v20 offset:0
    ds_read_b64_tr_b16 v[110:111], v20 offset:1024
    ds_read_b64_tr_b16 v[112:113], v24 offset:0
    ds_read_b64_tr_b16 v[114:115], v24 offset:1024
    s_waitcnt lgkmcnt(6)
    v_mfma_f32_32x32x16_bf16 v[28:43], v[100:103], v[116:119], v[28:43]
    v_mfma_f32_32x32x16_bf16 v[44:59], v[100:103], v[120:123], v[44:59]
    v_mfma_f32_32x32x16_bf16 v[60:75], v[104:107], v[116:119], v[60:75]
    v_mfma_f32_32x32x16_bf16 v[76:91], v[104:107], v[120:123], v[76:91]
    ds_read_b128 v[100:103], v16
    ds_read_b128 v[104:107], v17
    ds_read_b64_tr_b16 v[116:117], v21 offset:0
    ds_read_b64_tr_b16 v[118:119], v21 offset:1024
    ds_read_b64_tr_b16 v[120:121], v25 offset:0
    ds_read_b64_tr_b16 v[122:123], v25 offset:1024
    s_waitcnt lgkmcnt(6)
    v_mfma_f32_32x32x16_bf16 v[28:43], v[92:95], v[108:111], v[28:43]
    v_add_u32 v10, 49152, v10
    v_add_u32 v11, 49152, v11
    v_add_u32 v12, 49152, v12
    v_add_u32 v13, 49152, v13
    v_mfma_f32_32x32x16_bf16 v[44:59], v[92:95], v[112:115], v[44:59]
    v_add_u32 v14, 49152, v14
    v_add_u32 v15, 49152, v15
    v_add_u32 v16, 49152, v16
    v_add_u32 v17, 49152, v17
    v_mfma_f32_32x32x16_bf16 v[60:75], v[96:99], v[108:111], v[60:75]
    v_add_u32 v18, 49152, v18
    v_add_u32 v19, 49152, v19
    v_add_u32 v20, 49152, v20
    v_add_u32 v21, 49152, v21
    v_mfma_f32_32x32x16_bf16 v[76:91], v[96:99], v[112:115], v[76:91]
    v_add_u32 v22, 49152, v22
    v_add_u32 v23, 49152, v23
    v_add_u32 v24, 49152, v24
    v_add_u32 v25, 49152, v25
    s_waitcnt vmcnt(6) lgkmcnt(0)
    s_barrier
    ds_read_b128 v[92:95], v10
    ds_read_b128 v[96:99], v11
    ds_read_b64_tr_b16 v[108:109], v18 offset:0
    ds_read_b64_tr_b16 v[110:111], v18 offset:1024
    ds_read_b64_tr_b16 v[112:113], v22 offset:0
    ds_read_b64_tr_b16 v[114:115], v22 offset:1024
    v_mfma_f32_32x32x16_bf16 v[28:43], v[100:103], v[116:119], v[28:43]
    s_add_u32 m0, s7, 0
    s_mov_b32 s4, 640
    buffer_load_dwordx4 v8, s[36:39], s4 offen lds
    v_mfma_f32_32x32x16_bf16 v[44:59], v[100:103], v[120:123], v[44:59]
    s_add_u32 m0, s7, 8192
    s_mov_b32 s4, 66176
    buffer_load_dwordx4 v8, s[36:39], s4 offen lds
    v_mfma_f32_32x32x16_bf16 v[60:75], v[104:107], v[116:119], v[60:75]
    s_add_u32 m0, s7, 16384
    s_mov_b32 s4, 131712
    buffer_load_dwordx4 v8, s[36:39], s4 offen lds
    v_mfma_f32_32x32x16_bf16 v[76:91], v[104:107], v[120:123], v[76:91]
    s_add_u32 m0, s7, 24576
    s_mov_b32 s4, 197248
    buffer_load_dwordx4 v8, s[36:39], s4 offen lds
    ds_read_b128 v[100:103], v12
    ds_read_b128 v[104:107], v13
    ds_read_b64_tr_b16 v[116:117], v19 offset:0
    ds_read_b64_tr_b16 v[118:119], v19 offset:1024
    ds_read_b64_tr_b16 v[120:121], v23 offset:0
    ds_read_b64_tr_b16 v[122:123], v23 offset:1024
    s_waitcnt lgkmcnt(6)
    v_mfma_f32_32x32x16_bf16 v[28:43], v[92:95], v[108:111], v[28:43]
    s_add_u32 m0, s7, 32768
    s_mov_b32 s4, 2621440
    buffer_load_dwordx4 v9, s[40:43], s4 offen lds
    v_mfma_f32_32x32x16_bf16 v[44:59], v[92:95], v[112:115], v[44:59]
    s_add_u32 m0, s7, 40960
    s_mov_b32 s4, 2883584
    buffer_load_dwordx4 v9, s[40:43], s4 offen lds
    v_mfma_f32_32x32x16_bf16 v[60:75], v[96:99], v[108:111], v[60:75]
    v_mfma_f32_32x32x16_bf16 v[76:91], v[96:99], v[112:115], v[76:91]
    ds_read_b128 v[92:95], v14
    ds_read_b128 v[96:99], v15
    ds_read_b64_tr_b16 v[108:109], v20 offset:0
    ds_read_b64_tr_b16 v[110:111], v20 offset:1024
    ds_read_b64_tr_b16 v[112:113], v24 offset:0
    ds_read_b64_tr_b16 v[114:115], v24 offset:1024
    s_waitcnt lgkmcnt(6)
    v_mfma_f32_32x32x16_bf16 v[28:43], v[100:103], v[116:119], v[28:43]
    v_mfma_f32_32x32x16_bf16 v[44:59], v[100:103], v[120:123], v[44:59]
    v_mfma_f32_32x32x16_bf16 v[60:75], v[104:107], v[116:119], v[60:75]
    v_mfma_f32_32x32x16_bf16 v[76:91], v[104:107], v[120:123], v[76:91]
    ds_read_b128 v[100:103], v16
    ds_read_b128 v[104:107], v17
    ds_read_b64_tr_b16 v[116:117], v21 offset:0
    ds_read_b64_tr_b16 v[118:119], v21 offset:1024
    ds_read_b64_tr_b16 v[120:121], v25 offset:0
    ds_read_b64_tr_b16 v[122:123], v25 offset:1024
    s_waitcnt lgkmcnt(6)
    v_mfma_f32_32x32x16_bf16 v[28:43], v[92:95], v[108:111], v[28:43]
    v_add_u32 v10, 49152, v10
    v_add_u32 v11, 49152, v11
    v_add_u32 v12, 49152, v12
    v_add_u32 v13, 49152, v13
    v_mfma_f32_32x32x16_bf16 v[44:59], v[92:95], v[112:115], v[44:59]
    v_add_u32 v14, 49152, v14
    v_add_u32 v15, 49152, v15
    v_add_u32 v16, 49152, v16
    v_add_u32 v17, 49152, v17
    v_mfma_f32_32x32x16_bf16 v[60:75], v[96:99], v[108:111], v[60:75]
    v_add_u32 v18, 49152, v18
    v_add_u32 v19, 49152, v19
    v_add_u32 v20, 49152, v20
    v_add_u32 v21, 49152, v21
    v_mfma_f32_32x32x16_bf16 v[76:91], v[96:99], v[112:115], v[76:91]
    v_add_u32 v22, 49152, v22
    v_add_u32 v23, 49152, v23
    v_add_u32 v24, 49152, v24
    v_add_u32 v25, 49152, v25
    s_waitcnt vmcnt(6) lgkmcnt(0)
    s_barrier
    ds_read_b128 v[92:95], v10
    ds_read_b128 v[96:99], v11
    ds_read_b64_tr_b16 v[108:109], v18 offset:0
    ds_read_b64_tr_b16 v[110:111], v18 offset:1024
    ds_read_b64_tr_b16 v[112:113], v22 offset:0
    ds_read_b64_tr_b16 v[114:115], v22 offset:1024
    v_mfma_f32_32x32x16_bf16 v[28:43], v[100:103], v[116:119], v[28:43]
    s_add_u32 m0, s7, 49152
    s_mov_b32 s4, 768
    buffer_load_dwordx4 v8, s[36:39], s4 offen lds
    v_mfma_f32_32x32x16_bf16 v[44:59], v[100:103], v[120:123], v[44:59]
    s_add_u32 m0, s7, 57344
    s_mov_b32 s4, 66304
    buffer_load_dwordx4 v8, s[36:39], s4 offen lds
    v_mfma_f32_32x32x16_bf16 v[60:75], v[104:107], v[116:119], v[60:75]
    s_add_u32 m0, s7, 65536
    s_mov_b32 s4, 131840
    buffer_load_dwordx4 v8, s[36:39], s4 offen lds
    v_mfma_f32_32x32x16_bf16 v[76:91], v[104:107], v[120:123], v[76:91]
    s_add_u32 m0, s7, 73728
    s_mov_b32 s4, 197376
    buffer_load_dwordx4 v8, s[36:39], s4 offen lds
    ds_read_b128 v[100:103], v12
    ds_read_b128 v[104:107], v13
    ds_read_b64_tr_b16 v[116:117], v19 offset:0
    ds_read_b64_tr_b16 v[118:119], v19 offset:1024
    ds_read_b64_tr_b16 v[120:121], v23 offset:0
    ds_read_b64_tr_b16 v[122:123], v23 offset:1024
    s_waitcnt lgkmcnt(6)
    v_mfma_f32_32x32x16_bf16 v[28:43], v[92:95], v[108:111], v[28:43]
    s_add_u32 m0, s7, 81920
    s_mov_b32 s4, 3145728
    buffer_load_dwordx4 v9, s[40:43], s4 offen lds
    v_mfma_f32_32x32x16_bf16 v[44:59], v[92:95], v[112:115], v[44:59]
    s_add_u32 m0, s7, 90112
    s_mov_b32 s4, 3407872
    buffer_load_dwordx4 v9, s[40:43], s4 offen lds
    v_mfma_f32_32x32x16_bf16 v[60:75], v[96:99], v[108:111], v[60:75]
    v_mfma_f32_32x32x16_bf16 v[76:91], v[96:99], v[112:115], v[76:91]
    ds_read_b128 v[92:95], v14
    ds_read_b128 v[96:99], v15
    ds_read_b64_tr_b16 v[108:109], v20 offset:0
    ds_read_b64_tr_b16 v[110:111], v20 offset:1024
    ds_read_b64_tr_b16 v[112:113], v24 offset:0
    ds_read_b64_tr_b16 v[114:115], v24 offset:1024
    s_waitcnt lgkmcnt(6)
    v_mfma_f32_32x32x16_bf16 v[28:43], v[100:103], v[116:119], v[28:43]
    v_mfma_f32_32x32x16_bf16 v[44:59], v[100:103], v[120:123], v[44:59]
    v_mfma_f32_32x32x16_bf16 v[60:75], v[104:107], v[116:119], v[60:75]
    v_mfma_f32_32x32x16_bf16 v[76:91], v[104:107], v[120:123], v[76:91]
    ds_read_b128 v[100:103], v16
    ds_read_b128 v[104:107], v17
    ds_read_b64_tr_b16 v[116:117], v21 offset:0
    ds_read_b64_tr_b16 v[118:119], v21 offset:1024
    ds_read_b64_tr_b16 v[120:121], v25 offset:0
    ds_read_b64_tr_b16 v[122:123], v25 offset:1024
    s_waitcnt lgkmcnt(6)
    v_mfma_f32_32x32x16_bf16 v[28:43], v[92:95], v[108:111], v[28:43]
    v_subrev_u32 v10, 98304, v10
    v_subrev_u32 v11, 98304, v11
    v_subrev_u32 v12, 98304, v12
    v_subrev_u32 v13, 98304, v13
    v_mfma_f32_32x32x16_bf16 v[44:59], v[92:95], v[112:115], v[44:59]
    v_subrev_u32 v14, 98304, v14
    v_subrev_u32 v15, 98304, v15
    v_subrev_u32 v16, 98304, v16
    v_subrev_u32 v17, 98304, v17
    v_mfma_f32_32x32x16_bf16 v[60:75], v[96:99], v[108:111], v[60:75]
    v_subrev_u32 v18, 98304, v18
    v_subrev_u32 v19, 98304, v19
    v_subrev_u32 v20, 98304, v20
    v_subrev_u32 v21, 98304, v21
    v_mfma_f32_32x32x16_bf16 v[76:91], v[96:99], v[112:115], v[76:91]
    v_subrev_u32 v22, 98304, v22
    v_subrev_u32 v23, 98304, v23
    v_subrev_u32 v24, 98304, v24
    v_subrev_u32 v25, 98304, v25
    s_waitcnt vmcnt(6) lgkmcnt(0)
    s_barrier
    ds_read_b128 v[92:95], v10
    ds_read_b128 v[96:99], v11
    ds_read_b64_tr_b16 v[108:109], v18 offset:0
    ds_read_b64_tr_b16 v[110:111], v18 offset:1024
    ds_read_b64_tr_b16 v[112:113], v22 offset:0
    ds_read_b64_tr_b16 v[114:115], v22 offset:1024
    v_mfma_f32_32x32x16_bf16 v[28:43], v[100:103], v[116:119], v[28:43]
    s_add_u32 m0, s7, 98304
    s_mov_b32 s4, 896
    buffer_load_dwordx4 v8, s[36:39], s4 offen lds
    v_mfma_f32_32x32x16_bf16 v[44:59], v[100:103], v[120:123], v[44:59]
    s_add_u32 m0, s7, 106496
    s_mov_b32 s4, 66432
    buffer_load_dwordx4 v8, s[36:39], s4 offen lds
    v_mfma_f32_32x32x16_bf16 v[60:75], v[104:107], v[116:119], v[60:75]
    s_add_u32 m0, s7, 114688
    s_mov_b32 s4, 131968
    buffer_load_dwordx4 v8, s[36:39], s4 offen lds
    v_mfma_f32_32x32x16_bf16 v[76:91], v[104:107], v[120:123], v[76:91]
    s_add_u32 m0, s7, 122880
    s_mov_b32 s4, 197504
    buffer_load_dwordx4 v8, s[36:39], s4 offen lds
    ds_read_b128 v[100:103], v12
    ds_read_b128 v[104:107], v13
    ds_read_b64_tr_b16 v[116:117], v19 offset:0
    ds_read_b64_tr_b16 v[118:119], v19 offset:1024
    ds_read_b64_tr_b16 v[120:121], v23 offset:0
    ds_read_b64_tr_b16 v[122:123], v23 offset:1024
    s_waitcnt lgkmcnt(6)
    v_mfma_f32_32x32x16_bf16 v[28:43], v[92:95], v[108:111], v[28:43]
    s_add_u32 m0, s7, 131072
    s_mov_b32 s4, 3670016
    buffer_load_dwordx4 v9, s[40:43], s4 offen lds
    v_mfma_f32_32x32x16_bf16 v[44:59], v[92:95], v[112:115], v[44:59]
    s_add_u32 m0, s7, 139264
    s_mov_b32 s4, 3932160
    buffer_load_dwordx4 v9, s[40:43], s4 offen lds
    v_mfma_f32_32x32x16_bf16 v[60:75], v[96:99], v[108:111], v[60:75]
    v_mfma_f32_32x32x16_bf16 v[76:91], v[96:99], v[112:115], v[76:91]
    ds_read_b128 v[92:95], v14
    ds_read_b128 v[96:99], v15
    ds_read_b64_tr_b16 v[108:109], v20 offset:0
    ds_read_b64_tr_b16 v[110:111], v20 offset:1024
    ds_read_b64_tr_b16 v[112:113], v24 offset:0
    ds_read_b64_tr_b16 v[114:115], v24 offset:1024
    s_waitcnt lgkmcnt(6)
    v_mfma_f32_32x32x16_bf16 v[28:43], v[100:103], v[116:119], v[28:43]
    v_mfma_f32_32x32x16_bf16 v[44:59], v[100:103], v[120:123], v[44:59]
    v_mfma_f32_32x32x16_bf16 v[60:75], v[104:107], v[116:119], v[60:75]
    v_mfma_f32_32x32x16_bf16 v[76:91], v[104:107], v[120:123], v[76:91]
    ds_read_b128 v[100:103], v16
    ds_read_b128 v[104:107], v17
    ds_read_b64_tr_b16 v[116:117], v21 offset:0
    ds_read_b64_tr_b16 v[118:119], v21 offset:1024
    ds_read_b64_tr_b16 v[120:121], v25 offset:0
    ds_read_b64_tr_b16 v[122:123], v25 offset:1024
    s_waitcnt lgkmcnt(6)
    v_mfma_f32_32x32x16_bf16 v[28:43], v[92:95], v[108:111], v[28:43]
    v_add_u32 v10, 49152, v10
    v_add_u32 v11, 49152, v11
    v_add_u32 v12, 49152, v12
    v_add_u32 v13, 49152, v13
    v_mfma_f32_32x32x16_bf16 v[44:59], v[92:95], v[112:115], v[44:59]
    v_add_u32 v14, 49152, v14
    v_add_u32 v15, 49152, v15
    v_add_u32 v16, 49152, v16
    v_add_u32 v17, 49152, v17
    v_mfma_f32_32x32x16_bf16 v[60:75], v[96:99], v[108:111], v[60:75]
    v_add_u32 v18, 49152, v18
    v_add_u32 v19, 49152, v19
    v_add_u32 v20, 49152, v20
    v_add_u32 v21, 49152, v21
    v_mfma_f32_32x32x16_bf16 v[76:91], v[96:99], v[112:115], v[76:91]
    v_add_u32 v22, 49152, v22
    v_add_u32 v23, 49152, v23
    v_add_u32 v24, 49152, v24
    v_add_u32 v25, 49152, v25
    s_waitcnt vmcnt(6) lgkmcnt(0)
    s_barrier
    ds_read_b128 v[92:95], v10
    ds_read_b128 v[96:99], v11
    ds_read_b64_tr_b16 v[108:109], v18 offset:0
    ds_read_b64_tr_b16 v[110:111], v18 offset:1024
    ds_read_b64_tr_b16 v[112:113], v22 offset:0
    ds_read_b64_tr_b16 v[114:115], v22 offset:1024
    v_mfma_f32_32x32x16_bf16 v[28:43], v[100:103], v[116:119], v[28:43]
    v_mfma_f32_32x32x16_bf16 v[44:59], v[100:103], v[120:123], v[44:59]
    v_mfma_f32_32x32x16_bf16 v[60:75], v[104:107], v[116:119], v[60:75]
    v_mfma_f32_32x32x16_bf16 v[76:91], v[104:107], v[120:123], v[76:91]
    ds_read_b128 v[100:103], v12
    ds_read_b128 v[104:107], v13
    ds_read_b64_tr_b16 v[116:117], v19 offset:0
    ds_read_b64_tr_b16 v[118:119], v19 offset:1024
    ds_read_b64_tr_b16 v[120:121], v23 offset:0
    ds_read_b64_tr_b16 v[122:123], v23 offset:1024
    s_waitcnt lgkmcnt(6)
    v_mfma_f32_32x32x16_bf16 v[28:43], v[92:95], v[108:111], v[28:43]
    v_mfma_f32_32x32x16_bf16 v[44:59], v[92:95], v[112:115], v[44:59]
    v_mfma_f32_32x32x16_bf16 v[60:75], v[96:99], v[108:111], v[60:75]
    v_mfma_f32_32x32x16_bf16 v[76:91], v[96:99], v[112:115], v[76:91]
    ds_read_b128 v[92:95], v14
    ds_read_b128 v[96:99], v15
    ds_read_b64_tr_b16 v[108:109], v20 offset:0
    ds_read_b64_tr_b16 v[110:111], v20 offset:1024
    ds_read_b64_tr_b16 v[112:113], v24 offset:0
    ds_read_b64_tr_b16 v[114:115], v24 offset:1024
    s_waitcnt lgkmcnt(6)
    v_mfma_f32_32x32x16_bf16 v[28:43], v[100:103], v[116:119], v[28:43]
    v_mfma_f32_32x32x16_bf16 v[44:59], v[100:103], v[120:123], v[44:59]
    v_mfma_f32_32x32x16_bf16 v[60:75], v[104:107], v[116:119], v[60:75]
    v_mfma_f32_32x32x16_bf16 v[76:91], v[104:107], v[120:123], v[76:91]
    ds_read_b128 v[100:103], v16
    ds_read_b128 v[104:107], v17
    ds_read_b64_tr_b16 v[116:117], v21 offset:0
    ds_read_b64_tr_b16 v[118:119], v21 offset:1024
    ds_read_b64_tr_b16 v[120:121], v25 offset:0
    ds_read_b64_tr_b16 v[122:123], v25 offset:1024
    s_waitcnt lgkmcnt(6)
    v_mfma_f32_32x32x16_bf16 v[28:43], v[92:95], v[108:111], v[28:43]
    v_add_u32 v10, 49152, v10
    v_add_u32 v11, 49152, v11
    v_add_u32 v12, 49152, v12
    v_add_u32 v13, 49152, v13
    v_mfma_f32_32x32x16_bf16 v[44:59], v[92:95], v[112:115], v[44:59]
    v_add_u32 v14, 49152, v14
    v_add_u32 v15, 49152, v15
    v_add_u32 v16, 49152, v16
    v_add_u32 v17, 49152, v17
    v_mfma_f32_32x32x16_bf16 v[60:75], v[96:99], v[108:111], v[60:75]
    v_add_u32 v18, 49152, v18
    v_add_u32 v19, 49152, v19
    v_add_u32 v20, 49152, v20
    v_add_u32 v21, 49152, v21
    v_mfma_f32_32x32x16_bf16 v[76:91], v[96:99], v[112:115], v[76:91]
    v_add_u32 v22, 49152, v22
    v_add_u32 v23, 49152, v23
    v_add_u32 v24, 49152, v24
    v_add_u32 v25, 49152, v25
    s_waitcnt vmcnt(0) lgkmcnt(0)
    s_barrier
    ds_read_b128 v[92:95], v10
    ds_read_b128 v[96:99], v11
    ds_read_b64_tr_b16 v[108:109], v18 offset:0
    ds_read_b64_tr_b16 v[110:111], v18 offset:1024
    ds_read_b64_tr_b16 v[112:113], v22 offset:0
    ds_read_b64_tr_b16 v[114:115], v22 offset:1024
    v_mfma_f32_32x32x16_bf16 v[28:43], v[100:103], v[116:119], v[28:43]
    v_mfma_f32_32x32x16_bf16 v[44:59], v[100:103], v[120:123], v[44:59]
    v_mfma_f32_32x32x16_bf16 v[60:75], v[104:107], v[116:119], v[60:75]
    v_mfma_f32_32x32x16_bf16 v[76:91], v[104:107], v[120:123], v[76:91]
    ds_read_b128 v[100:103], v12
    ds_read_b128 v[104:107], v13
    ds_read_b64_tr_b16 v[116:117], v19 offset:0
    ds_read_b64_tr_b16 v[118:119], v19 offset:1024
    ds_read_b64_tr_b16 v[120:121], v23 offset:0
    ds_read_b64_tr_b16 v[122:123], v23 offset:1024
    s_waitcnt lgkmcnt(6)
    v_mfma_f32_32x32x16_bf16 v[28:43], v[92:95], v[108:111], v[28:43]
    v_mfma_f32_32x32x16_bf16 v[44:59], v[92:95], v[112:115], v[44:59]
    v_mfma_f32_32x32x16_bf16 v[60:75], v[96:99], v[108:111], v[60:75]
    v_mfma_f32_32x32x16_bf16 v[76:91], v[96:99], v[112:115], v[76:91]
    ds_read_b128 v[92:95], v14
    ds_read_b128 v[96:99], v15
    ds_read_b64_tr_b16 v[108:109], v20 offset:0
    ds_read_b64_tr_b16 v[110:111], v20 offset:1024
    ds_read_b64_tr_b16 v[112:113], v24 offset:0
    ds_read_b64_tr_b16 v[114:115], v24 offset:1024
    s_waitcnt lgkmcnt(6)
    v_mfma_f32_32x32x16_bf16 v[28:43], v[100:103], v[116:119], v[28:43]
    v_mfma_f32_32x32x16_bf16 v[44:59], v[100:103], v[120:123], v[44:59]
    v_mfma_f32_32x32x16_bf16 v[60:75], v[104:107], v[116:119], v[60:75]
    v_mfma_f32_32x32x16_bf16 v[76:91], v[104:107], v[120:123], v[76:91]
    ds_read_b128 v[100:103], v16
    ds_read_b128 v[104:107], v17
    ds_read_b64_tr_b16 v[116:117], v21 offset:0
    ds_read_b64_tr_b16 v[118:119], v21 offset:1024
    ds_read_b64_tr_b16 v[120:121], v25 offset:0
    ds_read_b64_tr_b16 v[122:123], v25 offset:1024
    s_waitcnt lgkmcnt(6)
    v_mfma_f32_32x32x16_bf16 v[28:43], v[92:95], v[108:111], v[28:43]
    v_mfma_f32_32x32x16_bf16 v[44:59], v[92:95], v[112:115], v[44:59]
    v_mfma_f32_32x32x16_bf16 v[60:75], v[96:99], v[108:111], v[60:75]
    v_mfma_f32_32x32x16_bf16 v[76:91], v[96:99], v[112:115], v[76:91]
    s_waitcnt lgkmcnt(0)
    v_mfma_f32_32x32x16_bf16 v[28:43], v[100:103], v[116:119], v[28:43]
    v_mfma_f32_32x32x16_bf16 v[44:59], v[100:103], v[120:123], v[44:59]
    v_mfma_f32_32x32x16_bf16 v[60:75], v[104:107], v[116:119], v[60:75]
    v_mfma_f32_32x32x16_bf16 v[76:91], v[104:107], v[120:123], v[76:91]
    v_lshlrev_b32 v4, 4, v1
    s_lshl_b32 s8, s6, 12
    s_lshl_b32 s9, s96, 6
    s_add_u32 s9, s9, s93
    s_lshl_b32 s9, s9, 6
    s_add_u32 s8, s8, s9
    s_lshl_b32 s9, s97, 18
    s_add_u32 s8, s8, s9
    v_add_u32 v4, s8, v4
    s_mul_i32 s8, s97, 2048
    s_sub_u32 s9, 2048, s8
    v_add_u32 v6, s9, v4
    v_add_u32 v4, s8, v4
    v_cvt_pk_bf16_f32 v124, v28, v29
    v_cvt_pk_bf16_f32 v125, v30, v31
    v_cvt_pk_bf16_f32 v126, v32, v33
    v_cvt_pk_bf16_f32 v127, v34, v35
    v_cvt_pk_bf16_f32 v128, v36, v37
    v_cvt_pk_bf16_f32 v129, v38, v39
    v_cvt_pk_bf16_f32 v130, v40, v41
    v_cvt_pk_bf16_f32 v131, v42, v43
    buffer_store_dwordx4 v[124:127], v4, s[44:47], 0 offen offset:0
    buffer_store_dwordx4 v[128:131], v4, s[44:47], 0 offen offset:1024
    s_nop 0
    v_cvt_pk_bf16_f32 v124, v60, v61
    v_cvt_pk_bf16_f32 v125, v62, v63
    v_cvt_pk_bf16_f32 v126, v64, v65
    v_cvt_pk_bf16_f32 v127, v66, v67
    v_cvt_pk_bf16_f32 v128, v68, v69
    v_cvt_pk_bf16_f32 v129, v70, v71
    v_cvt_pk_bf16_f32 v130, v72, v73
    v_cvt_pk_bf16_f32 v131, v74, v75
    buffer_store_dwordx4 v[124:127], v6, s[44:47], 0 offen offset:0
    buffer_store_dwordx4 v[128:131], v6, s[44:47], 0 offen offset:1024
    v_add_u32 v4, 131072, v4
    v_add_u32 v6, 131072, v6
    v_cvt_pk_bf16_f32 v124, v44, v45
    v_cvt_pk_bf16_f32 v125, v46, v47
    v_cvt_pk_bf16_f32 v126, v48, v49
    v_cvt_pk_bf16_f32 v127, v50, v51
    v_cvt_pk_bf16_f32 v128, v52, v53
    v_cvt_pk_bf16_f32 v129, v54, v55
    v_cvt_pk_bf16_f32 v130, v56, v57
    v_cvt_pk_bf16_f32 v131, v58, v59
    buffer_store_dwordx4 v[124:127], v4, s[44:47], 0 offen offset:0
    buffer_store_dwordx4 v[128:131], v4, s[44:47], 0 offen offset:1024
    s_nop 0
    v_cvt_pk_bf16_f32 v124, v76, v77
    v_cvt_pk_bf16_f32 v125, v78, v79
    v_cvt_pk_bf16_f32 v126, v80, v81
    v_cvt_pk_bf16_f32 v127, v82, v83
    v_cvt_pk_bf16_f32 v128, v84, v85
    v_cvt_pk_bf16_f32 v129, v86, v87
    v_cvt_pk_bf16_f32 v130, v88, v89
    v_cvt_pk_bf16_f32 v131, v90, v91
    buffer_store_dwordx4 v[124:127], v6, s[44:47], 0 offen offset:0
    buffer_store_dwordx4 v[128:131], v6, s[44:47], 0 offen offset:1024
    s_nop 0
k1_qkv_kernel_end:
    s_endpgm
.section .rodata,"a"
.p2align 6
.amdhsa_kernel k1_qkv_kernel
  .amdhsa_next_free_vgpr 228
  .amdhsa_next_free_sgpr 102
  .amdhsa_accum_offset 228
  .amdhsa_group_segment_fixed_size 0
  .amdhsa_kernarg_size 104
  .amdhsa_user_sgpr_count 2
  .amdhsa_user_sgpr_kernarg_segment_ptr 1
  .amdhsa_system_sgpr_workgroup_id_x 1
.end_amdhsa_kernel
.text
.globl k2_attn_kernel
.p2align 8
.type k2_attn_kernel,@function
k2_attn_kernel:
    s_cmp_ge_u32 s2, 256
    s_cbranch_scc1 k2_attn_kernel_end
    s_and_b32 s5, s2, 31
    s_lshr_b32 s6, s2, 5
    s_load_dwordx2 s[12:13], s[0:1], 96
    s_load_dwordx2 s[16:17], s[0:1], 96
    s_load_dwordx2 s[20:21], s[0:1], 96
    s_load_dwordx2 s[24:25], s[0:1], 96
    s_load_dwordx2 s[28:29], s[0:1], 40
    s_load_dwordx2 s[32:33], s[0:1], 56
    s_load_dwordx2 s[36:37], s[0:1], 64
    s_load_dwordx2 s[40:41], s[0:1], 72
    s_waitcnt lgkmcnt(0)
    s_and_b32 s13, s13, 0xffff
    s_mov_b32 s14, 16777216
    s_mov_b32 s15, 0x00020000
    s_add_u32 s16, s16, 16777216
    s_addc_u32 s17, s17, 0
    s_and_b32 s17, s17, 0xffff
    s_mov_b32 s18, 16777216
    s_mov_b32 s19, 0x00020000
    s_add_u32 s20, s20, 33554432
    s_addc_u32 s21, s21, 0
    s_and_b32 s21, s21, 0xffff
    s_mov_b32 s22, 16777216
    s_mov_b32 s23, 0x00020000
    s_add_u32 s24, s24, 50331648
    s_addc_u32 s25, s25, 0
    s_and_b32 s25, s25, 0xffff
    s_mov_b32 s26, 16777216
    s_mov_b32 s27, 0x00020000
    s_and_b32 s29, s29, 0xffff
    s_mov_b32 s30, 4194304
    s_mov_b32 s31, 0x00020000
    s_and_b32 s33, s33, 0xffff
    s_mov_b32 s34, 1835008
    s_mov_b32 s35, 0x00020000
    s_and_b32 s37, s37, 0xffff
    s_mov_b32 s38, 1835008
    s_mov_b32 s39, 0x00020000
    s_and_b32 s41, s41, 0xffff
    s_mov_b32 s42, 1835008
    s_mov_b32 s43, 0x00020000
    v_and_b32 v1, 63, v0
    v_lshrrev_b32 v4, 6, v0
    s_nop 0
    v_readfirstlane_b32 s3, v4
    v_and_b32 v2, 31, v0
    v_bfe_u32 v3, v0, 5, 1
    s_and_b32 s8, s3, 3
    s_lshr_b32 s9, s3, 2
    s_lshl_b32 s7, s3, 10
    v_lshlrev_b32 v4, 4, v1
    s_lshl_b32 s10, s5, 19
    s_add_u32 s10, s10, s7
    v_add_u32 v8, s10, v4
    v_mov_b32 v9, v8
    s_mov_b32 s69, 4096
    s_mov_b32 s60, 0
    s_mov_b32 s61, 0
    s_cmp_ge_u32 s3, 4
    s_cbranch_scc1 k2_attn_kernel_nodma0
    s_add_u32 m0, s7, 0
    s_add_u32 s4, s60, 0
    buffer_load_dwordx4 v8, s[16:19], s4 offen lds
    s_add_u32 m0, s7, 4096
    s_add_u32 s4, s60, 4096
    buffer_load_dwordx4 v8, s[16:19], s4 offen lds
    s_add_u32 m0, s7, 8192
    s_add_u32 s4, s60, 8192
    buffer_load_dwordx4 v8, s[16:19], s4 offen lds
    s_add_u32 m0, s7, 12288
    s_add_u32 s4, s60, 12288
    buffer_load_dwordx4 v8, s[16:19], s4 offen lds
    s_add_u32 m0, s7, 16384
    s_add_u32 s4, s60, 16384
    buffer_load_dwordx4 v8, s[16:19], s4 offen lds
    s_add_u32 m0, s7, 20480
    s_add_u32 s4, s60, 20480
    buffer_load_dwordx4 v8, s[16:19], s4 offen lds
    s_add_u32 m0, s7, 24576
    s_add_u32 s4, s60, 24576
    buffer_load_dwordx4 v8, s[16:19], s4 offen lds
    s_add_u32 m0, s7, 28672
    s_add_u32 s4, s60, 28672
    buffer_load_dwordx4 v8, s[16:19], s4 offen lds
k2_attn_kernel_nodma0:
    v_lshlrev_b32 v4, 4, v1
    s_lshl_b32 s10, s9, 14
    v_add_u32 v10, s10, v4
    s_lshl_b32 s10, s9, 12
    s_add_u32 s10, s10, 65536
    v_add_u32 v11, s10, v4
    v_mov_b32 v227, 0xf149f2ca
    v_mov_b32 v223, 0x41c00000
    s_mov_b32 s99, 0
    s_lshl_b32 s11, s6, 7
    s_lshl_b32 s10, s8, 5
    s_add_u32 s10, s10, s11
    s_lshl_b32 s10, s10, 8
    v_lshlrev_b32 v225, 4, v1
    s_lshl_b32 s11, s5, 19
    s_add_u32 s10, s10, s11
    v_add_u32 v225, s10, v225
    buffer_load_dwordx4 v[12:15], v225, s[12:15], 0 offen offset:0
    buffer_load_dwordx4 v[16:19], v225, s[12:15], 0 offen offset:1024
    buffer_load_dwordx4 v[20:23], v225, s[12:15], 0 offen offset:2048
    buffer_load_dwordx4 v[24:27], v225, s[12:15], 0 offen offset:3072
    buffer_load_dwordx4 v[28:31], v225, s[12:15], s69 offen offset:0
    buffer_load_dwordx4 v[32:35], v225, s[12:15], s69 offen offset:1024
    buffer_load_dwordx4 v[36:39], v225, s[12:15], s69 offen offset:2048
    buffer_load_dwordx4 v[40:43], v225, s[12:15], s69 offen offset:3072
    v_lshlrev_b32 v230, 4, v1
    s_mov_b32 s72, s28
    s_mov_b32 s73, s29
    s_mov_b32 s74, s30
    s_mov_b32 s75, s31
    s_mul_i32 s76, s2, 16384
    s_add_u32 s77, s76, 15360
    s_cmp_lg_u32 s3, 5
    s_cbranch_scc1 k2_attn_kernel_pfw_2
    s_mov_b32 s72, s32
    s_mov_b32 s73, s33
    s_mov_b32 s74, s34
    s_mov_b32 s75, s35
    s_mul_i32 s76, s2, 7168
    s_add_u32 s77, s76, 6144
k2_attn_kernel_pfw_2:
    s_cmp_lg_u32 s3, 6
    s_cbranch_scc1 k2_attn_kernel_pfw_3
    s_mov_b32 s72, s36
    s_mov_b32 s73, s37
    s_mov_b32 s74, s38
    s_mov_b32 s75, s39
    s_mul_i32 s76, s2, 7168
    s_add_u32 s77, s76, 6144
k2_attn_kernel_pfw_3:
    s_cmp_lg_u32 s3, 7
    s_cbranch_scc1 k2_attn_kernel_pfw_4
    s_mov_b32 s72, s40
    s_mov_b32 s73, s41
    s_mov_b32 s74, s42
    s_mov_b32 s75, s43
    s_mul_i32 s76, s2, 7168
    s_add_u32 s77, s76, 6144
k2_attn_kernel_pfw_4:
    s_mov_b32 s63, 0
    s_mov_b32 s68, 0
    s_cmp_ge_u32 s3, 4
    s_cbranch_scc1 k2_attn_kernel_blk1p
k2_attn_kernel_blk0:
    s_sub_u32 s10, 15, s6
    s_cmp_eq_u32 s63, 0
    s_cselect_b32 s62, s6, s10
    s_lshl_b32 s64, s62, 7
    v_mov_b32 v221, 0
    v_mov_b32 v222, 0
    s_lshl_b32 s10, s8, 5
    s_lshl_b32 s11, s9, 6
    s_sub_u32 s10, s10, s11
    v_add_u32 v226, s10, v2
    v_lshlrev_b32 v4, 2, v3
    v_sub_u32 v226, v226, v4
    s_cmp_eq_u32 s68, 1
    s_cbranch_scc1 k2_attn_kernel_pro1_0
k2_attn_kernel_pro0_0:
    s_waitcnt vmcnt(0) lgkmcnt(0)
    s_barrier
    s_cmp_eq_u32 s62, 0
    s_cbranch_scc1 k2_attn_kernel_pro10_0
    s_add_u32 s60, s60, 32768
    ds_read_b128 v[188:191], v10 offset:0
    ds_read_b128 v[192:195], v10 offset:1024
    ds_read_b128 v[196:199], v10 offset:2048
    ds_read_b128 v[200:203], v10 offset:3072
    ds_read_b128 v[204:207], v10 offset:4096
    ds_read_b128 v[208:211], v10 offset:5120
    ds_read_b128 v[212:215], v10 offset:6144
    v_mov_b32 v44, 0
    ds_read_b128 v[216:219], v10 offset:7168
    s_waitcnt lgkmcnt(7)
    v_mfma_f32_32x32x16_bf16 v[108:123], v[188:191], v[12:15], 0
    v_mov_b32 v45, 0
    s_add_u32 m0, s7, 32768
    s_add_u32 s4, s60, 0
    buffer_load_dwordx4 v8, s[16:19], s4 offen lds
    v_mov_b32 v46, 0
    v_mov_b32 v47, 0
    v_mov_b32 v48, 0
    ds_read_b128 v[188:191], v10 offset:8192
    s_waitcnt lgkmcnt(7)
    v_mfma_f32_32x32x16_bf16 v[108:123], v[192:195], v[16:19], v[108:123]
    s_add_u32 m0, s7, 36864
    s_add_u32 s4, s60, 4096
    buffer_load_dwordx4 v8, s[16:19], s4 offen lds
    v_mov_b32 v49, 0
    v_mov_b32 v50, 0
    v_mov_b32 v51, 0
    s_add_u32 m0, s7, 40960
    s_add_u32 s4, s60, 8192
    buffer_load_dwordx4 v8, s[16:19], s4 offen lds
    ds_read_b128 v[192:195], v10 offset:9216
    s_waitcnt lgkmcnt(7)
    v_mfma_f32_32x32x16_bf16 v[108:123], v[196:199], v[20:23], v[108:123]
    v_mov_b32 v52, 0
    v_mov_b32 v53, 0
    v_mov_b32 v54, 0
    s_add_u32 m0, s7, 45056
    s_add_u32 s4, s60, 12288
    buffer_load_dwordx4 v8, s[16:19], s4 offen lds
    v_mov_b32 v55, 0
    ds_read_b128 v[196:199], v10 offset:10240
    s_waitcnt lgkmcnt(7)
    v_mfma_f32_32x32x16_bf16 v[108:123], v[200:203], v[24:27], v[108:123]
    v_mov_b32 v56, 0
    v_mov_b32 v57, 0
    s_add_u32 m0, s7, 49152
    s_add_u32 s4, s60, 16384
    buffer_load_dwordx4 v8, s[16:19], s4 offen lds
    v_mov_b32 v58, 0
    v_mov_b32 v59, 0
    ds_read_b128 v[200:203], v10 offset:11264
    s_waitcnt lgkmcnt(7)
    v_mfma_f32_32x32x16_bf16 v[108:123], v[204:207], v[28:31], v[108:123]
    v_mov_b32 v60, 0
    s_add_u32 m0, s7, 53248
    s_add_u32 s4, s60, 20480
    buffer_load_dwordx4 v8, s[16:19], s4 offen lds
    v_mov_b32 v61, 0
    v_mov_b32 v62, 0
    v_mov_b32 v63, 0
    ds_read_b128 v[204:207], v10 offset:12288
    s_waitcnt lgkmcnt(7)
    v_mfma_f32_32x32x16_bf16 v[108:123], v[208:211], v[32:35], v[108:123]
    s_add_u32 m0, s7, 57344
    s_add_u32 s4, s60, 24576
    buffer_load_dwordx4 v8, s[16:19], s4 offen lds
    v_mov_b32 v64, 0
    v_mov_b32 v65, 0
    v_mov_b32 v66, 0
    s_add_u32 m0, s7, 61440
    s_add_u32 s4, s60, 28672
    buffer_load_dwordx4 v8, s[16:19], s4 offen lds
    ds_read_b128 v[208:211], v10 offset:13312
    s_waitcnt lgkmcnt(7)
    v_mfma_f32_32x32x16_bf16 v[108:123], v[212:215], v[36:39], v[108:123]
    v_mov_b32 v67, 0
    v_mov_b32 v68, 0
    v_mov_b32 v69, 0
    s_add_u32 m0, s7, 65536
    s_add_u32 s4, s61, 0
    buffer_load_dwordx4 v9, s[20:23], s4 offen lds
    v_mov_b32 v70, 0
    ds_read_b128 v[212:215], v10 offset:14336
    s_waitcnt lgkmcnt(7)
    v_mfma_f32_32x32x16_bf16 v[108:123], v[216:219], v[40:43], v[108:123]
    v_mov_b32 v71, 0
    v_mov_b32 v72, 0
    s_add_u32 m0, s7, 69632
    s_add_u32 s4, s61, 4096
    buffer_load_dwordx4 v9, s[20:23], s4 offen lds
    v_mov_b32 v73, 0
    v_mov_b32 v74, 0
    ds_read_b128 v[216:219], v10 offset:15360
    s_waitcnt lgkmcnt(7)
    v_mfma_f32_32x32x16_bf16 v[124:139], v[188:191], v[12:15], 0
    v_mov_b32 v75, 0
    s_add_u32 m0, s7, 73728
    s_add_u32 s4, s61, 131072
    buffer_load_dwordx4 v9, s[20:23], s4 offen lds
    v_mov_b32 v76, 0
    v_mov_b32 v77, 0
    v_mov_b32 v78, 0
    s_waitcnt lgkmcnt(6)
    v_mfma_f32_32x32x16_bf16 v[124:139], v[192:195], v[16:19], v[124:139]
    s_add_u32 m0, s7, 77824
    s_add_u32 s4, s61, 135168
    buffer_load_dwordx4 v9, s[20:23], s4 offen lds
    v_mov_b32 v79, 0
    v_mov_b32 v80, 0
    v_mov_b32 v81, 0
    s_add_u32 m0, s7, 81920
    s_add_u32 s4, s61, 262144
    buffer_load_dwordx4 v9, s[20:23], s4 offen lds
    s_waitcnt lgkmcnt(5)
    v_mfma_f32_32x32x16_bf16 v[124:139], v[196:199], v[20:23], v[124:139]
    v_mov_b32 v82, 0
    v_mov_b32 v83, 0
    v_mov_b32 v84, 0
    s_add_u32 m0, s7, 86016
    s_add_u32 s4, s61, 266240
    buffer_load_dwordx4 v9, s[20:23], s4 offen lds
    v_mov_b32 v85, 0
    s_waitcnt lgkmcnt(4)
    v_mfma_f32_32x32x16_bf16 v[124:139], v[200:203], v[24:27], v[124:139]
    v_mov_b32 v86, 0
    v_mov_b32 v87, 0
    s_add_u32 m0, s7, 90112
    s_add_u32 s4, s61, 393216
    buffer_load_dwordx4 v9, s[20:23], s4 offen lds
    v_mov_b32 v88, 0
    v_mov_b32 v89, 0
    s_waitcnt lgkmcnt(3)
    v_mfma_f32_32x32x16_bf16 v[124:139], v[204:207], v[28:31], v[124:139]
    v_mov_b32 v90, 0
    s_add_u32 m0, s7, 94208
    s_add_u32 s4, s61, 397312
    buffer_load_dwordx4 v9, s[20:23], s4 offen lds
    v_mov_b32 v91, 0
    v_mov_b32 v92, 0
    v_mov_b32 v93, 0
    s_waitcnt lgkmcnt(2)
    v_mfma_f32_32x32x16_bf16 v[124:139], v[208:211], v[32:35], v[124:139]
    v_mov_b32 v94, 0
    v_mov_b32 v95, 0
    v_mov_b32 v96, 0
    v_mov_b32 v97, 0
    v_mov_b32 v98, 0
    s_waitcnt lgkmcnt(1)
    v_mfma_f32_32x32x16_bf16 v[124:139], v[212:215], v[36:39], v[124:139]
    v_mov_b32 v99, 0
    v_mov_b32 v100, 0
    v_mov_b32 v101, 0
    v_mov_b32 v102, 0
    v_mov_b32 v103, 0
    s_waitcnt lgkmcnt(0)
    v_mfma_f32_32x32x16_bf16 v[124:139], v[216:219], v[40:43], v[124:139]
    v_mov_b32 v104, 0
    v_mov_b32 v105, 0
    v_mov_b32 v106, 0
    v_mov_b32 v107, 0
    v_max3_f32 v4, v108, v109, v110
    v_max3_f32 v5, v111, v112, v113
    v_max3_f32 v4, v4, v114, v115
    v_max3_f32 v5, v5, v116, v117
    v_max3_f32 v4, v4, v118, v119
    v_max3_f32 v5, v5, v120, v121
    v_max3_f32 v4, v4, v122, v123
    s_nop 0
    v_max3_f32 v5, v5, v124, v125
    v_max3_f32 v4, v4, v126, v127
    v_max3_f32 v5, v5, v128, v129
    v_max3_f32 v4, v4, v130, v131
    v_max3_f32 v5, v5, v132, v133
    v_max3_f32 v4, v4, v134, v135
    v_max3_f32 v5, v5, v136, v137
    v_max3_f32 v4, v4, v138, v139
    v_max_f32 v4, v4, v5
    v_mov_b32 v5, v4
    s_nop 1
    v_permlane32_swap_b32 v4, v5
    v_max_f32 v228, v4, v5
    v_mov_b32 v220, v228
    v_sub_f32 v172, 0, v228
    v_sub_f32 v173, 0, v228
    v_sub_f32 v174, 0, v228
    v_sub_f32 v175, 0, v228
    v_sub_f32 v176, 0, v228
    v_sub_f32 v177, 0, v228
    v_sub_f32 v178, 0, v228
    v_sub_f32 v179, 0, v228
    v_sub_f32 v180, 0, v228
    v_sub_f32 v181, 0, v228
    v_sub_f32 v182, 0, v228
    v_sub_f32 v183, 0, v228
    v_sub_f32 v184, 0, v228
    v_sub_f32 v185, 0, v228
    v_sub_f32 v186, 0, v228
    v_sub_f32 v187, 0, v228
    v_sub_f32 v108, v108, v228
    v_sub_f32 v109, v109, v228
    v_sub_f32 v110, v110, v228
    v_sub_f32 v111, v111, v228
    v_sub_f32 v112, v112, v228
    v_sub_f32 v113, v113, v228
    v_sub_f32 v114, v114, v228
    v_sub_f32 v115, v115, v228
    v_sub_f32 v116, v116, v228
    v_sub_f32 v117, v117, v228
    v_sub_f32 v118, v118, v228
    v_sub_f32 v119, v119, v228
    v_sub_f32 v120, v120, v228
    v_sub_f32 v121, v121, v228
    v_sub_f32 v122, v122, v228
    v_sub_f32 v123, v123, v228
    v_sub_f32 v124, v124, v228
    v_sub_f32 v125, v125, v228
    v_sub_f32 v126, v126, v228
    v_sub_f32 v127, v127, v228
    v_sub_f32 v128, v128, v228
    v_sub_f32 v129, v129, v228
    v_sub_f32 v130, v130, v228
    v_sub_f32 v131, v131, v228
    v_sub_f32 v132, v132, v228
    v_sub_f32 v133, v133, v228
    v_sub_f32 v134, v134, v228
    v_sub_f32 v135, v135, v228
    v_sub_f32 v136, v136, v228
    v_sub_f32 v137, v137, v228
    v_sub_f32 v138, v138, v228
    v_sub_f32 v139, v139, v228
    s_nop 0
    s_branch k2_attn_kernel_loop0_0
k2_attn_kernel_pro10_0:
    s_mov_b32 s60, 0
    ds_read_b128 v[188:191], v10 offset:0
    ds_read_b128 v[192:195], v10 offset:1024
    ds_read_b128 v[196:199], v10 offset:2048
    ds_read_b128 v[200:203], v10 offset:3072
    ds_read_b128 v[204:207], v10 offset:4096
    ds_read_b128 v[208:211], v10 offset:5120
    ds_read_b128 v[212:215], v10 offset:6144
    v_mov_b32 v44, 0
    ds_read_b128 v[216:219], v10 offset:7168
    s_waitcnt lgkmcnt(7)
    v_mfma_f32_32x32x16_bf16 v[108:123], v[188:191], v[12:15], 0
    v_mov_b32 v45, 0
    s_add_u32 m0, s7, 65536
    s_add_u32 s4, s61, 0
    buffer_load_dwordx4 v9, s[20:23], s4 offen lds
    v_mov_b32 v46, 0
    v_mov_b32 v47, 0
    v_mov_b32 v48, 0
    ds_read_b128 v[188:191], v10 offset:8192
    s_waitcnt lgkmcnt(7)
    v_mfma_f32_32x32x16_bf16 v[108:123], v[192:195], v[16:19], v[108:123]
    s_add_u32 m0, s7, 69632
    s_add_u32 s4, s61, 4096
    buffer_load_dwordx4 v9, s[20:23], s4 offen lds
    v_mov_b32 v49, 0
    v_mov_b32 v50, 0
    v_mov_b32 v51, 0
    s_add_u32 m0, s7, 73728
    s_add_u32 s4, s61, 131072
    buffer_load_dwordx4 v9, s[20:23], s4 offen lds
    ds_read_b128 v[192:195], v10 offset:9216
    s_waitcnt lgkmcnt(7)
    v_mfma_f32_32x32x16_bf16 v[108:123], v[196:199], v[20:23], v[108:123]
    v_mov_b32 v52, 0
    v_mov_b32 v53, 0
    v_mov_b32 v54, 0
    s_add_u32 m0, s7, 77824
    s_add_u32 s4, s61, 135168
    buffer_load_dwordx4 v9, s[20:23], s4 offen lds
    v_mov_b32 v55, 0
    ds_read_b128 v[196:199], v10 offset:10240
    s_waitcnt lgkmcnt(7)
    v_mfma_f32_32x32x16_bf16 v[108:123], v[200:203], v[24:27], v[108:123]
    v_mov_b32 v56, 0
    v_mov_b32 v57, 0
    s_add_u32 m0, s7, 81920
    s_add_u32 s4, s61, 262144
    buffer_load_dwordx4 v9, s[20:23], s4 offen lds
    v_mov_b32 v58, 0
    v_mov_b32 v59, 0
    ds_read_b128 v[200:203], v10 offset:11264
    s_waitcnt lgkmcnt(7)
    v_mfma_f32_32x32x16_bf16 v[108:123], v[204:207], v[28:31], v[108:123]
    v_mov_b32 v60, 0
    s_add_u32 m0, s7, 86016
    s_add_u32 s4, s61, 266240
    buffer_load_dwordx4 v9, s[20:23], s4 offen lds
    v_mov_b32 v61, 0
    v_mov_b32 v62, 0
    v_mov_b32 v63, 0
    ds_read_b128 v[204:207], v10 offset:12288
    s_waitcnt lgkmcnt(7)
    v_mfma_f32_32x32x16_bf16 v[108:123], v[208:211], v[32:35], v[108:123]
    s_add_u32 m0, s7, 90112
    s_add_u32 s4, s61, 393216
    buffer_load_dwordx4 v9, s[20:23], s4 offen lds
    v_mov_b32 v64, 0
    v_mov_b32 v65, 0
    v_mov_b32 v66, 0
    s_add_u32 m0, s7, 94208
    s_add_u32 s4, s61, 397312
    buffer_load_dwordx4 v9, s[20:23], s4 offen lds
    ds_read_b128 v[208:211], v10 offset:13312
    s_waitcnt lgkmcnt(7)
    v_mfma_f32_32x32x16_bf16 v[108:123], v[212:215], v[36:39], v[108:123]
    v_mov_b32 v67, 0
    v_mov_b32 v68, 0
    v_mov_b32 v69, 0
    s_add_u32 m0, s7, 32768
    s_add_u32 s4, s60, 0
    buffer_load_dwordx4 v8, s[16:19], s4 offen lds
    v_mov_b32 v70, 0
    ds_read_b128 v[212:215], v10 offset:14336
    s_waitcnt lgkmcnt(7)
    v_mfma_f32_32x32x16_bf16 v[108:123], v[216:219], v[40:43], v[108:123]
    v_mov_b32 v71, 0
    v_mov_b32 v72, 0
    s_add_u32 m0, s7, 36864
    s_add_u32 s4, s60, 4096
    buffer_load_dwordx4 v8, s[16:19], s4 offen lds
    v_mov_b32 v73, 0
    v_mov_b32 v74, 0
    ds_read_b128 v[216:219], v10 offset:15360
    s_waitcnt lgkmcnt(7)
    v_mfma_f32_32x32x16_bf16 v[124:139], v[188:191], v[12:15], 0
    v_mov_b32 v75, 0
    s_add_u32 m0, s7, 40960
    s_add_u32 s4, s60, 8192
    buffer_load_dwordx4 v8, s[16:19], s4 offen lds
    v_mov_b32 v76, 0
    v_mov_b32 v77, 0
    v_mov_b32 v78, 0
    s_waitcnt lgkmcnt(6)
    v_mfma_f32_32x32x16_bf16 v[124:139], v[192:195], v[16:19], v[124:139]
    s_add_u32 m0, s7, 45056
    s_add_u32 s4, s60, 12288
    buffer_load_dwordx4 v8, s[16:19], s4 offen lds
    v_mov_b32 v79, 0
    v_mov_b32 v80, 0
    v_mov_b32 v81, 0
    s_add_u32 m0, s7, 49152
    s_add_u32 s4, s60, 16384
    buffer_load_dwordx4 v8, s[16:19], s4 offen lds
    s_waitcnt lgkmcnt(5)
    v_mfma_f32_32x32x16_bf16 v[124:139], v[196:199], v[20:23], v[124:139]
    v_mov_b32 v82, 0
    v_mov_b32 v83, 0
    v_mov_b32 v84, 0
    s_add_u32 m0, s7, 53248
    s_add_u32 s4, s60, 20480
    buffer_load_dwordx4 v8, s[16:19], s4 offen lds
    v_mov_b32 v85, 0
    s_waitcnt lgkmcnt(4)
    v_mfma_f32_32x32x16_bf16 v[124:139], v[200:203], v[24:27], v[124:139]
    v_mov_b32 v86, 0
    v_mov_b32 v87, 0
    s_add_u32 m0, s7, 57344
    s_add_u32 s4, s60, 24576
    buffer_load_dwordx4 v8, s[16:19], s4 offen lds
    v_mov_b32 v88, 0
    v_mov_b32 v89, 0
    s_waitcnt lgkmcnt(3)
    v_mfma_f32_32x32x16_bf16 v[124:139], v[204:207], v[28:31], v[124:139]
    v_mov_b32 v90, 0
    s_add_u32 m0, s7, 61440
    s_add_u32 s4, s60, 28672
    buffer_load_dwordx4 v8, s[16:19], s4 offen lds
    v_mov_b32 v91, 0
    v_mov_b32 v92, 0
    v_mov_b32 v93, 0
    s_waitcnt lgkmcnt(2)
    v_mfma_f32_32x32x16_bf16 v[124:139], v[208:211], v[32:35], v[124:139]
    v_mov_b32 v94, 0
    v_mov_b32 v95, 0
    v_mov_b32 v96, 0
    v_mov_b32 v97, 0
    v_mov_b32 v98, 0
    s_waitcnt lgkmcnt(1)
    v_mfma_f32_32x32x16_bf16 v[124:139], v[212:215], v[36:39], v[124:139]
    v_mov_b32 v99, 0
    v_mov_b32 v100, 0
    v_mov_b32 v101, 0
    v_mov_b32 v102, 0
    v_mov_b32 v103, 0
    s_waitcnt lgkmcnt(0)
    v_mfma_f32_32x32x16_bf16 v[124:139], v[216:219], v[40:43], v[124:139]
    v_mov_b32 v104, 0
    v_mov_b32 v105, 0
    v_mov_b32 v106, 0
    v_mov_b32 v107, 0
    v_cmp_ge_i32 vcc, v226, 0
    s_nop 1
    v_cndmask_b32 v108, v227, v108, vcc
    v_cmp_ge_i32 vcc, v226, 1
    s_nop 1
    v_cndmask_b32 v109, v227, v109, vcc
    v_cmp_ge_i32 vcc, v226, 2
    s_nop 1
    v_cndmask_b32 v110, v227, v110, vcc
    v_cmp_ge_i32 vcc, v226, 3
    s_nop 1
    v_cndmask_b32 v111, v227, v111, vcc
    v_cmp_ge_i32 vcc, v226, 8
    s_nop 1
    v_cndmask_b32 v112, v227, v112, vcc
    v_cmp_ge_i32 vcc, v226, 9
    s_nop 1
    v_cndmask_b32 v113, v227, v113, vcc
    v_cmp_ge_i32 vcc, v226, 10
    s_nop 1
    v_cndmask_b32 v114, v227, v114, vcc
    v_cmp_ge_i32 vcc, v226, 11
    s_nop 1
    v_cndmask_b32 v115, v227, v115, vcc
    v_cmp_ge_i32 vcc, v226, 16
    s_nop 1
    v_cndmask_b32 v116, v227, v116, vcc
    v_cmp_ge_i32 vcc, v226, 17
    s_nop 1
    v_cndmask_b32 v117, v227, v117, vcc
    v_cmp_ge_i32 vcc, v226, 18
    s_nop 1
    v_cndmask_b32 v118, v227, v118, vcc
    v_cmp_ge_i32 vcc, v226, 19
    s_nop 1
    v_cndmask_b32 v119, v227, v119, vcc
    v_cmp_ge_i32 vcc, v226, 24
    s_nop 1
    v_cndmask_b32 v120, v227, v120, vcc
    v_cmp_ge_i32 vcc, v226, 25
    s_nop 1
    v_cndmask_b32 v121, v227, v121, vcc
    v_cmp_ge_i32 vcc, v226, 26
    s_nop 1
    v_cndmask_b32 v122, v227, v122, vcc
    v_cmp_ge_i32 vcc, v226, 27
    s_nop 1
    v_cndmask_b32 v123, v227, v123, vcc
    v_cmp_ge_i32 vcc, v226, 32
    s_nop 1
    v_cndmask_b32 v124, v227, v124, vcc
    v_cmp_ge_i32 vcc, v226, 33
    s_nop 1
    v_cndmask_b32 v125, v227, v125, vcc
    v_cmp_ge_i32 vcc, v226, 34
    s_nop 1
    v_cndmask_b32 v126, v227, v126, vcc
    v_cmp_ge_i32 vcc, v226, 35
    s_nop 1
    v_cndmask_b32 v127, v227, v127, vcc
    v_cmp_ge_i32 vcc, v226, 40
    s_nop 1
    v_cndmask_b32 v128, v227, v128, vcc
    v_cmp_ge_i32 vcc, v226, 41
    s_nop 1
    v_cndmask_b32 v129, v227, v129, vcc
    v_cmp_ge_i32 vcc, v226, 42
    s_nop 1
    v_cndmask_b32 v130, v227, v130, vcc
    v_cmp_ge_i32 vcc, v226, 43
    s_nop 1
    v_cndmask_b32 v131, v227, v131, vcc
    v_cmp_ge_i32 vcc, v226, 48
    s_nop 1
    v_cndmask_b32 v132, v227, v132, vcc
    v_cmp_ge_i32 vcc, v226, 49
    s_nop 1
    v_cndmask_b32 v133, v227, v133, vcc
    v_cmp_ge_i32 vcc, v226, 50
    s_nop 1
    v_cndmask_b32 v134, v227, v134, vcc
    v_cmp_ge_i32 vcc, v226, 51
    s_nop 1
    v_cndmask_b32 v135, v227, v135, vcc
    v_cmp_ge_i32 vcc, v226, 56
    s_nop 1
    v_cndmask_b32 v136, v227, v136, vcc
    v_cmp_ge_i32 vcc, v226, 57
    s_nop 1
    v_cndmask_b32 v137, v227, v137, vcc
    v_cmp_ge_i32 vcc, v226, 58
    s_nop 1
    v_cndmask_b32 v138, v227, v138, vcc
    v_cmp_ge_i32 vcc, v226, 59
    s_nop 1
    v_cndmask_b32 v139, v227, v139, vcc
    v_max3_f32 v4, v108, v109, v110
    v_max3_f32 v5, v111, v112, v113
    v_max3_f32 v4, v4, v114, v115
    v_max3_f32 v5, v5, v116, v117
    v_max3_f32 v4, v4, v118, v119
    v_max3_f32 v5, v5, v120, v121
    v_max3_f32 v4, v4, v122, v123
    v_max3_f32 v5, v5, v124, v125
    v_max3_f32 v4, v4, v126, v127
    v_max3_f32 v5, v5, v128, v129
    v_max3_f32 v4, v4, v130, v131
    v_max3_f32 v5, v5, v132, v133
    v_max3_f32 v4, v4, v134, v135
    v_max3_f32 v5, v5, v136, v137
    v_max3_f32 v4, v4, v138, v139
    v_max_f32 v4, v4, v5
    v_mov_b32 v5, v4
    s_nop 1
    v_permlane32_swap_b32 v4, v5
    v_max_f32 v228, v4, v5
    v_mov_b32 v220, v228
    v_sub_f32 v172, 0, v228
    v_sub_f32 v173, 0, v228
    v_sub_f32 v174, 0, v228
    v_sub_f32 v175, 0, v228
    v_sub_f32 v176, 0, v228
    v_sub_f32 v177, 0, v228
    v_sub_f32 v178, 0, v228
    v_sub_f32 v179, 0, v228
    v_sub_f32 v180, 0, v228
    v_sub_f32 v181, 0, v228
    v_sub_f32 v182, 0, v228
    v_sub_f32 v183, 0, v228
    v_sub_f32 v184, 0, v228
    v_sub_f32 v185, 0, v228
    v_sub_f32 v186, 0, v228
    v_sub_f32 v187, 0, v228
    v_sub_f32 v108, v108, v228
    v_sub_f32 v109, v109, v228
    v_sub_f32 v110, v110, v228
    v_sub_f32 v111, v111, v228
    v_sub_f32 v112, v112, v228
    v_sub_f32 v113, v113, v228
    v_sub_f32 v114, v114, v228
    v_sub_f32 v115, v115, v228
    v_sub_f32 v116, v116, v228
    v_sub_f32 v117, v117, v228
    v_sub_f32 v118, v118, v228
    v_sub_f32 v119, v119, v228
    v_sub_f32 v120, v120, v228
    v_sub_f32 v121, v121, v228
    v_sub_f32 v122, v122, v228
    v_sub_f32 v123, v123, v228
    v_sub_f32 v124, v124, v228
    v_sub_f32 v125, v125, v228
    v_sub_f32 v126, v126, v228
    v_sub_f32 v127, v127, v228
    v_sub_f32 v128, v128, v228
    v_sub_f32 v129, v129, v228
    v_sub_f32 v130, v130, v228
    v_sub_f32 v131, v131, v228
    v_sub_f32 v132, v132, v228
    v_sub_f32 v133, v133, v228
    v_sub_f32 v134, v134, v228
    v_sub_f32 v135, v135, v228
    v_sub_f32 v136, v136, v228
    v_sub_f32 v137, v137, v228
    v_sub_f32 v138, v138, v228
    v_sub_f32 v139, v139, v228
    s_nop 0
    s_branch k2_attn_kernel_epi0_0
k2_attn_kernel_pro1_0:
    s_waitcnt vmcnt(0) lgkmcnt(0)
    s_barrier
    s_cmp_eq_u32 s62, 0
    s_cbranch_scc1 k2_attn_kernel_pro11_0
    s_add_u32 s60, s60, 32768
    ds_read_b128 v[188:191], v10 offset:32768
    ds_read_b128 v[192:195], v10 offset:33792
    ds_read_b128 v[196:199], v10 offset:34816
    ds_read_b128 v[200:203], v10 offset:35840
    ds_read_b128 v[204:207], v10 offset:36864
    ds_read_b128 v[208:211], v10 offset:37888
    ds_read_b128 v[212:215], v10 offset:38912
    v_mov_b32 v44, 0
    ds_read_b128 v[216:219], v10 offset:39936
    s_waitcnt lgkmcnt(7)
    v_mfma_f32_32x32x16_bf16 v[140:155], v[188:191], v[12:15], 0
    v_mov_b32 v45, 0
    s_add_u32 m0, s7, 0
    s_add_u32 s4, s60, 0
    buffer_load_dwordx4 v8, s[16:19], s4 offen lds
    v_mov_b32 v46, 0
    v_mov_b32 v47, 0
    v_mov_b32 v48, 0
    ds_read_b128 v[188:191], v10 offset:40960
    s_waitcnt lgkmcnt(7)
    v_mfma_f32_32x32x16_bf16 v[140:155], v[192:195], v[16:19], v[140:155]
    s_add_u32 m0, s7, 4096
    s_add_u32 s4, s60, 4096
    buffer_load_dwordx4 v8, s[16:19], s4 offen lds
    v_mov_b32 v49, 0
    v_mov_b32 v50, 0
    v_mov_b32 v51, 0
    s_add_u32 m0, s7, 8192
    s_add_u32 s4, s60, 8192
    buffer_load_dwordx4 v8, s[16:19], s4 offen lds
    ds_read_b128 v[192:195], v10 offset:41984
    s_waitcnt lgkmcnt(7)
    v_mfma_f32_32x32x16_bf16 v[140:155], v[196:199], v[20:23], v[140:155]
    v_mov_b32 v52, 0
    v_mov_b32 v53, 0
    v_mov_b32 v54, 0
    s_add_u32 m0, s7, 12288
    s_add_u32 s4, s60, 12288
    buffer_load_dwordx4 v8, s[16:19], s4 offen lds
    v_mov_b32 v55, 0
    ds_read_b128 v[196:199], v10 offset:43008
    s_waitcnt lgkmcnt(7)
    v_mfma_f32_32x32x16_bf16 v[140:155], v[200:203], v[24:27], v[140:155]
    v_mov_b32 v56, 0
    v_mov_b32 v57, 0
    s_add_u32 m0, s7, 16384
    s_add_u32 s4, s60, 16384
    buffer_load_dwordx4 v8, s[16:19], s4 offen lds
    v_mov_b32 v58, 0
    v_mov_b32 v59, 0
    ds_read_b128 v[200:203], v10 offset:44032
    s_waitcnt lgkmcnt(7)
    v_mfma_f32_32x32x16_bf16 v[140:155], v[204:207], v[28:31], v[140:155]
    v_mov_b32 v60, 0
    s_add_u32 m0, s7, 20480
    s_add_u32 s4, s60, 20480
    buffer_load_dwordx4 v8, s[16:19], s4 offen lds
    v_mov_b32 v61, 0
    v_mov_b32 v62, 0
    v_mov_b32 v63, 0
    ds_read_b128 v[204:207], v10 offset:45056
    s_waitcnt lgkmcnt(7)
    v_mfma_f32_32x32x16_bf16 v[140:155], v[208:211], v[32:35], v[140:155]
    s_add_u32 m0, s7, 24576
    s_add_u32 s4, s60, 24576
    buffer_load_dwordx4 v8, s[16:19], s4 offen lds
    v_mov_b32 v64, 0
    v_mov_b32 v65, 0
    v_mov_b32 v66, 0
    s_add_u32 m0, s7, 28672
    s_add_u32 s4, s60, 28672
    buffer_load_dwordx4 v8, s[16:19], s4 offen lds
    ds_read_b128 v[208:211], v10 offset:46080
    s_waitcnt lgkmcnt(7)
    v_mfma_f32_32x32x16_bf16 v[140:155], v[212:215], v[36:39], v[140:155]
    v_mov_b32 v67, 0
    v_mov_b32 v68, 0
    v_mov_b32 v69, 0
    s_add_u32 m0, s7, 98304
    s_add_u32 s4, s61, 0
    buffer_load_dwordx4 v9, s[20:23], s4 offen lds
    v_mov_b32 v70, 0
    ds_read_b128 v[212:215], v10 offset:47104
    s_waitcnt lgkmcnt(7)
    v_mfma_f32_32x32x16_bf16 v[140:155], v[216:219], v[40:43], v[140:155]
    v_mov_b32 v71, 0
    v_mov_b32 v72, 0
    s_add_u32 m0, s7, 102400
    s_add_u32 s4, s61, 4096
    buffer_load_dwordx4 v9, s[20:23], s4 offen lds
    v_mov_b32 v73, 0
    v_mov_b32 v74, 0
    ds_read_b128 v[216:219], v10 offset:48128
    s_waitcnt lgkmcnt(7)
    v_mfma_f32_32x32x16_bf16 v[156:171], v[188:191], v[12:15], 0
    v_mov_b32 v75, 0
    s_add_u32 m0, s7, 106496
    s_add_u32 s4, s61, 131072
    buffer_load_dwordx4 v9, s[20:23], s4 offen lds
    v_mov_b32 v76, 0
    v_mov_b32 v77, 0
    v_mov_b32 v78, 0
    s_waitcnt lgkmcnt(6)
    v_mfma_f32_32x32x16_bf16 v[156:171], v[192:195], v[16:19], v[156:171]
    s_add_u32 m0, s7, 110592
    s_add_u32 s4, s61, 135168
    buffer_load_dwordx4 v9, s[20:23], s4 offen lds
    v_mov_b32 v79, 0
    v_mov_b32 v80, 0
    v_mov_b32 v81, 0
    s_add_u32 m0, s7, 114688
    s_add_u32 s4, s61, 262144
    buffer_load_dwordx4 v9, s[20:23], s4 offen lds
    s_waitcnt lgkmcnt(5)
    v_mfma_f32_32x32x16_bf16 v[156:171], v[196:199], v[20:23], v[156:171]
    v_mov_b32 v82, 0
    v_mov_b32 v83, 0
    v_mov_b32 v84, 0
    s_add_u32 m0, s7, 118784
    s_add_u32 s4, s61, 266240
    buffer_load_dwordx4 v9, s[20:23], s4 offen lds
    v_mov_b32 v85, 0
    s_waitcnt lgkmcnt(4)
    v_mfma_f32_32x32x16_bf16 v[156:171], v[200:203], v[24:27], v[156:171]
    v_mov_b32 v86, 0
    v_mov_b32 v87, 0
    s_add_u32 m0, s7, 122880
    s_add_u32 s4, s61, 393216
    buffer_load_dwordx4 v9, s[20:23], s4 offen lds
    v_mov_b32 v88, 0
    v_mov_b32 v89, 0
    s_waitcnt lgkmcnt(3)
    v_mfma_f32_32x32x16_bf16 v[156:171], v[204:207], v[28:31], v[156:171]
    v_mov_b32 v90, 0
    s_add_u32 m0, s7, 126976
    s_add_u32 s4, s61, 397312
    buffer_load_dwordx4 v9, s[20:23], s4 offen lds
    v_mov_b32 v91, 0
    v_mov_b32 v92, 0
    v_mov_b32 v93, 0
    s_waitcnt lgkmcnt(2)
    v_mfma_f32_32x32x16_bf16 v[156:171], v[208:211], v[32:35], v[156:171]
    v_mov_b32 v94, 0
    v_mov_b32 v95, 0
    v_mov_b32 v96, 0
    v_mov_b32 v97, 0
    v_mov_b32 v98, 0
    s_waitcnt lgkmcnt(1)
    v_mfma_f32_32x32x16_bf16 v[156:171], v[212:215], v[36:39], v[156:171]
    v_mov_b32 v99, 0
    v_mov_b32 v100, 0
    v_mov_b32 v101, 0
    v_mov_b32 v102, 0
    v_mov_b32 v103, 0
    s_waitcnt lgkmcnt(0)
    v_mfma_f32_32x32x16_bf16 v[156:171], v[216:219], v[40:43], v[156:171]
    v_mov_b32 v104, 0
    v_mov_b32 v105, 0
    v_mov_b32 v106, 0
    v_mov_b32 v107, 0
    v_max3_f32 v4, v140, v141, v142
    v_max3_f32 v5, v143, v144, v145
    v_max3_f32 v4, v4, v146, v147
    v_max3_f32 v5, v5, v148, v149
    v_max3_f32 v4, v4, v150, v151
    v_max3_f32 v5, v5, v152, v153
    v_max3_f32 v4, v4, v154, v155
    s_nop 0
    v_max3_f32 v5, v5, v156, v157
    v_max3_f32 v4, v4, v158, v159
    v_max3_f32 v5, v5, v160, v161
    v_max3_f32 v4, v4, v162, v163
    v_max3_f32 v5, v5, v164, v165
    v_max3_f32 v4, v4, v166, v167
    v_max3_f32 v5, v5, v168, v169
    v_max3_f32 v4, v4, v170, v171
    v_max_f32 v4, v4, v5
    v_mov_b32 v5, v4
    s_nop 1
    v_permlane32_swap_b32 v4, v5
    v_max_f32 v228, v4, v5
    v_mov_b32 v220, v228
    v_sub_f32 v172, 0, v228
    v_sub_f32 v173, 0, v228
    v_sub_f32 v174, 0, v228
    v_sub_f32 v175, 0, v228
    v_sub_f32 v176, 0, v228
    v_sub_f32 v177, 0, v228
    v_sub_f32 v178, 0, v228
    v_sub_f32 v179, 0, v228
    v_sub_f32 v180, 0, v228
    v_sub_f32 v181, 0, v228
    v_sub_f32 v182, 0, v228
    v_sub_f32 v183, 0, v228
    v_sub_f32 v184, 0, v228
    v_sub_f32 v185, 0, v228
    v_sub_f32 v186, 0, v228
    v_sub_f32 v187, 0, v228
    v_sub_f32 v140, v140, v228
    v_sub_f32 v141, v141, v228
    v_sub_f32 v142, v142, v228
    v_sub_f32 v143, v143, v228
    v_sub_f32 v144, v144, v228
    v_sub_f32 v145, v145, v228
    v_sub_f32 v146, v146, v228
    v_sub_f32 v147, v147, v228
    v_sub_f32 v148, v148, v228
    v_sub_f32 v149, v149, v228
    v_sub_f32 v150, v150, v228
    v_sub_f32 v151, v151, v228
    v_sub_f32 v152, v152, v228
    v_sub_f32 v153, v153, v228
    v_sub_f32 v154, v154, v228
    v_sub_f32 v155, v155, v228
    v_sub_f32 v156, v156, v228
    v_sub_f32 v157, v157, v228
    v_sub_f32 v158, v158, v228
    v_sub_f32 v159, v159, v228
    v_sub_f32 v160, v160, v228
    v_sub_f32 v161, v161, v228
    v_sub_f32 v162, v162, v228
    v_sub_f32 v163, v163, v228
    v_sub_f32 v164, v164, v228
    v_sub_f32 v165, v165, v228
    v_sub_f32 v166, v166, v228
    v_sub_f32 v167, v167, v228
    v_sub_f32 v168, v168, v228
    v_sub_f32 v169, v169, v228
    v_sub_f32 v170, v170, v228
    v_sub_f32 v171, v171, v228
    s_nop 0
    s_branch k2_attn_kernel_loop1_0
k2_attn_kernel_pro11_0:
    s_mov_b32 s60, 0
    ds_read_b128 v[188:191], v10 offset:32768
    ds_read_b128 v[192:195], v10 offset:33792
    ds_read_b128 v[196:199], v10 offset:34816
    ds_read_b128 v[200:203], v10 offset:35840
    ds_read_b128 v[204:207], v10 offset:36864
    ds_read_b128 v[208:211], v10 offset:37888
    ds_read_b128 v[212:215], v10 offset:38912
    v_mov_b32 v44, 0
    ds_read_b128 v[216:219], v10 offset:39936
    s_waitcnt lgkmcnt(7)
    v_mfma_f32_32x32x16_bf16 v[140:155], v[188:191], v[12:15], 0
    v_mov_b32 v45, 0
    s_add_u32 m0, s7, 98304
    s_add_u32 s4, s61, 0
    buffer_load_dwordx4 v9, s[20:23], s4 offen lds
    v_mov_b32 v46, 0
    v_mov_b32 v47, 0
    v_mov_b32 v48, 0
    ds_read_b128 v[188:191], v10 offset:40960
    s_waitcnt lgkmcnt(7)
    v_mfma_f32_32x32x16_bf16 v[140:155], v[192:195], v[16:19], v[140:155]
    s_add_u32 m0, s7, 102400
    s_add_u32 s4, s61, 4096
    buffer_load_dwordx4 v9, s[20:23], s4 offen lds
    v_mov_b32 v49, 0
    v_mov_b32 v50, 0
    v_mov_b32 v51, 0
    s_add_u32 m0, s7, 106496
    s_add_u32 s4, s61, 131072
    buffer_load_dwordx4 v9, s[20:23], s4 offen lds
    ds_read_b128 v[192:195], v10 offset:41984
    s_waitcnt lgkmcnt(7)
    v_mfma_f32_32x32x16_bf16 v[140:155], v[196:199], v[20:23], v[140:155]
    v_mov_b32 v52, 0
    v_mov_b32 v53, 0
    v_mov_b32 v54, 0
    s_add_u32 m0, s7, 110592
    s_add_u32 s4, s61, 135168
    buffer_load_dwordx4 v9, s[20:23], s4 offen lds
    v_mov_b32 v55, 0
    ds_read_b128 v[196:199], v10 offset:43008
    s_waitcnt lgkmcnt(7)
    v_mfma_f32_32x32x16_bf16 v[140:155], v[200:203], v[24:27], v[140:155]
    v_mov_b32 v56, 0
    v_mov_b32 v57, 0
    s_add_u32 m0, s7, 114688
    s_add_u32 s4, s61, 262144
    buffer_load_dwordx4 v9, s[20:23], s4 offen lds
    v_mov_b32 v58, 0
    v_mov_b32 v59, 0
    ds_read_b128 v[200:203], v10 offset:44032
    s_waitcnt lgkmcnt(7)
    v_mfma_f32_32x32x16_bf16 v[140:155], v[204:207], v[28:31], v[140:155]
    v_mov_b32 v60, 0
    s_add_u32 m0, s7, 118784
    s_add_u32 s4, s61, 266240
    buffer_load_dwordx4 v9, s[20:23], s4 offen lds
    v_mov_b32 v61, 0
    v_mov_b32 v62, 0
    v_mov_b32 v63, 0
    ds_read_b128 v[204:207], v10 offset:45056
    s_waitcnt lgkmcnt(7)
    v_mfma_f32_32x32x16_bf16 v[140:155], v[208:211], v[32:35], v[140:155]
    s_add_u32 m0, s7, 122880
    s_add_u32 s4, s61, 393216
    buffer_load_dwordx4 v9, s[20:23], s4 offen lds
    v_mov_b32 v64, 0
    v_mov_b32 v65, 0
    v_mov_b32 v66, 0
    s_add_u32 m0, s7, 126976
    s_add_u32 s4, s61, 397312
    buffer_load_dwordx4 v9, s[20:23], s4 offen lds
    ds_read_b128 v[208:211], v10 offset:46080
    s_waitcnt lgkmcnt(7)
    v_mfma_f32_32x32x16_bf16 v[140:155], v[212:215], v[36:39], v[140:155]
    v_mov_b32 v67, 0
    v_mov_b32 v68, 0
    v_mov_b32 v69, 0
    s_add_u32 m0, s7, 0
    s_add_u32 s4, s60, 0
    buffer_load_dwordx4 v8, s[16:19], s4 offen lds
    v_mov_b32 v70, 0
    ds_read_b128 v[212:215], v10 offset:47104
    s_waitcnt lgkmcnt(7)
    v_mfma_f32_32x32x16_bf16 v[140:155], v[216:219], v[40:43], v[140:155]
    v_mov_b32 v71, 0
    v_mov_b32 v72, 0
    s_add_u32 m0, s7, 4096
    s_add_u32 s4, s60, 4096
    buffer_load_dwordx4 v8, s[16:19], s4 offen lds
    v_mov_b32 v73, 0
    v_mov_b32 v74, 0
    ds_read_b128 v[216:219], v10 offset:48128
    s_waitcnt lgkmcnt(7)
    v_mfma_f32_32x32x16_bf16 v[156:171], v[188:191], v[12:15], 0
    v_mov_b32 v75, 0
    s_add_u32 m0, s7, 8192
    s_add_u32 s4, s60, 8192
    buffer_load_dwordx4 v8, s[16:19], s4 offen lds
    v_mov_b32 v76, 0
    v_mov_b32 v77, 0
    v_mov_b32 v78, 0
    s_waitcnt lgkmcnt(6)
    v_mfma_f32_32x32x16_bf16 v[156:171], v[192:195], v[16:19], v[156:171]
    s_add_u32 m0, s7, 12288
    s_add_u32 s4, s60, 12288
    buffer_load_dwordx4 v8, s[16:19], s4 offen lds
    v_mov_b32 v79, 0
    v_mov_b32 v80, 0
    v_mov_b32 v81, 0
    s_add_u32 m0, s7, 16384
    s_add_u32 s4, s60, 16384
    buffer_load_dwordx4 v8, s[16:19], s4 offen lds
    s_waitcnt lgkmcnt(5)
    v_mfma_f32_32x32x16_bf16 v[156:171], v[196:199], v[20:23], v[156:171]
    v_mov_b32 v82, 0
    v_mov_b32 v83, 0
    v_mov_b32 v84, 0
    s_add_u32 m0, s7, 20480
    s_add_u32 s4, s60, 20480
    buffer_load_dwordx4 v8, s[16:19], s4 offen lds
    v_mov_b32 v85, 0
    s_waitcnt lgkmcnt(4)
    v_mfma_f32_32x32x16_bf16 v[156:171], v[200:203], v[24:27], v[156:171]
    v_mov_b32 v86, 0
    v_mov_b32 v87, 0
    s_add_u32 m0, s7, 24576
    s_add_u32 s4, s60, 24576
    buffer_load_dwordx4 v8, s[16:19], s4 offen lds
    v_mov_b32 v88, 0
    v_mov_b32 v89, 0
    s_waitcnt lgkmcnt(3)
    v_mfma_f32_32x32x16_bf16 v[156:171], v[204:207], v[28:31], v[156:171]
    v_mov_b32 v90, 0
    s_add_u32 m0, s7, 28672
    s_add_u32 s4, s60, 28672
    buffer_load_dwordx4 v8, s[16:19], s4 offen lds
    v_mov_b32 v91, 0
    v_mov_b32 v92, 0
    v_mov_b32 v93, 0
    s_waitcnt lgkmcnt(2)
    v_mfma_f32_32x32x16_bf16 v[156:171], v[208:211], v[32:35], v[156:171]
    v_mov_b32 v94, 0
    v_mov_b32 v95, 0
    v_mov_b32 v96, 0
    v_mov_b32 v97, 0
    v_mov_b32 v98, 0
    s_waitcnt lgkmcnt(1)
    v_mfma_f32_32x32x16_bf16 v[156:171], v[212:215], v[36:39], v[156:171]
    v_mov_b32 v99, 0
    v_mov_b32 v100, 0
    v_mov_b32 v101, 0
    v_mov_b32 v102, 0
    v_mov_b32 v103, 0
    s_waitcnt lgkmcnt(0)
    v_mfma_f32_32x32x16_bf16 v[156:171], v[216:219], v[40:43], v[156:171]
    v_mov_b32 v104, 0
    v_mov_b32 v105, 0
    v_mov_b32 v106, 0
    v_mov_b32 v107, 0
    v_cmp_ge_i32 vcc, v226, 0
    s_nop 1
    v_cndmask_b32 v140, v227, v140, vcc
    v_cmp_ge_i32 vcc, v226, 1
    s_nop 1
    v_cndmask_b32 v141, v227, v141, vcc
    v_cmp_ge_i32 vcc, v226, 2
    s_nop 1
    v_cndmask_b32 v142, v227, v142, vcc
    v_cmp_ge_i32 vcc, v226, 3
    s_nop 1
    v_cndmask_b32 v143, v227, v143, vcc
    v_cmp_ge_i32 vcc, v226, 8
    s_nop 1
    v_cndmask_b32 v144, v227, v144, vcc
    v_cmp_ge_i32 vcc, v226, 9
    s_nop 1
    v_cndmask_b32 v145, v227, v145, vcc
    v_cmp_ge_i32 vcc, v226, 10
    s_nop 1
    v_cndmask_b32 v146, v227, v146, vcc
    v_cmp_ge_i32 vcc, v226, 11
    s_nop 1
    v_cndmask_b32 v147, v227, v147, vcc
    v_cmp_ge_i32 vcc, v226, 16
    s_nop 1
    v_cndmask_b32 v148, v227, v148, vcc
    v_cmp_ge_i32 vcc, v226, 17
    s_nop 1
    v_cndmask_b32 v149, v227, v149, vcc
    v_cmp_ge_i32 vcc, v226, 18
    s_nop 1
    v_cndmask_b32 v150, v227, v150, vcc
    v_cmp_ge_i32 vcc, v226, 19
    s_nop 1
    v_cndmask_b32 v151, v227, v151, vcc
    v_cmp_ge_i32 vcc, v226, 24
    s_nop 1
    v_cndmask_b32 v152, v227, v152, vcc
    v_cmp_ge_i32 vcc, v226, 25
    s_nop 1
    v_cndmask_b32 v153, v227, v153, vcc
    v_cmp_ge_i32 vcc, v226, 26
    s_nop 1
    v_cndmask_b32 v154, v227, v154, vcc
    v_cmp_ge_i32 vcc, v226, 27
    s_nop 1
    v_cndmask_b32 v155, v227, v155, vcc
    v_cmp_ge_i32 vcc, v226, 32
    s_nop 1
    v_cndmask_b32 v156, v227, v156, vcc
    v_cmp_ge_i32 vcc, v226, 33
    s_nop 1
    v_cndmask_b32 v157, v227, v157, vcc
    v_cmp_ge_i32 vcc, v226, 34
    s_nop 1
    v_cndmask_b32 v158, v227, v158, vcc
    v_cmp_ge_i32 vcc, v226, 35
    s_nop 1
    v_cndmask_b32 v159, v227, v159, vcc
    v_cmp_ge_i32 vcc, v226, 40
    s_nop 1
    v_cndmask_b32 v160, v227, v160, vcc
    v_cmp_ge_i32 vcc, v226, 41
    s_nop 1
    v_cndmask_b32 v161, v227, v161, vcc
    v_cmp_ge_i32 vcc, v226, 42
    s_nop 1
    v_cndmask_b32 v162, v227, v162, vcc
    v_cmp_ge_i32 vcc, v226, 43
    s_nop 1
    v_cndmask_b32 v163, v227, v163, vcc
    v_cmp_ge_i32 vcc, v226, 48
    s_nop 1
    v_cndmask_b32 v164, v227, v164, vcc
    v_cmp_ge_i32 vcc, v226, 49
    s_nop 1
    v_cndmask_b32 v165, v227, v165, vcc
    v_cmp_ge_i32 vcc, v226, 50
    s_nop 1
    v_cndmask_b32 v166, v227, v166, vcc
    v_cmp_ge_i32 vcc, v226, 51
    s_nop 1
    v_cndmask_b32 v167, v227, v167, vcc
    v_cmp_ge_i32 vcc, v226, 56
    s_nop 1
    v_cndmask_b32 v168, v227, v168, vcc
    v_cmp_ge_i32 vcc, v226, 57
    s_nop 1
    v_cndmask_b32 v169, v227, v169, vcc
    v_cmp_ge_i32 vcc, v226, 58
    s_nop 1
    v_cndmask_b32 v170, v227, v170, vcc
    v_cmp_ge_i32 vcc, v226, 59
    s_nop 1
    v_cndmask_b32 v171, v227, v171, vcc
    v_max3_f32 v4, v140, v141, v142
    v_max3_f32 v5, v143, v144, v145
    v_max3_f32 v4, v4, v146, v147
    v_max3_f32 v5, v5, v148, v149
    v_max3_f32 v4, v4, v150, v151
    v_max3_f32 v5, v5, v152, v153
    v_max3_f32 v4, v4, v154, v155
    v_max3_f32 v5, v5, v156, v157
    v_max3_f32 v4, v4, v158, v159
    v_max3_f32 v5, v5, v160, v161
    v_max3_f32 v4, v4, v162, v163
    v_max3_f32 v5, v5, v164, v165
    v_max3_f32 v4, v4, v166, v167
    v_max3_f32 v5, v5, v168, v169
    v_max3_f32 v4, v4, v170, v171
    v_max_f32 v4, v4, v5
    v_mov_b32 v5, v4
    s_nop 1
    v_permlane32_swap_b32 v4, v5
    v_max_f32 v228, v4, v5
    v_mov_b32 v220, v228
    v_sub_f32 v172, 0, v228
    v_sub_f32 v173, 0, v228
    v_sub_f32 v174, 0, v228
    v_sub_f32 v175, 0, v228
    v_sub_f32 v176, 0, v228
    v_sub_f32 v177, 0, v228
    v_sub_f32 v178, 0, v228
    v_sub_f32 v179, 0, v228
    v_sub_f32 v180, 0, v228
    v_sub_f32 v181, 0, v228
    v_sub_f32 v182, 0, v228
    v_sub_f32 v183, 0, v228
    v_sub_f32 v184, 0, v228
    v_sub_f32 v185, 0, v228
    v_sub_f32 v186, 0, v228
    v_sub_f32 v187, 0, v228
    v_sub_f32 v140, v140, v228
    v_sub_f32 v141, v141, v228
    v_sub_f32 v142, v142, v228
    v_sub_f32 v143, v143, v228
    v_sub_f32 v144, v144, v228
    v_sub_f32 v145, v145, v228
    v_sub_f32 v146, v146, v228
    v_sub_f32 v147, v147, v228
    v_sub_f32 v148, v148, v228
    v_sub_f32 v149, v149, v228
    v_sub_f32 v150, v150, v228
    v_sub_f32 v151, v151, v228
    v_sub_f32 v152, v152, v228
    v_sub_f32 v153, v153, v228
    v_sub_f32 v154, v154, v228
    v_sub_f32 v155, v155, v228
    v_sub_f32 v156, v156, v228
    v_sub_f32 v157, v157, v228
    v_sub_f32 v158, v158, v228
    v_sub_f32 v159, v159, v228
    v_sub_f32 v160, v160, v228
    v_sub_f32 v161, v161, v228
    v_sub_f32 v162, v162, v228
    v_sub_f32 v163, v163, v228
    v_sub_f32 v164, v164, v228
    v_sub_f32 v165, v165, v228
    v_sub_f32 v166, v166, v228
    v_sub_f32 v167, v167, v228
    v_sub_f32 v168, v168, v228
    v_sub_f32 v169, v169, v228
    v_sub_f32 v170, v170, v228
    v_sub_f32 v171, v171, v228
    s_nop 0
    s_branch k2_attn_kernel_epi1_0
k2_attn_kernel_loop0_0:
    s_sub_u32 s62, s62, 1
    s_waitcnt vmcnt(0) lgkmcnt(0)
    s_barrier
    s_cmp_eq_u32 s62, 0
    s_cbranch_scc1 k2_attn_kernel_last0_0
    s_add_u32 s60, s60, 32768
    s_add_u32 s61, s61, 8192
    ds_read_b128 v[188:191], v10 offset:32768
    ds_read_b128 v[192:195], v10 offset:33792
    ds_read_b128 v[196:199], v10 offset:34816
    ds_read_b128 v[200:203], v10 offset:35840
    ds_read_b128 v[204:207], v10 offset:36864
    ds_read_b128 v[208:211], v10 offset:37888
    ds_read_b128 v[212:215], v10 offset:38912
    v_exp_f32 v108, v108
    v_exp_f32 v109, v109
    v_exp_f32 v110, v110
    v_exp_f32 v111, v111
    s_add_u32 m0, s7, 0
    s_add_u32 s4, s60, 0
    buffer_load_dwordx4 v8, s[16:19], s4 offen lds
    v_exp_f32 v112, v112
    ds_read_b128 v[216:219], v10 offset:39936
    s_waitcnt lgkmcnt(7)
    v_mfma_f32_32x32x16_bf16 v[140:155], v[188:191], v[12:15], v[172:187]
    v_exp_f32 v113, v113
    v_exp_f32 v114, v114
    v_exp_f32 v115, v115
    v_add_f32 v221, v221, v108
    ds_read_b128 v[188:191], v10 offset:40960
    s_waitcnt lgkmcnt(7)
    v_mfma_f32_32x32x16_bf16 v[140:155], v[192:195], v[16:19], v[140:155]
    v_add_f32 v222, v222, v109
    s_add_u32 m0, s7, 4096
    s_add_u32 s4, s60, 4096
    buffer_load_dwordx4 v8, s[16:19], s4 offen lds
    v_cvt_pk_bf16_f32 v108, v108, v109
    ds_read_b128 v[192:195], v10 offset:41984
    s_waitcnt lgkmcnt(7)
    v_mfma_f32_32x32x16_bf16 v[140:155], v[196:199], v[20:23], v[140:155]
    v_add_f32 v221, v221, v110
    v_add_f32 v222, v222, v111
    v_cvt_pk_bf16_f32 v109, v110, v111
    v_add_f32 v221, v221, v112
    ds_read_b128 v[196:199], v10 offset:43008
    s_waitcnt lgkmcnt(7)
    v_mfma_f32_32x32x16_bf16 v[140:155], v[200:203], v[24:27], v[140:155]
    v_add_f32 v222, v222, v113
    s_add_u32 m0, s7, 8192
    s_add_u32 s4, s60, 8192
    buffer_load_dwordx4 v8, s[16:19], s4 offen lds
    v_cvt_pk_bf16_f32 v110, v112, v113
    ds_read_b128 v[200:203], v10 offset:44032
    s_waitcnt lgkmcnt(7)
    v_mfma_f32_32x32x16_bf16 v[140:155], v[204:207], v[28:31], v[140:155]
    v_add_f32 v221, v221, v114
    v_add_f32 v222, v222, v115
    v_cvt_pk_bf16_f32 v111, v114, v115
    v_exp_f32 v116, v116
    ds_read_b128 v[204:207], v10 offset:45056
    s_waitcnt lgkmcnt(7)
    v_mfma_f32_32x32x16_bf16 v[140:155], v[208:211], v[32:35], v[140:155]
    v_exp_f32 v117, v117
    s_add_u32 m0, s7, 12288
    s_add_u32 s4, s60, 12288
    buffer_load_dwordx4 v8, s[16:19], s4 offen lds
    v_exp_f32 v118, v118
    ds_read_b128 v[208:211], v10 offset:46080
    s_waitcnt lgkmcnt(7)
    v_mfma_f32_32x32x16_bf16 v[140:155], v[212:215], v[36:39], v[140:155]
    v_exp_f32 v119, v119
    v_exp_f32 v120, v120
    v_exp_f32 v121, v121
    ds_read_b128 v[212:215], v10 offset:47104
    s_waitcnt lgkmcnt(7)
    v_mfma_f32_32x32x16_bf16 v[140:155], v[216:219], v[40:43], v[140:155]
    v_exp_f32 v122, v122
    v_exp_f32 v123, v123
    s_add_u32 m0, s7, 16384
    s_add_u32 s4, s60, 16384
    buffer_load_dwordx4 v8, s[16:19], s4 offen lds
    v_add_f32 v221, v221, v116
    ds_read_b128 v[216:219], v10 offset:48128
    s_waitcnt lgkmcnt(7)
    v_mfma_f32_32x32x16_bf16 v[156:171], v[188:191], v[12:15], v[172:187]
    v_add_f32 v222, v222, v117
    v_cvt_pk_bf16_f32 v116, v116, v117
    v_add_f32 v221, v221, v118
    ds_read_b128 v[188:191], v11 offset:0
    s_waitcnt lgkmcnt(7)
    v_mfma_f32_32x32x16_bf16 v[156:171], v[192:195], v[16:19], v[156:171]
    v_add_f32 v222, v222, v119
    v_cvt_pk_bf16_f32 v117, v118, v119
    s_add_u32 m0, s7, 20480
    s_add_u32 s4, s60, 20480
    buffer_load_dwordx4 v8, s[16:19], s4 offen lds
    v_add_f32 v221, v221, v120
    ds_read_b128 v[192:195], v11 offset:8192
    s_waitcnt lgkmcnt(7)
    v_mfma_f32_32x32x16_bf16 v[156:171], v[196:199], v[20:23], v[156:171]
    v_add_f32 v222, v222, v121
    v_cvt_pk_bf16_f32 v118, v120, v121
    v_add_f32 v221, v221, v122
    ds_read_b128 v[196:199], v11 offset:16384
    s_waitcnt lgkmcnt(7)
    v_mfma_f32_32x32x16_bf16 v[156:171], v[200:203], v[24:27], v[156:171]
    v_add_f32 v222, v222, v123
    v_cvt_pk_bf16_f32 v119, v122, v123
    s_add_u32 m0, s7, 24576
    s_add_u32 s4, s60, 24576
    buffer_load_dwordx4 v8, s[16:19], s4 offen lds
    ds_read_b128 v[200:203], v11 offset:24576
    s_waitcnt lgkmcnt(7)
    v_mfma_f32_32x32x16_bf16 v[156:171], v[204:207], v[28:31], v[156:171]
    v_exp_f32 v124, v124
    v_exp_f32 v125, v125
    v_exp_f32 v126, v126
    v_exp_f32 v127, v127
    ds_read_b128 v[204:207], v11 offset:1024
    s_waitcnt lgkmcnt(7)
    v_mfma_f32_32x32x16_bf16 v[156:171], v[208:211], v[32:35], v[156:171]
    v_exp_f32 v128, v128
    v_exp_f32 v129, v129
    s_add_u32 m0, s7, 28672
    s_add_u32 s4, s60, 28672
    buffer_load_dwordx4 v8, s[16:19], s4 offen lds
    ds_read_b128 v[208:211], v11 offset:9216
    s_waitcnt lgkmcnt(7)
    v_mfma_f32_32x32x16_bf16 v[156:171], v[212:215], v[36:39], v[156:171]
    v_exp_f32 v130, v130
    v_exp_f32 v131, v131
    v_add_f32 v221, v221, v124
    v_add_f32 v222, v222, v125
    ds_read_b128 v[212:215], v11 offset:17408
    s_waitcnt lgkmcnt(7)
    v_mfma_f32_32x32x16_bf16 v[156:171], v[216:219], v[40:43], v[156:171]
    v_cvt_pk_bf16_f32 v124, v124, v125
    v_add_f32 v221, v221, v126
    s_add_u32 m0, s7, 98304
    s_add_u32 s4, s61, 0
    buffer_load_dwordx4 v9, s[20:23], s4 offen lds
    ds_read_b128 v[216:219], v11 offset:25600
    s_waitcnt lgkmcnt(7)
    v_mfma_f32_32x32x16_bf16 v[44:59], v[188:191], v[108:111], v[44:59]
    v_add_f32 v222, v222, v127
    v_cvt_pk_bf16_f32 v125, v126, v127
    v_add_f32 v221, v221, v128
    ds_read_b128 v[188:191], v11 offset:2048
    s_waitcnt lgkmcnt(7)
    v_mfma_f32_32x32x16_bf16 v[60:75], v[192:195], v[108:111], v[60:75]
    v_add_f32 v222, v222, v129
    v_cvt_pk_bf16_f32 v126, v128, v129
    v_add_f32 v221, v221, v130
    s_add_u32 m0, s7, 102400
    s_add_u32 s4, s61, 4096
    buffer_load_dwordx4 v9, s[20:23], s4 offen lds
    ds_read_b128 v[192:195], v11 offset:10240
    s_waitcnt lgkmcnt(7)
    v_mfma_f32_32x32x16_bf16 v[76:91], v[196:199], v[108:111], v[76:91]
    v_add_f32 v222, v222, v131
    v_cvt_pk_bf16_f32 v127, v130, v131
    v_exp_f32 v132, v132
    ds_read_b128 v[196:199], v11 offset:18432
    s_waitcnt lgkmcnt(7)
    v_mfma_f32_32x32x16_bf16 v[92:107], v[200:203], v[108:111], v[92:107]
    v_exp_f32 v133, v133
    v_exp_f32 v134, v134
    v_exp_f32 v135, v135
    s_add_u32 m0, s7, 106496
    s_add_u32 s4, s61, 131072
    buffer_load_dwordx4 v9, s[20:23], s4 offen lds
    ds_read_b128 v[200:203], v11 offset:26624
    s_waitcnt lgkmcnt(7)
    v_mfma_f32_32x32x16_bf16 v[44:59], v[204:207], v[116:119], v[44:59]
    v_exp_f32 v136, v136
    v_exp_f32 v137, v137
    v_exp_f32 v138, v138
    ds_read_b128 v[204:207], v11 offset:3072
    s_waitcnt lgkmcnt(7)
    v_mfma_f32_32x32x16_bf16 v[60:75], v[208:211], v[116:119], v[60:75]
    v_exp_f32 v139, v139
    v_add_f32 v221, v221, v132
    v_add_f32 v222, v222, v133
    ds_read_b128 v[208:211], v11 offset:11264
    s_waitcnt lgkmcnt(7)
    v_mfma_f32_32x32x16_bf16 v[76:91], v[212:215], v[116:119], v[76:91]
    s_add_u32 m0, s7, 110592
    s_add_u32 s4, s61, 135168
    buffer_load_dwordx4 v9, s[20:23], s4 offen lds
    v_cvt_pk_bf16_f32 v132, v132, v133
    v_add_f32 v221, v221, v134
    v_add_f32 v222, v222, v135
    ds_read_b128 v[212:215], v11 offset:19456
    s_waitcnt lgkmcnt(7)
    v_mfma_f32_32x32x16_bf16 v[92:107], v[216:219], v[116:119], v[92:107]
    v_cvt_pk_bf16_f32 v133, v134, v135
    v_add_f32 v221, v221, v136
    v_add_f32 v222, v222, v137
    ds_read_b128 v[216:219], v11 offset:27648
    s_waitcnt lgkmcnt(7)
    v_mfma_f32_32x32x16_bf16 v[44:59], v[188:191], v[124:127], v[44:59]
    s_add_u32 m0, s7, 114688
    s_add_u32 s4, s61, 262144
    buffer_load_dwordx4 v9, s[20:23], s4 offen lds
    v_cvt_pk_bf16_f32 v134, v136, v137
    v_add_f32 v221, v221, v138
    v_add_f32 v222, v222, v139
    s_waitcnt lgkmcnt(6)
    v_mfma_f32_32x32x16_bf16 v[60:75], v[192:195], v[124:127], v[60:75]
    v_cvt_pk_bf16_f32 v135, v138, v139
    v_max3_f32 v4, v140, v141, v142
    v_max3_f32 v5, v143, v144, v145
    s_waitcnt lgkmcnt(5)
    v_mfma_f32_32x32x16_bf16 v[76:91], v[196:199], v[124:127], v[76:91]
    s_add_u32 m0, s7, 118784
    s_add_u32 s4, s61, 266240
    buffer_load_dwordx4 v9, s[20:23], s4 offen lds
    v_max3_f32 v4, v4, v146, v147
    v_max3_f32 v5, v5, v148, v149
    s_waitcnt lgkmcnt(4)
    v_mfma_f32_32x32x16_bf16 v[92:107], v[200:203], v[124:127], v[92:107]
    v_max3_f32 v4, v4, v150, v151
    v_max3_f32 v5, v5, v152, v153
    v_max3_f32 v4, v4, v154, v155
    v_max3_f32 v5, v5, v156, v157
    s_waitcnt lgkmcnt(3)
    v_mfma_f32_32x32x16_bf16 v[44:59], v[204:207], v[132:135], v[44:59]
    s_add_u32 m0, s7, 122880
    s_add_u32 s4, s61, 393216
    buffer_load_dwordx4 v9, s[20:23], s4 offen lds
    v_max3_f32 v4, v4, v158, v159
    v_max3_f32 v5, v5, v160, v161
    s_waitcnt lgkmcnt(2)
    v_mfma_f32_32x32x16_bf16 v[60:75], v[208:211], v[132:135], v[60:75]
    v_max3_f32 v4, v4, v162, v163
    v_max3_f32 v5, v5, v164, v165
    v_max3_f32 v4, v4, v166, v167
    v_max3_f32 v5, v5, v168, v169
    s_waitcnt lgkmcnt(1)
    v_mfma_f32_32x32x16_bf16 v[76:91], v[212:215], v[132:135], v[76:91]
    s_add_u32 m0, s7, 126976
    s_add_u32 s4, s61, 397312
    buffer_load_dwordx4 v9, s[20:23], s4 offen lds
    v_max3_f32 v4, v4, v170, v171
    v_max_f32 v4, v4, v5
    s_waitcnt lgkmcnt(0)
    v_mfma_f32_32x32x16_bf16 v[92:107], v[216:219], v[132:135], v[92:107]
    v_mov_b32 v5, v4
    s_nop 1
    v_permlane32_swap_b32 v4, v5
    v_max_f32 v228, v4, v5
    v_cmp_gt_f32 vcc, v228, v223
    s_nop 4
    s_cbranch_vccz k2_attn_kernel_keep_5
    v_max_f32 v4, 0, v228
    v_sub_f32 v5, 0, v4
    v_exp_f32 v5, v5
    v_add_f32 v220, v220, v4
    v_sub_f32 v172, 0, v220
    v_sub_f32 v173, 0, v220
    v_sub_f32 v174, 0, v220
    v_sub_f32 v175, 0, v220
    v_sub_f32 v176, 0, v220
    v_sub_f32 v177, 0, v220
    v_sub_f32 v178, 0, v220
    v_sub_f32 v179, 0, v220
    v_sub_f32 v180, 0, v220
    v_sub_f32 v181, 0, v220
    v_sub_f32 v182, 0, v220
    v_sub_f32 v183, 0, v220
    v_sub_f32 v184, 0, v220
    v_sub_f32 v185, 0, v220
    v_sub_f32 v186, 0, v220
    v_sub_f32 v187, 0, v220
    v_sub_f32 v140, v140, v4
    v_sub_f32 v141, v141, v4
    v_sub_f32 v142, v142, v4
    v_sub_f32 v143, v143, v4
    v_sub_f32 v144, v144, v4
    v_sub_f32 v145, v145, v4
    v_sub_f32 v146, v146, v4
    v_sub_f32 v147, v147, v4
    v_sub_f32 v148, v148, v4
    v_sub_f32 v149, v149, v4
    v_sub_f32 v150, v150, v4
    v_sub_f32 v151, v151, v4
    v_sub_f32 v152, v152, v4
    v_sub_f32 v153, v153, v4
    v_sub_f32 v154, v154, v4
    v_sub_f32 v155, v155, v4
    v_sub_f32 v156, v156, v4
    v_sub_f32 v157, v157, v4
    v_sub_f32 v158, v158, v4
    v_sub_f32 v159, v159, v4
    v_sub_f32 v160, v160, v4
    v_sub_f32 v161, v161, v4
    v_sub_f32 v162, v162, v4
    v_sub_f32 v163, v163, v4
    v_sub_f32 v164, v164, v4
    v_sub_f32 v165, v165, v4
    v_sub_f32 v166, v166, v4
    v_sub_f32 v167, v167, v4
    v_sub_f32 v168, v168, v4
    v_sub_f32 v169, v169, v4
    v_sub_f32 v170, v170, v4
    v_sub_f32 v171, v171, v4
    v_mul_f32 v221, v221, v5
    v_mul_f32 v222, v222, v5
    v_mul_f32 v44, v44, v5
    v_mul_f32 v45, v45, v5
    v_mul_f32 v46, v46, v5
    v_mul_f32 v47, v47, v5
    v_mul_f32 v48, v48, v5
    v_mul_f32 v49, v49, v5
    v_mul_f32 v50, v50, v5
    v_mul_f32 v51, v51, v5
    v_mul_f32 v52, v52, v5
    v_mul_f32 v53, v53, v5
    v_mul_f32 v54, v54, v5
    v_mul_f32 v55, v55, v5
    v_mul_f32 v56, v56, v5
    v_mul_f32 v57, v57, v5
    v_mul_f32 v58, v58, v5
    v_mul_f32 v59, v59, v5
    v_mul_f32 v60, v60, v5
    v_mul_f32 v61, v61, v5
    v_mul_f32 v62, v62, v5
    v_mul_f32 v63, v63, v5
    v_mul_f32 v64, v64, v5
    v_mul_f32 v65, v65, v5
    v_mul_f32 v66, v66, v5
    v_mul_f32 v67, v67, v5
    v_mul_f32 v68, v68, v5
    v_mul_f32 v69, v69, v5
    v_mul_f32 v70, v70, v5
    v_mul_f32 v71, v71, v5
    v_mul_f32 v72, v72, v5
    v_mul_f32 v73, v73, v5
    v_mul_f32 v74, v74, v5
    v_mul_f32 v75, v75, v5
    v_mul_f32 v76, v76, v5
    v_mul_f32 v77, v77, v5
    v_mul_f32 v78, v78, v5
    v_mul_f32 v79, v79, v5
    v_mul_f32 v80, v80, v5
    v_mul_f32 v81, v81, v5
    v_mul_f32 v82, v82, v5
    v_mul_f32 v83, v83, v5
    v_mul_f32 v84, v84, v5
    v_mul_f32 v85, v85, v5
    v_mul_f32 v86, v86, v5
    v_mul_f32 v87, v87, v5
    v_mul_f32 v88, v88, v5
    v_mul_f32 v89, v89, v5
    v_mul_f32 v90, v90, v5
    v_mul_f32 v91, v91, v5
    v_mul_f32 v92, v92, v5
    v_mul_f32 v93, v93, v5
    v_mul_f32 v94, v94, v5
    v_mul_f32 v95, v95, v5
    v_mul_f32 v96, v96, v5
    v_mul_f32 v97, v97, v5
    v_mul_f32 v98, v98, v5
    v_mul_f32 v99, v99, v5
    v_mul_f32 v100, v100, v5
    v_mul_f32 v101, v101, v5
    v_mul_f32 v102, v102, v5
    v_mul_f32 v103, v103, v5
    v_mul_f32 v104, v104, v5
    v_mul_f32 v105, v105, v5
    v_mul_f32 v106, v106, v5
    v_mul_f32 v107, v107, v5
    s_nop 0
k2_attn_kernel_keep_5:
    s_branch k2_attn_kernel_loop1_0
k2_attn_kernel_last0_0:
    s_mov_b32 s60, 0
    s_add_u32 s61, s61, 8192
    ds_read_b128 v[188:191], v10 offset:32768
    ds_read_b128 v[192:195], v10 offset:33792
    ds_read_b128 v[196:199], v10 offset:34816
    ds_read_b128 v[200:203], v10 offset:35840
    ds_read_b128 v[204:207], v10 offset:36864
    ds_read_b128 v[208:211], v10 offset:37888
    ds_read_b128 v[212:215], v10 offset:38912
    v_exp_f32 v108, v108
    v_exp_f32 v109, v109
    v_exp_f32 v110, v110
    v_exp_f32 v111, v111
    s_add_u32 m0, s7, 98304
    s_add_u32 s4, s61, 0
    buffer_load_dwordx4 v9, s[20:23], s4 offen lds
    v_exp_f32 v112, v112
    ds_read_b128 v[216:219], v10 offset:39936
    s_waitcnt lgkmcnt(7)
    v_mfma_f32_32x32x16_bf16 v[140:155], v[188:191], v[12:15], v[172:187]
    v_exp_f32 v113, v113
    v_exp_f32 v114, v114
    v_exp_f32 v115, v115
    v_add_f32 v221, v221, v108
    v_add_f32 v222, v222, v109
    v_cvt_pk_bf16_f32 v108, v108, v109
    ds_read_b128 v[188:191], v10 offset:40960
    s_waitcnt lgkmcnt(7)
    v_mfma_f32_32x32x16_bf16 v[140:155], v[192:195], v[16:19], v[140:155]
    v_add_f32 v221, v221, v110
    v_add_f32 v222, v222, v111
    s_add_u32 m0, s7, 102400
    s_add_u32 s4, s61, 4096
    buffer_load_dwordx4 v9, s[20:23], s4 offen lds
    v_cvt_pk_bf16_f32 v109, v110, v111
    v_add_f32 v221, v221, v112
    ds_read_b128 v[192:195], v10 offset:41984
    s_waitcnt lgkmcnt(7)
    v_mfma_f32_32x32x16_bf16 v[140:155], v[196:199], v[20:23], v[140:155]
    v_add_f32 v222, v222, v113
    v_cvt_pk_bf16_f32 v110, v112, v113
    v_add_f32 v221, v221, v114
    v_add_f32 v222, v222, v115
    v_cvt_pk_bf16_f32 v111, v114, v115
    v_exp_f32 v116, v116
    ds_read_b128 v[196:199], v10 offset:43008
    s_waitcnt lgkmcnt(7)
    v_mfma_f32_32x32x16_bf16 v[140:155], v[200:203], v[24:27], v[140:155]
    v_exp_f32 v117, v117
    s_add_u32 m0, s7, 106496
    s_add_u32 s4, s61, 131072
    buffer_load_dwordx4 v9, s[20:23], s4 offen lds
    v_exp_f32 v118, v118
    v_exp_f32 v119, v119
    v_exp_f32 v120, v120
    ds_read_b128 v[200:203], v10 offset:44032
    s_waitcnt lgkmcnt(7)
    v_mfma_f32_32x32x16_bf16 v[140:155], v[204:207], v[28:31], v[140:155]
    v_exp_f32 v121, v121
    v_exp_f32 v122, v122
    v_exp_f32 v123, v123
    v_add_f32 v221, v221, v116
    v_add_f32 v222, v222, v117
    v_cvt_pk_bf16_f32 v116, v116, v117
    ds_read_b128 v[204:207], v10 offset:45056
    s_waitcnt lgkmcnt(7)
    v_mfma_f32_32x32x16_bf16 v[140:155], v[208:211], v[32:35], v[140:155]
    s_add_u32 m0, s7, 110592
    s_add_u32 s4, s61, 135168
    buffer_load_dwordx4 v9, s[20:23], s4 offen lds
    v_add_f32 v221, v221, v118
    v_add_f32 v222, v222, v119
    v_cvt_pk_bf16_f32 v117, v118, v119
    v_add_f32 v221, v221, v120
    ds_read_b128 v[208:211], v10 offset:46080
    s_waitcnt lgkmcnt(7)
    v_mfma_f32_32x32x16_bf16 v[140:155], v[212:215], v[36:39], v[140:155]
    v_add_f32 v222, v222, v121
    v_cvt_pk_bf16_f32 v118, v120, v121
    v_add_f32 v221, v221, v122
    v_add_f32 v222, v222, v123
    v_cvt_pk_bf16_f32 v119, v122, v123
    ds_read_b128 v[212:215], v10 offset:47104
    s_waitcnt lgkmcnt(7)
    v_mfma_f32_32x32x16_bf16 v[140:155], v[216:219], v[40:43], v[140:155]
    s_add_u32 m0, s7, 114688
    s_add_u32 s4, s61, 262144
    buffer_load_dwordx4 v9, s[20:23], s4 offen lds
    v_exp_f32 v124, v124
    v_exp_f32 v125, v125
    v_exp_f32 v126, v126
    v_exp_f32 v127, v127
    v_exp_f32 v128, v128
    ds_read_b128 v[216:219], v10 offset:48128
    s_waitcnt lgkmcnt(7)
    v_mfma_f32_32x32x16_bf16 v[156:171], v[188:191], v[12:15], v[172:187]
    v_exp_f32 v129, v129
    v_exp_f32 v130, v130
    v_exp_f32 v131, v131
    v_add_f32 v221, v221, v124
    s_add_u32 m0, s7, 118784
    s_add_u32 s4, s61, 266240
    buffer_load_dwordx4 v9, s[20:23], s4 offen lds
    ds_read_b128 v[188:191], v11 offset:0
    s_waitcnt lgkmcnt(7)
    v_mfma_f32_32x32x16_bf16 v[156:171], v[192:195], v[16:19], v[156:171]
    v_add_f32 v222, v222, v125
    v_cvt_pk_bf16_f32 v124, v124, v125
    v_add_f32 v221, v221, v126
    v_add_f32 v222, v222, v127
    v_cvt_pk_bf16_f32 v125, v126, v127
    v_add_f32 v221, v221, v128
    ds_read_b128 v[192:195], v11 offset:8192
    s_waitcnt lgkmcnt(7)
    v_mfma_f32_32x32x16_bf16 v[156:171], v[196:199], v[20:23], v[156:171]
    v_add_f32 v222, v222, v129
    v_cvt_pk_bf16_f32 v126, v128, v129
    v_add_f32 v221, v221, v130
    s_add_u32 m0, s7, 122880
    s_add_u32 s4, s61, 393216
    buffer_load_dwordx4 v9, s[20:23], s4 offen lds
    v_add_f32 v222, v222, v131
    ds_read_b128 v[196:199], v11 offset:16384
    s_waitcnt lgkmcnt(7)
    v_mfma_f32_32x32x16_bf16 v[156:171], v[200:203], v[24:27], v[156:171]
    v_cvt_pk_bf16_f32 v127, v130, v131
    v_exp_f32 v132, v132
    v_exp_f32 v133, v133
    v_exp_f32 v134, v134
    v_exp_f32 v135, v135
    ds_read_b128 v[200:203], v11 offset:24576
    s_waitcnt lgkmcnt(7)
    v_mfma_f32_32x32x16_bf16 v[156:171], v[204:207], v[28:31], v[156:171]
    v_exp_f32 v136, v136
    v_exp_f32 v137, v137
    v_exp_f32 v138, v138
    s_add_u32 m0, s7, 126976
    s_add_u32 s4, s61, 397312
    buffer_load_dwordx4 v9, s[20:23], s4 offen lds
    v_exp_f32 v139, v139
    v_add_f32 v221, v221, v132
    ds_read_b128 v[204:207], v11 offset:1024
    s_waitcnt lgkmcnt(7)
    v_mfma_f32_32x32x16_bf16 v[156:171], v[208:211], v[32:35], v[156:171]
    v_add_f32 v222, v222, v133
    v_cvt_pk_bf16_f32 v132, v132, v133
    v_add_f32 v221, v221, v134
    v_add_f32 v222, v222, v135
    v_cvt_pk_bf16_f32 v133, v134, v135
    ds_read_b128 v[208:211], v11 offset:9216
    s_waitcnt lgkmcnt(7)
    v_mfma_f32_32x32x16_bf16 v[156:171], v[212:215], v[36:39], v[156:171]
    v_add_f32 v221, v221, v136
    v_add_f32 v222, v222, v137
    s_add_u32 m0, s7, 0
    s_add_u32 s4, s60, 0
    buffer_load_dwordx4 v8, s[16:19], s4 offen lds
    v_cvt_pk_bf16_f32 v134, v136, v137
    v_add_f32 v221, v221, v138
    v_add_f32 v222, v222, v139
    ds_read_b128 v[212:215], v11 offset:17408
    s_waitcnt lgkmcnt(7)
    v_mfma_f32_32x32x16_bf16 v[156:171], v[216:219], v[40:43], v[156:171]
    v_cvt_pk_bf16_f32 v135, v138, v139
    v_cmp_ge_i32 vcc, v226, 0
    s_nop 1
    v_cndmask_b32 v140, v227, v140, vcc
    v_cmp_ge_i32 vcc, v226, 1
    s_nop 1
    v_cndmask_b32 v141, v227, v141, vcc
    ds_read_b128 v[216:219], v11 offset:25600
    s_waitcnt lgkmcnt(7)
    v_mfma_f32_32x32x16_bf16 v[44:59], v[188:191], v[108:111], v[44:59]
    v_cmp_ge_i32 vcc, v226, 2
    s_add_u32 m0, s7, 4096
    s_add_u32 s4, s60, 4096
    buffer_load_dwordx4 v8, s[16:19], s4 offen lds
    v_cndmask_b32 v142, v227, v142, vcc
    v_cmp_ge_i32 vcc, v226, 3
    s_nop 1
    v_cndmask_b32 v143, v227, v143, vcc
    ds_read_b128 v[188:191], v11 offset:2048
    s_waitcnt lgkmcnt(7)
    v_mfma_f32_32x32x16_bf16 v[60:75], v[192:195], v[108:111], v[60:75]
    v_cmp_ge_i32 vcc, v226, 8
    s_nop 1
    v_cndmask_b32 v144, v227, v144, vcc
    v_cmp_ge_i32 vcc, v226, 9
    s_nop 1
    v_cndmask_b32 v145, v227, v145, vcc
    v_cmp_ge_i32 vcc, v226, 10
    s_nop 1
    v_cndmask_b32 v146, v227, v146, vcc
    ds_read_b128 v[192:195], v11 offset:10240
    s_waitcnt lgkmcnt(7)
    v_mfma_f32_32x32x16_bf16 v[76:91], v[196:199], v[108:111], v[76:91]
    s_add_u32 m0, s7, 8192
    s_add_u32 s4, s60, 8192
    buffer_load_dwordx4 v8, s[16:19], s4 offen lds
    v_cmp_ge_i32 vcc, v226, 11
    s_nop 1
    v_cndmask_b32 v147, v227, v147, vcc
    v_cmp_ge_i32 vcc, v226, 16
    s_nop 1
    v_cndmask_b32 v148, v227, v148, vcc
    ds_read_b128 v[196:199], v11 offset:18432
    s_waitcnt lgkmcnt(7)
    v_mfma_f32_32x32x16_bf16 v[92:107], v[200:203], v[108:111], v[92:107]
    v_cmp_ge_i32 vcc, v226, 17
    s_nop 1
    v_cndmask_b32 v149, v227, v149, vcc
    v_cmp_ge_i32 vcc, v226, 18
    s_nop 1
    v_cndmask_b32 v150, v227, v150, vcc
    v_cmp_ge_i32 vcc, v226, 19
    s_add_u32 m0, s7, 12288
    s_add_u32 s4, s60, 12288
    buffer_load_dwordx4 v8, s[16:19], s4 offen lds
    ds_read_b128 v[200:203], v11 offset:26624
    s_waitcnt lgkmcnt(7)
    v_mfma_f32_32x32x16_bf16 v[44:59], v[204:207], v[116:119], v[44:59]
    v_cndmask_b32 v151, v227, v151, vcc
    v_cmp_ge_i32 vcc, v226, 24
    s_nop 1
    v_cndmask_b32 v152, v227, v152, vcc
    v_cmp_ge_i32 vcc, v226, 25
    s_nop 1
    v_cndmask_b32 v153, v227, v153, vcc
    ds_read_b128 v[204:207], v11 offset:3072
    s_waitcnt lgkmcnt(7)
    v_mfma_f32_32x32x16_bf16 v[60:75], v[208:211], v[116:119], v[60:75]
    v_cmp_ge_i32 vcc, v226, 26
    s_nop 1
    v_cndmask_b32 v154, v227, v154, vcc
    v_cmp_ge_i32 vcc, v226, 27
    s_nop 1
    v_cndmask_b32 v155, v227, v155, vcc
    s_add_u32 m0, s7, 16384
    s_add_u32 s4, s60, 16384
    buffer_load_dwordx4 v8, s[16:19], s4 offen lds
    ds_read_b128 v[208:211], v11 offset:11264
    s_waitcnt lgkmcnt(7)
    v_mfma_f32_32x32x16_bf16 v[76:91], v[212:215], v[116:119], v[76:91]
    v_cmp_ge_i32 vcc, v226, 32
    s_nop 1
    v_cndmask_b32 v156, v227, v156, vcc
    v_cmp_ge_i32 vcc, v226, 33
    s_nop 1
    v_cndmask_b32 v157, v227, v157, vcc
    v_cmp_ge_i32 vcc, v226, 34
    s_nop 1
    v_cndmask_b32 v158, v227, v158, vcc
    ds_read_b128 v[212:215], v11 offset:19456
    s_waitcnt lgkmcnt(7)
    v_mfma_f32_32x32x16_bf16 v[92:107], v[216:219], v[116:119], v[92:107]
    v_cmp_ge_i32 vcc, v226, 35
    s_nop 1
    v_cndmask_b32 v159, v227, v159, vcc
    v_cmp_ge_i32 vcc, v226, 40
    s_add_u32 m0, s7, 20480
    s_add_u32 s4, s60, 20480
    buffer_load_dwordx4 v8, s[16:19], s4 offen lds
    v_cndmask_b32 v160, v227, v160, vcc
    ds_read_b128 v[216:219], v11 offset:27648
    s_waitcnt lgkmcnt(7)
    v_mfma_f32_32x32x16_bf16 v[44:59], v[188:191], v[124:127], v[44:59]
    v_cmp_ge_i32 vcc, v226, 41
    s_nop 1
    v_cndmask_b32 v161, v227, v161, vcc
    v_cmp_ge_i32 vcc, v226, 42
    s_nop 1
    v_cndmask_b32 v162, v227, v162, vcc
    v_cmp_ge_i32 vcc, v226, 43
    s_nop 1
    v_cndmask_b32 v163, v227, v163, vcc
    s_waitcnt lgkmcnt(6)
    v_mfma_f32_32x32x16_bf16 v[60:75], v[192:195], v[124:127], v[60:75]
    v_cmp_ge_i32 vcc, v226, 48
    s_nop 1
    v_cndmask_b32 v164, v227, v164, vcc
    s_add_u32 m0, s7, 24576
    s_add_u32 s4, s60, 24576
    buffer_load_dwordx4 v8, s[16:19], s4 offen lds
    v_cmp_ge_i32 vcc, v226, 49
    s_nop 1
    v_cndmask_b32 v165, v227, v165, vcc
    s_waitcnt lgkmcnt(5)
    v_mfma_f32_32x32x16_bf16 v[76:91], v[196:199], v[124:127], v[76:91]
    v_cmp_ge_i32 vcc, v226, 50
    s_nop 1
    v_cndmask_b32 v166, v227, v166, vcc
    v_cmp_ge_i32 vcc, v226, 51
    s_nop 1
    v_cndmask_b32 v167, v227, v167, vcc
    v_cmp_ge_i32 vcc, v226, 56
    s_waitcnt lgkmcnt(4)
    v_mfma_f32_32x32x16_bf16 v[92:107], v[200:203], v[124:127], v[92:107]
    v_cndmask_b32 v168, v227, v168, vcc
    v_cmp_ge_i32 vcc, v226, 57
    s_add_u32 m0, s7, 28672
    s_add_u32 s4, s60, 28672
    buffer_load_dwordx4 v8, s[16:19], s4 offen lds
    v_cndmask_b32 v169, v227, v169, vcc
    v_cmp_ge_i32 vcc, v226, 58
    s_nop 1
    v_cndmask_b32 v170, v227, v170, vcc
    s_waitcnt lgkmcnt(3)
    v_mfma_f32_32x32x16_bf16 v[44:59], v[204:207], v[132:135], v[44:59]
    v_cmp_ge_i32 vcc, v226, 59
    s_nop 1
    v_cndmask_b32 v171, v227, v171, vcc
    v_max3_f32 v4, v140, v141, v142
    v_max3_f32 v5, v143, v144, v145
    v_max3_f32 v4, v4, v146, v147
    s_waitcnt lgkmcnt(2)
    v_mfma_f32_32x32x16_bf16 v[60:75], v[208:211], v[132:135], v[60:75]
    v_max3_f32 v5, v5, v148, v149
    v_max3_f32 v4, v4, v150, v151
    v_max3_f32 v5, v5, v152, v153
    v_max3_f32 v4, v4, v154, v155
    v_max3_f32 v5, v5, v156, v157
    v_max3_f32 v4, v4, v158, v159
    s_waitcnt lgkmcnt(1)
    v_mfma_f32_32x32x16_bf16 v[76:91], v[212:215], v[132:135], v[76:91]
    v_max3_f32 v5, v5, v160, v161
    v_max3_f32 v4, v4, v162, v163
    v_max3_f32 v5, v5, v164, v165
    v_max3_f32 v4, v4, v166, v167
    v_max3_f32 v5, v5, v168, v169
    s_waitcnt lgkmcnt(0)
    v_mfma_f32_32x32x16_bf16 v[92:107], v[216:219], v[132:135], v[92:107]
    v_max3_f32 v4, v4, v170, v171
    v_max_f32 v4, v4, v5
    v_mov_b32 v5, v4
    s_nop 1
    v_permlane32_swap_b32 v4, v5
    v_max_f32 v228, v4, v5
    v_cmp_gt_f32 vcc, v228, v223
    s_nop 3
    s_cbranch_vccz k2_attn_kernel_keep_6
    v_max_f32 v4, 0, v228
    v_sub_f32 v5, 0, v4
    v_exp_f32 v5, v5
    v_add_f32 v220, v220, v4
    v_sub_f32 v172, 0, v220
    v_sub_f32 v173, 0, v220
    v_sub_f32 v174, 0, v220
    v_sub_f32 v175, 0, v220
    v_sub_f32 v176, 0, v220
    v_sub_f32 v177, 0, v220
    v_sub_f32 v178, 0, v220
    v_sub_f32 v179, 0, v220
    v_sub_f32 v180, 0, v220
    v_sub_f32 v181, 0, v220
    v_sub_f32 v182, 0, v220
    v_sub_f32 v183, 0, v220
    v_sub_f32 v184, 0, v220
    v_sub_f32 v185, 0, v220
    v_sub_f32 v186, 0, v220
    v_sub_f32 v187, 0, v220
    v_sub_f32 v140, v140, v4
    v_sub_f32 v141, v141, v4
    v_sub_f32 v142, v142, v4
    v_sub_f32 v143, v143, v4
    v_sub_f32 v144, v144, v4
    v_sub_f32 v145, v145, v4
    v_sub_f32 v146, v146, v4
    v_sub_f32 v147, v147, v4
    v_sub_f32 v148, v148, v4
    v_sub_f32 v149, v149, v4
    v_sub_f32 v150, v150, v4
    v_sub_f32 v151, v151, v4
    v_sub_f32 v152, v152, v4
    v_sub_f32 v153, v153, v4
    v_sub_f32 v154, v154, v4
    v_sub_f32 v155, v155, v4
    v_sub_f32 v156, v156, v4
    v_sub_f32 v157, v157, v4
    v_sub_f32 v158, v158, v4
    v_sub_f32 v159, v159, v4
    v_sub_f32 v160, v160, v4
    v_sub_f32 v161, v161, v4
    v_sub_f32 v162, v162, v4
    v_sub_f32 v163, v163, v4
    v_sub_f32 v164, v164, v4
    v_sub_f32 v165, v165, v4
    v_sub_f32 v166, v166, v4
    v_sub_f32 v167, v167, v4
    v_sub_f32 v168, v168, v4
    v_sub_f32 v169, v169, v4
    v_sub_f32 v170, v170, v4
    v_sub_f32 v171, v171, v4
    v_mul_f32 v221, v221, v5
    v_mul_f32 v222, v222, v5
    v_mul_f32 v44, v44, v5
    v_mul_f32 v45, v45, v5
    v_mul_f32 v46, v46, v5
    v_mul_f32 v47, v47, v5
    v_mul_f32 v48, v48, v5
    v_mul_f32 v49, v49, v5
    v_mul_f32 v50, v50, v5
    v_mul_f32 v51, v51, v5
    v_mul_f32 v52, v52, v5
    v_mul_f32 v53, v53, v5
    v_mul_f32 v54, v54, v5
    v_mul_f32 v55, v55, v5
    v_mul_f32 v56, v56, v5
    v_mul_f32 v57, v57, v5
    v_mul_f32 v58, v58, v5
    v_mul_f32 v59, v59, v5
    v_mul_f32 v60, v60, v5
    v_mul_f32 v61, v61, v5
    v_mul_f32 v62, v62, v5
    v_mul_f32 v63, v63, v5
    v_mul_f32 v64, v64, v5
    v_mul_f32 v65, v65, v5
    v_mul_f32 v66, v66, v5
    v_mul_f32 v67, v67, v5
    v_mul_f32 v68, v68, v5
    v_mul_f32 v69, v69, v5
    v_mul_f32 v70, v70, v5
    v_mul_f32 v71, v71, v5
    v_mul_f32 v72, v72, v5
    v_mul_f32 v73, v73, v5
    v_mul_f32 v74, v74, v5
    v_mul_f32 v75, v75, v5
    v_mul_f32 v76, v76, v5
    v_mul_f32 v77, v77, v5
    v_mul_f32 v78, v78, v5
    v_mul_f32 v79, v79, v5
    v_mul_f32 v80, v80, v5
    v_mul_f32 v81, v81, v5
    v_mul_f32 v82, v82, v5
    v_mul_f32 v83, v83, v5
    v_mul_f32 v84, v84, v5
    v_mul_f32 v85, v85, v5
    v_mul_f32 v86, v86, v5
    v_mul_f32 v87, v87, v5
    v_mul_f32 v88, v88, v5
    v_mul_f32 v89, v89, v5
    v_mul_f32 v90, v90, v5
    v_mul_f32 v91, v91, v5
    v_mul_f32 v92, v92, v5
    v_mul_f32 v93, v93, v5
    v_mul_f32 v94, v94, v5
    v_mul_f32 v95, v95, v5
    v_mul_f32 v96, v96, v5
    v_mul_f32 v97, v97, v5
    v_mul_f32 v98, v98, v5
    v_mul_f32 v99, v99, v5
    v_mul_f32 v100, v100, v5
    v_mul_f32 v101, v101, v5
    v_mul_f32 v102, v102, v5
    v_mul_f32 v103, v103, v5
    v_mul_f32 v104, v104, v5
    v_mul_f32 v105, v105, v5
    v_mul_f32 v106, v106, v5
    v_mul_f32 v107, v107, v5
    s_nop 0
k2_attn_kernel_keep_6:
    s_branch k2_attn_kernel_epi1_0
k2_attn_kernel_loop1_0:
    s_sub_u32 s62, s62, 1
    s_waitcnt vmcnt(0) lgkmcnt(0)
    s_barrier
    s_cmp_eq_u32 s62, 0
    s_cbranch_scc1 k2_attn_kernel_last1_0
    s_add_u32 s60, s60, 32768
    s_add_u32 s61, s61, 8192
    ds_read_b128 v[188:191], v10 offset:0
    ds_read_b128 v[192:195], v10 offset:1024
    ds_read_b128 v[196:199], v10 offset:2048
    ds_read_b128 v[200:203], v10 offset:3072
    ds_read_b128 v[204:207], v10 offset:4096
    ds_read_b128 v[208:211], v10 offset:5120
    ds_read_b128 v[212:215], v10 offset:6144
    v_exp_f32 v140, v140
    v_exp_f32 v141, v141
    v_exp_f32 v142, v142
    v_exp_f32 v143, v143
    s_add_u32 m0, s7, 32768
    s_add_u32 s4, s60, 0
    buffer_load_dwordx4 v8, s[16:19], s4 offen lds
    v_exp_f32 v144, v144
    ds_read_b128 v[216:219], v10 offset:7168
    s_waitcnt lgkmcnt(7)
    v_mfma_f32_32x32x16_bf16 v[108:123], v[188:191], v[12:15], v[172:187]
    v_exp_f32 v145, v145
    v_exp_f32 v146, v146
    v_exp_f32 v147, v147
    v_add_f32 v221, v221, v140
    ds_read_b128 v[188:191], v10 offset:8192
    s_waitcnt lgkmcnt(7)
    v_mfma_f32_32x32x16_bf16 v[108:123], v[192:195], v[16:19], v[108:123]
    v_add_f32 v222, v222, v141
    s_add_u32 m0, s7, 36864
    s_add_u32 s4, s60, 4096
    buffer_load_dwordx4 v8, s[16:19], s4 offen lds
    v_cvt_pk_bf16_f32 v140, v140, v141
    ds_read_b128 v[192:195], v10 offset:9216
    s_waitcnt lgkmcnt(7)
    v_mfma_f32_32x32x16_bf16 v[108:123], v[196:199], v[20:23], v[108:123]
    v_add_f32 v221, v221, v142
    v_add_f32 v222, v222, v143
    v_cvt_pk_bf16_f32 v141, v142, v143
    v_add_f32 v221, v221, v144
    ds_read_b128 v[196:199], v10 offset:10240
    s_waitcnt lgkmcnt(7)
    v_mfma_f32_32x32x16_bf16 v[108:123], v[200:203], v[24:27], v[108:123]
    v_add_f32 v222, v222, v145
    s_add_u32 m0, s7, 40960
    s_add_u32 s4, s60, 8192
    buffer_load_dwordx4 v8, s[16:19], s4 offen lds
    v_cvt_pk_bf16_f32 v142, v144, v145
    ds_read_b128 v[200:203], v10 offset:11264
    s_waitcnt lgkmcnt(7)
    v_mfma_f32_32x32x16_bf16 v[108:123], v[204:207], v[28:31], v[108:123]
    v_add_f32 v221, v221, v146
    v_add_f32 v222, v222, v147
    v_cvt_pk_bf16_f32 v143, v146, v147
    v_exp_f32 v148, v148
    ds_read_b128 v[204:207], v10 offset:12288
    s_waitcnt lgkmcnt(7)
    v_mfma_f32_32x32x16_bf16 v[108:123], v[208:211], v[32:35], v[108:123]
    v_exp_f32 v149, v149
    s_add_u32 m0, s7, 45056
    s_add_u32 s4, s60, 12288
    buffer_load_dwordx4 v8, s[16:19], s4 offen lds
    v_exp_f32 v150, v150
    ds_read_b128 v[208:211], v10 offset:13312
    s_waitcnt lgkmcnt(7)
    v_mfma_f32_32x32x16_bf16 v[108:123], v[212:215], v[36:39], v[108:123]
    v_exp_f32 v151, v151
    v_exp_f32 v152, v152
    v_exp_f32 v153, v153
    ds_read_b128 v[212:215], v10 offset:14336
    s_waitcnt lgkmcnt(7)
    v_mfma_f32_32x32x16_bf16 v[108:123], v[216:219], v[40:43], v[108:123]
    v_exp_f32 v154, v154
    v_exp_f32 v155, v155
    s_add_u32 m0, s7, 49152
    s_add_u32 s4, s60, 16384
    buffer_load_dwordx4 v8, s[16:19], s4 offen lds
    v_add_f32 v221, v221, v148
    ds_read_b128 v[216:219], v10 offset:15360
    s_waitcnt lgkmcnt(7)
    v_mfma_f32_32x32x16_bf16 v[124:139], v[188:191], v[12:15], v[172:187]
    v_add_f32 v222, v222, v149
    v_cvt_pk_bf16_f32 v148, v148, v149
    v_add_f32 v221, v221, v150
    ds_read_b128 v[188:191], v11 offset:32768
    s_waitcnt lgkmcnt(7)
    v_mfma_f32_32x32x16_bf16 v[124:139], v[192:195], v[16:19], v[124:139]
    v_add_f32 v222, v222, v151
    v_cvt_pk_bf16_f32 v149, v150, v151
    s_add_u32 m0, s7, 53248
    s_add_u32 s4, s60, 20480
    buffer_load_dwordx4 v8, s[16:19], s4 offen lds
    v_add_f32 v221, v221, v152
    ds_read_b128 v[192:195], v11 offset:40960
    s_waitcnt lgkmcnt(7)
    v_mfma_f32_32x32x16_bf16 v[124:139], v[196:199], v[20:23], v[124:139]
    v_add_f32 v222, v222, v153
    v_cvt_pk_bf16_f32 v150, v152, v153
    v_add_f32 v221, v221, v154
    ds_read_b128 v[196:199], v11 offset:49152
    s_waitcnt lgkmcnt(7)
    v_mfma_f32_32x32x16_bf16 v[124:139], v[200:203], v[24:27], v[124:139]
    v_add_f32 v222, v222, v155
    v_cvt_pk_bf16_f32 v151, v154, v155
    s_add_u32 m0, s7, 57344
    s_add_u32 s4, s60, 24576
    buffer_load_dwordx4 v8, s[16:19], s4 offen lds
    ds_read_b128 v[200:203], v11 offset:57344
    s_waitcnt lgkmcnt(7)
    v_mfma_f32_32x32x16_bf16 v[124:139], v[204:207], v[28:31], v[124:139]
    v_exp_f32 v156, v156
    v_exp_f32 v157, v157
    v_exp_f32 v158, v158
    v_exp_f32 v159, v159
    ds_read_b128 v[204:207], v11 offset:33792
    s_waitcnt lgkmcnt(7)
    v_mfma_f32_32x32x16_bf16 v[124:139], v[208:211], v[32:35], v[124:139]
    v_exp_f32 v160, v160
    v_exp_f32 v161, v161
    s_add_u32 m0, s7, 61440
    s_add_u32 s4, s60, 28672
    buffer_load_dwordx4 v8, s[16:19], s4 offen lds
    ds_read_b128 v[208:211], v11 offset:41984
    s_waitcnt lgkmcnt(7)
    v_mfma_f32_32x32x16_bf16 v[124:139], v[212:215], v[36:39], v[124:139]
    v_exp_f32 v162, v162
    v_exp_f32 v163, v163
    v_add_f32 v221, v221, v156
    v_add_f32 v222, v222, v157
    ds_read_b128 v[212:215], v11 offset:50176
    s_waitcnt lgkmcnt(7)
    v_mfma_f32_32x32x16_bf16 v[124:139], v[216:219], v[40:43], v[124:139]
    v_cvt_pk_bf16_f32 v156, v156, v157
    v_add_f32 v221, v221, v158
    s_add_u32 m0, s7, 65536
    s_add_u32 s4, s61, 0
    buffer_load_dwordx4 v9, s[20:23], s4 offen lds
    ds_read_b128 v[216:219], v11 offset:58368
    s_waitcnt lgkmcnt(7)
    v_mfma_f32_32x32x16_bf16 v[44:59], v[188:191], v[140:143], v[44:59]
    v_add_f32 v222, v222, v159
    v_cvt_pk_bf16_f32 v157, v158, v159
    v_add_f32 v221, v221, v160
    ds_read_b128 v[188:191], v11 offset:34816
    s_waitcnt lgkmcnt(7)
    v_mfma_f32_32x32x16_bf16 v[60:75], v[192:195], v[140:143], v[60:75]
    v_add_f32 v222, v222, v161
    v_cvt_pk_bf16_f32 v158, v160, v161
    v_add_f32 v221, v221, v162
    s_add_u32 m0, s7, 69632
    s_add_u32 s4, s61, 4096
    buffer_load_dwordx4 v9, s[20:23], s4 offen lds
    ds_read_b128 v[192:195], v11 offset:43008
    s_waitcnt lgkmcnt(7)
    v_mfma_f32_32x32x16_bf16 v[76:91], v[196:199], v[140:143], v[76:91]
    v_add_f32 v222, v222, v163
    v_cvt_pk_bf16_f32 v159, v162, v163
    v_exp_f32 v164, v164
    ds_read_b128 v[196:199], v11 offset:51200
    s_waitcnt lgkmcnt(7)
    v_mfma_f32_32x32x16_bf16 v[92:107], v[200:203], v[140:143], v[92:107]
    v_exp_f32 v165, v165
    v_exp_f32 v166, v166
    v_exp_f32 v167, v167
    s_add_u32 m0, s7, 73728
    s_add_u32 s4, s61, 131072
    buffer_load_dwordx4 v9, s[20:23], s4 offen lds
    ds_read_b128 v[200:203], v11 offset:59392
    s_waitcnt lgkmcnt(7)
    v_mfma_f32_32x32x16_bf16 v[44:59], v[204:207], v[148:151], v[44:59]
    v_exp_f32 v168, v168
    v_exp_f32 v169, v169
    v_exp_f32 v170, v170
    ds_read_b128 v[204:207], v11 offset:35840
    s_waitcnt lgkmcnt(7)
    v_mfma_f32_32x32x16_bf16 v[60:75], v[208:211], v[148:151], v[60:75]
    v_exp_f32 v171, v171
    v_add_f32 v221, v221, v164
    v_add_f32 v222, v222, v165
    ds_read_b128 v[208:211], v11 offset:44032
    s_waitcnt lgkmcnt(7)
    v_mfma_f32_32x32x16_bf16 v[76:91], v[212:215], v[148:151], v[76:91]
    s_add_u32 m0, s7, 77824
    s_add_u32 s4, s61, 135168
    buffer_load_dwordx4 v9, s[20:23], s4 offen lds
    v_cvt_pk_bf16_f32 v164, v164, v165
    v_add_f32 v221, v221, v166
    v_add_f32 v222, v222, v167
    ds_read_b128 v[212:215], v11 offset:52224
    s_waitcnt lgkmcnt(7)
    v_mfma_f32_32x32x16_bf16 v[92:107], v[216:219], v[148:151], v[92:107]
    v_cvt_pk_bf16_f32 v165, v166, v167
    v_add_f32 v221, v221, v168
    v_add_f32 v222, v222, v169
    ds_read_b128 v[216:219], v11 offset:60416
    s_waitcnt lgkmcnt(7)
    v_mfma_f32_32x32x16_bf16 v[44:59], v[188:191], v[156:159], v[44:59]
    s_add_u32 m0, s7, 81920
    s_add_u32 s4, s61, 262144
    buffer_load_dwordx4 v9, s[20:23], s4 offen lds
    v_cvt_pk_bf16_f32 v166, v168, v169
    v_add_f32 v221, v221, v170
    v_add_f32 v222, v222, v171
    s_waitcnt lgkmcnt(6)
    v_mfma_f32_32x32x16_bf16 v[60:75], v[192:195], v[156:159], v[60:75]
    v_cvt_pk_bf16_f32 v167, v170, v171
    v_max3_f32 v4, v108, v109, v110
    v_max3_f32 v5, v111, v112, v113
    s_waitcnt lgkmcnt(5)
    v_mfma_f32_32x32x16_bf16 v[76:91], v[196:199], v[156:159], v[76:91]
    s_add_u32 m0, s7, 86016
    s_add_u32 s4, s61, 266240
    buffer_load_dwordx4 v9, s[20:23], s4 offen lds
    v_max3_f32 v4, v4, v114, v115
    v_max3_f32 v5, v5, v116, v117
    s_waitcnt lgkmcnt(4)
    v_mfma_f32_32x32x16_bf16 v[92:107], v[200:203], v[156:159], v[92:107]
    v_max3_f32 v4, v4, v118, v119
    v_max3_f32 v5, v5, v120, v121
    v_max3_f32 v4, v4, v122, v123
    v_max3_f32 v5, v5, v124, v125
    s_waitcnt lgkmcnt(3)
    v_mfma_f32_32x32x16_bf16 v[44:59], v[204:207], v[164:167], v[44:59]
    s_add_u32 m0, s7, 90112
    s_add_u32 s4, s61, 393216
    buffer_load_dwordx4 v9, s[20:23], s4 offen lds
    v_max3_f32 v4, v4, v126, v127
    v_max3_f32 v5, v5, v128, v129
    s_waitcnt lgkmcnt(2)
    v_mfma_f32_32x32x16_bf16 v[60:75], v[208:211], v[164:167], v[60:75]
    v_max3_f32 v4, v4, v130, v131
    v_max3_f32 v5, v5, v132, v133
    v_max3_f32 v4, v4, v134, v135
    v_max3_f32 v5, v5, v136, v137
    s_waitcnt lgkmcnt(1)
    v_mfma_f32_32x32x16_bf16 v[76:91], v[212:215], v[164:167], v[76:91]
    s_add_u32 m0, s7, 94208
    s_add_u32 s4, s61, 397312
    buffer_load_dwordx4 v9, s[20:23], s4 offen lds
    v_max3_f32 v4, v4, v138, v139
    v_max_f32 v4, v4, v5
    s_waitcnt lgkmcnt(0)
    v_mfma_f32_32x32x16_bf16 v[92:107], v[216:219], v[164:167], v[92:107]
    v_mov_b32 v5, v4
    s_nop 1
    v_permlane32_swap_b32 v4, v5
    v_max_f32 v228, v4, v5
    v_cmp_gt_f32 vcc, v228, v223
    s_nop 4
    s_cbranch_vccz k2_attn_kernel_keep_7
    v_max_f32 v4, 0, v228
    v_sub_f32 v5, 0, v4
    v_exp_f32 v5, v5
    v_add_f32 v220, v220, v4
    v_sub_f32 v172, 0, v220
    v_sub_f32 v173, 0, v220
    v_sub_f32 v174, 0, v220
    v_sub_f32 v175, 0, v220
    v_sub_f32 v176, 0, v220
    v_sub_f32 v177, 0, v220
    v_sub_f32 v178, 0, v220
    v_sub_f32 v179, 0, v220
    v_sub_f32 v180, 0, v220
    v_sub_f32 v181, 0, v220
    v_sub_f32 v182, 0, v220
    v_sub_f32 v183, 0, v220
    v_sub_f32 v184, 0, v220
    v_sub_f32 v185, 0, v220
    v_sub_f32 v186, 0, v220
    v_sub_f32 v187, 0, v220
    v_sub_f32 v108, v108, v4
    v_sub_f32 v109, v109, v4
    v_sub_f32 v110, v110, v4
    v_sub_f32 v111, v111, v4
    v_sub_f32 v112, v112, v4
    v_sub_f32 v113, v113, v4
    v_sub_f32 v114, v114, v4
    v_sub_f32 v115, v115, v4
    v_sub_f32 v116, v116, v4
    v_sub_f32 v117, v117, v4
    v_sub_f32 v118, v118, v4
    v_sub_f32 v119, v119, v4
    v_sub_f32 v120, v120, v4
    v_sub_f32 v121, v121, v4
    v_sub_f32 v122, v122, v4
    v_sub_f32 v123, v123, v4
    v_sub_f32 v124, v124, v4
    v_sub_f32 v125, v125, v4
    v_sub_f32 v126, v126, v4
    v_sub_f32 v127, v127, v4
    v_sub_f32 v128, v128, v4
    v_sub_f32 v129, v129, v4
    v_sub_f32 v130, v130, v4
    v_sub_f32 v131, v131, v4
    v_sub_f32 v132, v132, v4
    v_sub_f32 v133, v133, v4
    v_sub_f32 v134, v134, v4
    v_sub_f32 v135, v135, v4
    v_sub_f32 v136, v136, v4
    v_sub_f32 v137, v137, v4
    v_sub_f32 v138, v138, v4
    v_sub_f32 v139, v139, v4
    v_mul_f32 v221, v221, v5
    v_mul_f32 v222, v222, v5
    v_mul_f32 v44, v44, v5
    v_mul_f32 v45, v45, v5
    v_mul_f32 v46, v46, v5
    v_mul_f32 v47, v47, v5
    v_mul_f32 v48, v48, v5
    v_mul_f32 v49, v49, v5
    v_mul_f32 v50, v50, v5
    v_mul_f32 v51, v51, v5
    v_mul_f32 v52, v52, v5
    v_mul_f32 v53, v53, v5
    v_mul_f32 v54, v54, v5
    v_mul_f32 v55, v55, v5
    v_mul_f32 v56, v56, v5
    v_mul_f32 v57, v57, v5
    v_mul_f32 v58, v58, v5
    v_mul_f32 v59, v59, v5
    v_mul_f32 v60, v60, v5
    v_mul_f32 v61, v61, v5
    v_mul_f32 v62, v62, v5
    v_mul_f32 v63, v63, v5
    v_mul_f32 v64, v64, v5
    v_mul_f32 v65, v65, v5
    v_mul_f32 v66, v66, v5
    v_mul_f32 v67, v67, v5
    v_mul_f32 v68, v68, v5
    v_mul_f32 v69, v69, v5
    v_mul_f32 v70, v70, v5
    v_mul_f32 v71, v71, v5
    v_mul_f32 v72, v72, v5
    v_mul_f32 v73, v73, v5
    v_mul_f32 v74, v74, v5
    v_mul_f32 v75, v75, v5
    v_mul_f32 v76, v76, v5
    v_mul_f32 v77, v77, v5
    v_mul_f32 v78, v78, v5
    v_mul_f32 v79, v79, v5
    v_mul_f32 v80, v80, v5
    v_mul_f32 v81, v81, v5
    v_mul_f32 v82, v82, v5
    v_mul_f32 v83, v83, v5
    v_mul_f32 v84, v84, v5
    v_mul_f32 v85, v85, v5
    v_mul_f32 v86, v86, v5
    v_mul_f32 v87, v87, v5
    v_mul_f32 v88, v88, v5
    v_mul_f32 v89, v89, v5
    v_mul_f32 v90, v90, v5
    v_mul_f32 v91, v91, v5
    v_mul_f32 v92, v92, v5
    v_mul_f32 v93, v93, v5
    v_mul_f32 v94, v94, v5
    v_mul_f32 v95, v95, v5
    v_mul_f32 v96, v96, v5
    v_mul_f32 v97, v97, v5
    v_mul_f32 v98, v98, v5
    v_mul_f32 v99, v99, v5
    v_mul_f32 v100, v100, v5
    v_mul_f32 v101, v101, v5
    v_mul_f32 v102, v102, v5
    v_mul_f32 v103, v103, v5
    v_mul_f32 v104, v104, v5
    v_mul_f32 v105, v105, v5
    v_mul_f32 v106, v106, v5
    v_mul_f32 v107, v107, v5
    s_nop 0
k2_attn_kernel_keep_7:
    s_branch k2_attn_kernel_loop0_0
k2_attn_kernel_last1_0:
    s_mov_b32 s60, 0
    s_add_u32 s61, s61, 8192
    ds_read_b128 v[188:191], v10 offset:0
    ds_read_b128 v[192:195], v10 offset:1024
    ds_read_b128 v[196:199], v10 offset:2048
    ds_read_b128 v[200:203], v10 offset:3072
    ds_read_b128 v[204:207], v10 offset:4096
    ds_read_b128 v[208:211], v10 offset:5120
    ds_read_b128 v[212:215], v10 offset:6144
    v_exp_f32 v140, v140
    v_exp_f32 v141, v141
    v_exp_f32 v142, v142
    v_exp_f32 v143, v143
    s_add_u32 m0, s7, 65536
    s_add_u32 s4, s61, 0
    buffer_load_dwordx4 v9, s[20:23], s4 offen lds
    v_exp_f32 v144, v144
    ds_read_b128 v[216:219], v10 offset:7168
    s_waitcnt lgkmcnt(7)
    v_mfma_f32_32x32x16_bf16 v[108:123], v[188:191], v[12:15], v[172:187]
    v_exp_f32 v145, v145
    v_exp_f32 v146, v146
    v_exp_f32 v147, v147
    v_add_f32 v221, v221, v140
    v_add_f32 v222, v222, v141
    v_cvt_pk_bf16_f32 v140, v140, v141
    ds_read_b128 v[188:191], v10 offset:8192
    s_waitcnt lgkmcnt(7)
    v_mfma_f32_32x32x16_bf16 v[108:123], v[192:195], v[16:19], v[108:123]
    v_add_f32 v221, v221, v142
    v_add_f32 v222, v222, v143
    s_add_u32 m0, s7, 69632
    s_add_u32 s4, s61, 4096
    buffer_load_dwordx4 v9, s[20:23], s4 offen lds
    v_cvt_pk_bf16_f32 v141, v142, v143
    v_add_f32 v221, v221, v144
    ds_read_b128 v[192:195], v10 offset:9216
    s_waitcnt lgkmcnt(7)
    v_mfma_f32_32x32x16_bf16 v[108:123], v[196:199], v[20:23], v[108:123]
    v_add_f32 v222, v222, v145
    v_cvt_pk_bf16_f32 v142, v144, v145
    v_add_f32 v221, v221, v146
    v_add_f32 v222, v222, v147
    v_cvt_pk_bf16_f32 v143, v146, v147
    v_exp_f32 v148, v148
    ds_read_b128 v[196:199], v10 offset:10240
    s_waitcnt lgkmcnt(7)
    v_mfma_f32_32x32x16_bf16 v[108:123], v[200:203], v[24:27], v[108:123]
    v_exp_f32 v149, v149
    s_add_u32 m0, s7, 73728
    s_add_u32 s4, s61, 131072
    buffer_load_dwordx4 v9, s[20:23], s4 offen lds
    v_exp_f32 v150, v150
    v_exp_f32 v151, v151
    v_exp_f32 v152, v152
    ds_read_b128 v[200:203], v10 offset:11264
    s_waitcnt lgkmcnt(7)
    v_mfma_f32_32x32x16_bf16 v[108:123], v[204:207], v[28:31], v[108:123]
    v_exp_f32 v153, v153
    v_exp_f32 v154, v154
    v_exp_f32 v155, v155
    v_add_f32 v221, v221, v148
    v_add_f32 v222, v222, v149
    v_cvt_pk_bf16_f32 v148, v148, v149
    ds_read_b128 v[204:207], v10 offset:12288
    s_waitcnt lgkmcnt(7)
    v_mfma_f32_32x32x16_bf16 v[108:123], v[208:211], v[32:35], v[108:123]
    s_add_u32 m0, s7, 77824
    s_add_u32 s4, s61, 135168
    buffer_load_dwordx4 v9, s[20:23], s4 offen lds
    v_add_f32 v221, v221, v150
    v_add_f32 v222, v222, v151
    v_cvt_pk_bf16_f32 v149, v150, v151
    v_add_f32 v221, v221, v152
    ds_read_b128 v[208:211], v10 offset:13312
    s_waitcnt lgkmcnt(7)
    v_mfma_f32_32x32x16_bf16 v[108:123], v[212:215], v[36:39], v[108:123]
    v_add_f32 v222, v222, v153
    v_cvt_pk_bf16_f32 v150, v152, v153
    v_add_f32 v221, v221, v154
    v_add_f32 v222, v222, v155
    v_cvt_pk_bf16_f32 v151, v154, v155
    ds_read_b128 v[212:215], v10 offset:14336
    s_waitcnt lgkmcnt(7)
    v_mfma_f32_32x32x16_bf16 v[108:123], v[216:219], v[40:43], v[108:123]
    s_add_u32 m0, s7, 81920
    s_add_u32 s4, s61, 262144
    buffer_load_dwordx4 v9, s[20:23], s4 offen lds
    v_exp_f32 v156, v156
    v_exp_f32 v157, v157
    v_exp_f32 v158, v158
    v_exp_f32 v159, v159
    v_exp_f32 v160, v160
    ds_read_b128 v[216:219], v10 offset:15360
    s_waitcnt lgkmcnt(7)
    v_mfma_f32_32x32x16_bf16 v[124:139], v[188:191], v[12:15], v[172:187]
    v_exp_f32 v161, v161
    v_exp_f32 v162, v162
    v_exp_f32 v163, v163
    v_add_f32 v221, v221, v156
    s_add_u32 m0, s7, 86016
    s_add_u32 s4, s61, 266240
    buffer_load_dwordx4 v9, s[20:23], s4 offen lds
    ds_read_b128 v[188:191], v11 offset:32768
    s_waitcnt lgkmcnt(7)
    v_mfma_f32_32x32x16_bf16 v[124:139], v[192:195], v[16:19], v[124:139]
    v_add_f32 v222, v222, v157
    v_cvt_pk_bf16_f32 v156, v156, v157
    v_add_f32 v221, v221, v158
    v_add_f32 v222, v222, v159
    v_cvt_pk_bf16_f32 v157, v158, v159
    v_add_f32 v221, v221, v160
    ds_read_b128 v[192:195], v11 offset:40960
    s_waitcnt lgkmcnt(7)
    v_mfma_f32_32x32x16_bf16 v[124:139], v[196:199], v[20:23], v[124:139]
    v_add_f32 v222, v222, v161
    v_cvt_pk_bf16_f32 v158, v160, v161
    v_add_f32 v221, v221, v162
    s_add_u32 m0, s7, 90112
    s_add_u32 s4, s61, 393216
    buffer_load_dwordx4 v9, s[20:23], s4 offen lds
    v_add_f32 v222, v222, v163
    ds_read_b128 v[196:199], v11 offset:49152
    s_waitcnt lgkmcnt(7)
    v_mfma_f32_32x32x16_bf16 v[124:139], v[200:203], v[24:27], v[124:139]
    v_cvt_pk_bf16_f32 v159, v162, v163
    v_exp_f32 v164, v164
    v_exp_f32 v165, v165
    v_exp_f32 v166, v166
    v_exp_f32 v167, v167
    ds_read_b128 v[200:203], v11 offset:57344
    s_waitcnt lgkmcnt(7)
    v_mfma_f32_32x32x16_bf16 v[124:139], v[204:207], v[28:31], v[124:139]
    v_exp_f32 v168, v168
    v_exp_f32 v169, v169
    v_exp_f32 v170, v170
    s_add_u32 m0, s7, 94208
    s_add_u32 s4, s61, 397312
    buffer_load_dwordx4 v9, s[20:23], s4 offen lds
    v_exp_f32 v171, v171
    v_add_f32 v221, v221, v164
    ds_read_b128 v[204:207], v11 offset:33792
    s_waitcnt lgkmcnt(7)
    v_mfma_f32_32x32x16_bf16 v[124:139], v[208:211], v[32:35], v[124:139]
    v_add_f32 v222, v222, v165
    v_cvt_pk_bf16_f32 v164, v164, v165
    v_add_f32 v221, v221, v166
    v_add_f32 v222, v222, v167
    v_cvt_pk_bf16_f32 v165, v166, v167
    ds_read_b128 v[208:211], v11 offset:41984
    s_waitcnt lgkmcnt(7)
    v_mfma_f32_32x32x16_bf16 v[124:139], v[212:215], v[36:39], v[124:139]
    v_add_f32 v221, v221, v168
    v_add_f32 v222, v222, v169
    s_add_u32 m0, s7, 32768
    s_add_u32 s4, s60, 0
    buffer_load_dwordx4 v8, s[16:19], s4 offen lds
    v_cvt_pk_bf16_f32 v166, v168, v169
    v_add_f32 v221, v221, v170
    v_add_f32 v222, v222, v171
    ds_read_b128 v[212:215], v11 offset:50176
    s_waitcnt lgkmcnt(7)
    v_mfma_f32_32x32x16_bf16 v[124:139], v[216:219], v[40:43], v[124:139]
    v_cvt_pk_bf16_f32 v167, v170, v171
    v_cmp_ge_i32 vcc, v226, 0
    s_nop 1
    v_cndmask_b32 v108, v227, v108, vcc
    v_cmp_ge_i32 vcc, v226, 1
    s_nop 1
    v_cndmask_b32 v109, v227, v109, vcc
    ds_read_b128 v[216:219], v11 offset:58368
    s_waitcnt lgkmcnt(7)
    v_mfma_f32_32x32x16_bf16 v[44:59], v[188:191], v[140:143], v[44:59]
    v_cmp_ge_i32 vcc, v226, 2
    s_add_u32 m0, s7, 36864
    s_add_u32 s4, s60, 4096
    buffer_load_dwordx4 v8, s[16:19], s4 offen lds
    v_cndmask_b32 v110, v227, v110, vcc
    v_cmp_ge_i32 vcc, v226, 3
    s_nop 1
    v_cndmask_b32 v111, v227, v111, vcc
    ds_read_b128 v[188:191], v11 offset:34816
    s_waitcnt lgkmcnt(7)
    v_mfma_f32_32x32x16_bf16 v[60:75], v[192:195], v[140:143], v[60:75]
    v_cmp_ge_i32 vcc, v226, 8
    s_nop 1
    v_cndmask_b32 v112, v227, v112, vcc
    v_cmp_ge_i32 vcc, v226, 9
    s_nop 1
    v_cndmask_b32 v113, v227, v113, vcc
    v_cmp_ge_i32 vcc, v226, 10
    s_nop 1
    v_cndmask_b32 v114, v227, v114, vcc
    ds_read_b128 v[192:195], v11 offset:43008
    s_waitcnt lgkmcnt(7)
    v_mfma_f32_32x32x16_bf16 v[76:91], v[196:199], v[140:143], v[76:91]
    s_add_u32 m0, s7, 40960
    s_add_u32 s4, s60, 8192
    buffer_load_dwordx4 v8, s[16:19], s4 offen lds
    v_cmp_ge_i32 vcc, v226, 11
    s_nop 1
    v_cndmask_b32 v115, v227, v115, vcc
    v_cmp_ge_i32 vcc, v226, 16
    s_nop 1
    v_cndmask_b32 v116, v227, v116, vcc
    ds_read_b128 v[196:199], v11 offset:51200
    s_waitcnt lgkmcnt(7)
    v_mfma_f32_32x32x16_bf16 v[92:107], v[200:203], v[140:143], v[92:107]
    v_cmp_ge_i32 vcc, v226, 17
    s_nop 1
    v_cndmask_b32 v117, v227, v117, vcc
    v_cmp_ge_i32 vcc, v226, 18
    s_nop 1
    v_cndmask_b32 v118, v227, v118, vcc
    v_cmp_ge_i32 vcc, v226, 19
    s_add_u32 m0, s7, 45056
    s_add_u32 s4, s60, 12288
    buffer_load_dwordx4 v8, s[16:19], s4 offen lds
    ds_read_b128 v[200:203], v11 offset:59392
    s_waitcnt lgkmcnt(7)
    v_mfma_f32_32x32x16_bf16 v[44:59], v[204:207], v[148:151], v[44:59]
    v_cndmask_b32 v119, v227, v119, vcc
    v_cmp_ge_i32 vcc, v226, 24
    s_nop 1
    v_cndmask_b32 v120, v227, v120, vcc
    v_cmp_ge_i32 vcc, v226, 25
    s_nop 1
    v_cndmask_b32 v121, v227, v121, vcc
    ds_read_b128 v[204:207], v11 offset:35840
    s_waitcnt lgkmcnt(7)
    v_mfma_f32_32x32x16_bf16 v[60:75], v[208:211], v[148:151], v[60:75]
    v_cmp_ge_i32 vcc, v226, 26
    s_nop 1
    v_cndmask_b32 v122, v227, v122, vcc
    v_cmp_ge_i32 vcc, v226, 27
    s_nop 1
    v_cndmask_b32 v123, v227, v123, vcc
    s_add_u32 m0, s7, 49152
    s_add_u32 s4, s60, 16384
    buffer_load_dwordx4 v8, s[16:19], s4 offen lds
    ds_read_b128 v[208:211], v11 offset:44032
    s_waitcnt lgkmcnt(7)
    v_mfma_f32_32x32x16_bf16 v[76:91], v[212:215], v[148:151], v[76:91]
    v_cmp_ge_i32 vcc, v226, 32
    s_nop 1
    v_cndmask_b32 v124, v227, v124, vcc
    v_cmp_ge_i32 vcc, v226, 33
    s_nop 1
    v_cndmask_b32 v125, v227, v125, vcc
    v_cmp_ge_i32 vcc, v226, 34
    s_nop 1
    v_cndmask_b32 v126, v227, v126, vcc
    ds_read_b128 v[212:215], v11 offset:52224
    s_waitcnt lgkmcnt(7)
    v_mfma_f32_32x32x16_bf16 v[92:107], v[216:219], v[148:151], v[92:107]
    v_cmp_ge_i32 vcc, v226, 35
    s_nop 1
    v_cndmask_b32 v127, v227, v127, vcc
    v_cmp_ge_i32 vcc, v226, 40
    s_add_u32 m0, s7, 53248
    s_add_u32 s4, s60, 20480
    buffer_load_dwordx4 v8, s[16:19], s4 offen lds
    v_cndmask_b32 v128, v227, v128, vcc
    ds_read_b128 v[216:219], v11 offset:60416
    s_waitcnt lgkmcnt(7)
    v_mfma_f32_32x32x16_bf16 v[44:59], v[188:191], v[156:159], v[44:59]
    v_cmp_ge_i32 vcc, v226, 41
    s_nop 1
    v_cndmask_b32 v129, v227, v129, vcc
    v_cmp_ge_i32 vcc, v226, 42
    s_nop 1
    v_cndmask_b32 v130, v227, v130, vcc
    v_cmp_ge_i32 vcc, v226, 43
    s_nop 1
    v_cndmask_b32 v131, v227, v131, vcc
    s_waitcnt lgkmcnt(6)
    v_mfma_f32_32x32x16_bf16 v[60:75], v[192:195], v[156:159], v[60:75]
    v_cmp_ge_i32 vcc, v226, 48
    s_nop 1
    v_cndmask_b32 v132, v227, v132, vcc
    s_add_u32 m0, s7, 57344
    s_add_u32 s4, s60, 24576
    buffer_load_dwordx4 v8, s[16:19], s4 offen lds
    v_cmp_ge_i32 vcc, v226, 49
    s_nop 1
    v_cndmask_b32 v133, v227, v133, vcc
    s_waitcnt lgkmcnt(5)
    v_mfma_f32_32x32x16_bf16 v[76:91], v[196:199], v[156:159], v[76:91]
    v_cmp_ge_i32 vcc, v226, 50
    s_nop 1
    v_cndmask_b32 v134, v227, v134, vcc
    v_cmp_ge_i32 vcc, v226, 51
    s_nop 1
    v_cndmask_b32 v135, v227, v135, vcc
    v_cmp_ge_i32 vcc, v226, 56
    s_waitcnt lgkmcnt(4)
    v_mfma_f32_32x32x16_bf16 v[92:107], v[200:203], v[156:159], v[92:107]
    v_cndmask_b32 v136, v227, v136, vcc
    v_cmp_ge_i32 vcc, v226, 57
    s_add_u32 m0, s7, 61440
    s_add_u32 s4, s60, 28672
    buffer_load_dwordx4 v8, s[16:19], s4 offen lds
    v_cndmask_b32 v137, v227, v137, vcc
    v_cmp_ge_i32 vcc, v226, 58
    s_nop 1
    v_cndmask_b32 v138, v227, v138, vcc
    s_waitcnt lgkmcnt(3)
    v_mfma_f32_32x32x16_bf16 v[44:59], v[204:207], v[164:167], v[44:59]
    v_cmp_ge_i32 vcc, v226, 59
    s_nop 1
    v_cndmask_b32 v139, v227, v139, vcc
    v_max3_f32 v4, v108, v109, v110
    v_max3_f32 v5, v111, v112, v113
    v_max3_f32 v4, v4, v114, v115
    s_waitcnt lgkmcnt(2)
    v_mfma_f32_32x32x16_bf16 v[60:75], v[208:211], v[164:167], v[60:75]
    v_max3_f32 v5, v5, v116, v117
    v_max3_f32 v4, v4, v118, v119
    v_max3_f32 v5, v5, v120, v121
    v_max3_f32 v4, v4, v122, v123
    v_max3_f32 v5, v5, v124, v125
    v_max3_f32 v4, v4, v126, v127
    s_waitcnt lgkmcnt(1)
    v_mfma_f32_32x32x16_bf16 v[76:91], v[212:215], v[164:167], v[76:91]
    v_max3_f32 v5, v5, v128, v129
    v_max3_f32 v4, v4, v130, v131
    v_max3_f32 v5, v5, v132, v133
    v_max3_f32 v4, v4, v134, v135
    v_max3_f32 v5, v5, v136, v137
    s_waitcnt lgkmcnt(0)
    v_mfma_f32_32x32x16_bf16 v[92:107], v[216:219], v[164:167], v[92:107]
    v_max3_f32 v4, v4, v138, v139
    v_max_f32 v4, v4, v5
    v_mov_b32 v5, v4
    s_nop 1
    v_permlane32_swap_b32 v4, v5
    v_max_f32 v228, v4, v5
    v_cmp_gt_f32 vcc, v228, v223
    s_nop 3
    s_cbranch_vccz k2_attn_kernel_keep_8
    v_max_f32 v4, 0, v228
    v_sub_f32 v5, 0, v4
    v_exp_f32 v5, v5
    v_add_f32 v220, v220, v4
    v_sub_f32 v172, 0, v220
    v_sub_f32 v173, 0, v220
    v_sub_f32 v174, 0, v220
    v_sub_f32 v175, 0, v220
    v_sub_f32 v176, 0, v220
    v_sub_f32 v177, 0, v220
    v_sub_f32 v178, 0, v220
    v_sub_f32 v179, 0, v220
    v_sub_f32 v180, 0, v220
    v_sub_f32 v181, 0, v220
    v_sub_f32 v182, 0, v220
    v_sub_f32 v183, 0, v220
    v_sub_f32 v184, 0, v220
    v_sub_f32 v185, 0, v220
    v_sub_f32 v186, 0, v220
    v_sub_f32 v187, 0, v220
    v_sub_f32 v108, v108, v4
    v_sub_f32 v109, v109, v4
    v_sub_f32 v110, v110, v4
    v_sub_f32 v111, v111, v4
    v_sub_f32 v112, v112, v4
    v_sub_f32 v113, v113, v4
    v_sub_f32 v114, v114, v4
    v_sub_f32 v115, v115, v4
    v_sub_f32 v116, v116, v4
    v_sub_f32 v117, v117, v4
    v_sub_f32 v118, v118, v4
    v_sub_f32 v119, v119, v4
    v_sub_f32 v120, v120, v4
    v_sub_f32 v121, v121, v4
    v_sub_f32 v122, v122, v4
    v_sub_f32 v123, v123, v4
    v_sub_f32 v124, v124, v4
    v_sub_f32 v125, v125, v4
    v_sub_f32 v126, v126, v4
    v_sub_f32 v127, v127, v4
    v_sub_f32 v128, v128, v4
    v_sub_f32 v129, v129, v4
    v_sub_f32 v130, v130, v4
    v_sub_f32 v131, v131, v4
    v_sub_f32 v132, v132, v4
    v_sub_f32 v133, v133, v4
    v_sub_f32 v134, v134, v4
    v_sub_f32 v135, v135, v4
    v_sub_f32 v136, v136, v4
    v_sub_f32 v137, v137, v4
    v_sub_f32 v138, v138, v4
    v_sub_f32 v139, v139, v4
    v_mul_f32 v221, v221, v5
    v_mul_f32 v222, v222, v5
    v_mul_f32 v44, v44, v5
    v_mul_f32 v45, v45, v5
    v_mul_f32 v46, v46, v5
    v_mul_f32 v47, v47, v5
    v_mul_f32 v48, v48, v5
    v_mul_f32 v49, v49, v5
    v_mul_f32 v50, v50, v5
    v_mul_f32 v51, v51, v5
    v_mul_f32 v52, v52, v5
    v_mul_f32 v53, v53, v5
    v_mul_f32 v54, v54, v5
    v_mul_f32 v55, v55, v5
    v_mul_f32 v56, v56, v5
    v_mul_f32 v57, v57, v5
    v_mul_f32 v58, v58, v5
    v_mul_f32 v59, v59, v5
    v_mul_f32 v60, v60, v5
    v_mul_f32 v61, v61, v5
    v_mul_f32 v62, v62, v5
    v_mul_f32 v63, v63, v5
    v_mul_f32 v64, v64, v5
    v_mul_f32 v65, v65, v5
    v_mul_f32 v66, v66, v5
    v_mul_f32 v67, v67, v5
    v_mul_f32 v68, v68, v5
    v_mul_f32 v69, v69, v5
    v_mul_f32 v70, v70, v5
    v_mul_f32 v71, v71, v5
    v_mul_f32 v72, v72, v5
    v_mul_f32 v73, v73, v5
    v_mul_f32 v74, v74, v5
    v_mul_f32 v75, v75, v5
    v_mul_f32 v76, v76, v5
    v_mul_f32 v77, v77, v5
    v_mul_f32 v78, v78, v5
    v_mul_f32 v79, v79, v5
    v_mul_f32 v80, v80, v5
    v_mul_f32 v81, v81, v5
    v_mul_f32 v82, v82, v5
    v_mul_f32 v83, v83, v5
    v_mul_f32 v84, v84, v5
    v_mul_f32 v85, v85, v5
    v_mul_f32 v86, v86, v5
    v_mul_f32 v87, v87, v5
    v_mul_f32 v88, v88, v5
    v_mul_f32 v89, v89, v5
    v_mul_f32 v90, v90, v5
    v_mul_f32 v91, v91, v5
    v_mul_f32 v92, v92, v5
    v_mul_f32 v93, v93, v5
    v_mul_f32 v94, v94, v5
    v_mul_f32 v95, v95, v5
    v_mul_f32 v96, v96, v5
    v_mul_f32 v97, v97, v5
    v_mul_f32 v98, v98, v5
    v_mul_f32 v99, v99, v5
    v_mul_f32 v100, v100, v5
    v_mul_f32 v101, v101, v5
    v_mul_f32 v102, v102, v5
    v_mul_f32 v103, v103, v5
    v_mul_f32 v104, v104, v5
    v_mul_f32 v105, v105, v5
    v_mul_f32 v106, v106, v5
    v_mul_f32 v107, v107, v5
    s_nop 0
k2_attn_kernel_keep_8:
    s_branch k2_attn_kernel_epi0_0
k2_attn_kernel_epi0_0:
    s_waitcnt vmcnt(8) lgkmcnt(0)
    s_barrier
    s_sub_u32 s11, 15, s6
    s_lshl_b32 s11, s11, 7
    s_lshl_b32 s10, s8, 5
    s_add_u32 s10, s10, s11
    s_lshl_b32 s10, s10, 8
    v_lshlrev_b32 v225, 4, v1
    s_lshl_b32 s11, s5, 19
    s_add_u32 s10, s10, s11
    v_add_u32 v225, s10, v225
    buffer_load_dwordx4 v[12:15], v225, s[12:15], 0 offen offset:0
    buffer_load_dwordx4 v[16:19], v225, s[12:15], 0 offen offset:1024
    buffer_load_dwordx4 v[20:23], v225, s[12:15], 0 offen offset:2048
    buffer_load_dwordx4 v[24:27], v225, s[12:15], 0 offen offset:3072
    buffer_load_dwordx4 v[28:31], v225, s[12:15], s69 offen offset:0
    buffer_load_dwordx4 v[32:35], v225, s[12:15], s69 offen offset:1024
    buffer_load_dwordx4 v[36:39], v225, s[12:15], s69 offen offset:2048
    buffer_load_dwordx4 v[40:43], v225, s[12:15], s69 offen offset:3072
    ds_read_b128 v[188:191], v11 offset:0
    ds_read_b128 v[192:195], v11 offset:8192
    ds_read_b128 v[196:199], v11 offset:16384
    ds_read_b128 v[200:203], v11 offset:24576
    ds_read_b128 v[204:207], v11 offset:1024
    ds_read_b128 v[208:211], v11 offset:9216
    ds_read_b128 v[212:215], v11 offset:17408
    v_exp_f32 v108, v108
    v_exp_f32 v109, v109
    v_exp_f32 v110, v110
    v_exp_f32 v111, v111
    v_exp_f32 v112, v112
    v_exp_f32 v113, v113
    v_exp_f32 v114, v114
    v_exp_f32 v115, v115
    v_add_f32 v221, v221, v108
    v_add_f32 v222, v222, v109
    v_cvt_pk_bf16_f32 v108, v108, v109
    v_add_f32 v221, v221, v110
    v_add_f32 v222, v222, v111
    v_cvt_pk_bf16_f32 v109, v110, v111
    v_add_f32 v221, v221, v112
    v_add_f32 v222, v222, v113
    v_cvt_pk_bf16_f32 v110, v112, v113
    v_add_f32 v221, v221, v114
    v_add_f32 v222, v222, v115
    v_cvt_pk_bf16_f32 v111, v114, v115
    v_exp_f32 v116, v116
    v_exp_f32 v117, v117
    ds_read_b128 v[216:219], v11 offset:25600
    s_waitcnt lgkmcnt(7)
    v_mfma_f32_32x32x16_bf16 v[44:59], v[188:191], v[108:111], v[44:59]
    v_exp_f32 v118, v118
    v_exp_f32 v119, v119
    v_exp_f32 v120, v120
    v_exp_f32 v121, v121
    ds_read_b128 v[188:191], v11 offset:2048
    s_waitcnt lgkmcnt(7)
    v_mfma_f32_32x32x16_bf16 v[60:75], v[192:195], v[108:111], v[60:75]
    v_exp_f32 v122, v122
    v_exp_f32 v123, v123
    v_add_f32 v221, v221, v116
    v_add_f32 v222, v222, v117
    ds_read_b128 v[192:195], v11 offset:10240
    s_waitcnt lgkmcnt(7)
    v_mfma_f32_32x32x16_bf16 v[76:91], v[196:199], v[108:111], v[76:91]
    v_cvt_pk_bf16_f32 v116, v116, v117
    v_add_f32 v221, v221, v118
    v_add_f32 v222, v222, v119
    ds_read_b128 v[196:199], v11 offset:18432
    s_waitcnt lgkmcnt(7)
    v_mfma_f32_32x32x16_bf16 v[92:107], v[200:203], v[108:111], v[92:107]
    v_cvt_pk_bf16_f32 v117, v118, v119
    v_add_f32 v221, v221, v120
    v_add_f32 v222, v222, v121
    v_cvt_pk_bf16_f32 v118, v120, v121
    ds_read_b128 v[200:203], v11 offset:26624
    v_add_f32 v221, v221, v122
    v_add_f32 v222, v222, v123
    v_cvt_pk_bf16_f32 v119, v122, v123
    s_waitcnt lgkmcnt(7)
    s_nop 0
    v_mfma_f32_32x32x16_bf16 v[44:59], v[204:207], v[116:119], v[44:59]
    v_exp_f32 v124, v124
    ds_read_b128 v[204:207], v11 offset:3072
    s_waitcnt lgkmcnt(7)
    v_mfma_f32_32x32x16_bf16 v[60:75], v[208:211], v[116:119], v[60:75]
    v_exp_f32 v125, v125
    v_exp_f32 v126, v126
    v_exp_f32 v127, v127
    ds_read_b128 v[208:211], v11 offset:11264
    s_waitcnt lgkmcnt(7)
    v_mfma_f32_32x32x16_bf16 v[76:91], v[212:215], v[116:119], v[76:91]
    v_exp_f32 v128, v128
    v_exp_f32 v129, v129
    v_exp_f32 v130, v130
    v_exp_f32 v131, v131
    ds_read_b128 v[212:215], v11 offset:19456
    s_waitcnt lgkmcnt(7)
    v_mfma_f32_32x32x16_bf16 v[92:107], v[216:219], v[116:119], v[92:107]
    v_add_f32 v221, v221, v124
    v_add_f32 v222, v222, v125
    v_cvt_pk_bf16_f32 v124, v124, v125
    ds_read_b128 v[216:219], v11 offset:27648
    v_add_f32 v221, v221, v126
    v_add_f32 v222, v222, v127
    v_cvt_pk_bf16_f32 v125, v126, v127
    v_add_f32 v221, v221, v128
    v_add_f32 v222, v222, v129
    v_cvt_pk_bf16_f32 v126, v128, v129
    v_add_f32 v221, v221, v130
    v_add_f32 v222, v222, v131
    v_cvt_pk_bf16_f32 v127, v130, v131
    s_waitcnt lgkmcnt(7)
    s_nop 0
    v_mfma_f32_32x32x16_bf16 v[44:59], v[188:191], v[124:127], v[44:59]
    s_waitcnt lgkmcnt(6)
    v_mfma_f32_32x32x16_bf16 v[60:75], v[192:195], v[124:127], v[60:75]
    s_waitcnt lgkmcnt(5)
    v_mfma_f32_32x32x16_bf16 v[76:91], v[196:199], v[124:127], v[76:91]
    v_exp_f32 v132, v132
    v_exp_f32 v133, v133
    s_waitcnt lgkmcnt(4)
    v_mfma_f32_32x32x16_bf16 v[92:107], v[200:203], v[124:127], v[92:107]
    v_exp_f32 v134, v134
    v_exp_f32 v135, v135
    v_exp_f32 v136, v136
    v_exp_f32 v137, v137
    v_exp_f32 v138, v138
    v_exp_f32 v139, v139
    v_add_f32 v221, v221, v132
    v_add_f32 v222, v222, v133
    v_cvt_pk_bf16_f32 v132, v132, v133
    v_add_f32 v221, v221, v134
    v_add_f32 v222, v222, v135
    v_cvt_pk_bf16_f32 v133, v134, v135
    v_add_f32 v221, v221, v136
    v_add_f32 v222, v222, v137
    v_cvt_pk_bf16_f32 v134, v136, v137
    v_add_f32 v221, v221, v138
    v_add_f32 v222, v222, v139
    v_cvt_pk_bf16_f32 v135, v138, v139
    s_waitcnt lgkmcnt(3)
    s_nop 0
    v_mfma_f32_32x32x16_bf16 v[44:59], v[204:207], v[132:135], v[44:59]
    s_waitcnt lgkmcnt(2)
    v_mfma_f32_32x32x16_bf16 v[60:75], v[208:211], v[132:135], v[60:75]
    s_waitcnt lgkmcnt(1)
    v_mfma_f32_32x32x16_bf16 v[76:91], v[212:215], v[132:135], v[76:91]
    s_waitcnt lgkmcnt(0)
    v_mfma_f32_32x32x16_bf16 v[92:107], v[216:219], v[132:135], v[92:107]
    s_mov_b32 s68, 1
    s_mov_b32 s67, 0
    s_mov_b32 s61, 0
    s_nop 7
    s_branch k2_attn_kernel_merge0
k2_attn_kernel_epi1_0:
    s_waitcnt vmcnt(8) lgkmcnt(0)
    s_barrier
    s_sub_u32 s11, 15, s6
    s_lshl_b32 s11, s11, 7
    s_lshl_b32 s10, s8, 5
    s_add_u32 s10, s10, s11
    s_lshl_b32 s10, s10, 8
    v_lshlrev_b32 v225, 4, v1
    s_lshl_b32 s11, s5, 19
    s_add_u32 s10, s10, s11
    v_add_u32 v225, s10, v225
    buffer_load_dwordx4 v[12:15], v225, s[12:15], 0 offen offset:0
    buffer_load_dwordx4 v[16:19], v225, s[12:15], 0 offen offset:1024
    buffer_load_dwordx4 v[20:23], v225, s[12:15], 0 offen offset:2048
    buffer_load_dwordx4 v[24:27], v225, s[12:15], 0 offen offset:3072
    buffer_load_dwordx4 v[28:31], v225, s[12:15], s69 offen offset:0
    buffer_load_dwordx4 v[32:35], v225, s[12:15], s69 offen offset:1024
    buffer_load_dwordx4 v[36:39], v225, s[12:15], s69 offen offset:2048
    buffer_load_dwordx4 v[40:43], v225, s[12:15], s69 offen offset:3072
    ds_read_b128 v[188:191], v11 offset:32768
    ds_read_b128 v[192:195], v11 offset:40960
    ds_read_b128 v[196:199], v11 offset:49152
    ds_read_b128 v[200:203], v11 offset:57344
    ds_read_b128 v[204:207], v11 offset:33792
    ds_read_b128 v[208:211], v11 offset:41984
    ds_read_b128 v[212:215], v11 offset:50176
    v_exp_f32 v140, v140
    v_exp_f32 v141, v141
    v_exp_f32 v142, v142
    v_exp_f32 v143, v143
    v_exp_f32 v144, v144
    v_exp_f32 v145, v145
    v_exp_f32 v146, v146
    v_exp_f32 v147, v147
    v_add_f32 v221, v221, v140
    v_add_f32 v222, v222, v141
    v_cvt_pk_bf16_f32 v140, v140, v141
    v_add_f32 v221, v221, v142
    v_add_f32 v222, v222, v143
    v_cvt_pk_bf16_f32 v141, v142, v143
    v_add_f32 v221, v221, v144
    v_add_f32 v222, v222, v145
    v_cvt_pk_bf16_f32 v142, v144, v145
    v_add_f32 v221, v221, v146
    v_add_f32 v222, v222, v147
    v_cvt_pk_bf16_f32 v143, v146, v147
    v_exp_f32 v148, v148
    v_exp_f32 v149, v149
    ds_read_b128 v[216:219], v11 offset:58368
    s_waitcnt lgkmcnt(7)
    v_mfma_f32_32x32x16_bf16 v[44:59], v[188:191], v[140:143], v[44:59]
    v_exp_f32 v150, v150
    v_exp_f32 v151, v151
    v_exp_f32 v152, v152
    v_exp_f32 v153, v153
    ds_read_b128 v[188:191], v11 offset:34816
    s_waitcnt lgkmcnt(7)
    v_mfma_f32_32x32x16_bf16 v[60:75], v[192:195], v[140:143], v[60:75]
    v_exp_f32 v154, v154
    v_exp_f32 v155, v155
    v_add_f32 v221, v221, v148
    v_add_f32 v222, v222, v149
    ds_read_b128 v[192:195], v11 offset:43008
    s_waitcnt lgkmcnt(7)
    v_mfma_f32_32x32x16_bf16 v[76:91], v[196:199], v[140:143], v[76:91]
    v_cvt_pk_bf16_f32 v148, v148, v149
    v_add_f32 v221, v221, v150
    v_add_f32 v222, v222, v151
    ds_read_b128 v[196:199], v11 offset:51200
    s_waitcnt lgkmcnt(7)
    v_mfma_f32_32x32x16_bf16 v[92:107], v[200:203], v[140:143], v[92:107]
    v_cvt_pk_bf16_f32 v149, v150, v151
    v_add_f32 v221, v221, v152
    v_add_f32 v222, v222, v153
    v_cvt_pk_bf16_f32 v150, v152, v153
    ds_read_b128 v[200:203], v11 offset:59392
    v_add_f32 v221, v221, v154
    v_add_f32 v222, v222, v155
    v_cvt_pk_bf16_f32 v151, v154, v155
    s_waitcnt lgkmcnt(7)
    s_nop 0
    v_mfma_f32_32x32x16_bf16 v[44:59], v[204:207], v[148:151], v[44:59]
    v_exp_f32 v156, v156
    ds_read_b128 v[204:207], v11 offset:35840
    s_waitcnt lgkmcnt(7)
    v_mfma_f32_32x32x16_bf16 v[60:75], v[208:211], v[148:151], v[60:75]
    v_exp_f32 v157, v157
    v_exp_f32 v158, v158
    v_exp_f32 v159, v159
    ds_read_b128 v[208:211], v11 offset:44032
    s_waitcnt lgkmcnt(7)
    v_mfma_f32_32x32x16_bf16 v[76:91], v[212:215], v[148:151], v[76:91]
    v_exp_f32 v160, v160
    v_exp_f32 v161, v161
    v_exp_f32 v162, v162
    v_exp_f32 v163, v163
    ds_read_b128 v[212:215], v11 offset:52224
    s_waitcnt lgkmcnt(7)
    v_mfma_f32_32x32x16_bf16 v[92:107], v[216:219], v[148:151], v[92:107]
    v_add_f32 v221, v221, v156
    v_add_f32 v222, v222, v157
    v_cvt_pk_bf16_f32 v156, v156, v157
    ds_read_b128 v[216:219], v11 offset:60416
    v_add_f32 v221, v221, v158
    v_add_f32 v222, v222, v159
    v_cvt_pk_bf16_f32 v157, v158, v159
    v_add_f32 v221, v221, v160
    v_add_f32 v222, v222, v161
    v_cvt_pk_bf16_f32 v158, v160, v161
    v_add_f32 v221, v221, v162
    v_add_f32 v222, v222, v163
    v_cvt_pk_bf16_f32 v159, v162, v163
    s_waitcnt lgkmcnt(7)
    s_nop 0
    v_mfma_f32_32x32x16_bf16 v[44:59], v[188:191], v[156:159], v[44:59]
    s_waitcnt lgkmcnt(6)
    v_mfma_f32_32x32x16_bf16 v[60:75], v[192:195], v[156:159], v[60:75]
    s_waitcnt lgkmcnt(5)
    v_mfma_f32_32x32x16_bf16 v[76:91], v[196:199], v[156:159], v[76:91]
    v_exp_f32 v164, v164
    v_exp_f32 v165, v165
    s_waitcnt lgkmcnt(4)
    v_mfma_f32_32x32x16_bf16 v[92:107], v[200:203], v[156:159], v[92:107]
    v_exp_f32 v166, v166
    v_exp_f32 v167, v167
    v_exp_f32 v168, v168
    v_exp_f32 v169, v169
    v_exp_f32 v170, v170
    v_exp_f32 v171, v171
    v_add_f32 v221, v221, v164
    v_add_f32 v222, v222, v165
    v_cvt_pk_bf16_f32 v164, v164, v165
    v_add_f32 v221, v221, v166
    v_add_f32 v222, v222, v167
    v_cvt_pk_bf16_f32 v165, v166, v167
    v_add_f32 v221, v221, v168
    v_add_f32 v222, v222, v169
    v_cvt_pk_bf16_f32 v166, v168, v169
    v_add_f32 v221, v221, v170
    v_add_f32 v222, v222, v171
    v_cvt_pk_bf16_f32 v167, v170, v171
    s_waitcnt lgkmcnt(3)
    s_nop 0
    v_mfma_f32_32x32x16_bf16 v[44:59], v[204:207], v[164:167], v[44:59]
    s_waitcnt lgkmcnt(2)
    v_mfma_f32_32x32x16_bf16 v[60:75], v[208:211], v[164:167], v[60:75]
    s_waitcnt lgkmcnt(1)
    v_mfma_f32_32x32x16_bf16 v[76:91], v[212:215], v[164:167], v[76:91]
    s_waitcnt lgkmcnt(0)
    v_mfma_f32_32x32x16_bf16 v[92:107], v[216:219], v[164:167], v[92:107]
    s_mov_b32 s68, 0
    s_mov_b32 s67, 32768
    s_mov_b32 s61, 0
    s_nop 7
k2_attn_kernel_merge0:
    s_waitcnt lgkmcnt(0)
    s_barrier
    v_add_f32 v221, v221, v222
    v_mov_b32 v4, v221
    s_nop 1
    v_permlane32_swap_b32 v221, v4
    v_add_f32 v221, v221, v4
    s_lshl_b32 s10, s8, 13
    s_add_u32 s10, s10, s67
    s_lshl_b32 s11, s9, 16
    v_lshlrev_b32 v6, 4, v1
    v_add_u32 v6, s10, v6
    v_add_u32 v5, s11, v6
    s_xor_b32 s11, s11, 65536
    v_add_u32 v6, s11, v6
    s_cmp_eq_u32 s9, 1
    s_cbranch_scc1 k2_attn_kernel_mk1_9
    ds_write_b128 v5, v[76:79] offset:0
    ds_write_b128 v5, v[80:83] offset:1024
    ds_write_b128 v5, v[84:87] offset:2048
    ds_write_b128 v5, v[88:91] offset:3072
    ds_write_b128 v5, v[92:95] offset:4096
    ds_write_b128 v5, v[96:99] offset:5120
    ds_write_b128 v5, v[100:103] offset:6144
    ds_write_b128 v5, v[104:107] offset:7168
    s_branch k2_attn_kernel_mj_10
k2_attn_kernel_mk1_9:
    ds_write_b128 v5, v[44:47] offset:0
    ds_write_b128 v5, v[48:51] offset:1024
    ds_write_b128 v5, v[52:55] offset:2048
    ds_write_b128 v5, v[56:59] offset:3072
    ds_write_b128 v5, v[60:63] offset:4096
    ds_write_b128 v5, v[64:67] offset:5120
    ds_write_b128 v5, v[68:71] offset:6144
    ds_write_b128 v5, v[72:75] offset:7168
k2_attn_kernel_mj_10:
    v_lshlrev_b32 v7, 3, v1
    s_lshl_b32 s10, s3, 9
    s_add_u32 s10, s10, 131072
    v_add_u32 v4, s10, v7
    v_mov_b32 v108, v220
    v_mov_b32 v109, v221
    ds_write_b64 v4, v[108:109]
    s_xor_b32 s10, s10, 2048
    v_add_u32 v4, s10, v7
    s_waitcnt lgkmcnt(0)
    s_barrier
    ds_read_b64 v[110:111], v4
    ds_read_b128 v[140:143], v6 offset:0
    ds_read_b128 v[144:147], v6 offset:1024
    ds_read_b128 v[148:151], v6 offset:2048
    ds_read_b128 v[152:155], v6 offset:3072
    ds_read_b128 v[156:159], v6 offset:4096
    ds_read_b128 v[160:163], v6 offset:5120
    ds_read_b128 v[164:167], v6 offset:6144
    ds_read_b128 v[168:171], v6 offset:7168
    s_waitcnt lgkmcnt(0)
    v_max_f32 v112, v220, v110
    v_sub_f32 v113, v220, v112
    v_sub_f32 v114, v110, v112
    v_exp_f32 v113, v113
    v_exp_f32 v114, v114
    v_mul_f32 v112, v221, v113
    v_fma_f32 v112, v111, v114, v112
    v_rcp_f32 v112, v112
    s_nop 0
    v_mul_f32 v113, v113, v112
    v_mul_f32 v114, v114, v112
    s_lshl_b32 s10, s8, 5
    s_add_u32 s10, s10, s64
    s_lshl_b32 s10, s10, 13
    v_lshlrev_b32 v4, 4, v1
    s_lshl_b32 s11, s5, 13
    s_add_u32 s10, s10, s11
    s_lshl_b32 s11, s9, 12
    s_add_u32 s10, s10, s11
    v_add_u32 v4, s10, v4
    s_cmp_eq_u32 s9, 1
    s_cbranch_scc1 k2_attn_kernel_sk1_11
    v_mul_f32 v44, v44, v113
    v_fma_f32 v44, v140, v114, v44
    v_mul_f32 v45, v45, v113
    v_fma_f32 v45, v141, v114, v45
    v_mul_f32 v46, v46, v113
    v_fma_f32 v46, v142, v114, v46
    v_mul_f32 v47, v47, v113
    v_fma_f32 v47, v143, v114, v47
    v_mul_f32 v48, v48, v113
    v_fma_f32 v48, v144, v114, v48
    v_mul_f32 v49, v49, v113
    v_fma_f32 v49, v145, v114, v49
    v_mul_f32 v50, v50, v113
    v_fma_f32 v50, v146, v114, v50
    v_mul_f32 v51, v51, v113
    v_fma_f32 v51, v147, v114, v51
    v_mul_f32 v52, v52, v113
    v_fma_f32 v52, v148, v114, v52
    v_mul_f32 v53, v53, v113
    v_fma_f32 v53, v149, v114, v53
    v_mul_f32 v54, v54, v113
    v_fma_f32 v54, v150, v114, v54
    v_mul_f32 v55, v55, v113
    v_fma_f32 v55, v151, v114, v55
    v_mul_f32 v56, v56, v113
    v_fma_f32 v56, v152, v114, v56
    v_mul_f32 v57, v57, v113
    v_fma_f32 v57, v153, v114, v57
    v_mul_f32 v58, v58, v113
    v_fma_f32 v58, v154, v114, v58
    v_mul_f32 v59, v59, v113
    v_fma_f32 v59, v155, v114, v59
    v_mul_f32 v60, v60, v113
    v_fma_f32 v60, v156, v114, v60
    v_mul_f32 v61, v61, v113
    v_fma_f32 v61, v157, v114, v61
    v_mul_f32 v62, v62, v113
    v_fma_f32 v62, v158, v114, v62
    v_mul_f32 v63, v63, v113
    v_fma_f32 v63, v159, v114, v63
    v_mul_f32 v64, v64, v113
    v_fma_f32 v64, v160, v114, v64
    v_mul_f32 v65, v65, v113
    v_fma_f32 v65, v161, v114, v65
    v_mul_f32 v66, v66, v113
    v_fma_f32 v66, v162, v114, v66
    v_mul_f32 v67, v67, v113
    v_fma_f32 v67, v163, v114, v67
    v_mul_f32 v68, v68, v113
    v_fma_f32 v68, v164, v114, v68
    v_mul_f32 v69, v69, v113
    v_fma_f32 v69, v165, v114, v69
    v_mul_f32 v70, v70, v113
    v_fma_f32 v70, v166, v114, v70
    v_mul_f32 v71, v71, v113
    v_fma_f32 v71, v167, v114, v71
    v_mul_f32 v72, v72, v113
    v_fma_f32 v72, v168, v114, v72
    v_mul_f32 v73, v73, v113
    v_fma_f32 v73, v169, v114, v73
    v_mul_f32 v74, v74, v113
    v_fma_f32 v74, v170, v114, v74
    v_mul_f32 v75, v75, v113
    v_fma_f32 v75, v171, v114, v75
    v_cvt_pk_bf16_f32 v116, v44, v45
    v_cvt_pk_bf16_f32 v117, v46, v47
    v_cvt_pk_bf16_f32 v118, v48, v49
    v_cvt_pk_bf16_f32 v119, v50, v51
    buffer_store_dwordx4 v[116:119], v4, s[24:27], 0 offen offset:0
    v_cvt_pk_bf16_f32 v120, v52, v53
    v_cvt_pk_bf16_f32 v121, v54, v55
    v_cvt_pk_bf16_f32 v122, v56, v57
    v_cvt_pk_bf16_f32 v123, v58, v59
    buffer_store_dwordx4 v[120:123], v4, s[24:27], 0 offen offset:1024
    v_cvt_pk_bf16_f32 v124, v60, v61
    v_cvt_pk_bf16_f32 v125, v62, v63
    v_cvt_pk_bf16_f32 v126, v64, v65
    v_cvt_pk_bf16_f32 v127, v66, v67
    buffer_store_dwordx4 v[124:127], v4, s[24:27], 0 offen offset:2048
    v_cvt_pk_bf16_f32 v128, v68, v69
    v_cvt_pk_bf16_f32 v129, v70, v71
    v_cvt_pk_bf16_f32 v130, v72, v73
    v_cvt_pk_bf16_f32 v131, v74, v75
    buffer_store_dwordx4 v[128:131], v4, s[24:27], 0 offen offset:3072
    s_nop 0
    s_branch k2_attn_kernel_sj_12
k2_attn_kernel_sk1_11:
    v_mul_f32 v76, v76, v113
    v_fma_f32 v76, v140, v114, v76
    v_mul_f32 v77, v77, v113
    v_fma_f32 v77, v141, v114, v77
    v_mul_f32 v78, v78, v113
    v_fma_f32 v78, v142, v114, v78
    v_mul_f32 v79, v79, v113
    v_fma_f32 v79, v143, v114, v79
    v_mul_f32 v80, v80, v113
    v_fma_f32 v80, v144, v114, v80
    v_mul_f32 v81, v81, v113
    v_fma_f32 v81, v145, v114, v81
    v_mul_f32 v82, v82, v113
    v_fma_f32 v82, v146, v114, v82
    v_mul_f32 v83, v83, v113
    v_fma_f32 v83, v147, v114, v83
    v_mul_f32 v84, v84, v113
    v_fma_f32 v84, v148, v114, v84
    v_mul_f32 v85, v85, v113
    v_fma_f32 v85, v149, v114, v85
    v_mul_f32 v86, v86, v113
    v_fma_f32 v86, v150, v114, v86
    v_mul_f32 v87, v87, v113
    v_fma_f32 v87, v151, v114, v87
    v_mul_f32 v88, v88, v113
    v_fma_f32 v88, v152, v114, v88
    v_mul_f32 v89, v89, v113
    v_fma_f32 v89, v153, v114, v89
    v_mul_f32 v90, v90, v113
    v_fma_f32 v90, v154, v114, v90
    v_mul_f32 v91, v91, v113
    v_fma_f32 v91, v155, v114, v91
    v_mul_f32 v92, v92, v113
    v_fma_f32 v92, v156, v114, v92
    v_mul_f32 v93, v93, v113
    v_fma_f32 v93, v157, v114, v93
    v_mul_f32 v94, v94, v113
    v_fma_f32 v94, v158, v114, v94
    v_mul_f32 v95, v95, v113
    v_fma_f32 v95, v159, v114, v95
    v_mul_f32 v96, v96, v113
    v_fma_f32 v96, v160, v114, v96
    v_mul_f32 v97, v97, v113
    v_fma_f32 v97, v161, v114, v97
    v_mul_f32 v98, v98, v113
    v_fma_f32 v98, v162, v114, v98
    v_mul_f32 v99, v99, v113
    v_fma_f32 v99, v163, v114, v99
    v_mul_f32 v100, v100, v113
    v_fma_f32 v100, v164, v114, v100
    v_mul_f32 v101, v101, v113
    v_fma_f32 v101, v165, v114, v101
    v_mul_f32 v102, v102, v113
    v_fma_f32 v102, v166, v114, v102
    v_mul_f32 v103, v103, v113
    v_fma_f32 v103, v167, v114, v103
    v_mul_f32 v104, v104, v113
    v_fma_f32 v104, v168, v114, v104
    v_mul_f32 v105, v105, v113
    v_fma_f32 v105, v169, v114, v105
    v_mul_f32 v106, v106, v113
    v_fma_f32 v106, v170, v114, v106
    v_mul_f32 v107, v107, v113
    v_fma_f32 v107, v171, v114, v107
    v_cvt_pk_bf16_f32 v116, v76, v77
    v_cvt_pk_bf16_f32 v117, v78, v79
    v_cvt_pk_bf16_f32 v118, v80, v81
    v_cvt_pk_bf16_f32 v119, v82, v83
    buffer_store_dwordx4 v[116:119], v4, s[24:27], 0 offen offset:0
    v_cvt_pk_bf16_f32 v120, v84, v85
    v_cvt_pk_bf16_f32 v121, v86, v87
    v_cvt_pk_bf16_f32 v122, v88, v89
    v_cvt_pk_bf16_f32 v123, v90, v91
    buffer_store_dwordx4 v[120:123], v4, s[24:27], 0 offen offset:1024
    v_cvt_pk_bf16_f32 v124, v92, v93
    v_cvt_pk_bf16_f32 v125, v94, v95
    v_cvt_pk_bf16_f32 v126, v96, v97
    v_cvt_pk_bf16_f32 v127, v98, v99
    buffer_store_dwordx4 v[124:127], v4, s[24:27], 0 offen offset:2048
    v_cvt_pk_bf16_f32 v128, v100, v101
    v_cvt_pk_bf16_f32 v129, v102, v103
    v_cvt_pk_bf16_f32 v130, v104, v105
    v_cvt_pk_bf16_f32 v131, v106, v107
    buffer_store_dwordx4 v[128:131], v4, s[24:27], 0 offen offset:3072
    s_nop 0
k2_attn_kernel_sj_12:
    s_add_u32 s63, s63, 1
    s_cmp_lt_u32 s63, 2
    s_cbranch_scc1 k2_attn_kernel_blk0
    s_branch k2_attn_kernel_fin
k2_attn_kernel_blk1p:
k2_attn_kernel_blk1:
    s_sub_u32 s10, 15, s6
    s_cmp_eq_u32 s63, 0
    s_cselect_b32 s62, s6, s10
    s_lshl_b32 s64, s62, 7
    v_mov_b32 v221, 0
    v_mov_b32 v222, 0
    s_lshl_b32 s10, s8, 5
    s_lshl_b32 s11, s9, 6
    s_sub_u32 s10, s10, s11
    v_add_u32 v226, s10, v2
    v_lshlrev_b32 v4, 2, v3
    v_sub_u32 v226, v226, v4
    s_cmp_eq_u32 s68, 1
    s_cbranch_scc1 k2_attn_kernel_pro1_1
k2_attn_kernel_pro0_1:
    s_waitcnt vmcnt(0) lgkmcnt(0)
    s_barrier
    s_cmp_eq_u32 s62, 0
    s_cbranch_scc1 k2_attn_kernel_pro10_1
    s_add_u32 s60, s60, 32768
    ds_read_b128 v[188:191], v10 offset:0
    ds_read_b128 v[192:195], v10 offset:1024
    ds_read_b128 v[196:199], v10 offset:2048
    ds_read_b128 v[200:203], v10 offset:3072
    ds_read_b128 v[204:207], v10 offset:4096
    ds_read_b128 v[208:211], v10 offset:5120
    ds_read_b128 v[212:215], v10 offset:6144
    v_mov_b32 v44, 0
    ds_read_b128 v[216:219], v10 offset:7168
    s_waitcnt lgkmcnt(7)
    v_mfma_f32_32x32x16_bf16 v[108:123], v[188:191], v[12:15], 0
    v_mov_b32 v45, 0
    v_mov_b32 v46, 0
    v_mov_b32 v47, 0
    v_mov_b32 v48, 0
    ds_read_b128 v[188:191], v10 offset:8192
    s_waitcnt lgkmcnt(7)
    v_mfma_f32_32x32x16_bf16 v[108:123], v[192:195], v[16:19], v[108:123]
    v_mov_b32 v49, 0
    v_mov_b32 v50, 0
    v_mov_b32 v51, 0
    v_mov_b32 v52, 0
    ds_read_b128 v[192:195], v10 offset:9216
    s_waitcnt lgkmcnt(7)
    v_mfma_f32_32x32x16_bf16 v[108:123], v[196:199], v[20:23], v[108:123]
    v_mov_b32 v53, 0
    v_mov_b32 v54, 0
    v_mov_b32 v55, 0
    v_mov_b32 v56, 0
    ds_read_b128 v[196:199], v10 offset:10240
    s_waitcnt lgkmcnt(7)
    v_mfma_f32_32x32x16_bf16 v[108:123], v[200:203], v[24:27], v[108:123]
    v_mov_b32 v57, 0
    v_mov_b32 v58, 0
    v_mov_b32 v59, 0
    v_mov_b32 v60, 0
    ds_read_b128 v[200:203], v10 offset:11264
    s_waitcnt lgkmcnt(7)
    v_mfma_f32_32x32x16_bf16 v[108:123], v[204:207], v[28:31], v[108:123]
    v_mov_b32 v61, 0
    v_mov_b32 v62, 0
    v_mov_b32 v63, 0
    v_mov_b32 v64, 0
    ds_read_b128 v[204:207], v10 offset:12288
    s_waitcnt lgkmcnt(7)
    v_mfma_f32_32x32x16_bf16 v[108:123], v[208:211], v[32:35], v[108:123]
    v_mov_b32 v65, 0
    v_mov_b32 v66, 0
    v_mov_b32 v67, 0
    v_mov_b32 v68, 0
    ds_read_b128 v[208:211], v10 offset:13312
    s_waitcnt lgkmcnt(7)
    v_mfma_f32_32x32x16_bf16 v[108:123], v[212:215], v[36:39], v[108:123]
    v_mov_b32 v69, 0
    v_mov_b32 v70, 0
    v_mov_b32 v71, 0
    v_mov_b32 v72, 0
    ds_read_b128 v[212:215], v10 offset:14336
    s_waitcnt lgkmcnt(7)
    v_mfma_f32_32x32x16_bf16 v[108:123], v[216:219], v[40:43], v[108:123]
    v_mov_b32 v73, 0
    v_mov_b32 v74, 0
    v_mov_b32 v75, 0
    v_mov_b32 v76, 0
    ds_read_b128 v[216:219], v10 offset:15360
    s_waitcnt lgkmcnt(7)
    v_mfma_f32_32x32x16_bf16 v[124:139], v[188:191], v[12:15], 0
    v_mov_b32 v77, 0
    v_mov_b32 v78, 0
    v_mov_b32 v79, 0
    v_mov_b32 v80, 0
    s_waitcnt lgkmcnt(6)
    v_mfma_f32_32x32x16_bf16 v[124:139], v[192:195], v[16:19], v[124:139]
    v_mov_b32 v81, 0
    v_mov_b32 v82, 0
    v_mov_b32 v83, 0
    v_mov_b32 v84, 0
    s_waitcnt lgkmcnt(5)
    v_mfma_f32_32x32x16_bf16 v[124:139], v[196:199], v[20:23], v[124:139]
    v_mov_b32 v85, 0
    v_mov_b32 v86, 0
    v_mov_b32 v87, 0
    v_mov_b32 v88, 0
    s_waitcnt lgkmcnt(4)
    v_mfma_f32_32x32x16_bf16 v[124:139], v[200:203], v[24:27], v[124:139]
    v_mov_b32 v89, 0
    v_mov_b32 v90, 0
    v_mov_b32 v91, 0
    v_mov_b32 v92, 0
    s_waitcnt lgkmcnt(3)
    v_mfma_f32_32x32x16_bf16 v[124:139], v[204:207], v[28:31], v[124:139]
    v_mov_b32 v93, 0
    v_mov_b32 v94, 0
    v_mov_b32 v95, 0
    v_mov_b32 v96, 0
    s_waitcnt lgkmcnt(2)
    v_mfma_f32_32x32x16_bf16 v[124:139], v[208:211], v[32:35], v[124:139]
    v_mov_b32 v97, 0
    v_mov_b32 v98, 0
    v_mov_b32 v99, 0
    v_mov_b32 v100, 0
    s_waitcnt lgkmcnt(1)
    v_mfma_f32_32x32x16_bf16 v[124:139], v[212:215], v[36:39], v[124:139]
    v_mov_b32 v101, 0
    v_mov_b32 v102, 0
    v_mov_b32 v103, 0
    v_mov_b32 v104, 0
    s_waitcnt lgkmcnt(0)
    v_mfma_f32_32x32x16_bf16 v[124:139], v[216:219], v[40:43], v[124:139]
    v_mov_b32 v105, 0
    v_mov_b32 v106, 0
    v_mov_b32 v107, 0
    v_max3_f32 v4, v108, v109, v110
    v_max3_f32 v5, v111, v112, v113
    v_max3_f32 v4, v4, v114, v115
    v_max3_f32 v5, v5, v116, v117
    v_max3_f32 v4, v4, v118, v119
    v_max3_f32 v5, v5, v120, v121
    v_max3_f32 v4, v4, v122, v123
    s_nop 1
    v_max3_f32 v5, v5, v124, v125
    v_max3_f32 v4, v4, v126, v127
    v_max3_f32 v5, v5, v128, v129
    v_max3_f32 v4, v4, v130, v131
    v_max3_f32 v5, v5, v132, v133
    v_max3_f32 v4, v4, v134, v135
    v_max3_f32 v5, v5, v136, v137
    v_max3_f32 v4, v4, v138, v139
    v_max_f32 v4, v4, v5
    v_mov_b32 v5, v4
    s_nop 1
    v_permlane32_swap_b32 v4, v5
    v_max_f32 v228, v4, v5
    v_mov_b32 v220, v228
    v_sub_f32 v172, 0, v228
    v_sub_f32 v173, 0, v228
    v_sub_f32 v174, 0, v228
    v_sub_f32 v175, 0, v228
    v_sub_f32 v176, 0, v228
    v_sub_f32 v177, 0, v228
    v_sub_f32 v178, 0, v228
    v_sub_f32 v179, 0, v228
    v_sub_f32 v180, 0, v228
    v_sub_f32 v181, 0, v228
    v_sub_f32 v182, 0, v228
    v_sub_f32 v183, 0, v228
    v_sub_f32 v184, 0, v228
    v_sub_f32 v185, 0, v228
    v_sub_f32 v186, 0, v228
    v_sub_f32 v187, 0, v228
    v_sub_f32 v108, v108, v228
    v_sub_f32 v109, v109, v228
    v_sub_f32 v110, v110, v228
    v_sub_f32 v111, v111, v228
    v_sub_f32 v112, v112, v228
    v_sub_f32 v113, v113, v228
    v_sub_f32 v114, v114, v228
    v_sub_f32 v115, v115, v228
    v_sub_f32 v116, v116, v228
    v_sub_f32 v117, v117, v228
    v_sub_f32 v118, v118, v228
    v_sub_f32 v119, v119, v228
    v_sub_f32 v120, v120, v228
    v_sub_f32 v121, v121, v228
    v_sub_f32 v122, v122, v228
    v_sub_f32 v123, v123, v228
    v_sub_f32 v124, v124, v228
    v_sub_f32 v125, v125, v228
    v_sub_f32 v126, v126, v228
    v_sub_f32 v127, v127, v228
    v_sub_f32 v128, v128, v228
    v_sub_f32 v129, v129, v228
    v_sub_f32 v130, v130, v228
    v_sub_f32 v131, v131, v228
    v_sub_f32 v132, v132, v228
    v_sub_f32 v133, v133, v228
    v_sub_f32 v134, v134, v228
    v_sub_f32 v135, v135, v228
    v_sub_f32 v136, v136, v228
    v_sub_f32 v137, v137, v228
    v_sub_f32 v138, v138, v228
    v_sub_f32 v139, v139, v228
    s_nop 0
    s_branch k2_attn_kernel_loop0_1
k2_attn_kernel_pro10_1:
    s_mov_b32 s60, 0
    ds_read_b128 v[188:191], v10 offset:0
    ds_read_b128 v[192:195], v10 offset:1024
    ds_read_b128 v[196:199], v10 offset:2048
    ds_read_b128 v[200:203], v10 offset:3072
    ds_read_b128 v[204:207], v10 offset:4096
    ds_read_b128 v[208:211], v10 offset:5120
    ds_read_b128 v[212:215], v10 offset:6144
    v_mov_b32 v44, 0
    ds_read_b128 v[216:219], v10 offset:7168
    s_waitcnt lgkmcnt(7)
    v_mfma_f32_32x32x16_bf16 v[108:123], v[188:191], v[12:15], 0
    v_mov_b32 v45, 0
    v_mov_b32 v46, 0
    v_mov_b32 v47, 0
    v_mov_b32 v48, 0
    ds_read_b128 v[188:191], v10 offset:8192
    s_waitcnt lgkmcnt(7)
    v_mfma_f32_32x32x16_bf16 v[108:123], v[192:195], v[16:19], v[108:123]
    v_mov_b32 v49, 0
    v_mov_b32 v50, 0
    v_mov_b32 v51, 0
    v_mov_b32 v52, 0
    ds_read_b128 v[192:195], v10 offset:9216
    s_waitcnt lgkmcnt(7)
    v_mfma_f32_32x32x16_bf16 v[108:123], v[196:199], v[20:23], v[108:123]
    v_mov_b32 v53, 0
    v_mov_b32 v54, 0
    v_mov_b32 v55, 0
    v_mov_b32 v56, 0
    ds_read_b128 v[196:199], v10 offset:10240
    s_waitcnt lgkmcnt(7)
    v_mfma_f32_32x32x16_bf16 v[108:123], v[200:203], v[24:27], v[108:123]
    v_mov_b32 v57, 0
    v_mov_b32 v58, 0
    v_mov_b32 v59, 0
    v_mov_b32 v60, 0
    ds_read_b128 v[200:203], v10 offset:11264
    s_waitcnt lgkmcnt(7)
    v_mfma_f32_32x32x16_bf16 v[108:123], v[204:207], v[28:31], v[108:123]
    v_mov_b32 v61, 0
    v_mov_b32 v62, 0
    v_mov_b32 v63, 0
    v_mov_b32 v64, 0
    ds_read_b128 v[204:207], v10 offset:12288
    s_waitcnt lgkmcnt(7)
    v_mfma_f32_32x32x16_bf16 v[108:123], v[208:211], v[32:35], v[108:123]
    v_mov_b32 v65, 0
    v_mov_b32 v66, 0
    v_mov_b32 v67, 0
    v_mov_b32 v68, 0
    ds_read_b128 v[208:211], v10 offset:13312
    s_waitcnt lgkmcnt(7)
    v_mfma_f32_32x32x16_bf16 v[108:123], v[212:215], v[36:39], v[108:123]
    v_mov_b32 v69, 0
    v_mov_b32 v70, 0
    v_mov_b32 v71, 0
    v_mov_b32 v72, 0
    ds_read_b128 v[212:215], v10 offset:14336
    s_waitcnt lgkmcnt(7)
    v_mfma_f32_32x32x16_bf16 v[108:123], v[216:219], v[40:43], v[108:123]
    v_mov_b32 v73, 0
    v_mov_b32 v74, 0
    v_mov_b32 v75, 0
    v_mov_b32 v76, 0
    ds_read_b128 v[216:219], v10 offset:15360
    s_waitcnt lgkmcnt(7)
    v_mfma_f32_32x32x16_bf16 v[124:139], v[188:191], v[12:15], 0
    v_mov_b32 v77, 0
    v_mov_b32 v78, 0
    v_mov_b32 v79, 0
    v_mov_b32 v80, 0
    s_waitcnt lgkmcnt(6)
    v_mfma_f32_32x32x16_bf16 v[124:139], v[192:195], v[16:19], v[124:139]
    v_mov_b32 v81, 0
    v_mov_b32 v82, 0
    v_mov_b32 v83, 0
    v_mov_b32 v84, 0
    s_waitcnt lgkmcnt(5)
    v_mfma_f32_32x32x16_bf16 v[124:139], v[196:199], v[20:23], v[124:139]
    v_mov_b32 v85, 0
    v_mov_b32 v86, 0
    v_mov_b32 v87, 0
    v_mov_b32 v88, 0
    s_waitcnt lgkmcnt(4)
    v_mfma_f32_32x32x16_bf16 v[124:139], v[200:203], v[24:27], v[124:139]
    v_mov_b32 v89, 0
    v_mov_b32 v90, 0
    v_mov_b32 v91, 0
    v_mov_b32 v92, 0
    s_waitcnt lgkmcnt(3)
    v_mfma_f32_32x32x16_bf16 v[124:139], v[204:207], v[28:31], v[124:139]
    v_mov_b32 v93, 0
    v_mov_b32 v94, 0
    v_mov_b32 v95, 0
    v_mov_b32 v96, 0
    s_waitcnt lgkmcnt(2)
    v_mfma_f32_32x32x16_bf16 v[124:139], v[208:211], v[32:35], v[124:139]
    v_mov_b32 v97, 0
    v_mov_b32 v98, 0
    v_mov_b32 v99, 0
    v_mov_b32 v100, 0
    s_waitcnt lgkmcnt(1)
    v_mfma_f32_32x32x16_bf16 v[124:139], v[212:215], v[36:39], v[124:139]
    v_mov_b32 v101, 0
    v_mov_b32 v102, 0
    v_mov_b32 v103, 0
    v_mov_b32 v104, 0
    s_waitcnt lgkmcnt(0)
    v_mfma_f32_32x32x16_bf16 v[124:139], v[216:219], v[40:43], v[124:139]
    v_mov_b32 v105, 0
    v_mov_b32 v106, 0
    v_mov_b32 v107, 0
    v_cmp_ge_i32 vcc, v226, 0
    s_nop 1
    v_cndmask_b32 v108, v227, v108, vcc
    v_cmp_ge_i32 vcc, v226, 1
    s_nop 1
    v_cndmask_b32 v109, v227, v109, vcc
    v_cmp_ge_i32 vcc, v226, 2
    s_nop 1
    v_cndmask_b32 v110, v227, v110, vcc
    v_cmp_ge_i32 vcc, v226, 3
    s_nop 1
    v_cndmask_b32 v111, v227, v111, vcc
    v_cmp_ge_i32 vcc, v226, 8
    s_nop 1
    v_cndmask_b32 v112, v227, v112, vcc
    v_cmp_ge_i32 vcc, v226, 9
    s_nop 1
    v_cndmask_b32 v113, v227, v113, vcc
    v_cmp_ge_i32 vcc, v226, 10
    s_nop 1
    v_cndmask_b32 v114, v227, v114, vcc
    v_cmp_ge_i32 vcc, v226, 11
    s_nop 1
    v_cndmask_b32 v115, v227, v115, vcc
    v_cmp_ge_i32 vcc, v226, 16
    s_nop 1
    v_cndmask_b32 v116, v227, v116, vcc
    v_cmp_ge_i32 vcc, v226, 17
    s_nop 1
    v_cndmask_b32 v117, v227, v117, vcc
    v_cmp_ge_i32 vcc, v226, 18
    s_nop 1
    v_cndmask_b32 v118, v227, v118, vcc
    v_cmp_ge_i32 vcc, v226, 19
    s_nop 1
    v_cndmask_b32 v119, v227, v119, vcc
    v_cmp_ge_i32 vcc, v226, 24
    s_nop 1
    v_cndmask_b32 v120, v227, v120, vcc
    v_cmp_ge_i32 vcc, v226, 25
    s_nop 1
    v_cndmask_b32 v121, v227, v121, vcc
    v_cmp_ge_i32 vcc, v226, 26
    s_nop 1
    v_cndmask_b32 v122, v227, v122, vcc
    v_cmp_ge_i32 vcc, v226, 27
    s_nop 1
    v_cndmask_b32 v123, v227, v123, vcc
    v_cmp_ge_i32 vcc, v226, 32
    s_nop 1
    v_cndmask_b32 v124, v227, v124, vcc
    v_cmp_ge_i32 vcc, v226, 33
    s_nop 1
    v_cndmask_b32 v125, v227, v125, vcc
    v_cmp_ge_i32 vcc, v226, 34
    s_nop 1
    v_cndmask_b32 v126, v227, v126, vcc
    v_cmp_ge_i32 vcc, v226, 35
    s_nop 1
    v_cndmask_b32 v127, v227, v127, vcc
    v_cmp_ge_i32 vcc, v226, 40
    s_nop 1
    v_cndmask_b32 v128, v227, v128, vcc
    v_cmp_ge_i32 vcc, v226, 41
    s_nop 1
    v_cndmask_b32 v129, v227, v129, vcc
    v_cmp_ge_i32 vcc, v226, 42
    s_nop 1
    v_cndmask_b32 v130, v227, v130, vcc
    v_cmp_ge_i32 vcc, v226, 43
    s_nop 1
    v_cndmask_b32 v131, v227, v131, vcc
    v_cmp_ge_i32 vcc, v226, 48
    s_nop 1
    v_cndmask_b32 v132, v227, v132, vcc
    v_cmp_ge_i32 vcc, v226, 49
    s_nop 1
    v_cndmask_b32 v133, v227, v133, vcc
    v_cmp_ge_i32 vcc, v226, 50
    s_nop 1
    v_cndmask_b32 v134, v227, v134, vcc
    v_cmp_ge_i32 vcc, v226, 51
    s_nop 1
    v_cndmask_b32 v135, v227, v135, vcc
    v_cmp_ge_i32 vcc, v226, 56
    s_nop 1
    v_cndmask_b32 v136, v227, v136, vcc
    v_cmp_ge_i32 vcc, v226, 57
    s_nop 1
    v_cndmask_b32 v137, v227, v137, vcc
    v_cmp_ge_i32 vcc, v226, 58
    s_nop 1
    v_cndmask_b32 v138, v227, v138, vcc
    v_cmp_ge_i32 vcc, v226, 59
    s_nop 1
    v_cndmask_b32 v139, v227, v139, vcc
    v_max3_f32 v4, v108, v109, v110
    v_max3_f32 v5, v111, v112, v113
    v_max3_f32 v4, v4, v114, v115
    v_max3_f32 v5, v5, v116, v117
    v_max3_f32 v4, v4, v118, v119
    v_max3_f32 v5, v5, v120, v121
    v_max3_f32 v4, v4, v122, v123
    v_max3_f32 v5, v5, v124, v125
    v_max3_f32 v4, v4, v126, v127
    v_max3_f32 v5, v5, v128, v129
    v_max3_f32 v4, v4, v130, v131
    v_max3_f32 v5, v5, v132, v133
    v_max3_f32 v4, v4, v134, v135
    v_max3_f32 v5, v5, v136, v137
    v_max3_f32 v4, v4, v138, v139
    v_max_f32 v4, v4, v5
    v_mov_b32 v5, v4
    s_nop 1
    v_permlane32_swap_b32 v4, v5
    v_max_f32 v228, v4, v5
    v_mov_b32 v220, v228
    v_sub_f32 v172, 0, v228
    v_sub_f32 v173, 0, v228
    v_sub_f32 v174, 0, v228
    v_sub_f32 v175, 0, v228
    v_sub_f32 v176, 0, v228
    v_sub_f32 v177, 0, v228
    v_sub_f32 v178, 0, v228
    v_sub_f32 v179, 0, v228
    v_sub_f32 v180, 0, v228
    v_sub_f32 v181, 0, v228
    v_sub_f32 v182, 0, v228
    v_sub_f32 v183, 0, v228
    v_sub_f32 v184, 0, v228
    v_sub_f32 v185, 0, v228
    v_sub_f32 v186, 0, v228
    v_sub_f32 v187, 0, v228
    v_sub_f32 v108, v108, v228
    v_sub_f32 v109, v109, v228
    v_sub_f32 v110, v110, v228
    v_sub_f32 v111, v111, v228
    v_sub_f32 v112, v112, v228
    v_sub_f32 v113, v113, v228
    v_sub_f32 v114, v114, v228
    v_sub_f32 v115, v115, v228
    v_sub_f32 v116, v116, v228
    v_sub_f32 v117, v117, v228
    v_sub_f32 v118, v118, v228
    v_sub_f32 v119, v119, v228
    v_sub_f32 v120, v120, v228
    v_sub_f32 v121, v121, v228
    v_sub_f32 v122, v122, v228
    v_sub_f32 v123, v123, v228
    v_sub_f32 v124, v124, v228
    v_sub_f32 v125, v125, v228
    v_sub_f32 v126, v126, v228
    v_sub_f32 v127, v127, v228
    v_sub_f32 v128, v128, v228
    v_sub_f32 v129, v129, v228
    v_sub_f32 v130, v130, v228
    v_sub_f32 v131, v131, v228
    v_sub_f32 v132, v132, v228
    v_sub_f32 v133, v133, v228
    v_sub_f32 v134, v134, v228
    v_sub_f32 v135, v135, v228
    v_sub_f32 v136, v136, v228
    v_sub_f32 v137, v137, v228
    v_sub_f32 v138, v138, v228
    v_sub_f32 v139, v139, v228
    s_nop 0
    s_branch k2_attn_kernel_epi0_1
k2_attn_kernel_pro1_1:
    s_waitcnt vmcnt(0) lgkmcnt(0)
    s_barrier
    s_cmp_eq_u32 s62, 0
    s_cbranch_scc1 k2_attn_kernel_pro11_1
    s_add_u32 s60, s60, 32768
    ds_read_b128 v[188:191], v10 offset:32768
    ds_read_b128 v[192:195], v10 offset:33792
    ds_read_b128 v[196:199], v10 offset:34816
    ds_read_b128 v[200:203], v10 offset:35840
    ds_read_b128 v[204:207], v10 offset:36864
    ds_read_b128 v[208:211], v10 offset:37888
    ds_read_b128 v[212:215], v10 offset:38912
    v_mov_b32 v44, 0
    ds_read_b128 v[216:219], v10 offset:39936
    s_waitcnt lgkmcnt(7)
    v_mfma_f32_32x32x16_bf16 v[140:155], v[188:191], v[12:15], 0
    v_mov_b32 v45, 0
    v_mov_b32 v46, 0
    v_mov_b32 v47, 0
    v_mov_b32 v48, 0
    ds_read_b128 v[188:191], v10 offset:40960
    s_waitcnt lgkmcnt(7)
    v_mfma_f32_32x32x16_bf16 v[140:155], v[192:195], v[16:19], v[140:155]
    v_mov_b32 v49, 0
    v_mov_b32 v50, 0
    v_mov_b32 v51, 0
    v_mov_b32 v52, 0
    ds_read_b128 v[192:195], v10 offset:41984
    s_waitcnt lgkmcnt(7)
    v_mfma_f32_32x32x16_bf16 v[140:155], v[196:199], v[20:23], v[140:155]
    v_mov_b32 v53, 0
    v_mov_b32 v54, 0
    v_mov_b32 v55, 0
    v_mov_b32 v56, 0
    ds_read_b128 v[196:199], v10 offset:43008
    s_waitcnt lgkmcnt(7)
    v_mfma_f32_32x32x16_bf16 v[140:155], v[200:203], v[24:27], v[140:155]
    v_mov_b32 v57, 0
    v_mov_b32 v58, 0
    v_mov_b32 v59, 0
    v_mov_b32 v60, 0
    ds_read_b128 v[200:203], v10 offset:44032
    s_waitcnt lgkmcnt(7)
    v_mfma_f32_32x32x16_bf16 v[140:155], v[204:207], v[28:31], v[140:155]
    v_mov_b32 v61, 0
    v_mov_b32 v62, 0
    v_mov_b32 v63, 0
    v_mov_b32 v64, 0
    ds_read_b128 v[204:207], v10 offset:45056
    s_waitcnt lgkmcnt(7)
    v_mfma_f32_32x32x16_bf16 v[140:155], v[208:211], v[32:35], v[140:155]
    v_mov_b32 v65, 0
    v_mov_b32 v66, 0
    v_mov_b32 v67, 0
    v_mov_b32 v68, 0
    ds_read_b128 v[208:211], v10 offset:46080
    s_waitcnt lgkmcnt(7)
    v_mfma_f32_32x32x16_bf16 v[140:155], v[212:215], v[36:39], v[140:155]
    v_mov_b32 v69, 0
    v_mov_b32 v70, 0
    v_mov_b32 v71, 0
    v_mov_b32 v72, 0
    ds_read_b128 v[212:215], v10 offset:47104
    s_waitcnt lgkmcnt(7)
    v_mfma_f32_32x32x16_bf16 v[140:155], v[216:219], v[40:43], v[140:155]
    v_mov_b32 v73, 0
    v_mov_b32 v74, 0
    v_mov_b32 v75, 0
    v_mov_b32 v76, 0
    ds_read_b128 v[216:219], v10 offset:48128
    s_waitcnt lgkmcnt(7)
    v_mfma_f32_32x32x16_bf16 v[156:171], v[188:191], v[12:15], 0
    v_mov_b32 v77, 0
    v_mov_b32 v78, 0
    v_mov_b32 v79, 0
    v_mov_b32 v80, 0
    s_waitcnt lgkmcnt(6)
    v_mfma_f32_32x32x16_bf16 v[156:171], v[192:195], v[16:19], v[156:171]
    v_mov_b32 v81, 0
    v_mov_b32 v82, 0
    v_mov_b32 v83, 0
    v_mov_b32 v84, 0
    s_waitcnt lgkmcnt(5)
    v_mfma_f32_32x32x16_bf16 v[156:171], v[196:199], v[20:23], v[156:171]
    v_mov_b32 v85, 0
    v_mov_b32 v86, 0
    v_mov_b32 v87, 0
    v_mov_b32 v88, 0
    s_waitcnt lgkmcnt(4)
    v_mfma_f32_32x32x16_bf16 v[156:171], v[200:203], v[24:27], v[156:171]
    v_mov_b32 v89, 0
    v_mov_b32 v90, 0
    v_mov_b32 v91, 0
    v_mov_b32 v92, 0
    s_waitcnt lgkmcnt(3)
    v_mfma_f32_32x32x16_bf16 v[156:171], v[204:207], v[28:31], v[156:171]
    v_mov_b32 v93, 0
    v_mov_b32 v94, 0
    v_mov_b32 v95, 0
    v_mov_b32 v96, 0
    s_waitcnt lgkmcnt(2)
    v_mfma_f32_32x32x16_bf16 v[156:171], v[208:211], v[32:35], v[156:171]
    v_mov_b32 v97, 0
    v_mov_b32 v98, 0
    v_mov_b32 v99, 0
    v_mov_b32 v100, 0
    s_waitcnt lgkmcnt(1)
    v_mfma_f32_32x32x16_bf16 v[156:171], v[212:215], v[36:39], v[156:171]
    v_mov_b32 v101, 0
    v_mov_b32 v102, 0
    v_mov_b32 v103, 0
    v_mov_b32 v104, 0
    s_waitcnt lgkmcnt(0)
    v_mfma_f32_32x32x16_bf16 v[156:171], v[216:219], v[40:43], v[156:171]
    v_mov_b32 v105, 0
    v_mov_b32 v106, 0
    v_mov_b32 v107, 0
    v_max3_f32 v4, v140, v141, v142
    v_max3_f32 v5, v143, v144, v145
    v_max3_f32 v4, v4, v146, v147
    v_max3_f32 v5, v5, v148, v149
    v_max3_f32 v4, v4, v150, v151
    v_max3_f32 v5, v5, v152, v153
    v_max3_f32 v4, v4, v154, v155
    s_nop 1
    v_max3_f32 v5, v5, v156, v157
    v_max3_f32 v4, v4, v158, v159
    v_max3_f32 v5, v5, v160, v161
    v_max3_f32 v4, v4, v162, v163
    v_max3_f32 v5, v5, v164, v165
    v_max3_f32 v4, v4, v166, v167
    v_max3_f32 v5, v5, v168, v169
    v_max3_f32 v4, v4, v170, v171
    v_max_f32 v4, v4, v5
    v_mov_b32 v5, v4
    s_nop 1
    v_permlane32_swap_b32 v4, v5
    v_max_f32 v228, v4, v5
    v_mov_b32 v220, v228
    v_sub_f32 v172, 0, v228
    v_sub_f32 v173, 0, v228
    v_sub_f32 v174, 0, v228
    v_sub_f32 v175, 0, v228
    v_sub_f32 v176, 0, v228
    v_sub_f32 v177, 0, v228
    v_sub_f32 v178, 0, v228
    v_sub_f32 v179, 0, v228
    v_sub_f32 v180, 0, v228
    v_sub_f32 v181, 0, v228
    v_sub_f32 v182, 0, v228
    v_sub_f32 v183, 0, v228
    v_sub_f32 v184, 0, v228
    v_sub_f32 v185, 0, v228
    v_sub_f32 v186, 0, v228
    v_sub_f32 v187, 0, v228
    v_sub_f32 v140, v140, v228
    v_sub_f32 v141, v141, v228
    v_sub_f32 v142, v142, v228
    v_sub_f32 v143, v143, v228
    v_sub_f32 v144, v144, v228
    v_sub_f32 v145, v145, v228
    v_sub_f32 v146, v146, v228
    v_sub_f32 v147, v147, v228
    v_sub_f32 v148, v148, v228
    v_sub_f32 v149, v149, v228
    v_sub_f32 v150, v150, v228
    v_sub_f32 v151, v151, v228
    v_sub_f32 v152, v152, v228
    v_sub_f32 v153, v153, v228
    v_sub_f32 v154, v154, v228
    v_sub_f32 v155, v155, v228
    v_sub_f32 v156, v156, v228
    v_sub_f32 v157, v157, v228
    v_sub_f32 v158, v158, v228
    v_sub_f32 v159, v159, v228
    v_sub_f32 v160, v160, v228
    v_sub_f32 v161, v161, v228
    v_sub_f32 v162, v162, v228
    v_sub_f32 v163, v163, v228
    v_sub_f32 v164, v164, v228
    v_sub_f32 v165, v165, v228
    v_sub_f32 v166, v166, v228
    v_sub_f32 v167, v167, v228
    v_sub_f32 v168, v168, v228
    v_sub_f32 v169, v169, v228
    v_sub_f32 v170, v170, v228
    v_sub_f32 v171, v171, v228
    s_nop 0
    s_branch k2_attn_kernel_loop1_1
k2_attn_kernel_pro11_1:
    s_mov_b32 s60, 0
    ds_read_b128 v[188:191], v10 offset:32768
    ds_read_b128 v[192:195], v10 offset:33792
    ds_read_b128 v[196:199], v10 offset:34816
    ds_read_b128 v[200:203], v10 offset:35840
    ds_read_b128 v[204:207], v10 offset:36864
    ds_read_b128 v[208:211], v10 offset:37888
    ds_read_b128 v[212:215], v10 offset:38912
    v_mov_b32 v44, 0
    ds_read_b128 v[216:219], v10 offset:39936
    s_waitcnt lgkmcnt(7)
    v_mfma_f32_32x32x16_bf16 v[140:155], v[188:191], v[12:15], 0
    v_mov_b32 v45, 0
    v_mov_b32 v46, 0
    v_mov_b32 v47, 0
    v_mov_b32 v48, 0
    ds_read_b128 v[188:191], v10 offset:40960
    s_waitcnt lgkmcnt(7)
    v_mfma_f32_32x32x16_bf16 v[140:155], v[192:195], v[16:19], v[140:155]
    v_mov_b32 v49, 0
    v_mov_b32 v50, 0
    v_mov_b32 v51, 0
    v_mov_b32 v52, 0
    ds_read_b128 v[192:195], v10 offset:41984
    s_waitcnt lgkmcnt(7)
    v_mfma_f32_32x32x16_bf16 v[140:155], v[196:199], v[20:23], v[140:155]
    v_mov_b32 v53, 0
    v_mov_b32 v54, 0
    v_mov_b32 v55, 0
    v_mov_b32 v56, 0
    ds_read_b128 v[196:199], v10 offset:43008
    s_waitcnt lgkmcnt(7)
    v_mfma_f32_32x32x16_bf16 v[140:155], v[200:203], v[24:27], v[140:155]
    v_mov_b32 v57, 0
    v_mov_b32 v58, 0
    v_mov_b32 v59, 0
    v_mov_b32 v60, 0
    ds_read_b128 v[200:203], v10 offset:44032
    s_waitcnt lgkmcnt(7)
    v_mfma_f32_32x32x16_bf16 v[140:155], v[204:207], v[28:31], v[140:155]
    v_mov_b32 v61, 0
    v_mov_b32 v62, 0
    v_mov_b32 v63, 0
    v_mov_b32 v64, 0
    ds_read_b128 v[204:207], v10 offset:45056
    s_waitcnt lgkmcnt(7)
    v_mfma_f32_32x32x16_bf16 v[140:155], v[208:211], v[32:35], v[140:155]
    v_mov_b32 v65, 0
    v_mov_b32 v66, 0
    v_mov_b32 v67, 0
    v_mov_b32 v68, 0
    ds_read_b128 v[208:211], v10 offset:46080
    s_waitcnt lgkmcnt(7)
    v_mfma_f32_32x32x16_bf16 v[140:155], v[212:215], v[36:39], v[140:155]
    v_mov_b32 v69, 0
    v_mov_b32 v70, 0
    v_mov_b32 v71, 0
    v_mov_b32 v72, 0
    ds_read_b128 v[212:215], v10 offset:47104
    s_waitcnt lgkmcnt(7)
    v_mfma_f32_32x32x16_bf16 v[140:155], v[216:219], v[40:43], v[140:155]
    v_mov_b32 v73, 0
    v_mov_b32 v74, 0
    v_mov_b32 v75, 0
    v_mov_b32 v76, 0
    ds_read_b128 v[216:219], v10 offset:48128
    s_waitcnt lgkmcnt(7)
    v_mfma_f32_32x32x16_bf16 v[156:171], v[188:191], v[12:15], 0
    v_mov_b32 v77, 0
    v_mov_b32 v78, 0
    v_mov_b32 v79, 0
    v_mov_b32 v80, 0
    s_waitcnt lgkmcnt(6)
    v_mfma_f32_32x32x16_bf16 v[156:171], v[192:195], v[16:19], v[156:171]
    v_mov_b32 v81, 0
    v_mov_b32 v82, 0
    v_mov_b32 v83, 0
    v_mov_b32 v84, 0
    s_waitcnt lgkmcnt(5)
    v_mfma_f32_32x32x16_bf16 v[156:171], v[196:199], v[20:23], v[156:171]
    v_mov_b32 v85, 0
    v_mov_b32 v86, 0
    v_mov_b32 v87, 0
    v_mov_b32 v88, 0
    s_waitcnt lgkmcnt(4)
    v_mfma_f32_32x32x16_bf16 v[156:171], v[200:203], v[24:27], v[156:171]
    v_mov_b32 v89, 0
    v_mov_b32 v90, 0
    v_mov_b32 v91, 0
    v_mov_b32 v92, 0
    s_waitcnt lgkmcnt(3)
    v_mfma_f32_32x32x16_bf16 v[156:171], v[204:207], v[28:31], v[156:171]
    v_mov_b32 v93, 0
    v_mov_b32 v94, 0
    v_mov_b32 v95, 0
    v_mov_b32 v96, 0
    s_waitcnt lgkmcnt(2)
    v_mfma_f32_32x32x16_bf16 v[156:171], v[208:211], v[32:35], v[156:171]
    v_mov_b32 v97, 0
    v_mov_b32 v98, 0
    v_mov_b32 v99, 0
    v_mov_b32 v100, 0
    s_waitcnt lgkmcnt(1)
    v_mfma_f32_32x32x16_bf16 v[156:171], v[212:215], v[36:39], v[156:171]
    v_mov_b32 v101, 0
    v_mov_b32 v102, 0
    v_mov_b32 v103, 0
    v_mov_b32 v104, 0
    s_waitcnt lgkmcnt(0)
    v_mfma_f32_32x32x16_bf16 v[156:171], v[216:219], v[40:43], v[156:171]
    v_mov_b32 v105, 0
    v_mov_b32 v106, 0
    v_mov_b32 v107, 0
    v_cmp_ge_i32 vcc, v226, 0
    s_nop 1
    v_cndmask_b32 v140, v227, v140, vcc
    v_cmp_ge_i32 vcc, v226, 1
    s_nop 1
    v_cndmask_b32 v141, v227, v141, vcc
    v_cmp_ge_i32 vcc, v226, 2
    s_nop 1
    v_cndmask_b32 v142, v227, v142, vcc
    v_cmp_ge_i32 vcc, v226, 3
    s_nop 1
    v_cndmask_b32 v143, v227, v143, vcc
    v_cmp_ge_i32 vcc, v226, 8
    s_nop 1
    v_cndmask_b32 v144, v227, v144, vcc
    v_cmp_ge_i32 vcc, v226, 9
    s_nop 1
    v_cndmask_b32 v145, v227, v145, vcc
    v_cmp_ge_i32 vcc, v226, 10
    s_nop 1
    v_cndmask_b32 v146, v227, v146, vcc
    v_cmp_ge_i32 vcc, v226, 11
    s_nop 1
    v_cndmask_b32 v147, v227, v147, vcc
    v_cmp_ge_i32 vcc, v226, 16
    s_nop 1
    v_cndmask_b32 v148, v227, v148, vcc
    v_cmp_ge_i32 vcc, v226, 17
    s_nop 1
    v_cndmask_b32 v149, v227, v149, vcc
    v_cmp_ge_i32 vcc, v226, 18
    s_nop 1
    v_cndmask_b32 v150, v227, v150, vcc
    v_cmp_ge_i32 vcc, v226, 19
    s_nop 1
    v_cndmask_b32 v151, v227, v151, vcc
    v_cmp_ge_i32 vcc, v226, 24
    s_nop 1
    v_cndmask_b32 v152, v227, v152, vcc
    v_cmp_ge_i32 vcc, v226, 25
    s_nop 1
    v_cndmask_b32 v153, v227, v153, vcc
    v_cmp_ge_i32 vcc, v226, 26
    s_nop 1
    v_cndmask_b32 v154, v227, v154, vcc
    v_cmp_ge_i32 vcc, v226, 27
    s_nop 1
    v_cndmask_b32 v155, v227, v155, vcc
    v_cmp_ge_i32 vcc, v226, 32
    s_nop 1
    v_cndmask_b32 v156, v227, v156, vcc
    v_cmp_ge_i32 vcc, v226, 33
    s_nop 1
    v_cndmask_b32 v157, v227, v157, vcc
    v_cmp_ge_i32 vcc, v226, 34
    s_nop 1
    v_cndmask_b32 v158, v227, v158, vcc
    v_cmp_ge_i32 vcc, v226, 35
    s_nop 1
    v_cndmask_b32 v159, v227, v159, vcc
    v_cmp_ge_i32 vcc, v226, 40
    s_nop 1
    v_cndmask_b32 v160, v227, v160, vcc
    v_cmp_ge_i32 vcc, v226, 41
    s_nop 1
    v_cndmask_b32 v161, v227, v161, vcc
    v_cmp_ge_i32 vcc, v226, 42
    s_nop 1
    v_cndmask_b32 v162, v227, v162, vcc
    v_cmp_ge_i32 vcc, v226, 43
    s_nop 1
    v_cndmask_b32 v163, v227, v163, vcc
    v_cmp_ge_i32 vcc, v226, 48
    s_nop 1
    v_cndmask_b32 v164, v227, v164, vcc
    v_cmp_ge_i32 vcc, v226, 49
    s_nop 1
    v_cndmask_b32 v165, v227, v165, vcc
    v_cmp_ge_i32 vcc, v226, 50
    s_nop 1
    v_cndmask_b32 v166, v227, v166, vcc
    v_cmp_ge_i32 vcc, v226, 51
    s_nop 1
    v_cndmask_b32 v167, v227, v167, vcc
    v_cmp_ge_i32 vcc, v226, 56
    s_nop 1
    v_cndmask_b32 v168, v227, v168, vcc
    v_cmp_ge_i32 vcc, v226, 57
    s_nop 1
    v_cndmask_b32 v169, v227, v169, vcc
    v_cmp_ge_i32 vcc, v226, 58
    s_nop 1
    v_cndmask_b32 v170, v227, v170, vcc
    v_cmp_ge_i32 vcc, v226, 59
    s_nop 1
    v_cndmask_b32 v171, v227, v171, vcc
    v_max3_f32 v4, v140, v141, v142
    v_max3_f32 v5, v143, v144, v145
    v_max3_f32 v4, v4, v146, v147
    v_max3_f32 v5, v5, v148, v149
    v_max3_f32 v4, v4, v150, v151
    v_max3_f32 v5, v5, v152, v153
    v_max3_f32 v4, v4, v154, v155
    v_max3_f32 v5, v5, v156, v157
    v_max3_f32 v4, v4, v158, v159
    v_max3_f32 v5, v5, v160, v161
    v_max3_f32 v4, v4, v162, v163
    v_max3_f32 v5, v5, v164, v165
    v_max3_f32 v4, v4, v166, v167
    v_max3_f32 v5, v5, v168, v169
    v_max3_f32 v4, v4, v170, v171
    v_max_f32 v4, v4, v5
    v_mov_b32 v5, v4
    s_nop 1
    v_permlane32_swap_b32 v4, v5
    v_max_f32 v228, v4, v5
    v_mov_b32 v220, v228
    v_sub_f32 v172, 0, v228
    v_sub_f32 v173, 0, v228
    v_sub_f32 v174, 0, v228
    v_sub_f32 v175, 0, v228
    v_sub_f32 v176, 0, v228
    v_sub_f32 v177, 0, v228
    v_sub_f32 v178, 0, v228
    v_sub_f32 v179, 0, v228
    v_sub_f32 v180, 0, v228
    v_sub_f32 v181, 0, v228
    v_sub_f32 v182, 0, v228
    v_sub_f32 v183, 0, v228
    v_sub_f32 v184, 0, v228
    v_sub_f32 v185, 0, v228
    v_sub_f32 v186, 0, v228
    v_sub_f32 v187, 0, v228
    v_sub_f32 v140, v140, v228
    v_sub_f32 v141, v141, v228
    v_sub_f32 v142, v142, v228
    v_sub_f32 v143, v143, v228
    v_sub_f32 v144, v144, v228
    v_sub_f32 v145, v145, v228
    v_sub_f32 v146, v146, v228
    v_sub_f32 v147, v147, v228
    v_sub_f32 v148, v148, v228
    v_sub_f32 v149, v149, v228
    v_sub_f32 v150, v150, v228
    v_sub_f32 v151, v151, v228
    v_sub_f32 v152, v152, v228
    v_sub_f32 v153, v153, v228
    v_sub_f32 v154, v154, v228
    v_sub_f32 v155, v155, v228
    v_sub_f32 v156, v156, v228
    v_sub_f32 v157, v157, v228
    v_sub_f32 v158, v158, v228
    v_sub_f32 v159, v159, v228
    v_sub_f32 v160, v160, v228
    v_sub_f32 v161, v161, v228
    v_sub_f32 v162, v162, v228
    v_sub_f32 v163, v163, v228
    v_sub_f32 v164, v164, v228
    v_sub_f32 v165, v165, v228
    v_sub_f32 v166, v166, v228
    v_sub_f32 v167, v167, v228
    v_sub_f32 v168, v168, v228
    v_sub_f32 v169, v169, v228
    v_sub_f32 v170, v170, v228
    v_sub_f32 v171, v171, v228
    s_nop 0
    s_branch k2_attn_kernel_epi1_1
k2_attn_kernel_loop0_1:
    s_sub_u32 s62, s62, 1
    s_waitcnt lgkmcnt(0)
    s_barrier
    s_cmp_eq_u32 s62, 0
    s_cbranch_scc1 k2_attn_kernel_last0_1
    s_add_u32 s60, s60, 32768
    s_add_u32 s61, s61, 8192
    ds_read_b128 v[188:191], v10 offset:32768
    ds_read_b128 v[192:195], v10 offset:33792
    ds_read_b128 v[196:199], v10 offset:34816
    ds_read_b128 v[200:203], v10 offset:35840
    ds_read_b128 v[204:207], v10 offset:36864
    ds_read_b128 v[208:211], v10 offset:37888
    ds_read_b128 v[212:215], v10 offset:38912
    v_exp_f32 v108, v108
    v_exp_f32 v109, v109
    v_exp_f32 v110, v110
    v_exp_f32 v111, v111
    v_exp_f32 v112, v112
    v_exp_f32 v113, v113
    ds_read_b128 v[216:219], v10 offset:39936
    s_waitcnt lgkmcnt(7)
    v_mfma_f32_32x32x16_bf16 v[140:155], v[188:191], v[12:15], v[172:187]
    v_exp_f32 v114, v114
    v_exp_f32 v115, v115
    v_add_f32 v221, v221, v108
    ds_read_b128 v[188:191], v10 offset:40960
    s_waitcnt lgkmcnt(7)
    v_mfma_f32_32x32x16_bf16 v[140:155], v[192:195], v[16:19], v[140:155]
    v_add_f32 v222, v222, v109
    s_mov_b32 m0, 139264
    s_min_u32 s4, s76, s77
    s_add_u32 s76, s76, 1024
    buffer_load_dwordx4 v230, s[72:75], s4 offen lds
    v_cvt_pk_bf16_f32 v108, v108, v109
    ds_read_b128 v[192:195], v10 offset:41984
    s_waitcnt lgkmcnt(7)
    v_mfma_f32_32x32x16_bf16 v[140:155], v[196:199], v[20:23], v[140:155]
    v_add_f32 v221, v221, v110
    v_add_f32 v222, v222, v111
    v_cvt_pk_bf16_f32 v109, v110, v111
    ds_read_b128 v[196:199], v10 offset:43008
    s_waitcnt lgkmcnt(7)
    v_mfma_f32_32x32x16_bf16 v[140:155], v[200:203], v[24:27], v[140:155]
    v_add_f32 v221, v221, v112
    v_add_f32 v222, v222, v113
    v_cvt_pk_bf16_f32 v110, v112, v113
    ds_read_b128 v[200:203], v10 offset:44032
    s_waitcnt lgkmcnt(7)
    v_mfma_f32_32x32x16_bf16 v[140:155], v[204:207], v[28:31], v[140:155]
    v_add_f32 v221, v221, v114
    v_add_f32 v222, v222, v115
    v_cvt_pk_bf16_f32 v111, v114, v115
    ds_read_b128 v[204:207], v10 offset:45056
    s_waitcnt lgkmcnt(7)
    v_mfma_f32_32x32x16_bf16 v[140:155], v[208:211], v[32:35], v[140:155]
    v_exp_f32 v116, v116
    v_exp_f32 v117, v117
    v_exp_f32 v118, v118
    ds_read_b128 v[208:211], v10 offset:46080
    s_waitcnt lgkmcnt(7)
    v_mfma_f32_32x32x16_bf16 v[140:155], v[212:215], v[36:39], v[140:155]
    v_exp_f32 v119, v119
    v_exp_f32 v120, v120
    v_exp_f32 v121, v121
    ds_read_b128 v[212:215], v10 offset:47104
    s_waitcnt lgkmcnt(7)
    v_mfma_f32_32x32x16_bf16 v[140:155], v[216:219], v[40:43], v[140:155]
    v_exp_f32 v122, v122
    v_exp_f32 v123, v123
    v_add_f32 v221, v221, v116
    ds_read_b128 v[216:219], v10 offset:48128
    s_waitcnt lgkmcnt(7)
    v_mfma_f32_32x32x16_bf16 v[156:171], v[188:191], v[12:15], v[172:187]
    v_add_f32 v222, v222, v117
    v_cvt_pk_bf16_f32 v116, v116, v117
    v_add_f32 v221, v221, v118
    ds_read_b128 v[188:191], v11 offset:0
    s_waitcnt lgkmcnt(7)
    v_mfma_f32_32x32x16_bf16 v[156:171], v[192:195], v[16:19], v[156:171]
    v_add_f32 v222, v222, v119
    v_cvt_pk_bf16_f32 v117, v118, v119
    v_add_f32 v221, v221, v120
    ds_read_b128 v[192:195], v11 offset:8192
    s_waitcnt lgkmcnt(7)
    v_mfma_f32_32x32x16_bf16 v[156:171], v[196:199], v[20:23], v[156:171]
    v_add_f32 v222, v222, v121
    v_cvt_pk_bf16_f32 v118, v120, v121
    v_add_f32 v221, v221, v122
    ds_read_b128 v[196:199], v11 offset:16384
    s_waitcnt lgkmcnt(7)
    v_mfma_f32_32x32x16_bf16 v[156:171], v[200:203], v[24:27], v[156:171]
    v_add_f32 v222, v222, v123
    s_mov_b32 m0, 139264
    s_min_u32 s4, s76, s77
    s_add_u32 s76, s76, 1024
    buffer_load_dwordx4 v230, s[72:75], s4 offen lds
    v_cvt_pk_bf16_f32 v119, v122, v123
    ds_read_b128 v[200:203], v11 offset:24576
    s_waitcnt lgkmcnt(7)
    v_mfma_f32_32x32x16_bf16 v[156:171], v[204:207], v[28:31], v[156:171]
    v_exp_f32 v124, v124
    v_exp_f32 v125, v125
    v_exp_f32 v126, v126
    ds_read_b128 v[204:207], v11 offset:1024
    s_waitcnt lgkmcnt(7)
    v_mfma_f32_32x32x16_bf16 v[156:171], v[208:211], v[32:35], v[156:171]
    v_exp_f32 v127, v127
    v_exp_f32 v128, v128
    v_exp_f32 v129, v129
    ds_read_b128 v[208:211], v11 offset:9216
    s_waitcnt lgkmcnt(7)
    v_mfma_f32_32x32x16_bf16 v[156:171], v[212:215], v[36:39], v[156:171]
    v_exp_f32 v130, v130
    v_exp_f32 v131, v131
    v_add_f32 v221, v221, v124
    ds_read_b128 v[212:215], v11 offset:17408
    s_waitcnt lgkmcnt(7)
    v_mfma_f32_32x32x16_bf16 v[156:171], v[216:219], v[40:43], v[156:171]
    v_add_f32 v222, v222, v125
    v_cvt_pk_bf16_f32 v124, v124, v125
    v_add_f32 v221, v221, v126
    ds_read_b128 v[216:219], v11 offset:25600
    s_waitcnt lgkmcnt(7)
    v_mfma_f32_32x32x16_bf16 v[44:59], v[188:191], v[108:111], v[44:59]
    v_add_f32 v222, v222, v127
    v_cvt_pk_bf16_f32 v125, v126, v127
    v_add_f32 v221, v221, v128
    ds_read_b128 v[188:191], v11 offset:2048
    s_waitcnt lgkmcnt(7)
    v_mfma_f32_32x32x16_bf16 v[60:75], v[192:195], v[108:111], v[60:75]
    v_add_f32 v222, v222, v129
    v_cvt_pk_bf16_f32 v126, v128, v129
    v_add_f32 v221, v221, v130
    ds_read_b128 v[192:195], v11 offset:10240
    s_waitcnt lgkmcnt(7)
    v_mfma_f32_32x32x16_bf16 v[76:91], v[196:199], v[108:111], v[76:91]
    v_add_f32 v222, v222, v131
    v_cvt_pk_bf16_f32 v127, v130, v131
    v_exp_f32 v132, v132
    ds_read_b128 v[196:199], v11 offset:18432
    s_waitcnt lgkmcnt(7)
    v_mfma_f32_32x32x16_bf16 v[92:107], v[200:203], v[108:111], v[92:107]
    v_exp_f32 v133, v133
    v_exp_f32 v134, v134
    v_exp_f32 v135, v135
    ds_read_b128 v[200:203], v11 offset:26624
    s_waitcnt lgkmcnt(7)
    v_mfma_f32_32x32x16_bf16 v[44:59], v[204:207], v[116:119], v[44:59]
    v_exp_f32 v136, v136
    v_exp_f32 v137, v137
    v_exp_f32 v138, v138
    ds_read_b128 v[204:207], v11 offset:3072
    s_waitcnt lgkmcnt(7)
    v_mfma_f32_32x32x16_bf16 v[60:75], v[208:211], v[116:119], v[60:75]
    v_exp_f32 v139, v139
    v_add_f32 v221, v221, v132
    v_add_f32 v222, v222, v133
    ds_read_b128 v[208:211], v11 offset:11264
    s_waitcnt lgkmcnt(7)
    v_mfma_f32_32x32x16_bf16 v[76:91], v[212:215], v[116:119], v[76:91]
    v_cvt_pk_bf16_f32 v132, v132, v133
    v_add_f32 v221, v221, v134
    v_add_f32 v222, v222, v135
    ds_read_b128 v[212:215], v11 offset:19456
    s_waitcnt lgkmcnt(7)
    v_mfma_f32_32x32x16_bf16 v[92:107], v[216:219], v[116:119], v[92:107]
    v_cvt_pk_bf16_f32 v133, v134, v135
    v_add_f32 v221, v221, v136
    v_add_f32 v222, v222, v137
    ds_read_b128 v[216:219], v11 offset:27648
    s_waitcnt lgkmcnt(7)
    v_mfma_f32_32x32x16_bf16 v[44:59], v[188:191], v[124:127], v[44:59]
    v_cvt_pk_bf16_f32 v134, v136, v137
    v_add_f32 v221, v221, v138
    v_add_f32 v222, v222, v139
    s_waitcnt lgkmcnt(6)
    v_mfma_f32_32x32x16_bf16 v[60:75], v[192:195], v[124:127], v[60:75]
    v_cvt_pk_bf16_f32 v135, v138, v139
    v_max3_f32 v4, v140, v141, v142
    v_max3_f32 v5, v143, v144, v145
    s_waitcnt lgkmcnt(5)
    v_mfma_f32_32x32x16_bf16 v[76:91], v[196:199], v[124:127], v[76:91]
    v_max3_f32 v4, v4, v146, v147
    v_max3_f32 v5, v5, v148, v149
    v_max3_f32 v4, v4, v150, v151
    s_waitcnt lgkmcnt(4)
    v_mfma_f32_32x32x16_bf16 v[92:107], v[200:203], v[124:127], v[92:107]
    v_max3_f32 v5, v5, v152, v153
    v_max3_f32 v4, v4, v154, v155
    v_max3_f32 v5, v5, v156, v157
    s_waitcnt lgkmcnt(3)
    v_mfma_f32_32x32x16_bf16 v[44:59], v[204:207], v[132:135], v[44:59]
    v_max3_f32 v4, v4, v158, v159
    v_max3_f32 v5, v5, v160, v161
    v_max3_f32 v4, v4, v162, v163
    s_waitcnt lgkmcnt(2)
    v_mfma_f32_32x32x16_bf16 v[60:75], v[208:211], v[132:135], v[60:75]
    v_max3_f32 v5, v5, v164, v165
    v_max3_f32 v4, v4, v166, v167
    v_max3_f32 v5, v5, v168, v169
    s_waitcnt lgkmcnt(1)
    v_mfma_f32_32x32x16_bf16 v[76:91], v[212:215], v[132:135], v[76:91]
    v_max3_f32 v4, v4, v170, v171
    v_max_f32 v4, v4, v5
    v_mov_b32 v5, v4
    s_waitcnt lgkmcnt(0)
    v_mfma_f32_32x32x16_bf16 v[92:107], v[216:219], v[132:135], v[92:107]
    v_permlane32_swap_b32 v4, v5
    v_max_f32 v228, v4, v5
    v_cmp_gt_f32 vcc, v228, v223
    s_nop 7
    s_cbranch_vccz k2_attn_kernel_keep_13
    v_max_f32 v4, 0, v228
    v_sub_f32 v5, 0, v4
    v_exp_f32 v5, v5
    v_add_f32 v220, v220, v4
    v_sub_f32 v172, 0, v220
    v_sub_f32 v173, 0, v220
    v_sub_f32 v174, 0, v220
    v_sub_f32 v175, 0, v220
    v_sub_f32 v176, 0, v220
    v_sub_f32 v177, 0, v220
    v_sub_f32 v178, 0, v220
    v_sub_f32 v179, 0, v220
    v_sub_f32 v180, 0, v220
    v_sub_f32 v181, 0, v220
    v_sub_f32 v182, 0, v220
    v_sub_f32 v183, 0, v220
    v_sub_f32 v184, 0, v220
    v_sub_f32 v185, 0, v220
    v_sub_f32 v186, 0, v220
    v_sub_f32 v187, 0, v220
    v_sub_f32 v140, v140, v4
    v_sub_f32 v141, v141, v4
    v_sub_f32 v142, v142, v4
    v_sub_f32 v143, v143, v4
    v_sub_f32 v144, v144, v4
    v_sub_f32 v145, v145, v4
    v_sub_f32 v146, v146, v4
    v_sub_f32 v147, v147, v4
    v_sub_f32 v148, v148, v4
    v_sub_f32 v149, v149, v4
    v_sub_f32 v150, v150, v4
    v_sub_f32 v151, v151, v4
    v_sub_f32 v152, v152, v4
    v_sub_f32 v153, v153, v4
    v_sub_f32 v154, v154, v4
    v_sub_f32 v155, v155, v4
    v_sub_f32 v156, v156, v4
    v_sub_f32 v157, v157, v4
    v_sub_f32 v158, v158, v4
    v_sub_f32 v159, v159, v4
    v_sub_f32 v160, v160, v4
    v_sub_f32 v161, v161, v4
    v_sub_f32 v162, v162, v4
    v_sub_f32 v163, v163, v4
    v_sub_f32 v164, v164, v4
    v_sub_f32 v165, v165, v4
    v_sub_f32 v166, v166, v4
    v_sub_f32 v167, v167, v4
    v_sub_f32 v168, v168, v4
    v_sub_f32 v169, v169, v4
    v_sub_f32 v170, v170, v4
    v_sub_f32 v171, v171, v4
    v_mul_f32 v221, v221, v5
    v_mul_f32 v222, v222, v5
    v_mul_f32 v44, v44, v5
    v_mul_f32 v45, v45, v5
    v_mul_f32 v46, v46, v5
    v_mul_f32 v47, v47, v5
    v_mul_f32 v48, v48, v5
    v_mul_f32 v49, v49, v5
    v_mul_f32 v50, v50, v5
    v_mul_f32 v51, v51, v5
    v_mul_f32 v52, v52, v5
    v_mul_f32 v53, v53, v5
    v_mul_f32 v54, v54, v5
    v_mul_f32 v55, v55, v5
    v_mul_f32 v56, v56, v5
    v_mul_f32 v57, v57, v5
    v_mul_f32 v58, v58, v5
    v_mul_f32 v59, v59, v5
    v_mul_f32 v60, v60, v5
    v_mul_f32 v61, v61, v5
    v_mul_f32 v62, v62, v5
    v_mul_f32 v63, v63, v5
    v_mul_f32 v64, v64, v5
    v_mul_f32 v65, v65, v5
    v_mul_f32 v66, v66, v5
    v_mul_f32 v67, v67, v5
    v_mul_f32 v68, v68, v5
    v_mul_f32 v69, v69, v5
    v_mul_f32 v70, v70, v5
    v_mul_f32 v71, v71, v5
    v_mul_f32 v72, v72, v5
    v_mul_f32 v73, v73, v5
    v_mul_f32 v74, v74, v5
    v_mul_f32 v75, v75, v5
    v_mul_f32 v76, v76, v5
    v_mul_f32 v77, v77, v5
    v_mul_f32 v78, v78, v5
    v_mul_f32 v79, v79, v5
    v_mul_f32 v80, v80, v5
    v_mul_f32 v81, v81, v5
    v_mul_f32 v82, v82, v5
    v_mul_f32 v83, v83, v5
    v_mul_f32 v84, v84, v5
    v_mul_f32 v85, v85, v5
    v_mul_f32 v86, v86, v5
    v_mul_f32 v87, v87, v5
    v_mul_f32 v88, v88, v5
    v_mul_f32 v89, v89, v5
    v_mul_f32 v90, v90, v5
    v_mul_f32 v91, v91, v5
    v_mul_f32 v92, v92, v5
    v_mul_f32 v93, v93, v5
    v_mul_f32 v94, v94, v5
    v_mul_f32 v95, v95, v5
    v_mul_f32 v96, v96, v5
    v_mul_f32 v97, v97, v5
    v_mul_f32 v98, v98, v5
    v_mul_f32 v99, v99, v5
    v_mul_f32 v100, v100, v5
    v_mul_f32 v101, v101, v5
    v_mul_f32 v102, v102, v5
    v_mul_f32 v103, v103, v5
    v_mul_f32 v104, v104, v5
    v_mul_f32 v105, v105, v5
    v_mul_f32 v106, v106, v5
    v_mul_f32 v107, v107, v5
    s_nop 0
k2_attn_kernel_keep_13:
    s_branch k2_attn_kernel_loop1_1
k2_attn_kernel_last0_1:
    s_mov_b32 s60, 0
    s_add_u32 s61, s61, 8192
    ds_read_b128 v[188:191], v10 offset:32768
    ds_read_b128 v[192:195], v10 offset:33792
    ds_read_b128 v[196:199], v10 offset:34816
    ds_read_b128 v[200:203], v10 offset:35840
    ds_read_b128 v[204:207], v10 offset:36864
    ds_read_b128 v[208:211], v10 offset:37888
    ds_read_b128 v[212:215], v10 offset:38912
    v_exp_f32 v108, v108
    v_exp_f32 v109, v109
    v_exp_f32 v110, v110
    v_exp_f32 v111, v111
    v_exp_f32 v112, v112
    v_exp_f32 v113, v113
    ds_read_b128 v[216:219], v10 offset:39936
    s_waitcnt lgkmcnt(7)
    v_mfma_f32_32x32x16_bf16 v[140:155], v[188:191], v[12:15], v[172:187]
    v_exp_f32 v114, v114
    v_exp_f32 v115, v115
    v_add_f32 v221, v221, v108
    v_add_f32 v222, v222, v109
    v_cvt_pk_bf16_f32 v108, v108, v109
    ds_read_b128 v[188:191], v10 offset:40960
    s_waitcnt lgkmcnt(7)
    v_mfma_f32_32x32x16_bf16 v[140:155], v[192:195], v[16:19], v[140:155]
    v_add_f32 v221, v221, v110
    v_add_f32 v222, v222, v111
    v_cvt_pk_bf16_f32 v109, v110, v111
    v_add_f32 v221, v221, v112
    v_add_f32 v222, v222, v113
    ds_read_b128 v[192:195], v10 offset:41984
    s_waitcnt lgkmcnt(7)
    v_mfma_f32_32x32x16_bf16 v[140:155], v[196:199], v[20:23], v[140:155]
    v_cvt_pk_bf16_f32 v110, v112, v113
    v_add_f32 v221, v221, v114
    v_add_f32 v222, v222, v115
    v_cvt_pk_bf16_f32 v111, v114, v115
    v_exp_f32 v116, v116
    ds_read_b128 v[196:199], v10 offset:43008
    s_waitcnt lgkmcnt(7)
    v_mfma_f32_32x32x16_bf16 v[140:155], v[200:203], v[24:27], v[140:155]
    v_exp_f32 v117, v117
    v_exp_f32 v118, v118
    v_exp_f32 v119, v119
    v_exp_f32 v120, v120
    v_exp_f32 v121, v121
    ds_read_b128 v[200:203], v10 offset:44032
    s_waitcnt lgkmcnt(7)
    v_mfma_f32_32x32x16_bf16 v[140:155], v[204:207], v[28:31], v[140:155]
    v_exp_f32 v122, v122
    v_exp_f32 v123, v123
    v_add_f32 v221, v221, v116
    v_add_f32 v222, v222, v117
    v_cvt_pk_bf16_f32 v116, v116, v117
    ds_read_b128 v[204:207], v10 offset:45056
    s_waitcnt lgkmcnt(7)
    v_mfma_f32_32x32x16_bf16 v[140:155], v[208:211], v[32:35], v[140:155]
    v_add_f32 v221, v221, v118
    v_add_f32 v222, v222, v119
    v_cvt_pk_bf16_f32 v117, v118, v119
    v_add_f32 v221, v221, v120
    v_add_f32 v222, v222, v121
    ds_read_b128 v[208:211], v10 offset:46080
    s_waitcnt lgkmcnt(7)
    v_mfma_f32_32x32x16_bf16 v[140:155], v[212:215], v[36:39], v[140:155]
    v_cvt_pk_bf16_f32 v118, v120, v121
    v_add_f32 v221, v221, v122
    v_add_f32 v222, v222, v123
    v_cvt_pk_bf16_f32 v119, v122, v123
    v_exp_f32 v124, v124
    ds_read_b128 v[212:215], v10 offset:47104
    s_waitcnt lgkmcnt(7)
    v_mfma_f32_32x32x16_bf16 v[140:155], v[216:219], v[40:43], v[140:155]
    v_exp_f32 v125, v125
    v_exp_f32 v126, v126
    v_exp_f32 v127, v127
    v_exp_f32 v128, v128
    v_exp_f32 v129, v129
    ds_read_b128 v[216:219], v10 offset:48128
    s_waitcnt lgkmcnt(7)
    v_mfma_f32_32x32x16_bf16 v[156:171], v[188:191], v[12:15], v[172:187]
    v_exp_f32 v130, v130
    v_exp_f32 v131, v131
    v_add_f32 v221, v221, v124
    v_add_f32 v222, v222, v125
    v_cvt_pk_bf16_f32 v124, v124, v125
    ds_read_b128 v[188:191], v11 offset:0
    s_waitcnt lgkmcnt(7)
    v_mfma_f32_32x32x16_bf16 v[156:171], v[192:195], v[16:19], v[156:171]
    v_add_f32 v221, v221, v126
    v_add_f32 v222, v222, v127
    v_cvt_pk_bf16_f32 v125, v126, v127
    v_add_f32 v221, v221, v128
    v_add_f32 v222, v222, v129
    ds_read_b128 v[192:195], v11 offset:8192
    s_waitcnt lgkmcnt(7)
    v_mfma_f32_32x32x16_bf16 v[156:171], v[196:199], v[20:23], v[156:171]
    v_cvt_pk_bf16_f32 v126, v128, v129
    v_add_f32 v221, v221, v130
    v_add_f32 v222, v222, v131
    v_cvt_pk_bf16_f32 v127, v130, v131
    ds_read_b128 v[196:199], v11 offset:16384
    s_waitcnt lgkmcnt(7)
    v_mfma_f32_32x32x16_bf16 v[156:171], v[200:203], v[24:27], v[156:171]
    v_exp_f32 v132, v132
    v_exp_f32 v133, v133
    v_exp_f32 v134, v134
    v_exp_f32 v135, v135
    v_exp_f32 v136, v136
    ds_read_b128 v[200:203], v11 offset:24576
    s_waitcnt lgkmcnt(7)
    v_mfma_f32_32x32x16_bf16 v[156:171], v[204:207], v[28:31], v[156:171]
    v_exp_f32 v137, v137
    v_exp_f32 v138, v138
    v_exp_f32 v139, v139
    v_add_f32 v221, v221, v132
    v_add_f32 v222, v222, v133
    ds_read_b128 v[204:207], v11 offset:1024
    s_waitcnt lgkmcnt(7)
    v_mfma_f32_32x32x16_bf16 v[156:171], v[208:211], v[32:35], v[156:171]
    v_cvt_pk_bf16_f32 v132, v132, v133
    v_add_f32 v221, v221, v134
    v_add_f32 v222, v222, v135
    v_cvt_pk_bf16_f32 v133, v134, v135
    v_add_f32 v221, v221, v136
    ds_read_b128 v[208:211], v11 offset:9216
    s_waitcnt lgkmcnt(7)
    v_mfma_f32_32x32x16_bf16 v[156:171], v[212:215], v[36:39], v[156:171]
    v_add_f32 v222, v222, v137
    v_cvt_pk_bf16_f32 v134, v136, v137
    v_add_f32 v221, v221, v138
    v_add_f32 v222, v222, v139
    v_cvt_pk_bf16_f32 v135, v138, v139
    ds_read_b128 v[212:215], v11 offset:17408
    s_waitcnt lgkmcnt(7)
    v_mfma_f32_32x32x16_bf16 v[156:171], v[216:219], v[40:43], v[156:171]
    v_cmp_ge_i32 vcc, v226, 0
    s_nop 1
    v_cndmask_b32 v140, v227, v140, vcc
    v_cmp_ge_i32 vcc, v226, 1
    s_nop 1
    v_cndmask_b32 v141, v227, v141, vcc
    v_cmp_ge_i32 vcc, v226, 2
    ds_read_b128 v[216:219], v11 offset:25600
    s_waitcnt lgkmcnt(7)
    v_mfma_f32_32x32x16_bf16 v[44:59], v[188:191], v[108:111], v[44:59]
    v_cndmask_b32 v142, v227, v142, vcc
    v_cmp_ge_i32 vcc, v226, 3
    s_nop 1
    v_cndmask_b32 v143, v227, v143, vcc
    v_cmp_ge_i32 vcc, v226, 8
    s_nop 1
    v_cndmask_b32 v144, v227, v144, vcc
    ds_read_b128 v[188:191], v11 offset:2048
    s_waitcnt lgkmcnt(7)
    v_mfma_f32_32x32x16_bf16 v[60:75], v[192:195], v[108:111], v[60:75]
    v_cmp_ge_i32 vcc, v226, 9
    s_nop 1
    v_cndmask_b32 v145, v227, v145, vcc
    v_cmp_ge_i32 vcc, v226, 10
    s_nop 1
    v_cndmask_b32 v146, v227, v146, vcc
    v_cmp_ge_i32 vcc, v226, 11
    ds_read_b128 v[192:195], v11 offset:10240
    s_waitcnt lgkmcnt(7)
    v_mfma_f32_32x32x16_bf16 v[76:91], v[196:199], v[108:111], v[76:91]
    v_cndmask_b32 v147, v227, v147, vcc
    v_cmp_ge_i32 vcc, v226, 16
    s_nop 1
    v_cndmask_b32 v148, v227, v148, vcc
    v_cmp_ge_i32 vcc, v226, 17
    s_nop 1
    v_cndmask_b32 v149, v227, v149, vcc
    ds_read_b128 v[196:199], v11 offset:18432
    s_waitcnt lgkmcnt(7)
    v_mfma_f32_32x32x16_bf16 v[92:107], v[200:203], v[108:111], v[92:107]
    v_cmp_ge_i32 vcc, v226, 18
    s_nop 1
    v_cndmask_b32 v150, v227, v150, vcc
    v_cmp_ge_i32 vcc, v226, 19
    s_nop 1
    v_cndmask_b32 v151, v227, v151, vcc
    v_cmp_ge_i32 vcc, v226, 24
    ds_read_b128 v[200:203], v11 offset:26624
    s_waitcnt lgkmcnt(7)
    v_mfma_f32_32x32x16_bf16 v[44:59], v[204:207], v[116:119], v[44:59]
    v_cndmask_b32 v152, v227, v152, vcc
    v_cmp_ge_i32 vcc, v226, 25
    s_nop 1
    v_cndmask_b32 v153, v227, v153, vcc
    v_cmp_ge_i32 vcc, v226, 26
    s_nop 1
    v_cndmask_b32 v154, v227, v154, vcc
    ds_read_b128 v[204:207], v11 offset:3072
    s_waitcnt lgkmcnt(7)
    v_mfma_f32_32x32x16_bf16 v[60:75], v[208:211], v[116:119], v[60:75]
    v_cmp_ge_i32 vcc, v226, 27
    s_nop 1
    v_cndmask_b32 v155, v227, v155, vcc
    v_cmp_ge_i32 vcc, v226, 32
    s_nop 1
    v_cndmask_b32 v156, v227, v156, vcc
    ds_read_b128 v[208:211], v11 offset:11264
    s_waitcnt lgkmcnt(7)
    v_mfma_f32_32x32x16_bf16 v[76:91], v[212:215], v[116:119], v[76:91]
    v_cmp_ge_i32 vcc, v226, 33
    s_nop 1
    v_cndmask_b32 v157, v227, v157, vcc
    v_cmp_ge_i32 vcc, v226, 34
    s_nop 1
    v_cndmask_b32 v158, v227, v158, vcc
    v_cmp_ge_i32 vcc, v226, 35
    ds_read_b128 v[212:215], v11 offset:19456
    s_waitcnt lgkmcnt(7)
    v_mfma_f32_32x32x16_bf16 v[92:107], v[216:219], v[116:119], v[92:107]
    v_cndmask_b32 v159, v227, v159, vcc
    v_cmp_ge_i32 vcc, v226, 40
    s_nop 1
    v_cndmask_b32 v160, v227, v160, vcc
    v_cmp_ge_i32 vcc, v226, 41
    s_nop 1
    v_cndmask_b32 v161, v227, v161, vcc
    ds_read_b128 v[216:219], v11 offset:27648
    s_waitcnt lgkmcnt(7)
    v_mfma_f32_32x32x16_bf16 v[44:59], v[188:191], v[124:127], v[44:59]
    v_cmp_ge_i32 vcc, v226, 42
    s_nop 1
    v_cndmask_b32 v162, v227, v162, vcc
    v_cmp_ge_i32 vcc, v226, 43
    s_nop 1
    v_cndmask_b32 v163, v227, v163, vcc
    v_cmp_ge_i32 vcc, v226, 48
    s_waitcnt lgkmcnt(6)
    v_mfma_f32_32x32x16_bf16 v[60:75], v[192:195], v[124:127], v[60:75]
    v_cndmask_b32 v164, v227, v164, vcc
    v_cmp_ge_i32 vcc, v226, 49
    s_nop 1
    v_cndmask_b32 v165, v227, v165, vcc
    v_cmp_ge_i32 vcc, v226, 50
    s_nop 1
    v_cndmask_b32 v166, v227, v166, vcc
    s_waitcnt lgkmcnt(5)
    v_mfma_f32_32x32x16_bf16 v[76:91], v[196:199], v[124:127], v[76:91]
    v_cmp_ge_i32 vcc, v226, 51
    s_nop 1
    v_cndmask_b32 v167, v227, v167, vcc
    v_cmp_ge_i32 vcc, v226, 56
    s_nop 1
    v_cndmask_b32 v168, v227, v168, vcc
    v_cmp_ge_i32 vcc, v226, 57
    s_waitcnt lgkmcnt(4)
    v_mfma_f32_32x32x16_bf16 v[92:107], v[200:203], v[124:127], v[92:107]
    v_cndmask_b32 v169, v227, v169, vcc
    v_cmp_ge_i32 vcc, v226, 58
    s_nop 1
    v_cndmask_b32 v170, v227, v170, vcc
    v_cmp_ge_i32 vcc, v226, 59
    s_nop 1
    v_cndmask_b32 v171, v227, v171, vcc
    s_waitcnt lgkmcnt(3)
    v_mfma_f32_32x32x16_bf16 v[44:59], v[204:207], v[132:135], v[44:59]
    v_max3_f32 v4, v140, v141, v142
    v_max3_f32 v5, v143, v144, v145
    v_max3_f32 v4, v4, v146, v147
    v_max3_f32 v5, v5, v148, v149
    v_max3_f32 v4, v4, v150, v151
    s_waitcnt lgkmcnt(2)
    v_mfma_f32_32x32x16_bf16 v[60:75], v[208:211], v[132:135], v[60:75]
    v_max3_f32 v5, v5, v152, v153
    v_max3_f32 v4, v4, v154, v155
    v_max3_f32 v5, v5, v156, v157
    v_max3_f32 v4, v4, v158, v159
    v_max3_f32 v5, v5, v160, v161
    s_waitcnt lgkmcnt(1)
    v_mfma_f32_32x32x16_bf16 v[76:91], v[212:215], v[132:135], v[76:91]
    v_max3_f32 v4, v4, v162, v163
    v_max3_f32 v5, v5, v164, v165
    v_max3_f32 v4, v4, v166, v167
    v_max3_f32 v5, v5, v168, v169
    v_max3_f32 v4, v4, v170, v171
    s_waitcnt lgkmcnt(0)
    v_mfma_f32_32x32x16_bf16 v[92:107], v[216:219], v[132:135], v[92:107]
    v_max_f32 v4, v4, v5
    v_mov_b32 v5, v4
    s_nop 1
    v_permlane32_swap_b32 v4, v5
    v_max_f32 v228, v4, v5
    v_cmp_gt_f32 vcc, v228, v223
    s_nop 3
    s_cbranch_vccz k2_attn_kernel_keep_14
    v_max_f32 v4, 0, v228
    v_sub_f32 v5, 0, v4
    v_exp_f32 v5, v5
    v_add_f32 v220, v220, v4
    v_sub_f32 v172, 0, v220
    v_sub_f32 v173, 0, v220
    v_sub_f32 v174, 0, v220
    v_sub_f32 v175, 0, v220
    v_sub_f32 v176, 0, v220
    v_sub_f32 v177, 0, v220
    v_sub_f32 v178, 0, v220
    v_sub_f32 v179, 0, v220
    v_sub_f32 v180, 0, v220
    v_sub_f32 v181, 0, v220
    v_sub_f32 v182, 0, v220
    v_sub_f32 v183, 0, v220
    v_sub_f32 v184, 0, v220
    v_sub_f32 v185, 0, v220
    v_sub_f32 v186, 0, v220
    v_sub_f32 v187, 0, v220
    v_sub_f32 v140, v140, v4
    v_sub_f32 v141, v141, v4
    v_sub_f32 v142, v142, v4
    v_sub_f32 v143, v143, v4
    v_sub_f32 v144, v144, v4
    v_sub_f32 v145, v145, v4
    v_sub_f32 v146, v146, v4
    v_sub_f32 v147, v147, v4
    v_sub_f32 v148, v148, v4
    v_sub_f32 v149, v149, v4
    v_sub_f32 v150, v150, v4
    v_sub_f32 v151, v151, v4
    v_sub_f32 v152, v152, v4
    v_sub_f32 v153, v153, v4
    v_sub_f32 v154, v154, v4
    v_sub_f32 v155, v155, v4
    v_sub_f32 v156, v156, v4
    v_sub_f32 v157, v157, v4
    v_sub_f32 v158, v158, v4
    v_sub_f32 v159, v159, v4
    v_sub_f32 v160, v160, v4
    v_sub_f32 v161, v161, v4
    v_sub_f32 v162, v162, v4
    v_sub_f32 v163, v163, v4
    v_sub_f32 v164, v164, v4
    v_sub_f32 v165, v165, v4
    v_sub_f32 v166, v166, v4
    v_sub_f32 v167, v167, v4
    v_sub_f32 v168, v168, v4
    v_sub_f32 v169, v169, v4
    v_sub_f32 v170, v170, v4
    v_sub_f32 v171, v171, v4
    v_mul_f32 v221, v221, v5
    v_mul_f32 v222, v222, v5
    v_mul_f32 v44, v44, v5
    v_mul_f32 v45, v45, v5
    v_mul_f32 v46, v46, v5
    v_mul_f32 v47, v47, v5
    v_mul_f32 v48, v48, v5
    v_mul_f32 v49, v49, v5
    v_mul_f32 v50, v50, v5
    v_mul_f32 v51, v51, v5
    v_mul_f32 v52, v52, v5
    v_mul_f32 v53, v53, v5
    v_mul_f32 v54, v54, v5
    v_mul_f32 v55, v55, v5
    v_mul_f32 v56, v56, v5
    v_mul_f32 v57, v57, v5
    v_mul_f32 v58, v58, v5
    v_mul_f32 v59, v59, v5
    v_mul_f32 v60, v60, v5
    v_mul_f32 v61, v61, v5
    v_mul_f32 v62, v62, v5
    v_mul_f32 v63, v63, v5
    v_mul_f32 v64, v64, v5
    v_mul_f32 v65, v65, v5
    v_mul_f32 v66, v66, v5
    v_mul_f32 v67, v67, v5
    v_mul_f32 v68, v68, v5
    v_mul_f32 v69, v69, v5
    v_mul_f32 v70, v70, v5
    v_mul_f32 v71, v71, v5
    v_mul_f32 v72, v72, v5
    v_mul_f32 v73, v73, v5
    v_mul_f32 v74, v74, v5
    v_mul_f32 v75, v75, v5
    v_mul_f32 v76, v76, v5
    v_mul_f32 v77, v77, v5
    v_mul_f32 v78, v78, v5
    v_mul_f32 v79, v79, v5
    v_mul_f32 v80, v80, v5
    v_mul_f32 v81, v81, v5
    v_mul_f32 v82, v82, v5
    v_mul_f32 v83, v83, v5
    v_mul_f32 v84, v84, v5
    v_mul_f32 v85, v85, v5
    v_mul_f32 v86, v86, v5
    v_mul_f32 v87, v87, v5
    v_mul_f32 v88, v88, v5
    v_mul_f32 v89, v89, v5
    v_mul_f32 v90, v90, v5
    v_mul_f32 v91, v91, v5
    v_mul_f32 v92, v92, v5
    v_mul_f32 v93, v93, v5
    v_mul_f32 v94, v94, v5
    v_mul_f32 v95, v95, v5
    v_mul_f32 v96, v96, v5
    v_mul_f32 v97, v97, v5
    v_mul_f32 v98, v98, v5
    v_mul_f32 v99, v99, v5
    v_mul_f32 v100, v100, v5
    v_mul_f32 v101, v101, v5
    v_mul_f32 v102, v102, v5
    v_mul_f32 v103, v103, v5
    v_mul_f32 v104, v104, v5
    v_mul_f32 v105, v105, v5
    v_mul_f32 v106, v106, v5
    v_mul_f32 v107, v107, v5
    s_nop 0
k2_attn_kernel_keep_14:
    s_branch k2_attn_kernel_epi1_1
k2_attn_kernel_loop1_1:
    s_sub_u32 s62, s62, 1
    s_waitcnt lgkmcnt(0)
    s_barrier
    s_cmp_eq_u32 s62, 0
    s_cbranch_scc1 k2_attn_kernel_last1_1
    s_add_u32 s60, s60, 32768
    s_add_u32 s61, s61, 8192
    ds_read_b128 v[188:191], v10 offset:0
    ds_read_b128 v[192:195], v10 offset:1024
    ds_read_b128 v[196:199], v10 offset:2048
    ds_read_b128 v[200:203], v10 offset:3072
    ds_read_b128 v[204:207], v10 offset:4096
    ds_read_b128 v[208:211], v10 offset:5120
    ds_read_b128 v[212:215], v10 offset:6144
    v_exp_f32 v140, v140
    v_exp_f32 v141, v141
    v_exp_f32 v142, v142
    v_exp_f32 v143, v143
    v_exp_f32 v144, v144
    v_exp_f32 v145, v145
    ds_read_b128 v[216:219], v10 offset:7168
    s_waitcnt lgkmcnt(7)
    v_mfma_f32_32x32x16_bf16 v[108:123], v[188:191], v[12:15], v[172:187]
    v_exp_f32 v146, v146
    v_exp_f32 v147, v147
    v_add_f32 v221, v221, v140
    ds_read_b128 v[188:191], v10 offset:8192
    s_waitcnt lgkmcnt(7)
    v_mfma_f32_32x32x16_bf16 v[108:123], v[192:195], v[16:19], v[108:123]
    v_add_f32 v222, v222, v141
    s_mov_b32 m0, 139264
    s_min_u32 s4, s76, s77
    s_add_u32 s76, s76, 1024
    buffer_load_dwordx4 v230, s[72:75], s4 offen lds
    v_cvt_pk_bf16_f32 v140, v140, v141
    ds_read_b128 v[192:195], v10 offset:9216
    s_waitcnt lgkmcnt(7)
    v_mfma_f32_32x32x16_bf16 v[108:123], v[196:199], v[20:23], v[108:123]
    v_add_f32 v221, v221, v142
    v_add_f32 v222, v222, v143
    v_cvt_pk_bf16_f32 v141, v142, v143
    ds_read_b128 v[196:199], v10 offset:10240
    s_waitcnt lgkmcnt(7)
    v_mfma_f32_32x32x16_bf16 v[108:123], v[200:203], v[24:27], v[108:123]
    v_add_f32 v221, v221, v144
    v_add_f32 v222, v222, v145
    v_cvt_pk_bf16_f32 v142, v144, v145
    ds_read_b128 v[200:203], v10 offset:11264
    s_waitcnt lgkmcnt(7)
    v_mfma_f32_32x32x16_bf16 v[108:123], v[204:207], v[28:31], v[108:123]
    v_add_f32 v221, v221, v146
    v_add_f32 v222, v222, v147
    v_cvt_pk_bf16_f32 v143, v146, v147
    ds_read_b128 v[204:207], v10 offset:12288
    s_waitcnt lgkmcnt(7)
    v_mfma_f32_32x32x16_bf16 v[108:123], v[208:211], v[32:35], v[108:123]
    v_exp_f32 v148, v148
    v_exp_f32 v149, v149
    v_exp_f32 v150, v150
    ds_read_b128 v[208:211], v10 offset:13312
    s_waitcnt lgkmcnt(7)
    v_mfma_f32_32x32x16_bf16 v[108:123], v[212:215], v[36:39], v[108:123]
    v_exp_f32 v151, v151
    v_exp_f32 v152, v152
    v_exp_f32 v153, v153
    ds_read_b128 v[212:215], v10 offset:14336
    s_waitcnt lgkmcnt(7)
    v_mfma_f32_32x32x16_bf16 v[108:123], v[216:219], v[40:43], v[108:123]
    v_exp_f32 v154, v154
    v_exp_f32 v155, v155
    v_add_f32 v221, v221, v148
    ds_read_b128 v[216:219], v10 offset:15360
    s_waitcnt lgkmcnt(7)
    v_mfma_f32_32x32x16_bf16 v[124:139], v[188:191], v[12:15], v[172:187]
    v_add_f32 v222, v222, v149
    v_cvt_pk_bf16_f32 v148, v148, v149
    v_add_f32 v221, v221, v150
    ds_read_b128 v[188:191], v11 offset:32768
    s_waitcnt lgkmcnt(7)
    v_mfma_f32_32x32x16_bf16 v[124:139], v[192:195], v[16:19], v[124:139]
    v_add_f32 v222, v222, v151
    v_cvt_pk_bf16_f32 v149, v150, v151
    v_add_f32 v221, v221, v152
    ds_read_b128 v[192:195], v11 offset:40960
    s_waitcnt lgkmcnt(7)
    v_mfma_f32_32x32x16_bf16 v[124:139], v[196:199], v[20:23], v[124:139]
    v_add_f32 v222, v222, v153
    v_cvt_pk_bf16_f32 v150, v152, v153
    v_add_f32 v221, v221, v154
    ds_read_b128 v[196:199], v11 offset:49152
    s_waitcnt lgkmcnt(7)
    v_mfma_f32_32x32x16_bf16 v[124:139], v[200:203], v[24:27], v[124:139]
    v_add_f32 v222, v222, v155
    s_mov_b32 m0, 139264
    s_min_u32 s4, s76, s77
    s_add_u32 s76, s76, 1024
    buffer_load_dwordx4 v230, s[72:75], s4 offen lds
    v_cvt_pk_bf16_f32 v151, v154, v155
    ds_read_b128 v[200:203], v11 offset:57344
    s_waitcnt lgkmcnt(7)
    v_mfma_f32_32x32x16_bf16 v[124:139], v[204:207], v[28:31], v[124:139]
    v_exp_f32 v156, v156
    v_exp_f32 v157, v157
    v_exp_f32 v158, v158
    ds_read_b128 v[204:207], v11 offset:33792
    s_waitcnt lgkmcnt(7)
    v_mfma_f32_32x32x16_bf16 v[124:139], v[208:211], v[32:35], v[124:139]
    v_exp_f32 v159, v159
    v_exp_f32 v160, v160
    v_exp_f32 v161, v161
    ds_read_b128 v[208:211], v11 offset:41984
    s_waitcnt lgkmcnt(7)
    v_mfma_f32_32x32x16_bf16 v[124:139], v[212:215], v[36:39], v[124:139]
    v_exp_f32 v162, v162
    v_exp_f32 v163, v163
    v_add_f32 v221, v221, v156
    ds_read_b128 v[212:215], v11 offset:50176
    s_waitcnt lgkmcnt(7)
    v_mfma_f32_32x32x16_bf16 v[124:139], v[216:219], v[40:43], v[124:139]
    v_add_f32 v222, v222, v157
    v_cvt_pk_bf16_f32 v156, v156, v157
    v_add_f32 v221, v221, v158
    ds_read_b128 v[216:219], v11 offset:58368
    s_waitcnt lgkmcnt(7)
    v_mfma_f32_32x32x16_bf16 v[44:59], v[188:191], v[140:143], v[44:59]
    v_add_f32 v222, v222, v159
    v_cvt_pk_bf16_f32 v157, v158, v159
    v_add_f32 v221, v221, v160
    ds_read_b128 v[188:191], v11 offset:34816
    s_waitcnt lgkmcnt(7)
    v_mfma_f32_32x32x16_bf16 v[60:75], v[192:195], v[140:143], v[60:75]
    v_add_f32 v222, v222, v161
    v_cvt_pk_bf16_f32 v158, v160, v161
    v_add_f32 v221, v221, v162
    ds_read_b128 v[192:195], v11 offset:43008
    s_waitcnt lgkmcnt(7)
    v_mfma_f32_32x32x16_bf16 v[76:91], v[196:199], v[140:143], v[76:91]
    v_add_f32 v222, v222, v163
    v_cvt_pk_bf16_f32 v159, v162, v163
    v_exp_f32 v164, v164
    ds_read_b128 v[196:199], v11 offset:51200
    s_waitcnt lgkmcnt(7)
    v_mfma_f32_32x32x16_bf16 v[92:107], v[200:203], v[140:143], v[92:107]
    v_exp_f32 v165, v165
    v_exp_f32 v166, v166
    v_exp_f32 v167, v167
    ds_read_b128 v[200:203], v11 offset:59392
    s_waitcnt lgkmcnt(7)
    v_mfma_f32_32x32x16_bf16 v[44:59], v[204:207], v[148:151], v[44:59]
    v_exp_f32 v168, v168
    v_exp_f32 v169, v169
    v_exp_f32 v170, v170
    ds_read_b128 v[204:207], v11 offset:35840
    s_waitcnt lgkmcnt(7)
    v_mfma_f32_32x32x16_bf16 v[60:75], v[208:211], v[148:151], v[60:75]
    v_exp_f32 v171, v171
    v_add_f32 v221, v221, v164
    v_add_f32 v222, v222, v165
    ds_read_b128 v[208:211], v11 offset:44032
    s_waitcnt lgkmcnt(7)
    v_mfma_f32_32x32x16_bf16 v[76:91], v[212:215], v[148:151], v[76:91]
    v_cvt_pk_bf16_f32 v164, v164, v165
    v_add_f32 v221, v221, v166
    v_add_f32 v222, v222, v167
    ds_read_b128 v[212:215], v11 offset:52224
    s_waitcnt lgkmcnt(7)
    v_mfma_f32_32x32x16_bf16 v[92:107], v[216:219], v[148:151], v[92:107]
    v_cvt_pk_bf16_f32 v165, v166, v167
    v_add_f32 v221, v221, v168
    v_add_f32 v222, v222, v169
    ds_read_b128 v[216:219], v11 offset:60416
    s_waitcnt lgkmcnt(7)
    v_mfma_f32_32x32x16_bf16 v[44:59], v[188:191], v[156:159], v[44:59]
    v_cvt_pk_bf16_f32 v166, v168, v169
    v_add_f32 v221, v221, v170
    v_add_f32 v222, v222, v171
    s_waitcnt lgkmcnt(6)
    v_mfma_f32_32x32x16_bf16 v[60:75], v[192:195], v[156:159], v[60:75]
    v_cvt_pk_bf16_f32 v167, v170, v171
    v_max3_f32 v4, v108, v109, v110
    v_max3_f32 v5, v111, v112, v113
    s_waitcnt lgkmcnt(5)
    v_mfma_f32_32x32x16_bf16 v[76:91], v[196:199], v[156:159], v[76:91]
    v_max3_f32 v4, v4, v114, v115
    v_max3_f32 v5, v5, v116, v117
    v_max3_f32 v4, v4, v118, v119
    s_waitcnt lgkmcnt(4)
    v_mfma_f32_32x32x16_bf16 v[92:107], v[200:203], v[156:159], v[92:107]
    v_max3_f32 v5, v5, v120, v121
    v_max3_f32 v4, v4, v122, v123
    v_max3_f32 v5, v5, v124, v125
    s_waitcnt lgkmcnt(3)
    v_mfma_f32_32x32x16_bf16 v[44:59], v[204:207], v[164:167], v[44:59]
    v_max3_f32 v4, v4, v126, v127
    v_max3_f32 v5, v5, v128, v129
    v_max3_f32 v4, v4, v130, v131
    s_waitcnt lgkmcnt(2)
    v_mfma_f32_32x32x16_bf16 v[60:75], v[208:211], v[164:167], v[60:75]
    v_max3_f32 v5, v5, v132, v133
    v_max3_f32 v4, v4, v134, v135
    v_max3_f32 v5, v5, v136, v137
    s_waitcnt lgkmcnt(1)
    v_mfma_f32_32x32x16_bf16 v[76:91], v[212:215], v[164:167], v[76:91]
    v_max3_f32 v4, v4, v138, v139
    v_max_f32 v4, v4, v5
    v_mov_b32 v5, v4
    s_waitcnt lgkmcnt(0)
    v_mfma_f32_32x32x16_bf16 v[92:107], v[216:219], v[164:167], v[92:107]
    v_permlane32_swap_b32 v4, v5
    v_max_f32 v228, v4, v5
    v_cmp_gt_f32 vcc, v228, v223
    s_nop 7
    s_cbranch_vccz k2_attn_kernel_keep_15
    v_max_f32 v4, 0, v228
    v_sub_f32 v5, 0, v4
    v_exp_f32 v5, v5
    v_add_f32 v220, v220, v4
    v_sub_f32 v172, 0, v220
    v_sub_f32 v173, 0, v220
    v_sub_f32 v174, 0, v220
    v_sub_f32 v175, 0, v220
    v_sub_f32 v176, 0, v220
    v_sub_f32 v177, 0, v220
    v_sub_f32 v178, 0, v220
    v_sub_f32 v179, 0, v220
    v_sub_f32 v180, 0, v220
    v_sub_f32 v181, 0, v220
    v_sub_f32 v182, 0, v220
    v_sub_f32 v183, 0, v220
    v_sub_f32 v184, 0, v220
    v_sub_f32 v185, 0, v220
    v_sub_f32 v186, 0, v220
    v_sub_f32 v187, 0, v220
    v_sub_f32 v108, v108, v4
    v_sub_f32 v109, v109, v4
    v_sub_f32 v110, v110, v4
    v_sub_f32 v111, v111, v4
    v_sub_f32 v112, v112, v4
    v_sub_f32 v113, v113, v4
    v_sub_f32 v114, v114, v4
    v_sub_f32 v115, v115, v4
    v_sub_f32 v116, v116, v4
    v_sub_f32 v117, v117, v4
    v_sub_f32 v118, v118, v4
    v_sub_f32 v119, v119, v4
    v_sub_f32 v120, v120, v4
    v_sub_f32 v121, v121, v4
    v_sub_f32 v122, v122, v4
    v_sub_f32 v123, v123, v4
    v_sub_f32 v124, v124, v4
    v_sub_f32 v125, v125, v4
    v_sub_f32 v126, v126, v4
    v_sub_f32 v127, v127, v4
    v_sub_f32 v128, v128, v4
    v_sub_f32 v129, v129, v4
    v_sub_f32 v130, v130, v4
    v_sub_f32 v131, v131, v4
    v_sub_f32 v132, v132, v4
    v_sub_f32 v133, v133, v4
    v_sub_f32 v134, v134, v4
    v_sub_f32 v135, v135, v4
    v_sub_f32 v136, v136, v4
    v_sub_f32 v137, v137, v4
    v_sub_f32 v138, v138, v4
    v_sub_f32 v139, v139, v4
    v_mul_f32 v221, v221, v5
    v_mul_f32 v222, v222, v5
    v_mul_f32 v44, v44, v5
    v_mul_f32 v45, v45, v5
    v_mul_f32 v46, v46, v5
    v_mul_f32 v47, v47, v5
    v_mul_f32 v48, v48, v5
    v_mul_f32 v49, v49, v5
    v_mul_f32 v50, v50, v5
    v_mul_f32 v51, v51, v5
    v_mul_f32 v52, v52, v5
    v_mul_f32 v53, v53, v5
    v_mul_f32 v54, v54, v5
    v_mul_f32 v55, v55, v5
    v_mul_f32 v56, v56, v5
    v_mul_f32 v57, v57, v5
    v_mul_f32 v58, v58, v5
    v_mul_f32 v59, v59, v5
    v_mul_f32 v60, v60, v5
    v_mul_f32 v61, v61, v5
    v_mul_f32 v62, v62, v5
    v_mul_f32 v63, v63, v5
    v_mul_f32 v64, v64, v5
    v_mul_f32 v65, v65, v5
    v_mul_f32 v66, v66, v5
    v_mul_f32 v67, v67, v5
    v_mul_f32 v68, v68, v5
    v_mul_f32 v69, v69, v5
    v_mul_f32 v70, v70, v5
    v_mul_f32 v71, v71, v5
    v_mul_f32 v72, v72, v5
    v_mul_f32 v73, v73, v5
    v_mul_f32 v74, v74, v5
    v_mul_f32 v75, v75, v5
    v_mul_f32 v76, v76, v5
    v_mul_f32 v77, v77, v5
    v_mul_f32 v78, v78, v5
    v_mul_f32 v79, v79, v5
    v_mul_f32 v80, v80, v5
    v_mul_f32 v81, v81, v5
    v_mul_f32 v82, v82, v5
    v_mul_f32 v83, v83, v5
    v_mul_f32 v84, v84, v5
    v_mul_f32 v85, v85, v5
    v_mul_f32 v86, v86, v5
    v_mul_f32 v87, v87, v5
    v_mul_f32 v88, v88, v5
    v_mul_f32 v89, v89, v5
    v_mul_f32 v90, v90, v5
    v_mul_f32 v91, v91, v5
    v_mul_f32 v92, v92, v5
    v_mul_f32 v93, v93, v5
    v_mul_f32 v94, v94, v5
    v_mul_f32 v95, v95, v5
    v_mul_f32 v96, v96, v5
    v_mul_f32 v97, v97, v5
    v_mul_f32 v98, v98, v5
    v_mul_f32 v99, v99, v5
    v_mul_f32 v100, v100, v5
    v_mul_f32 v101, v101, v5
    v_mul_f32 v102, v102, v5
    v_mul_f32 v103, v103, v5
    v_mul_f32 v104, v104, v5
    v_mul_f32 v105, v105, v5
    v_mul_f32 v106, v106, v5
    v_mul_f32 v107, v107, v5
    s_nop 0
k2_attn_kernel_keep_15:
    s_branch k2_attn_kernel_loop0_1
k2_attn_kernel_last1_1:
    s_mov_b32 s60, 0
    s_add_u32 s61, s61, 8192
    ds_read_b128 v[188:191], v10 offset:0
    ds_read_b128 v[192:195], v10 offset:1024
    ds_read_b128 v[196:199], v10 offset:2048
    ds_read_b128 v[200:203], v10 offset:3072
    ds_read_b128 v[204:207], v10 offset:4096
    ds_read_b128 v[208:211], v10 offset:5120
    ds_read_b128 v[212:215], v10 offset:6144
    v_exp_f32 v140, v140
    v_exp_f32 v141, v141
    v_exp_f32 v142, v142
    v_exp_f32 v143, v143
    v_exp_f32 v144, v144
    v_exp_f32 v145, v145
    ds_read_b128 v[216:219], v10 offset:7168
    s_waitcnt lgkmcnt(7)
    v_mfma_f32_32x32x16_bf16 v[108:123], v[188:191], v[12:15], v[172:187]
    v_exp_f32 v146, v146
    v_exp_f32 v147, v147
    v_add_f32 v221, v221, v140
    v_add_f32 v222, v222, v141
    v_cvt_pk_bf16_f32 v140, v140, v141
    ds_read_b128 v[188:191], v10 offset:8192
    s_waitcnt lgkmcnt(7)
    v_mfma_f32_32x32x16_bf16 v[108:123], v[192:195], v[16:19], v[108:123]
    v_add_f32 v221, v221, v142
    v_add_f32 v222, v222, v143
    v_cvt_pk_bf16_f32 v141, v142, v143
    v_add_f32 v221, v221, v144
    v_add_f32 v222, v222, v145
    ds_read_b128 v[192:195], v10 offset:9216
    s_waitcnt lgkmcnt(7)
    v_mfma_f32_32x32x16_bf16 v[108:123], v[196:199], v[20:23], v[108:123]
    v_cvt_pk_bf16_f32 v142, v144, v145
    v_add_f32 v221, v221, v146
    v_add_f32 v222, v222, v147
    v_cvt_pk_bf16_f32 v143, v146, v147
    v_exp_f32 v148, v148
    ds_read_b128 v[196:199], v10 offset:10240
    s_waitcnt lgkmcnt(7)
    v_mfma_f32_32x32x16_bf16 v[108:123], v[200:203], v[24:27], v[108:123]
    v_exp_f32 v149, v149
    v_exp_f32 v150, v150
    v_exp_f32 v151, v151
    v_exp_f32 v152, v152
    v_exp_f32 v153, v153
    ds_read_b128 v[200:203], v10 offset:11264
    s_waitcnt lgkmcnt(7)
    v_mfma_f32_32x32x16_bf16 v[108:123], v[204:207], v[28:31], v[108:123]
    v_exp_f32 v154, v154
    v_exp_f32 v155, v155
    v_add_f32 v221, v221, v148
    v_add_f32 v222, v222, v149
    v_cvt_pk_bf16_f32 v148, v148, v149
    ds_read_b128 v[204:207], v10 offset:12288
    s_waitcnt lgkmcnt(7)
    v_mfma_f32_32x32x16_bf16 v[108:123], v[208:211], v[32:35], v[108:123]
    v_add_f32 v221, v221, v150
    v_add_f32 v222, v222, v151
    v_cvt_pk_bf16_f32 v149, v150, v151
    v_add_f32 v221, v221, v152
    v_add_f32 v222, v222, v153
    ds_read_b128 v[208:211], v10 offset:13312
    s_waitcnt lgkmcnt(7)
    v_mfma_f32_32x32x16_bf16 v[108:123], v[212:215], v[36:39], v[108:123]
    v_cvt_pk_bf16_f32 v150, v152, v153
    v_add_f32 v221, v221, v154
    v_add_f32 v222, v222, v155
    v_cvt_pk_bf16_f32 v151, v154, v155
    v_exp_f32 v156, v156
    ds_read_b128 v[212:215], v10 offset:14336
    s_waitcnt lgkmcnt(7)
    v_mfma_f32_32x32x16_bf16 v[108:123], v[216:219], v[40:43], v[108:123]
    v_exp_f32 v157, v157
    v_exp_f32 v158, v158
    v_exp_f32 v159, v159
    v_exp_f32 v160, v160
    v_exp_f32 v161, v161
    ds_read_b128 v[216:219], v10 offset:15360
    s_waitcnt lgkmcnt(7)
    v_mfma_f32_32x32x16_bf16 v[124:139], v[188:191], v[12:15], v[172:187]
    v_exp_f32 v162, v162
    v_exp_f32 v163, v163
    v_add_f32 v221, v221, v156
    v_add_f32 v222, v222, v157
    v_cvt_pk_bf16_f32 v156, v156, v157
    ds_read_b128 v[188:191], v11 offset:32768
    s_waitcnt lgkmcnt(7)
    v_mfma_f32_32x32x16_bf16 v[124:139], v[192:195], v[16:19], v[124:139]
    v_add_f32 v221, v221, v158
    v_add_f32 v222, v222, v159
    v_cvt_pk_bf16_f32 v157, v158, v159
    v_add_f32 v221, v221, v160
    v_add_f32 v222, v222, v161
    ds_read_b128 v[192:195], v11 offset:40960
    s_waitcnt lgkmcnt(7)
    v_mfma_f32_32x32x16_bf16 v[124:139], v[196:199], v[20:23], v[124:139]
    v_cvt_pk_bf16_f32 v158, v160, v161
    v_add_f32 v221, v221, v162
    v_add_f32 v222, v222, v163
    v_cvt_pk_bf16_f32 v159, v162, v163
    ds_read_b128 v[196:199], v11 offset:49152
    s_waitcnt lgkmcnt(7)
    v_mfma_f32_32x32x16_bf16 v[124:139], v[200:203], v[24:27], v[124:139]
    v_exp_f32 v164, v164
    v_exp_f32 v165, v165
    v_exp_f32 v166, v166
    v_exp_f32 v167, v167
    v_exp_f32 v168, v168
    ds_read_b128 v[200:203], v11 offset:57344
    s_waitcnt lgkmcnt(7)
    v_mfma_f32_32x32x16_bf16 v[124:139], v[204:207], v[28:31], v[124:139]
    v_exp_f32 v169, v169
    v_exp_f32 v170, v170
    v_exp_f32 v171, v171
    v_add_f32 v221, v221, v164
    v_add_f32 v222, v222, v165
    ds_read_b128 v[204:207], v11 offset:33792
    s_waitcnt lgkmcnt(7)
    v_mfma_f32_32x32x16_bf16 v[124:139], v[208:211], v[32:35], v[124:139]
    v_cvt_pk_bf16_f32 v164, v164, v165
    v_add_f32 v221, v221, v166
    v_add_f32 v222, v222, v167
    v_cvt_pk_bf16_f32 v165, v166, v167
    v_add_f32 v221, v221, v168
    ds_read_b128 v[208:211], v11 offset:41984
    s_waitcnt lgkmcnt(7)
    v_mfma_f32_32x32x16_bf16 v[124:139], v[212:215], v[36:39], v[124:139]
    v_add_f32 v222, v222, v169
    v_cvt_pk_bf16_f32 v166, v168, v169
    v_add_f32 v221, v221, v170
    v_add_f32 v222, v222, v171
    v_cvt_pk_bf16_f32 v167, v170, v171
    ds_read_b128 v[212:215], v11 offset:50176
    s_waitcnt lgkmcnt(7)
    v_mfma_f32_32x32x16_bf16 v[124:139], v[216:219], v[40:43], v[124:139]
    v_cmp_ge_i32 vcc, v226, 0
    s_nop 1
    v_cndmask_b32 v108, v227, v108, vcc
    v_cmp_ge_i32 vcc, v226, 1
    s_nop 1
    v_cndmask_b32 v109, v227, v109, vcc
    v_cmp_ge_i32 vcc, v226, 2
    ds_read_b128 v[216:219], v11 offset:58368
    s_waitcnt lgkmcnt(7)
    v_mfma_f32_32x32x16_bf16 v[44:59], v[188:191], v[140:143], v[44:59]
    v_cndmask_b32 v110, v227, v110, vcc
    v_cmp_ge_i32 vcc, v226, 3
    s_nop 1
    v_cndmask_b32 v111, v227, v111, vcc
    v_cmp_ge_i32 vcc, v226, 8
    s_nop 1
    v_cndmask_b32 v112, v227, v112, vcc
    ds_read_b128 v[188:191], v11 offset:34816
    s_waitcnt lgkmcnt(7)
    v_mfma_f32_32x32x16_bf16 v[60:75], v[192:195], v[140:143], v[60:75]
    v_cmp_ge_i32 vcc, v226, 9
    s_nop 1
    v_cndmask_b32 v113, v227, v113, vcc
    v_cmp_ge_i32 vcc, v226, 10
    s_nop 1
    v_cndmask_b32 v114, v227, v114, vcc
    v_cmp_ge_i32 vcc, v226, 11
    ds_read_b128 v[192:195], v11 offset:43008
    s_waitcnt lgkmcnt(7)
    v_mfma_f32_32x32x16_bf16 v[76:91], v[196:199], v[140:143], v[76:91]
    v_cndmask_b32 v115, v227, v115, vcc
    v_cmp_ge_i32 vcc, v226, 16
    s_nop 1
    v_cndmask_b32 v116, v227, v116, vcc
    v_cmp_ge_i32 vcc, v226, 17
    s_nop 1
    v_cndmask_b32 v117, v227, v117, vcc
    ds_read_b128 v[196:199], v11 offset:51200
    s_waitcnt lgkmcnt(7)
    v_mfma_f32_32x32x16_bf16 v[92:107], v[200:203], v[140:143], v[92:107]
    v_cmp_ge_i32 vcc, v226, 18
    s_nop 1
    v_cndmask_b32 v118, v227, v118, vcc
    v_cmp_ge_i32 vcc, v226, 19
    s_nop 1
    v_cndmask_b32 v119, v227, v119, vcc
    v_cmp_ge_i32 vcc, v226, 24
    ds_read_b128 v[200:203], v11 offset:59392
    s_waitcnt lgkmcnt(7)
    v_mfma_f32_32x32x16_bf16 v[44:59], v[204:207], v[148:151], v[44:59]
    v_cndmask_b32 v120, v227, v120, vcc
    v_cmp_ge_i32 vcc, v226, 25
    s_nop 1
    v_cndmask_b32 v121, v227, v121, vcc
    v_cmp_ge_i32 vcc, v226, 26
    s_nop 1
    v_cndmask_b32 v122, v227, v122, vcc
    ds_read_b128 v[204:207], v11 offset:35840
    s_waitcnt lgkmcnt(7)
    v_mfma_f32_32x32x16_bf16 v[60:75], v[208:211], v[148:151], v[60:75]
    v_cmp_ge_i32 vcc, v226, 27
    s_nop 1
    v_cndmask_b32 v123, v227, v123, vcc
    v_cmp_ge_i32 vcc, v226, 32
    s_nop 1
    v_cndmask_b32 v124, v227, v124, vcc
    ds_read_b128 v[208:211], v11 offset:44032
    s_waitcnt lgkmcnt(7)
    v_mfma_f32_32x32x16_bf16 v[76:91], v[212:215], v[148:151], v[76:91]
    v_cmp_ge_i32 vcc, v226, 33
    s_nop 1
    v_cndmask_b32 v125, v227, v125, vcc
    v_cmp_ge_i32 vcc, v226, 34
    s_nop 1
    v_cndmask_b32 v126, v227, v126, vcc
    v_cmp_ge_i32 vcc, v226, 35
    ds_read_b128 v[212:215], v11 offset:52224
    s_waitcnt lgkmcnt(7)
    v_mfma_f32_32x32x16_bf16 v[92:107], v[216:219], v[148:151], v[92:107]
    v_cndmask_b32 v127, v227, v127, vcc
    v_cmp_ge_i32 vcc, v226, 40
    s_nop 1
    v_cndmask_b32 v128, v227, v128, vcc
    v_cmp_ge_i32 vcc, v226, 41
    s_nop 1
    v_cndmask_b32 v129, v227, v129, vcc
    ds_read_b128 v[216:219], v11 offset:60416
    s_waitcnt lgkmcnt(7)
    v_mfma_f32_32x32x16_bf16 v[44:59], v[188:191], v[156:159], v[44:59]
    v_cmp_ge_i32 vcc, v226, 42
    s_nop 1
    v_cndmask_b32 v130, v227, v130, vcc
    v_cmp_ge_i32 vcc, v226, 43
    s_nop 1
    v_cndmask_b32 v131, v227, v131, vcc
    v_cmp_ge_i32 vcc, v226, 48
    s_waitcnt lgkmcnt(6)
    v_mfma_f32_32x32x16_bf16 v[60:75], v[192:195], v[156:159], v[60:75]
    v_cndmask_b32 v132, v227, v132, vcc
    v_cmp_ge_i32 vcc, v226, 49
    s_nop 1
    v_cndmask_b32 v133, v227, v133, vcc
    v_cmp_ge_i32 vcc, v226, 50
    s_nop 1
    v_cndmask_b32 v134, v227, v134, vcc
    s_waitcnt lgkmcnt(5)
    v_mfma_f32_32x32x16_bf16 v[76:91], v[196:199], v[156:159], v[76:91]
    v_cmp_ge_i32 vcc, v226, 51
    s_nop 1
    v_cndmask_b32 v135, v227, v135, vcc
    v_cmp_ge_i32 vcc, v226, 56
    s_nop 1
    v_cndmask_b32 v136, v227, v136, vcc
    v_cmp_ge_i32 vcc, v226, 57
    s_waitcnt lgkmcnt(4)
    v_mfma_f32_32x32x16_bf16 v[92:107], v[200:203], v[156:159], v[92:107]
    v_cndmask_b32 v137, v227, v137, vcc
    v_cmp_ge_i32 vcc, v226, 58
    s_nop 1
    v_cndmask_b32 v138, v227, v138, vcc
    v_cmp_ge_i32 vcc, v226, 59
    s_nop 1
    v_cndmask_b32 v139, v227, v139, vcc
    s_waitcnt lgkmcnt(3)
    v_mfma_f32_32x32x16_bf16 v[44:59], v[204:207], v[164:167], v[44:59]
    v_max3_f32 v4, v108, v109, v110
    v_max3_f32 v5, v111, v112, v113
    v_max3_f32 v4, v4, v114, v115
    v_max3_f32 v5, v5, v116, v117
    v_max3_f32 v4, v4, v118, v119
    s_waitcnt lgkmcnt(2)
    v_mfma_f32_32x32x16_bf16 v[60:75], v[208:211], v[164:167], v[60:75]
    v_max3_f32 v5, v5, v120, v121
    v_max3_f32 v4, v4, v122, v123
    v_max3_f32 v5, v5, v124, v125
    v_max3_f32 v4, v4, v126, v127
    v_max3_f32 v5, v5, v128, v129
    s_waitcnt lgkmcnt(1)
    v_mfma_f32_32x32x16_bf16 v[76:91], v[212:215], v[164:167], v[76:91]
    v_max3_f32 v4, v4, v130, v131
    v_max3_f32 v5, v5, v132, v133
    v_max3_f32 v4, v4, v134, v135
    v_max3_f32 v5, v5, v136, v137
    v_max3_f32 v4, v4, v138, v139
    s_waitcnt lgkmcnt(0)
    v_mfma_f32_32x32x16_bf16 v[92:107], v[216:219], v[164:167], v[92:107]
    v_max_f32 v4, v4, v5
    v_mov_b32 v5, v4
    s_nop 1
    v_permlane32_swap_b32 v4, v5
    v_max_f32 v228, v4, v5
    v_cmp_gt_f32 vcc, v228, v223
    s_nop 3
    s_cbranch_vccz k2_attn_kernel_keep_16
    v_max_f32 v4, 0, v228
    v_sub_f32 v5, 0, v4
    v_exp_f32 v5, v5
    v_add_f32 v220, v220, v4
    v_sub_f32 v172, 0, v220
    v_sub_f32 v173, 0, v220
    v_sub_f32 v174, 0, v220
    v_sub_f32 v175, 0, v220
    v_sub_f32 v176, 0, v220
    v_sub_f32 v177, 0, v220
    v_sub_f32 v178, 0, v220
    v_sub_f32 v179, 0, v220
    v_sub_f32 v180, 0, v220
    v_sub_f32 v181, 0, v220
    v_sub_f32 v182, 0, v220
    v_sub_f32 v183, 0, v220
    v_sub_f32 v184, 0, v220
    v_sub_f32 v185, 0, v220
    v_sub_f32 v186, 0, v220
    v_sub_f32 v187, 0, v220
    v_sub_f32 v108, v108, v4
    v_sub_f32 v109, v109, v4
    v_sub_f32 v110, v110, v4
    v_sub_f32 v111, v111, v4
    v_sub_f32 v112, v112, v4
    v_sub_f32 v113, v113, v4
    v_sub_f32 v114, v114, v4
    v_sub_f32 v115, v115, v4
    v_sub_f32 v116, v116, v4
    v_sub_f32 v117, v117, v4
    v_sub_f32 v118, v118, v4
    v_sub_f32 v119, v119, v4
    v_sub_f32 v120, v120, v4
    v_sub_f32 v121, v121, v4
    v_sub_f32 v122, v122, v4
    v_sub_f32 v123, v123, v4
    v_sub_f32 v124, v124, v4
    v_sub_f32 v125, v125, v4
    v_sub_f32 v126, v126, v4
    v_sub_f32 v127, v127, v4
    v_sub_f32 v128, v128, v4
    v_sub_f32 v129, v129, v4
    v_sub_f32 v130, v130, v4
    v_sub_f32 v131, v131, v4
    v_sub_f32 v132, v132, v4
    v_sub_f32 v133, v133, v4
    v_sub_f32 v134, v134, v4
    v_sub_f32 v135, v135, v4
    v_sub_f32 v136, v136, v4
    v_sub_f32 v137, v137, v4
    v_sub_f32 v138, v138, v4
    v_sub_f32 v139, v139, v4
    v_mul_f32 v221, v221, v5
    v_mul_f32 v222, v222, v5
    v_mul_f32 v44, v44, v5
    v_mul_f32 v45, v45, v5
    v_mul_f32 v46, v46, v5
    v_mul_f32 v47, v47, v5
    v_mul_f32 v48, v48, v5
    v_mul_f32 v49, v49, v5
    v_mul_f32 v50, v50, v5
    v_mul_f32 v51, v51, v5
    v_mul_f32 v52, v52, v5
    v_mul_f32 v53, v53, v5
    v_mul_f32 v54, v54, v5
    v_mul_f32 v55, v55, v5
    v_mul_f32 v56, v56, v5
    v_mul_f32 v57, v57, v5
    v_mul_f32 v58, v58, v5
    v_mul_f32 v59, v59, v5
    v_mul_f32 v60, v60, v5
    v_mul_f32 v61, v61, v5
    v_mul_f32 v62, v62, v5
    v_mul_f32 v63, v63, v5
    v_mul_f32 v64, v64, v5
    v_mul_f32 v65, v65, v5
    v_mul_f32 v66, v66, v5
    v_mul_f32 v67, v67, v5
    v_mul_f32 v68, v68, v5
    v_mul_f32 v69, v69, v5
    v_mul_f32 v70, v70, v5
    v_mul_f32 v71, v71, v5
    v_mul_f32 v72, v72, v5
    v_mul_f32 v73, v73, v5
    v_mul_f32 v74, v74, v5
    v_mul_f32 v75, v75, v5
    v_mul_f32 v76, v76, v5
    v_mul_f32 v77, v77, v5
    v_mul_f32 v78, v78, v5
    v_mul_f32 v79, v79, v5
    v_mul_f32 v80, v80, v5
    v_mul_f32 v81, v81, v5
    v_mul_f32 v82, v82, v5
    v_mul_f32 v83, v83, v5
    v_mul_f32 v84, v84, v5
    v_mul_f32 v85, v85, v5
    v_mul_f32 v86, v86, v5
    v_mul_f32 v87, v87, v5
    v_mul_f32 v88, v88, v5
    v_mul_f32 v89, v89, v5
    v_mul_f32 v90, v90, v5
    v_mul_f32 v91, v91, v5
    v_mul_f32 v92, v92, v5
    v_mul_f32 v93, v93, v5
    v_mul_f32 v94, v94, v5
    v_mul_f32 v95, v95, v5
    v_mul_f32 v96, v96, v5
    v_mul_f32 v97, v97, v5
    v_mul_f32 v98, v98, v5
    v_mul_f32 v99, v99, v5
    v_mul_f32 v100, v100, v5
    v_mul_f32 v101, v101, v5
    v_mul_f32 v102, v102, v5
    v_mul_f32 v103, v103, v5
    v_mul_f32 v104, v104, v5
    v_mul_f32 v105, v105, v5
    v_mul_f32 v106, v106, v5
    v_mul_f32 v107, v107, v5
    s_nop 0
k2_attn_kernel_keep_16:
    s_branch k2_attn_kernel_epi0_1
k2_attn_kernel_epi0_1:
    s_waitcnt lgkmcnt(0)
    s_barrier
    s_sub_u32 s11, 15, s6
    s_lshl_b32 s11, s11, 7
    s_lshl_b32 s10, s8, 5
    s_add_u32 s10, s10, s11
    s_lshl_b32 s10, s10, 8
    v_lshlrev_b32 v225, 4, v1
    s_lshl_b32 s11, s5, 19
    s_add_u32 s10, s10, s11
    v_add_u32 v225, s10, v225
    buffer_load_dwordx4 v[12:15], v225, s[12:15], 0 offen offset:0
    buffer_load_dwordx4 v[16:19], v225, s[12:15], 0 offen offset:1024
    buffer_load_dwordx4 v[20:23], v225, s[12:15], 0 offen offset:2048
    buffer_load_dwordx4 v[24:27], v225, s[12:15], 0 offen offset:3072
    buffer_load_dwordx4 v[28:31], v225, s[12:15], s69 offen offset:0
    buffer_load_dwordx4 v[32:35], v225, s[12:15], s69 offen offset:1024
    buffer_load_dwordx4 v[36:39], v225, s[12:15], s69 offen offset:2048
    buffer_load_dwordx4 v[40:43], v225, s[12:15], s69 offen offset:3072
    ds_read_b128 v[188:191], v11 offset:0
    ds_read_b128 v[192:195], v11 offset:8192
    ds_read_b128 v[196:199], v11 offset:16384
    ds_read_b128 v[200:203], v11 offset:24576
    ds_read_b128 v[204:207], v11 offset:1024
    ds_read_b128 v[208:211], v11 offset:9216
    ds_read_b128 v[212:215], v11 offset:17408
    v_exp_f32 v108, v108
    v_exp_f32 v109, v109
    v_exp_f32 v110, v110
    v_exp_f32 v111, v111
    v_exp_f32 v112, v112
    v_exp_f32 v113, v113
    v_exp_f32 v114, v114
    v_exp_f32 v115, v115
    v_add_f32 v221, v221, v108
    v_add_f32 v222, v222, v109
    v_cvt_pk_bf16_f32 v108, v108, v109
    v_add_f32 v221, v221, v110
    v_add_f32 v222, v222, v111
    v_cvt_pk_bf16_f32 v109, v110, v111
    v_add_f32 v221, v221, v112
    v_add_f32 v222, v222, v113
    v_cvt_pk_bf16_f32 v110, v112, v113
    v_add_f32 v221, v221, v114
    v_add_f32 v222, v222, v115
    v_cvt_pk_bf16_f32 v111, v114, v115
    v_exp_f32 v116, v116
    v_exp_f32 v117, v117
    ds_read_b128 v[216:219], v11 offset:25600
    s_waitcnt lgkmcnt(7)
    v_mfma_f32_32x32x16_bf16 v[44:59], v[188:191], v[108:111], v[44:59]
    v_exp_f32 v118, v118
    v_exp_f32 v119, v119
    v_exp_f32 v120, v120
    v_exp_f32 v121, v121
    ds_read_b128 v[188:191], v11 offset:2048
    s_waitcnt lgkmcnt(7)
    v_mfma_f32_32x32x16_bf16 v[60:75], v[192:195], v[108:111], v[60:75]
    v_exp_f32 v122, v122
    v_exp_f32 v123, v123
    v_add_f32 v221, v221, v116
    v_add_f32 v222, v222, v117
    ds_read_b128 v[192:195], v11 offset:10240
    s_waitcnt lgkmcnt(7)
    v_mfma_f32_32x32x16_bf16 v[76:91], v[196:199], v[108:111], v[76:91]
    v_cvt_pk_bf16_f32 v116, v116, v117
    v_add_f32 v221, v221, v118
    v_add_f32 v222, v222, v119
    ds_read_b128 v[196:199], v11 offset:18432
    s_waitcnt lgkmcnt(7)
    v_mfma_f32_32x32x16_bf16 v[92:107], v[200:203], v[108:111], v[92:107]
    v_cvt_pk_bf16_f32 v117, v118, v119
    v_add_f32 v221, v221, v120
    v_add_f32 v222, v222, v121
    v_cvt_pk_bf16_f32 v118, v120, v121
    ds_read_b128 v[200:203], v11 offset:26624
    v_add_f32 v221, v221, v122
    v_add_f32 v222, v222, v123
    v_cvt_pk_bf16_f32 v119, v122, v123
    s_waitcnt lgkmcnt(7)
    s_nop 0
    v_mfma_f32_32x32x16_bf16 v[44:59], v[204:207], v[116:119], v[44:59]
    v_exp_f32 v124, v124
    ds_read_b128 v[204:207], v11 offset:3072
    s_waitcnt lgkmcnt(7)
    v_mfma_f32_32x32x16_bf16 v[60:75], v[208:211], v[116:119], v[60:75]
    v_exp_f32 v125, v125
    v_exp_f32 v126, v126
    v_exp_f32 v127, v127
    ds_read_b128 v[208:211], v11 offset:11264
    s_waitcnt lgkmcnt(7)
    v_mfma_f32_32x32x16_bf16 v[76:91], v[212:215], v[116:119], v[76:91]
    v_exp_f32 v128, v128
    v_exp_f32 v129, v129
    v_exp_f32 v130, v130
    v_exp_f32 v131, v131
    ds_read_b128 v[212:215], v11 offset:19456
    s_waitcnt lgkmcnt(7)
    v_mfma_f32_32x32x16_bf16 v[92:107], v[216:219], v[116:119], v[92:107]
    v_add_f32 v221, v221, v124
    v_add_f32 v222, v222, v125
    v_cvt_pk_bf16_f32 v124, v124, v125
    ds_read_b128 v[216:219], v11 offset:27648
    v_add_f32 v221, v221, v126
    v_add_f32 v222, v222, v127
    v_cvt_pk_bf16_f32 v125, v126, v127
    v_add_f32 v221, v221, v128
    v_add_f32 v222, v222, v129
    v_cvt_pk_bf16_f32 v126, v128, v129
    v_add_f32 v221, v221, v130
    v_add_f32 v222, v222, v131
    v_cvt_pk_bf16_f32 v127, v130, v131
    s_waitcnt lgkmcnt(7)
    s_nop 0
    v_mfma_f32_32x32x16_bf16 v[44:59], v[188:191], v[124:127], v[44:59]
    s_waitcnt lgkmcnt(6)
    v_mfma_f32_32x32x16_bf16 v[60:75], v[192:195], v[124:127], v[60:75]
    s_waitcnt lgkmcnt(5)
    v_mfma_f32_32x32x16_bf16 v[76:91], v[196:199], v[124:127], v[76:91]
    v_exp_f32 v132, v132
    v_exp_f32 v133, v133
    s_waitcnt lgkmcnt(4)
    v_mfma_f32_32x32x16_bf16 v[92:107], v[200:203], v[124:127], v[92:107]
    v_exp_f32 v134, v134
    v_exp_f32 v135, v135
    v_exp_f32 v136, v136
    v_exp_f32 v137, v137
    v_exp_f32 v138, v138
    v_exp_f32 v139, v139
    v_add_f32 v221, v221, v132
    v_add_f32 v222, v222, v133
    v_cvt_pk_bf16_f32 v132, v132, v133
    v_add_f32 v221, v221, v134
    v_add_f32 v222, v222, v135
    v_cvt_pk_bf16_f32 v133, v134, v135
    v_add_f32 v221, v221, v136
    v_add_f32 v222, v222, v137
    v_cvt_pk_bf16_f32 v134, v136, v137
    v_add_f32 v221, v221, v138
    v_add_f32 v222, v222, v139
    v_cvt_pk_bf16_f32 v135, v138, v139
    s_waitcnt lgkmcnt(3)
    s_nop 0
    v_mfma_f32_32x32x16_bf16 v[44:59], v[204:207], v[132:135], v[44:59]
    s_waitcnt lgkmcnt(2)
    v_mfma_f32_32x32x16_bf16 v[60:75], v[208:211], v[132:135], v[60:75]
    s_waitcnt lgkmcnt(1)
    v_mfma_f32_32x32x16_bf16 v[76:91], v[212:215], v[132:135], v[76:91]
    s_waitcnt lgkmcnt(0)
    v_mfma_f32_32x32x16_bf16 v[92:107], v[216:219], v[132:135], v[92:107]
    s_mov_b32 s68, 1
    s_mov_b32 s67, 0
    s_mov_b32 s61, 0
    s_nop 7
    s_branch k2_attn_kernel_merge1
k2_attn_kernel_epi1_1:
    s_waitcnt lgkmcnt(0)
    s_barrier
    s_sub_u32 s11, 15, s6
    s_lshl_b32 s11, s11, 7
    s_lshl_b32 s10, s8, 5
    s_add_u32 s10, s10, s11
    s_lshl_b32 s10, s10, 8
    v_lshlrev_b32 v225, 4, v1
    s_lshl_b32 s11, s5, 19
    s_add_u32 s10, s10, s11
    v_add_u32 v225, s10, v225
    buffer_load_dwordx4 v[12:15], v225, s[12:15], 0 offen offset:0
    buffer_load_dwordx4 v[16:19], v225, s[12:15], 0 offen offset:1024
    buffer_load_dwordx4 v[20:23], v225, s[12:15], 0 offen offset:2048
    buffer_load_dwordx4 v[24:27], v225, s[12:15], 0 offen offset:3072
    buffer_load_dwordx4 v[28:31], v225, s[12:15], s69 offen offset:0
    buffer_load_dwordx4 v[32:35], v225, s[12:15], s69 offen offset:1024
    buffer_load_dwordx4 v[36:39], v225, s[12:15], s69 offen offset:2048
    buffer_load_dwordx4 v[40:43], v225, s[12:15], s69 offen offset:3072
    ds_read_b128 v[188:191], v11 offset:32768
    ds_read_b128 v[192:195], v11 offset:40960
    ds_read_b128 v[196:199], v11 offset:49152
    ds_read_b128 v[200:203], v11 offset:57344
    ds_read_b128 v[204:207], v11 offset:33792
    ds_read_b128 v[208:211], v11 offset:41984
    ds_read_b128 v[212:215], v11 offset:50176
    v_exp_f32 v140, v140
    v_exp_f32 v141, v141
    v_exp_f32 v142, v142
    v_exp_f32 v143, v143
    v_exp_f32 v144, v144
    v_exp_f32 v145, v145
    v_exp_f32 v146, v146
    v_exp_f32 v147, v147
    v_add_f32 v221, v221, v140
    v_add_f32 v222, v222, v141
    v_cvt_pk_bf16_f32 v140, v140, v141
    v_add_f32 v221, v221, v142
    v_add_f32 v222, v222, v143
    v_cvt_pk_bf16_f32 v141, v142, v143
    v_add_f32 v221, v221, v144
    v_add_f32 v222, v222, v145
    v_cvt_pk_bf16_f32 v142, v144, v145
    v_add_f32 v221, v221, v146
    v_add_f32 v222, v222, v147
    v_cvt_pk_bf16_f32 v143, v146, v147
    v_exp_f32 v148, v148
    v_exp_f32 v149, v149
    ds_read_b128 v[216:219], v11 offset:58368
    s_waitcnt lgkmcnt(7)
    v_mfma_f32_32x32x16_bf16 v[44:59], v[188:191], v[140:143], v[44:59]
    v_exp_f32 v150, v150
    v_exp_f32 v151, v151
    v_exp_f32 v152, v152
    v_exp_f32 v153, v153
    ds_read_b128 v[188:191], v11 offset:34816
    s_waitcnt lgkmcnt(7)
    v_mfma_f32_32x32x16_bf16 v[60:75], v[192:195], v[140:143], v[60:75]
    v_exp_f32 v154, v154
    v_exp_f32 v155, v155
    v_add_f32 v221, v221, v148
    v_add_f32 v222, v222, v149
    ds_read_b128 v[192:195], v11 offset:43008
    s_waitcnt lgkmcnt(7)
    v_mfma_f32_32x32x16_bf16 v[76:91], v[196:199], v[140:143], v[76:91]
    v_cvt_pk_bf16_f32 v148, v148, v149
    v_add_f32 v221, v221, v150
    v_add_f32 v222, v222, v151
    ds_read_b128 v[196:199], v11 offset:51200
    s_waitcnt lgkmcnt(7)
    v_mfma_f32_32x32x16_bf16 v[92:107], v[200:203], v[140:143], v[92:107]
    v_cvt_pk_bf16_f32 v149, v150, v151
    v_add_f32 v221, v221, v152
    v_add_f32 v222, v222, v153
    v_cvt_pk_bf16_f32 v150, v152, v153
    ds_read_b128 v[200:203], v11 offset:59392
    v_add_f32 v221, v221, v154
    v_add_f32 v222, v222, v155
    v_cvt_pk_bf16_f32 v151, v154, v155
    s_waitcnt lgkmcnt(7)
    s_nop 0
    v_mfma_f32_32x32x16_bf16 v[44:59], v[204:207], v[148:151], v[44:59]
    v_exp_f32 v156, v156
    ds_read_b128 v[204:207], v11 offset:35840
    s_waitcnt lgkmcnt(7)
    v_mfma_f32_32x32x16_bf16 v[60:75], v[208:211], v[148:151], v[60:75]
    v_exp_f32 v157, v157
    v_exp_f32 v158, v158
    v_exp_f32 v159, v159
    ds_read_b128 v[208:211], v11 offset:44032
    s_waitcnt lgkmcnt(7)
    v_mfma_f32_32x32x16_bf16 v[76:91], v[212:215], v[148:151], v[76:91]
    v_exp_f32 v160, v160
    v_exp_f32 v161, v161
    v_exp_f32 v162, v162
    v_exp_f32 v163, v163
    ds_read_b128 v[212:215], v11 offset:52224
    s_waitcnt lgkmcnt(7)
    v_mfma_f32_32x32x16_bf16 v[92:107], v[216:219], v[148:151], v[92:107]
    v_add_f32 v221, v221, v156
    v_add_f32 v222, v222, v157
    v_cvt_pk_bf16_f32 v156, v156, v157
    ds_read_b128 v[216:219], v11 offset:60416
    v_add_f32 v221, v221, v158
    v_add_f32 v222, v222, v159
    v_cvt_pk_bf16_f32 v157, v158, v159
    v_add_f32 v221, v221, v160
    v_add_f32 v222, v222, v161
    v_cvt_pk_bf16_f32 v158, v160, v161
    v_add_f32 v221, v221, v162
    v_add_f32 v222, v222, v163
    v_cvt_pk_bf16_f32 v159, v162, v163
    s_waitcnt lgkmcnt(7)
    s_nop 0
    v_mfma_f32_32x32x16_bf16 v[44:59], v[188:191], v[156:159], v[44:59]
    s_waitcnt lgkmcnt(6)
    v_mfma_f32_32x32x16_bf16 v[60:75], v[192:195], v[156:159], v[60:75]
    s_waitcnt lgkmcnt(5)
    v_mfma_f32_32x32x16_bf16 v[76:91], v[196:199], v[156:159], v[76:91]
    v_exp_f32 v164, v164
    v_exp_f32 v165, v165
    s_waitcnt lgkmcnt(4)
    v_mfma_f32_32x32x16_bf16 v[92:107], v[200:203], v[156:159], v[92:107]
    v_exp_f32 v166, v166
    v_exp_f32 v167, v167
    v_exp_f32 v168, v168
    v_exp_f32 v169, v169
    v_exp_f32 v170, v170
    v_exp_f32 v171, v171
    v_add_f32 v221, v221, v164
    v_add_f32 v222, v222, v165
    v_cvt_pk_bf16_f32 v164, v164, v165
    v_add_f32 v221, v221, v166
    v_add_f32 v222, v222, v167
    v_cvt_pk_bf16_f32 v165, v166, v167
    v_add_f32 v221, v221, v168
    v_add_f32 v222, v222, v169
    v_cvt_pk_bf16_f32 v166, v168, v169
    v_add_f32 v221, v221, v170
    v_add_f32 v222, v222, v171
    v_cvt_pk_bf16_f32 v167, v170, v171
    s_waitcnt lgkmcnt(3)
    s_nop 0
    v_mfma_f32_32x32x16_bf16 v[44:59], v[204:207], v[164:167], v[44:59]
    s_waitcnt lgkmcnt(2)
    v_mfma_f32_32x32x16_bf16 v[60:75], v[208:211], v[164:167], v[60:75]
    s_waitcnt lgkmcnt(1)
    v_mfma_f32_32x32x16_bf16 v[76:91], v[212:215], v[164:167], v[76:91]
    s_waitcnt lgkmcnt(0)
    v_mfma_f32_32x32x16_bf16 v[92:107], v[216:219], v[164:167], v[92:107]
    s_mov_b32 s68, 0
    s_mov_b32 s67, 32768
    s_mov_b32 s61, 0
    s_nop 7
k2_attn_kernel_merge1:
    s_waitcnt lgkmcnt(0)
    s_barrier
    v_add_f32 v221, v221, v222
    v_mov_b32 v4, v221
    s_nop 1
    v_permlane32_swap_b32 v221, v4
    v_add_f32 v221, v221, v4
    s_lshl_b32 s10, s8, 13
    s_add_u32 s10, s10, s67
    s_lshl_b32 s11, s9, 16
    v_lshlrev_b32 v6, 4, v1
    v_add_u32 v6, s10, v6
    v_add_u32 v5, s11, v6
    s_xor_b32 s11, s11, 65536
    v_add_u32 v6, s11, v6
    s_cmp_eq_u32 s9, 1
    s_cbranch_scc1 k2_attn_kernel_mk1_17
    ds_write_b128 v5, v[76:79] offset:0
    ds_write_b128 v5, v[80:83] offset:1024
    ds_write_b128 v5, v[84:87] offset:2048
    ds_write_b128 v5, v[88:91] offset:3072
    ds_write_b128 v5, v[92:95] offset:4096
    ds_write_b128 v5, v[96:99] offset:5120
    ds_write_b128 v5, v[100:103] offset:6144
    ds_write_b128 v5, v[104:107] offset:7168
    s_branch k2_attn_kernel_mj_18
k2_attn_kernel_mk1_17:
    ds_write_b128 v5, v[44:47] offset:0
    ds_write_b128 v5, v[48:51] offset:1024
    ds_write_b128 v5, v[52:55] offset:2048
    ds_write_b128 v5, v[56:59] offset:3072
    ds_write_b128 v5, v[60:63] offset:4096
    ds_write_b128 v5, v[64:67] offset:5120
    ds_write_b128 v5, v[68:71] offset:6144
    ds_write_b128 v5, v[72:75] offset:7168
k2_attn_kernel_mj_18:
    v_lshlrev_b32 v7, 3, v1
    s_lshl_b32 s10, s3, 9
    s_add_u32 s10, s10, 131072
    v_add_u32 v4, s10, v7
    v_mov_b32 v108, v220
    v_mov_b32 v109, v221
    ds_write_b64 v4, v[108:109]
    s_xor_b32 s10, s10, 2048
    v_add_u32 v4, s10, v7
    s_waitcnt lgkmcnt(0)
    s_barrier
    ds_read_b64 v[110:111], v4
    ds_read_b128 v[140:143], v6 offset:0
    ds_read_b128 v[144:147], v6 offset:1024
    ds_read_b128 v[148:151], v6 offset:2048
    ds_read_b128 v[152:155], v6 offset:3072
    ds_read_b128 v[156:159], v6 offset:4096
    ds_read_b128 v[160:163], v6 offset:5120
    ds_read_b128 v[164:167], v6 offset:6144
    ds_read_b128 v[168:171], v6 offset:7168
    s_waitcnt lgkmcnt(0)
    v_max_f32 v112, v220, v110
    v_sub_f32 v113, v220, v112
    v_sub_f32 v114, v110, v112
    v_exp_f32 v113, v113
    v_exp_f32 v114, v114
    v_mul_f32 v112, v221, v113
    v_fma_f32 v112, v111, v114, v112
    v_rcp_f32 v112, v112
    s_nop 0
    v_mul_f32 v113, v113, v112
    v_mul_f32 v114, v114, v112
    s_lshl_b32 s10, s8, 5
    s_add_u32 s10, s10, s64
    s_lshl_b32 s10, s10, 13
    v_lshlrev_b32 v4, 4, v1
    s_lshl_b32 s11, s5, 13
    s_add_u32 s10, s10, s11
    s_lshl_b32 s11, s9, 12
    s_add_u32 s10, s10, s11
    v_add_u32 v4, s10, v4
    s_cmp_eq_u32 s9, 1
    s_cbranch_scc1 k2_attn_kernel_sk1_19
    v_mul_f32 v44, v44, v113
    v_fma_f32 v44, v140, v114, v44
    v_mul_f32 v45, v45, v113
    v_fma_f32 v45, v141, v114, v45
    v_mul_f32 v46, v46, v113
    v_fma_f32 v46, v142, v114, v46
    v_mul_f32 v47, v47, v113
    v_fma_f32 v47, v143, v114, v47
    v_mul_f32 v48, v48, v113
    v_fma_f32 v48, v144, v114, v48
    v_mul_f32 v49, v49, v113
    v_fma_f32 v49, v145, v114, v49
    v_mul_f32 v50, v50, v113
    v_fma_f32 v50, v146, v114, v50
    v_mul_f32 v51, v51, v113
    v_fma_f32 v51, v147, v114, v51
    v_mul_f32 v52, v52, v113
    v_fma_f32 v52, v148, v114, v52
    v_mul_f32 v53, v53, v113
    v_fma_f32 v53, v149, v114, v53
    v_mul_f32 v54, v54, v113
    v_fma_f32 v54, v150, v114, v54
    v_mul_f32 v55, v55, v113
    v_fma_f32 v55, v151, v114, v55
    v_mul_f32 v56, v56, v113
    v_fma_f32 v56, v152, v114, v56
    v_mul_f32 v57, v57, v113
    v_fma_f32 v57, v153, v114, v57
    v_mul_f32 v58, v58, v113
    v_fma_f32 v58, v154, v114, v58
    v_mul_f32 v59, v59, v113
    v_fma_f32 v59, v155, v114, v59
    v_mul_f32 v60, v60, v113
    v_fma_f32 v60, v156, v114, v60
    v_mul_f32 v61, v61, v113
    v_fma_f32 v61, v157, v114, v61
    v_mul_f32 v62, v62, v113
    v_fma_f32 v62, v158, v114, v62
    v_mul_f32 v63, v63, v113
    v_fma_f32 v63, v159, v114, v63
    v_mul_f32 v64, v64, v113
    v_fma_f32 v64, v160, v114, v64
    v_mul_f32 v65, v65, v113
    v_fma_f32 v65, v161, v114, v65
    v_mul_f32 v66, v66, v113
    v_fma_f32 v66, v162, v114, v66
    v_mul_f32 v67, v67, v113
    v_fma_f32 v67, v163, v114, v67
    v_mul_f32 v68, v68, v113
    v_fma_f32 v68, v164, v114, v68
    v_mul_f32 v69, v69, v113
    v_fma_f32 v69, v165, v114, v69
    v_mul_f32 v70, v70, v113
    v_fma_f32 v70, v166, v114, v70
    v_mul_f32 v71, v71, v113
    v_fma_f32 v71, v167, v114, v71
    v_mul_f32 v72, v72, v113
    v_fma_f32 v72, v168, v114, v72
    v_mul_f32 v73, v73, v113
    v_fma_f32 v73, v169, v114, v73
    v_mul_f32 v74, v74, v113
    v_fma_f32 v74, v170, v114, v74
    v_mul_f32 v75, v75, v113
    v_fma_f32 v75, v171, v114, v75
    v_cvt_pk_bf16_f32 v116, v44, v45
    v_cvt_pk_bf16_f32 v117, v46, v47
    v_cvt_pk_bf16_f32 v118, v48, v49
    v_cvt_pk_bf16_f32 v119, v50, v51
    buffer_store_dwordx4 v[116:119], v4, s[24:27], 0 offen offset:0
    v_cvt_pk_bf16_f32 v120, v52, v53
    v_cvt_pk_bf16_f32 v121, v54, v55
    v_cvt_pk_bf16_f32 v122, v56, v57
    v_cvt_pk_bf16_f32 v123, v58, v59
    buffer_store_dwordx4 v[120:123], v4, s[24:27], 0 offen offset:1024
    v_cvt_pk_bf16_f32 v124, v60, v61
    v_cvt_pk_bf16_f32 v125, v62, v63
    v_cvt_pk_bf16_f32 v126, v64, v65
    v_cvt_pk_bf16_f32 v127, v66, v67
    buffer_store_dwordx4 v[124:127], v4, s[24:27], 0 offen offset:2048
    v_cvt_pk_bf16_f32 v128, v68, v69
    v_cvt_pk_bf16_f32 v129, v70, v71
    v_cvt_pk_bf16_f32 v130, v72, v73
    v_cvt_pk_bf16_f32 v131, v74, v75
    buffer_store_dwordx4 v[128:131], v4, s[24:27], 0 offen offset:3072
    s_nop 0
    s_branch k2_attn_kernel_sj_20
k2_attn_kernel_sk1_19:
    v_mul_f32 v76, v76, v113
    v_fma_f32 v76, v140, v114, v76
    v_mul_f32 v77, v77, v113
    v_fma_f32 v77, v141, v114, v77
    v_mul_f32 v78, v78, v113
    v_fma_f32 v78, v142, v114, v78
    v_mul_f32 v79, v79, v113
    v_fma_f32 v79, v143, v114, v79
    v_mul_f32 v80, v80, v113
    v_fma_f32 v80, v144, v114, v80
    v_mul_f32 v81, v81, v113
    v_fma_f32 v81, v145, v114, v81
    v_mul_f32 v82, v82, v113
    v_fma_f32 v82, v146, v114, v82
    v_mul_f32 v83, v83, v113
    v_fma_f32 v83, v147, v114, v83
    v_mul_f32 v84, v84, v113
    v_fma_f32 v84, v148, v114, v84
    v_mul_f32 v85, v85, v113
    v_fma_f32 v85, v149, v114, v85
    v_mul_f32 v86, v86, v113
    v_fma_f32 v86, v150, v114, v86
    v_mul_f32 v87, v87, v113
    v_fma_f32 v87, v151, v114, v87
    v_mul_f32 v88, v88, v113
    v_fma_f32 v88, v152, v114, v88
    v_mul_f32 v89, v89, v113
    v_fma_f32 v89, v153, v114, v89
    v_mul_f32 v90, v90, v113
    v_fma_f32 v90, v154, v114, v90
    v_mul_f32 v91, v91, v113
    v_fma_f32 v91, v155, v114, v91
    v_mul_f32 v92, v92, v113
    v_fma_f32 v92, v156, v114, v92
    v_mul_f32 v93, v93, v113
    v_fma_f32 v93, v157, v114, v93
    v_mul_f32 v94, v94, v113
    v_fma_f32 v94, v158, v114, v94
    v_mul_f32 v95, v95, v113
    v_fma_f32 v95, v159, v114, v95
    v_mul_f32 v96, v96, v113
    v_fma_f32 v96, v160, v114, v96
    v_mul_f32 v97, v97, v113
    v_fma_f32 v97, v161, v114, v97
    v_mul_f32 v98, v98, v113
    v_fma_f32 v98, v162, v114, v98
    v_mul_f32 v99, v99, v113
    v_fma_f32 v99, v163, v114, v99
    v_mul_f32 v100, v100, v113
    v_fma_f32 v100, v164, v114, v100
    v_mul_f32 v101, v101, v113
    v_fma_f32 v101, v165, v114, v101
    v_mul_f32 v102, v102, v113
    v_fma_f32 v102, v166, v114, v102
    v_mul_f32 v103, v103, v113
    v_fma_f32 v103, v167, v114, v103
    v_mul_f32 v104, v104, v113
    v_fma_f32 v104, v168, v114, v104
    v_mul_f32 v105, v105, v113
    v_fma_f32 v105, v169, v114, v105
    v_mul_f32 v106, v106, v113
    v_fma_f32 v106, v170, v114, v106
    v_mul_f32 v107, v107, v113
    v_fma_f32 v107, v171, v114, v107
    v_cvt_pk_bf16_f32 v116, v76, v77
    v_cvt_pk_bf16_f32 v117, v78, v79
    v_cvt_pk_bf16_f32 v118, v80, v81
    v_cvt_pk_bf16_f32 v119, v82, v83
    buffer_store_dwordx4 v[116:119], v4, s[24:27], 0 offen offset:0
    v_cvt_pk_bf16_f32 v120, v84, v85
    v_cvt_pk_bf16_f32 v121, v86, v87
    v_cvt_pk_bf16_f32 v122, v88, v89
    v_cvt_pk_bf16_f32 v123, v90, v91
    buffer_store_dwordx4 v[120:123], v4, s[24:27], 0 offen offset:1024
    v_cvt_pk_bf16_f32 v124, v92, v93
    v_cvt_pk_bf16_f32 v125, v94, v95
    v_cvt_pk_bf16_f32 v126, v96, v97
    v_cvt_pk_bf16_f32 v127, v98, v99
    buffer_store_dwordx4 v[124:127], v4, s[24:27], 0 offen offset:2048
    v_cvt_pk_bf16_f32 v128, v100, v101
    v_cvt_pk_bf16_f32 v129, v102, v103
    v_cvt_pk_bf16_f32 v130, v104, v105
    v_cvt_pk_bf16_f32 v131, v106, v107
    buffer_store_dwordx4 v[128:131], v4, s[24:27], 0 offen offset:3072
    s_nop 0
k2_attn_kernel_sj_20:
    s_add_u32 s63, s63, 1
    s_cmp_lt_u32 s63, 2
    s_cbranch_scc1 k2_attn_kernel_blk1
k2_attn_kernel_fin:
k2_attn_kernel_end:
    s_endpgm
.section .rodata,"a"
.p2align 6
.amdhsa_kernel k2_attn_kernel
  .amdhsa_next_free_vgpr 232
  .amdhsa_next_free_sgpr 102
  .amdhsa_accum_offset 232
  .amdhsa_group_segment_fixed_size 0
  .amdhsa_kernarg_size 104
  .amdhsa_user_sgpr_count 2
  .amdhsa_user_sgpr_kernarg_segment_ptr 1
  .amdhsa_system_sgpr_workgroup_id_x 1
.end_amdhsa_kernel
.text
.globl k3_oproj_kernel
.p2align 8
.type k3_oproj_kernel,@function
k3_oproj_kernel:
    s_cmp_ge_u32 s2, 256
    s_cbranch_scc1 k3_oproj_kernel_end
    s_load_dwordx2 s[12:13], s[0:1], 96
    s_load_dwordx2 s[16:17], s[0:1], 40
    s_load_dwordx2 s[20:21], s[0:1], 96
    s_load_dwordx2 s[24:25], s[0:1], 0
    s_load_dwordx2 s[28:29], s[0:1], 96
    s_lshr_b32 s6, s2, 3
    s_and_b32 s6, s6, 7
    s_lshl_b32 s6, s6, 6
    s_and_b32 s5, s2, 7
    s_lshl_b32 s5, s5, 2
    s_lshr_b32 s8, s2, 6
    s_add_u32 s5, s5, s8
    s_lshl_b32 s5, s5, 6
    v_and_b32 v1, 63, v0
    v_lshrrev_b32 v4, 6, v0
    s_nop 0
    v_readfirstlane_b32 s3, v4
    v_and_b32 v2, 31, v0
    v_bfe_u32 v3, v0, 5, 1
    s_and_b32 s97, s3, 1
    s_lshr_b32 s8, s3, 1
    s_and_b32 s96, s8, 1
    s_lshr_b32 s98, s8, 1
    s_lshl_b32 s7, s3, 10
    s_mov_b32 s93, s5
    v_lshrrev_b32 v4, 4, v1
    s_mul_i32 s8, s3, 4
    v_add_u32 v4, s8, v4
    v_lshrrev_b32 v5, 0, v4
    v_and_b32 v5, 15, v5
    v_and_b32 v6, 15, v1
    v_xor_b32 v5, v5, v6
    v_lshlrev_b32 v6, 4, v1
    s_lshr_b32 s8, s5, 5
    s_mul_i32 s8, s8, 262144
    s_add_u32 s8, s8, s7
    v_add_u32 v8, s8, v6
    v_lshrrev_b32 v4, 3, v1
    v_bfe_u32 v5, v4, 1, 1
    v_lshlrev_b32 v5, 2, v5
    v_and_b32 v6, 7, v1
    v_xor_b32 v5, v5, v6
    v_lshlrev_b32 v5, 4, v5
    s_mul_i32 s8, s3, 8
    v_add_u32 v4, s8, v4
    s_mov_b32 s8, 1024
    v_mul_lo_u32 v4, v4, s8
    v_add_u32 v4, v4, v5
    s_lshl_b32 s8, s6, 1
    v_add_u32 v9, s8, v4
    s_waitcnt lgkmcnt(0)
    s_add_u32 s12, s12, 50331648
    s_addc_u32 s13, s13, 0
    s_and_b32 s13, s13, 0xffff
    s_mov_b32 s14, 16777216
    s_mov_b32 s15, 0x00020000
    s_and_b32 s17, s17, 0xffff
    s_mov_b32 s18, 4194304
    s_mov_b32 s19, 0x00020000
    s_add_u32 s20, s20, 67108864
    s_addc_u32 s21, s21, 0
    s_and_b32 s21, s21, 0xffff
    s_mov_b32 s22, 2097152
    s_mov_b32 s23, 0x00020000
    s_and_b32 s25, s25, 0xffff
    s_mov_b32 s26, 2097152
    s_mov_b32 s27, 0x00020000
    s_add_u32 s28, s28, 79691776
    s_addc_u32 s29, s29, 0
    s_and_b32 s29, s29, 0xffff
    s_mov_b32 s30, 131072
    s_mov_b32 s31, 0x00020000
    s_add_u32 m0, s7, 0
    s_mov_b32 s4, 0
    buffer_load_dwordx4 v8, s[12:15], s4 offen lds
    s_add_u32 m0, s7, 8192
    s_mov_b32 s4, 262144
    buffer_load_dwordx4 v8, s[12:15], s4 offen lds
    s_add_u32 m0, s7, 16384
    s_mov_b32 s4, 0
    buffer_load_dwordx4 v9, s[16:19], s4 offen lds
    s_add_u32 m0, s7, 24576
    s_mov_b32 s4, 65536
    buffer_load_dwordx4 v9, s[16:19], s4 offen lds
    s_add_u32 m0, s7, 32768
    s_mov_b32 s4, 8192
    buffer_load_dwordx4 v8, s[12:15], s4 offen lds
    s_add_u32 m0, s7, 40960
    s_mov_b32 s4, 270336
    buffer_load_dwordx4 v8, s[12:15], s4 offen lds
    s_add_u32 m0, s7, 49152
    s_mov_b32 s4, 131072
    buffer_load_dwordx4 v9, s[16:19], s4 offen lds
    s_add_u32 m0, s7, 57344
    s_mov_b32 s4, 196608
    buffer_load_dwordx4 v9, s[16:19], s4 offen lds
    s_add_u32 m0, s7, 65536
    s_mov_b32 s4, 16384
    buffer_load_dwordx4 v8, s[12:15], s4 offen lds
    s_add_u32 m0, s7, 73728
    s_mov_b32 s4, 278528
    buffer_load_dwordx4 v8, s[12:15], s4 offen lds
    s_add_u32 m0, s7, 81920
    s_mov_b32 s4, 262144
    buffer_load_dwordx4 v9, s[16:19], s4 offen lds
    s_add_u32 m0, s7, 90112
    s_mov_b32 s4, 327680
    buffer_load_dwordx4 v9, s[16:19], s4 offen lds
    s_add_u32 m0, s7, 98304
    s_mov_b32 s4, 24576
    buffer_load_dwordx4 v8, s[12:15], s4 offen lds
    s_add_u32 m0, s7, 106496
    s_mov_b32 s4, 286720
    buffer_load_dwordx4 v8, s[12:15], s4 offen lds
    s_add_u32 m0, s7, 114688
    s_mov_b32 s4, 393216
    buffer_load_dwordx4 v9, s[16:19], s4 offen lds
    s_add_u32 m0, s7, 122880
    s_mov_b32 s4, 458752
    buffer_load_dwordx4 v9, s[16:19], s4 offen lds
    s_mul_i32 s92, s96, 2
    s_lshl_b32 s8, s96, 6
    v_add_u32 v4, s8, v2
    v_lshrrev_b32 v5, 0, v4
    v_and_b32 v5, 15, v5
    v_mul_u32_u24 v4, 256, v4
    s_mul_i32 s8, s98, 4096
    s_mul_i32 s9, s96, 8192
    s_add_u32 s8, s8, s9
    v_lshlrev_b32 v7, 4, v1
    s_add_u32 s9, s8, 0
    v_add_u32 v10, s9, v7
    s_mul_i32 s8, s98, 4096
    s_mul_i32 s9, s96, 8192
    s_add_u32 s8, s8, s9
    v_lshlrev_b32 v7, 4, v1
    s_add_u32 s9, s8, 1024
    v_add_u32 v11, s9, v7
    s_mul_i32 s8, s98, 4096
    s_mul_i32 s9, s96, 8192
    s_add_u32 s8, s8, s9
    v_lshlrev_b32 v7, 4, v1
    s_add_u32 s9, s8, 2048
    v_add_u32 v12, s9, v7
    s_mul_i32 s8, s98, 4096
    s_mul_i32 s9, s96, 8192
    s_add_u32 s8, s8, s9
    v_lshlrev_b32 v7, 4, v1
    s_add_u32 s9, s8, 3072
    v_add_u32 v13, s9, v7
    v_bfe_u32 v4, v1, 2, 2
    v_lshrrev_b32 v5, 5, v1
    v_lshlrev_b32 v5, 2, v5
    v_add_u32 v5, v5, v4
    s_mul_i32 s8, s98, 64
    v_add_u32 v5, s8, v5
    v_mul_u32_u24 v5, 128, v5
    v_bfe_u32 v6, v1, 4, 1
    v_lshlrev_b32 v6, 4, v6
    v_and_b32 v7, 3, v1
    v_lshl_add_u32 v6, v7, 2, v6
    s_mul_i32 s8, s97, 32
    s_add_u32 s8, s8, 0
    v_add_u32 v6, s8, v6
    v_lshlrev_b32 v6, 1, v6
    v_bfe_u32 v7, v4, 1, 1
    v_lshlrev_b32 v7, 6, v7
    v_xor_b32 v6, v6, v7
    v_add_u32 v5, v5, v6
    s_mov_b32 s8, 0
    s_mul_i32 s8, s8, 2048
    s_add_u32 s8, s8, 16384
    v_add_u32 v14, s8, v5
    s_mov_b32 s8, 1
    s_mul_i32 s8, s8, 2048
    s_add_u32 s8, s8, 16384
    v_add_u32 v15, s8, v5
    s_mov_b32 s8, 2
    s_mul_i32 s8, s8, 2048
    s_add_u32 s8, s8, 16384
    v_add_u32 v16, s8, v5
    s_mov_b32 s8, 3
    s_mul_i32 s8, s8, 2048
    s_add_u32 s8, s8, 16384
    v_add_u32 v17, s8, v5
    s_waitcnt vmcnt(12) lgkmcnt(0)
    s_barrier
    ds_read_b128 v[36:39], v10
    ds_read_b64_tr_b16 v[44:45], v14 offset:0
    ds_read_b64_tr_b16 v[46:47], v14 offset:1024
    ds_read_b128 v[40:43], v11
    ds_read_b64_tr_b16 v[48:49], v15 offset:0
    ds_read_b64_tr_b16 v[50:51], v15 offset:1024
    s_waitcnt lgkmcnt(3)
    v_mfma_f32_32x32x16_bf16 v[20:35], v[44:47], v[36:39], 0
    ds_read_b128 v[36:39], v12
    ds_read_b64_tr_b16 v[44:45], v16 offset:0
    ds_read_b64_tr_b16 v[46:47], v16 offset:1024
    s_waitcnt lgkmcnt(3)
    v_mfma_f32_32x32x16_bf16 v[20:35], v[48:51], v[40:43], v[20:35]
    ds_read_b128 v[40:43], v13
    ds_read_b64_tr_b16 v[48:49], v17 offset:0
    ds_read_b64_tr_b16 v[50:51], v17 offset:1024
    s_waitcnt lgkmcnt(3)
    v_mfma_f32_32x32x16_bf16 v[20:35], v[44:47], v[36:39], v[20:35]
    v_add_u32 v10, 32768, v10
    v_add_u32 v11, 32768, v11
    v_add_u32 v12, 32768, v12
    v_add_u32 v13, 32768, v13
    v_add_u32 v14, 32768, v14
    v_add_u32 v15, 32768, v15
    v_add_u32 v16, 32768, v16
    v_add_u32 v17, 32768, v17
    s_waitcnt vmcnt(8) lgkmcnt(0)
    s_barrier
    ds_read_b128 v[36:39], v10
    ds_read_b64_tr_b16 v[44:45], v14 offset:0
    ds_read_b64_tr_b16 v[46:47], v14 offset:1024
    v_mfma_f32_32x32x16_bf16 v[20:35], v[48:51], v[40:43], v[20:35]
    s_add_u32 m0, s7, 0
    s_mov_b32 s4, 32768
    buffer_load_dwordx4 v8, s[12:15], s4 offen lds
    s_add_u32 m0, s7, 8192
    s_mov_b32 s4, 294912
    buffer_load_dwordx4 v8, s[12:15], s4 offen lds
    ds_read_b128 v[40:43], v11
    ds_read_b64_tr_b16 v[48:49], v15 offset:0
    ds_read_b64_tr_b16 v[50:51], v15 offset:1024
    s_waitcnt lgkmcnt(3)
    v_mfma_f32_32x32x16_bf16 v[20:35], v[44:47], v[36:39], v[20:35]
    s_add_u32 m0, s7, 16384
    s_mov_b32 s4, 524288
    buffer_load_dwordx4 v9, s[16:19], s4 offen lds
    s_add_u32 m0, s7, 24576
    s_mov_b32 s4, 589824
    buffer_load_dwordx4 v9, s[16:19], s4 offen lds
    ds_read_b128 v[36:39], v12
    ds_read_b64_tr_b16 v[44:45], v16 offset:0
    ds_read_b64_tr_b16 v[46:47], v16 offset:1024
    s_waitcnt lgkmcnt(3)
    v_mfma_f32_32x32x16_bf16 v[20:35], v[48:51], v[40:43], v[20:35]
    ds_read_b128 v[40:43], v13
    ds_read_b64_tr_b16 v[48:49], v17 offset:0
    ds_read_b64_tr_b16 v[50:51], v17 offset:1024
    s_waitcnt lgkmcnt(3)
    v_mfma_f32_32x32x16_bf16 v[20:35], v[44:47], v[36:39], v[20:35]
    v_add_u32 v10, 32768, v10
    v_add_u32 v11, 32768, v11
    v_add_u32 v12, 32768, v12
    v_add_u32 v13, 32768, v13
    v_add_u32 v14, 32768, v14
    v_add_u32 v15, 32768, v15
    v_add_u32 v16, 32768, v16
    v_add_u32 v17, 32768, v17
    s_waitcnt vmcnt(8) lgkmcnt(0)
    s_barrier
    ds_read_b128 v[36:39], v10
    ds_read_b64_tr_b16 v[44:45], v14 offset:0
    ds_read_b64_tr_b16 v[46:47], v14 offset:1024
    v_mfma_f32_32x32x16_bf16 v[20:35], v[48:51], v[40:43], v[20:35]
    s_add_u32 m0, s7, 32768
    s_mov_b32 s4, 40960
    buffer_load_dwordx4 v8, s[12:15], s4 offen lds
    s_add_u32 m0, s7, 40960
    s_mov_b32 s4, 303104
    buffer_load_dwordx4 v8, s[12:15], s4 offen lds
    ds_read_b128 v[40:43], v11
    ds_read_b64_tr_b16 v[48:49], v15 offset:0
    ds_read_b64_tr_b16 v[50:51], v15 offset:1024
    s_waitcnt lgkmcnt(3)
    v_mfma_f32_32x32x16_bf16 v[20:35], v[44:47], v[36:39], v[20:35]
    s_add_u32 m0, s7, 49152
    s_mov_b32 s4, 655360
    buffer_load_dwordx4 v9, s[16:19], s4 offen lds
    s_add_u32 m0, s7, 57344
    s_mov_b32 s4, 720896
    buffer_load_dwordx4 v9, s[16:19], s4 offen lds
    ds_read_b128 v[36:39], v12
    ds_read_b64_tr_b16 v[44:45], v16 offset:0
    ds_read_b64_tr_b16 v[46:47], v16 offset:1024
    s_waitcnt lgkmcnt(3)
    v_mfma_f32_32x32x16_bf16 v[20:35], v[48:51], v[40:43], v[20:35]
    ds_read_b128 v[40:43], v13
    ds_read_b64_tr_b16 v[48:49], v17 offset:0
    ds_read_b64_tr_b16 v[50:51], v17 offset:1024
    s_waitcnt lgkmcnt(3)
    v_mfma_f32_32x32x16_bf16 v[20:35], v[44:47], v[36:39], v[20:35]
    v_add_u32 v10, 32768, v10
    v_add_u32 v11, 32768, v11
    v_add_u32 v12, 32768, v12
    v_add_u32 v13, 32768, v13
    v_add_u32 v14, 32768, v14
    v_add_u32 v15, 32768, v15
    v_add_u32 v16, 32768, v16
    v_add_u32 v17, 32768, v17
    s_waitcnt vmcnt(8) lgkmcnt(0)
    s_barrier
    ds_read_b128 v[36:39], v10
    ds_read_b64_tr_b16 v[44:45], v14 offset:0
    ds_read_b64_tr_b16 v[46:47], v14 offset:1024
    v_mfma_f32_32x32x16_bf16 v[20:35], v[48:51], v[40:43], v[20:35]
    s_add_u32 m0, s7, 65536
    s_mov_b32 s4, 49152
    buffer_load_dwordx4 v8, s[12:15], s4 offen lds
    s_add_u32 m0, s7, 73728
    s_mov_b32 s4, 311296
    buffer_load_dwordx4 v8, s[12:15], s4 offen lds
    ds_read_b128 v[40:43], v11
    ds_read_b64_tr_b16 v[48:49], v15 offset:0
    ds_read_b64_tr_b16 v[50:51], v15 offset:1024
    s_waitcnt lgkmcnt(3)
    v_mfma_f32_32x32x16_bf16 v[20:35], v[44:47], v[36:39], v[20:35]
    s_add_u32 m0, s7, 81920
    s_mov_b32 s4, 786432
    buffer_load_dwordx4 v9, s[16:19], s4 offen lds
    s_add_u32 m0, s7, 90112
    s_mov_b32 s4, 851968
    buffer_load_dwordx4 v9, s[16:19], s4 offen lds
    ds_read_b128 v[36:39], v12
    ds_read_b64_tr_b16 v[44:45], v16 offset:0
    ds_read_b64_tr_b16 v[46:47], v16 offset:1024
    s_waitcnt lgkmcnt(3)
    v_mfma_f32_32x32x16_bf16 v[20:35], v[48:51], v[40:43], v[20:35]
    ds_read_b128 v[40:43], v13
    ds_read_b64_tr_b16 v[48:49], v17 offset:0
    ds_read_b64_tr_b16 v[50:51], v17 offset:1024
    s_waitcnt lgkmcnt(3)
    v_mfma_f32_32x32x16_bf16 v[20:35], v[44:47], v[36:39], v[20:35]
    v_subrev_u32 v10, 98304, v10
    v_subrev_u32 v11, 98304, v11
    v_subrev_u32 v12, 98304, v12
    v_subrev_u32 v13, 98304, v13
    v_subrev_u32 v14, 98304, v14
    v_subrev_u32 v15, 98304, v15
    v_subrev_u32 v16, 98304, v16
    v_subrev_u32 v17, 98304, v17
    s_waitcnt vmcnt(8) lgkmcnt(0)
    s_barrier
    ds_read_b128 v[36:39], v10
    ds_read_b64_tr_b16 v[44:45], v14 offset:0
    ds_read_b64_tr_b16 v[46:47], v14 offset:1024
    v_mfma_f32_32x32x16_bf16 v[20:35], v[48:51], v[40:43], v[20:35]
    s_add_u32 m0, s7, 98304
    s_mov_b32 s4, 57344
    buffer_load_dwordx4 v8, s[12:15], s4 offen lds
    s_add_u32 m0, s7, 106496
    s_mov_b32 s4, 319488
    buffer_load_dwordx4 v8, s[12:15], s4 offen lds
    ds_read_b128 v[40:43], v11
    ds_read_b64_tr_b16 v[48:49], v15 offset:0
    ds_read_b64_tr_b16 v[50:51], v15 offset:1024
    s_waitcnt lgkmcnt(3)
    v_mfma_f32_32x32x16_bf16 v[20:35], v[44:47], v[36:39], v[20:35]
    s_add_u32 m0, s7, 114688
    s_mov_b32 s4, 917504
    buffer_load_dwordx4 v9, s[16:19], s4 offen lds
    s_add_u32 m0, s7, 122880
    s_mov_b32 s4, 983040
    buffer_load_dwordx4 v9, s[16:19], s4 offen lds
    ds_read_b128 v[36:39], v12
    ds_read_b64_tr_b16 v[44:45], v16 offset:0
    ds_read_b64_tr_b16 v[46:47], v16 offset:1024
    s_waitcnt lgkmcnt(3)
    v_mfma_f32_32x32x16_bf16 v[20:35], v[48:51], v[40:43], v[20:35]
    ds_read_b128 v[40:43], v13
    ds_read_b64_tr_b16 v[48:49], v17 offset:0
    ds_read_b64_tr_b16 v[50:51], v17 offset:1024
    s_waitcnt lgkmcnt(3)
    v_mfma_f32_32x32x16_bf16 v[20:35], v[44:47], v[36:39], v[20:35]
    v_add_u32 v10, 32768, v10
    v_add_u32 v11, 32768, v11
    v_add_u32 v12, 32768, v12
    v_add_u32 v13, 32768, v13
    v_add_u32 v14, 32768, v14
    v_add_u32 v15, 32768, v15
    v_add_u32 v16, 32768, v16
    v_add_u32 v17, 32768, v17
    s_waitcnt vmcnt(8) lgkmcnt(0)
    s_barrier
    ds_read_b128 v[36:39], v10
    ds_read_b64_tr_b16 v[44:45], v14 offset:0
    ds_read_b64_tr_b16 v[46:47], v14 offset:1024
    v_mfma_f32_32x32x16_bf16 v[20:35], v[48:51], v[40:43], v[20:35]
    s_add_u32 m0, s7, 0
    s_mov_b32 s4, 65536
    buffer_load_dwordx4 v8, s[12:15], s4 offen lds
    s_add_u32 m0, s7, 8192
    s_mov_b32 s4, 327680
    buffer_load_dwordx4 v8, s[12:15], s4 offen lds
    ds_read_b128 v[40:43], v11
    ds_read_b64_tr_b16 v[48:49], v15 offset:0
    ds_read_b64_tr_b16 v[50:51], v15 offset:1024
    s_waitcnt lgkmcnt(3)
    v_mfma_f32_32x32x16_bf16 v[20:35], v[44:47], v[36:39], v[20:35]
    s_add_u32 m0, s7, 16384
    s_mov_b32 s4, 1048576
    buffer_load_dwordx4 v9, s[16:19], s4 offen lds
    s_add_u32 m0, s7, 24576
    s_mov_b32 s4, 1114112
    buffer_load_dwordx4 v9, s[16:19], s4 offen lds
    ds_read_b128 v[36:39], v12
    ds_read_b64_tr_b16 v[44:45], v16 offset:0
    ds_read_b64_tr_b16 v[46:47], v16 offset:1024
    s_waitcnt lgkmcnt(3)
    v_mfma_f32_32x32x16_bf16 v[20:35], v[48:51], v[40:43], v[20:35]
    ds_read_b128 v[40:43], v13
    ds_read_b64_tr_b16 v[48:49], v17 offset:0
    ds_read_b64_tr_b16 v[50:51], v17 offset:1024
    s_waitcnt lgkmcnt(3)
    v_mfma_f32_32x32x16_bf16 v[20:35], v[44:47], v[36:39], v[20:35]
    v_add_u32 v10, 32768, v10
    v_add_u32 v11, 32768, v11
    v_add_u32 v12, 32768, v12
    v_add_u32 v13, 32768, v13
    v_add_u32 v14, 32768, v14
    v_add_u32 v15, 32768, v15
    v_add_u32 v16, 32768, v16
    v_add_u32 v17, 32768, v17
    s_waitcnt vmcnt(8) lgkmcnt(0)
    s_barrier
    ds_read_b128 v[36:39], v10
    ds_read_b64_tr_b16 v[44:45], v14 offset:0
    ds_read_b64_tr_b16 v[46:47], v14 offset:1024
    v_mfma_f32_32x32x16_bf16 v[20:35], v[48:51], v[40:43], v[20:35]
    s_add_u32 m0, s7, 32768
    s_mov_b32 s4, 73728
    buffer_load_dwordx4 v8, s[12:15], s4 offen lds
    s_add_u32 m0, s7, 40960
    s_mov_b32 s4, 335872
    buffer_load_dwordx4 v8, s[12:15], s4 offen lds
    ds_read_b128 v[40:43], v11
    ds_read_b64_tr_b16 v[48:49], v15 offset:0
    ds_read_b64_tr_b16 v[50:51], v15 offset:1024
    s_waitcnt lgkmcnt(3)
    v_mfma_f32_32x32x16_bf16 v[20:35], v[44:47], v[36:39], v[20:35]
    s_add_u32 m0, s7, 49152
    s_mov_b32 s4, 1179648
    buffer_load_dwordx4 v9, s[16:19], s4 offen lds
    s_add_u32 m0, s7, 57344
    s_mov_b32 s4, 1245184
    buffer_load_dwordx4 v9, s[16:19], s4 offen lds
    ds_read_b128 v[36:39], v12
    ds_read_b64_tr_b16 v[44:45], v16 offset:0
    ds_read_b64_tr_b16 v[46:47], v16 offset:1024
    s_waitcnt lgkmcnt(3)
    v_mfma_f32_32x32x16_bf16 v[20:35], v[48:51], v[40:43], v[20:35]
    ds_read_b128 v[40:43], v13
    ds_read_b64_tr_b16 v[48:49], v17 offset:0
    ds_read_b64_tr_b16 v[50:51], v17 offset:1024
    s_waitcnt lgkmcnt(3)
    v_mfma_f32_32x32x16_bf16 v[20:35], v[44:47], v[36:39], v[20:35]
    v_add_u32 v10, 32768, v10
    v_add_u32 v11, 32768, v11
    v_add_u32 v12, 32768, v12
    v_add_u32 v13, 32768, v13
    v_add_u32 v14, 32768, v14
    v_add_u32 v15, 32768, v15
    v_add_u32 v16, 32768, v16
    v_add_u32 v17, 32768, v17
    s_waitcnt vmcnt(8) lgkmcnt(0)
    s_barrier
    ds_read_b128 v[36:39], v10
    ds_read_b64_tr_b16 v[44:45], v14 offset:0
    ds_read_b64_tr_b16 v[46:47], v14 offset:1024
    v_mfma_f32_32x32x16_bf16 v[20:35], v[48:51], v[40:43], v[20:35]
    s_add_u32 m0, s7, 65536
    s_mov_b32 s4, 81920
    buffer_load_dwordx4 v8, s[12:15], s4 offen lds
    s_add_u32 m0, s7, 73728
    s_mov_b32 s4, 344064
    buffer_load_dwordx4 v8, s[12:15], s4 offen lds
    ds_read_b128 v[40:43], v11
    ds_read_b64_tr_b16 v[48:49], v15 offset:0
    ds_read_b64_tr_b16 v[50:51], v15 offset:1024
    s_waitcnt lgkmcnt(3)
    v_mfma_f32_32x32x16_bf16 v[20:35], v[44:47], v[36:39], v[20:35]
    s_add_u32 m0, s7, 81920
    s_mov_b32 s4, 1310720
    buffer_load_dwordx4 v9, s[16:19], s4 offen lds
    s_add_u32 m0, s7, 90112
    s_mov_b32 s4, 1376256
    buffer_load_dwordx4 v9, s[16:19], s4 offen lds
    ds_read_b128 v[36:39], v12
    ds_read_b64_tr_b16 v[44:45], v16 offset:0
    ds_read_b64_tr_b16 v[46:47], v16 offset:1024
    s_waitcnt lgkmcnt(3)
    v_mfma_f32_32x32x16_bf16 v[20:35], v[48:51], v[40:43], v[20:35]
    ds_read_b128 v[40:43], v13
    ds_read_b64_tr_b16 v[48:49], v17 offset:0
    ds_read_b64_tr_b16 v[50:51], v17 offset:1024
    s_waitcnt lgkmcnt(3)
    v_mfma_f32_32x32x16_bf16 v[20:35], v[44:47], v[36:39], v[20:35]
    v_subrev_u32 v10, 98304, v10
    v_subrev_u32 v11, 98304, v11
    v_subrev_u32 v12, 98304, v12
    v_subrev_u32 v13, 98304, v13
    v_subrev_u32 v14, 98304, v14
    v_subrev_u32 v15, 98304, v15
    v_subrev_u32 v16, 98304, v16
    v_subrev_u32 v17, 98304, v17
    s_waitcnt vmcnt(8) lgkmcnt(0)
    s_barrier
    ds_read_b128 v[36:39], v10
    ds_read_b64_tr_b16 v[44:45], v14 offset:0
    ds_read_b64_tr_b16 v[46:47], v14 offset:1024
    v_mfma_f32_32x32x16_bf16 v[20:35], v[48:51], v[40:43], v[20:35]
    s_add_u32 m0, s7, 98304
    s_mov_b32 s4, 90112
    buffer_load_dwordx4 v8, s[12:15], s4 offen lds
    s_add_u32 m0, s7, 106496
    s_mov_b32 s4, 352256
    buffer_load_dwordx4 v8, s[12:15], s4 offen lds
    ds_read_b128 v[40:43], v11
    ds_read_b64_tr_b16 v[48:49], v15 offset:0
    ds_read_b64_tr_b16 v[50:51], v15 offset:1024
    s_waitcnt lgkmcnt(3)
    v_mfma_f32_32x32x16_bf16 v[20:35], v[44:47], v[36:39], v[20:35]
    s_add_u32 m0, s7, 114688
    s_mov_b32 s4, 1441792
    buffer_load_dwordx4 v9, s[16:19], s4 offen lds
    s_add_u32 m0, s7, 122880
    s_mov_b32 s4, 1507328
    buffer_load_dwordx4 v9, s[16:19], s4 offen lds
    ds_read_b128 v[36:39], v12
    ds_read_b64_tr_b16 v[44:45], v16 offset:0
    ds_read_b64_tr_b16 v[46:47], v16 offset:1024
    s_waitcnt lgkmcnt(3)
    v_mfma_f32_32x32x16_bf16 v[20:35], v[48:51], v[40:43], v[20:35]
    ds_read_b128 v[40:43], v13
    ds_read_b64_tr_b16 v[48:49], v17 offset:0
    ds_read_b64_tr_b16 v[50:51], v17 offset:1024
    s_waitcnt lgkmcnt(3)
    v_mfma_f32_32x32x16_bf16 v[20:35], v[44:47], v[36:39], v[20:35]
    v_add_u32 v10, 32768, v10
    v_add_u32 v11, 32768, v11
    v_add_u32 v12, 32768, v12
    v_add_u32 v13, 32768, v13
    v_add_u32 v14, 32768, v14
    v_add_u32 v15, 32768, v15
    v_add_u32 v16, 32768, v16
    v_add_u32 v17, 32768, v17
    s_waitcnt vmcnt(8) lgkmcnt(0)
    s_barrier
    ds_read_b128 v[36:39], v10
    ds_read_b64_tr_b16 v[44:45], v14 offset:0
    ds_read_b64_tr_b16 v[46:47], v14 offset:1024
    v_mfma_f32_32x32x16_bf16 v[20:35], v[48:51], v[40:43], v[20:35]
    s_add_u32 m0, s7, 0
    s_mov_b32 s4, 98304
    buffer_load_dwordx4 v8, s[12:15], s4 offen lds
    s_add_u32 m0, s7, 8192
    s_mov_b32 s4, 360448
    buffer_load_dwordx4 v8, s[12:15], s4 offen lds
    ds_read_b128 v[40:43], v11
    ds_read_b64_tr_b16 v[48:49], v15 offset:0
    ds_read_b64_tr_b16 v[50:51], v15 offset:1024
    s_waitcnt lgkmcnt(3)
    v_mfma_f32_32x32x16_bf16 v[20:35], v[44:47], v[36:39], v[20:35]
    s_add_u32 m0, s7, 16384
    s_mov_b32 s4, 1572864
    buffer_load_dwordx4 v9, s[16:19], s4 offen lds
    s_add_u32 m0, s7, 24576
    s_mov_b32 s4, 1638400
    buffer_load_dwordx4 v9, s[16:19], s4 offen lds
    ds_read_b128 v[36:39], v12
    ds_read_b64_tr_b16 v[44:45], v16 offset:0
    ds_read_b64_tr_b16 v[46:47], v16 offset:1024
    s_waitcnt lgkmcnt(3)
    v_mfma_f32_32x32x16_bf16 v[20:35], v[48:51], v[40:43], v[20:35]
    ds_read_b128 v[40:43], v13
    ds_read_b64_tr_b16 v[48:49], v17 offset:0
    ds_read_b64_tr_b16 v[50:51], v17 offset:1024
    s_waitcnt lgkmcnt(3)
    v_mfma_f32_32x32x16_bf16 v[20:35], v[44:47], v[36:39], v[20:35]
    v_add_u32 v10, 32768, v10
    v_add_u32 v11, 32768, v11
    v_add_u32 v12, 32768, v12
    v_add_u32 v13, 32768, v13
    v_add_u32 v14, 32768, v14
    v_add_u32 v15, 32768, v15
    v_add_u32 v16, 32768, v16
    v_add_u32 v17, 32768, v17
    s_waitcnt vmcnt(8) lgkmcnt(0)
    s_barrier
    ds_read_b128 v[36:39], v10
    ds_read_b64_tr_b16 v[44:45], v14 offset:0
    ds_read_b64_tr_b16 v[46:47], v14 offset:1024
    v_mfma_f32_32x32x16_bf16 v[20:35], v[48:51], v[40:43], v[20:35]
    s_add_u32 m0, s7, 32768
    s_mov_b32 s4, 106496
    buffer_load_dwordx4 v8, s[12:15], s4 offen lds
    s_add_u32 m0, s7, 40960
    s_mov_b32 s4, 368640
    buffer_load_dwordx4 v8, s[12:15], s4 offen lds
    ds_read_b128 v[40:43], v11
    ds_read_b64_tr_b16 v[48:49], v15 offset:0
    ds_read_b64_tr_b16 v[50:51], v15 offset:1024
    s_waitcnt lgkmcnt(3)
    v_mfma_f32_32x32x16_bf16 v[20:35], v[44:47], v[36:39], v[20:35]
    s_add_u32 m0, s7, 49152
    s_mov_b32 s4, 1703936
    buffer_load_dwordx4 v9, s[16:19], s4 offen lds
    s_add_u32 m0, s7, 57344
    s_mov_b32 s4, 1769472
    buffer_load_dwordx4 v9, s[16:19], s4 offen lds
    ds_read_b128 v[36:39], v12
    ds_read_b64_tr_b16 v[44:45], v16 offset:0
    ds_read_b64_tr_b16 v[46:47], v16 offset:1024
    s_waitcnt lgkmcnt(3)
    v_mfma_f32_32x32x16_bf16 v[20:35], v[48:51], v[40:43], v[20:35]
    ds_read_b128 v[40:43], v13
    ds_read_b64_tr_b16 v[48:49], v17 offset:0
    ds_read_b64_tr_b16 v[50:51], v17 offset:1024
    s_waitcnt lgkmcnt(3)
    v_mfma_f32_32x32x16_bf16 v[20:35], v[44:47], v[36:39], v[20:35]
    v_add_u32 v10, 32768, v10
    v_add_u32 v11, 32768, v11
    v_add_u32 v12, 32768, v12
    v_add_u32 v13, 32768, v13
    v_add_u32 v14, 32768, v14
    v_add_u32 v15, 32768, v15
    v_add_u32 v16, 32768, v16
    v_add_u32 v17, 32768, v17
    s_waitcnt vmcnt(8) lgkmcnt(0)
    s_barrier
    ds_read_b128 v[36:39], v10
    ds_read_b64_tr_b16 v[44:45], v14 offset:0
    ds_read_b64_tr_b16 v[46:47], v14 offset:1024
    v_mfma_f32_32x32x16_bf16 v[20:35], v[48:51], v[40:43], v[20:35]
    s_add_u32 m0, s7, 65536
    s_mov_b32 s4, 114688
    buffer_load_dwordx4 v8, s[12:15], s4 offen lds
    s_add_u32 m0, s7, 73728
    s_mov_b32 s4, 376832
    buffer_load_dwordx4 v8, s[12:15], s4 offen lds
    ds_read_b128 v[40:43], v11
    ds_read_b64_tr_b16 v[48:49], v15 offset:0
    ds_read_b64_tr_b16 v[50:51], v15 offset:1024
    s_waitcnt lgkmcnt(3)
    v_mfma_f32_32x32x16_bf16 v[20:35], v[44:47], v[36:39], v[20:35]
    s_add_u32 m0, s7, 81920
    s_mov_b32 s4, 1835008
    buffer_load_dwordx4 v9, s[16:19], s4 offen lds
    s_add_u32 m0, s7, 90112
    s_mov_b32 s4, 1900544
    buffer_load_dwordx4 v9, s[16:19], s4 offen lds
    ds_read_b128 v[36:39], v12
    ds_read_b64_tr_b16 v[44:45], v16 offset:0
    ds_read_b64_tr_b16 v[46:47], v16 offset:1024
    s_waitcnt lgkmcnt(3)
    v_mfma_f32_32x32x16_bf16 v[20:35], v[48:51], v[40:43], v[20:35]
    ds_read_b128 v[40:43], v13
    ds_read_b64_tr_b16 v[48:49], v17 offset:0
    ds_read_b64_tr_b16 v[50:51], v17 offset:1024
    s_waitcnt lgkmcnt(3)
    v_mfma_f32_32x32x16_bf16 v[20:35], v[44:47], v[36:39], v[20:35]
    v_subrev_u32 v10, 98304, v10
    v_subrev_u32 v11, 98304, v11
    v_subrev_u32 v12, 98304, v12
    v_subrev_u32 v13, 98304, v13
    v_subrev_u32 v14, 98304, v14
    v_subrev_u32 v15, 98304, v15
    v_subrev_u32 v16, 98304, v16
    v_subrev_u32 v17, 98304, v17
    s_waitcnt vmcnt(8) lgkmcnt(0)
    s_barrier
    ds_read_b128 v[36:39], v10
    ds_read_b64_tr_b16 v[44:45], v14 offset:0
    ds_read_b64_tr_b16 v[46:47], v14 offset:1024
    v_mfma_f32_32x32x16_bf16 v[20:35], v[48:51], v[40:43], v[20:35]
    s_add_u32 m0, s7, 98304
    s_mov_b32 s4, 122880
    buffer_load_dwordx4 v8, s[12:15], s4 offen lds
    s_add_u32 m0, s7, 106496
    s_mov_b32 s4, 385024
    buffer_load_dwordx4 v8, s[12:15], s4 offen lds
    ds_read_b128 v[40:43], v11
    ds_read_b64_tr_b16 v[48:49], v15 offset:0
    ds_read_b64_tr_b16 v[50:51], v15 offset:1024
    s_waitcnt lgkmcnt(3)
    v_mfma_f32_32x32x16_bf16 v[20:35], v[44:47], v[36:39], v[20:35]
    s_add_u32 m0, s7, 114688
    s_mov_b32 s4, 1966080
    buffer_load_dwordx4 v9, s[16:19], s4 offen lds
    s_add_u32 m0, s7, 122880
    s_mov_b32 s4, 2031616
    buffer_load_dwordx4 v9, s[16:19], s4 offen lds
    ds_read_b128 v[36:39], v12
    ds_read_b64_tr_b16 v[44:45], v16 offset:0
    ds_read_b64_tr_b16 v[46:47], v16 offset:1024
    s_waitcnt lgkmcnt(3)
    v_mfma_f32_32x32x16_bf16 v[20:35], v[48:51], v[40:43], v[20:35]
    ds_read_b128 v[40:43], v13
    ds_read_b64_tr_b16 v[48:49], v17 offset:0
    ds_read_b64_tr_b16 v[50:51], v17 offset:1024
    s_waitcnt lgkmcnt(3)
    v_mfma_f32_32x32x16_bf16 v[20:35], v[44:47], v[36:39], v[20:35]
    v_add_u32 v10, 32768, v10
    v_add_u32 v11, 32768, v11
    v_add_u32 v12, 32768, v12
    v_add_u32 v13, 32768, v13
    v_add_u32 v14, 32768, v14
    v_add_u32 v15, 32768, v15
    v_add_u32 v16, 32768, v16
    v_add_u32 v17, 32768, v17
    s_waitcnt vmcnt(8) lgkmcnt(0)
    s_barrier
    ds_read_b128 v[36:39], v10
    ds_read_b64_tr_b16 v[44:45], v14 offset:0
    ds_read_b64_tr_b16 v[46:47], v14 offset:1024
    v_mfma_f32_32x32x16_bf16 v[20:35], v[48:51], v[40:43], v[20:35]
    s_add_u32 m0, s7, 0
    s_mov_b32 s4, 131072
    buffer_load_dwordx4 v8, s[12:15], s4 offen lds
    s_add_u32 m0, s7, 8192
    s_mov_b32 s4, 393216
    buffer_load_dwordx4 v8, s[12:15], s4 offen lds
    ds_read_b128 v[40:43], v11
    ds_read_b64_tr_b16 v[48:49], v15 offset:0
    ds_read_b64_tr_b16 v[50:51], v15 offset:1024
    s_waitcnt lgkmcnt(3)
    v_mfma_f32_32x32x16_bf16 v[20:35], v[44:47], v[36:39], v[20:35]
    s_add_u32 m0, s7, 16384
    s_mov_b32 s4, 2097152
    buffer_load_dwordx4 v9, s[16:19], s4 offen lds
    s_add_u32 m0, s7, 24576
    s_mov_b32 s4, 2162688
    buffer_load_dwordx4 v9, s[16:19], s4 offen lds
    ds_read_b128 v[36:39], v12
    ds_read_b64_tr_b16 v[44:45], v16 offset:0
    ds_read_b64_tr_b16 v[46:47], v16 offset:1024
    s_waitcnt lgkmcnt(3)
    v_mfma_f32_32x32x16_bf16 v[20:35], v[48:51], v[40:43], v[20:35]
    ds_read_b128 v[40:43], v13
    ds_read_b64_tr_b16 v[48:49], v17 offset:0
    ds_read_b64_tr_b16 v[50:51], v17 offset:1024
    s_waitcnt lgkmcnt(3)
    v_mfma_f32_32x32x16_bf16 v[20:35], v[44:47], v[36:39], v[20:35]
    v_add_u32 v10, 32768, v10
    v_add_u32 v11, 32768, v11
    v_add_u32 v12, 32768, v12
    v_add_u32 v13, 32768, v13
    v_add_u32 v14, 32768, v14
    v_add_u32 v15, 32768, v15
    v_add_u32 v16, 32768, v16
    v_add_u32 v17, 32768, v17
    s_waitcnt vmcnt(8) lgkmcnt(0)
    s_barrier
    ds_read_b128 v[36:39], v10
    ds_read_b64_tr_b16 v[44:45], v14 offset:0
    ds_read_b64_tr_b16 v[46:47], v14 offset:1024
    v_mfma_f32_32x32x16_bf16 v[20:35], v[48:51], v[40:43], v[20:35]
    s_add_u32 m0, s7, 32768
    s_mov_b32 s4, 139264
    buffer_load_dwordx4 v8, s[12:15], s4 offen lds
    s_add_u32 m0, s7, 40960
    s_mov_b32 s4, 401408
    buffer_load_dwordx4 v8, s[12:15], s4 offen lds
    ds_read_b128 v[40:43], v11
    ds_read_b64_tr_b16 v[48:49], v15 offset:0
    ds_read_b64_tr_b16 v[50:51], v15 offset:1024
    s_waitcnt lgkmcnt(3)
    v_mfma_f32_32x32x16_bf16 v[20:35], v[44:47], v[36:39], v[20:35]
    s_add_u32 m0, s7, 49152
    s_mov_b32 s4, 2228224
    buffer_load_dwordx4 v9, s[16:19], s4 offen lds
    s_add_u32 m0, s7, 57344
    s_mov_b32 s4, 2293760
    buffer_load_dwordx4 v9, s[16:19], s4 offen lds
    ds_read_b128 v[36:39], v12
    ds_read_b64_tr_b16 v[44:45], v16 offset:0
    ds_read_b64_tr_b16 v[46:47], v16 offset:1024
    s_waitcnt lgkmcnt(3)
    v_mfma_f32_32x32x16_bf16 v[20:35], v[48:51], v[40:43], v[20:35]
    ds_read_b128 v[40:43], v13
    ds_read_b64_tr_b16 v[48:49], v17 offset:0
    ds_read_b64_tr_b16 v[50:51], v17 offset:1024
    s_waitcnt lgkmcnt(3)
    v_mfma_f32_32x32x16_bf16 v[20:35], v[44:47], v[36:39], v[20:35]
    v_add_u32 v10, 32768, v10
    v_add_u32 v11, 32768, v11
    v_add_u32 v12, 32768, v12
    v_add_u32 v13, 32768, v13
    v_add_u32 v14, 32768, v14
    v_add_u32 v15, 32768, v15
    v_add_u32 v16, 32768, v16
    v_add_u32 v17, 32768, v17
    s_waitcnt vmcnt(8) lgkmcnt(0)
    s_barrier
    ds_read_b128 v[36:39], v10
    ds_read_b64_tr_b16 v[44:45], v14 offset:0
    ds_read_b64_tr_b16 v[46:47], v14 offset:1024
    v_mfma_f32_32x32x16_bf16 v[20:35], v[48:51], v[40:43], v[20:35]
    s_add_u32 m0, s7, 65536
    s_mov_b32 s4, 147456
    buffer_load_dwordx4 v8, s[12:15], s4 offen lds
    s_add_u32 m0, s7, 73728
    s_mov_b32 s4, 409600
    buffer_load_dwordx4 v8, s[12:15], s4 offen lds
    ds_read_b128 v[40:43], v11
    ds_read_b64_tr_b16 v[48:49], v15 offset:0
    ds_read_b64_tr_b16 v[50:51], v15 offset:1024
    s_waitcnt lgkmcnt(3)
    v_mfma_f32_32x32x16_bf16 v[20:35], v[44:47], v[36:39], v[20:35]
    s_add_u32 m0, s7, 81920
    s_mov_b32 s4, 2359296
    buffer_load_dwordx4 v9, s[16:19], s4 offen lds
    s_add_u32 m0, s7, 90112
    s_mov_b32 s4, 2424832
    buffer_load_dwordx4 v9, s[16:19], s4 offen lds
    ds_read_b128 v[36:39], v12
    ds_read_b64_tr_b16 v[44:45], v16 offset:0
    ds_read_b64_tr_b16 v[46:47], v16 offset:1024
    s_waitcnt lgkmcnt(3)
    v_mfma_f32_32x32x16_bf16 v[20:35], v[48:51], v[40:43], v[20:35]
    ds_read_b128 v[40:43], v13
    ds_read_b64_tr_b16 v[48:49], v17 offset:0
    ds_read_b64_tr_b16 v[50:51], v17 offset:1024
    s_waitcnt lgkmcnt(3)
    v_mfma_f32_32x32x16_bf16 v[20:35], v[44:47], v[36:39], v[20:35]
    v_subrev_u32 v10, 98304, v10
    v_subrev_u32 v11, 98304, v11
    v_subrev_u32 v12, 98304, v12
    v_subrev_u32 v13, 98304, v13
    v_subrev_u32 v14, 98304, v14
    v_subrev_u32 v15, 98304, v15
    v_subrev_u32 v16, 98304, v16
    v_subrev_u32 v17, 98304, v17
    s_waitcnt vmcnt(8) lgkmcnt(0)
    s_barrier
    ds_read_b128 v[36:39], v10
    ds_read_b64_tr_b16 v[44:45], v14 offset:0
    ds_read_b64_tr_b16 v[46:47], v14 offset:1024
    v_mfma_f32_32x32x16_bf16 v[20:35], v[48:51], v[40:43], v[20:35]
    s_add_u32 m0, s7, 98304
    s_mov_b32 s4, 155648
    buffer_load_dwordx4 v8, s[12:15], s4 offen lds
    s_add_u32 m0, s7, 106496
    s_mov_b32 s4, 417792
    buffer_load_dwordx4 v8, s[12:15], s4 offen lds
    ds_read_b128 v[40:43], v11
    ds_read_b64_tr_b16 v[48:49], v15 offset:0
    ds_read_b64_tr_b16 v[50:51], v15 offset:1024
    s_waitcnt lgkmcnt(3)
    v_mfma_f32_32x32x16_bf16 v[20:35], v[44:47], v[36:39], v[20:35]
    s_add_u32 m0, s7, 114688
    s_mov_b32 s4, 2490368
    buffer_load_dwordx4 v9, s[16:19], s4 offen lds
    s_add_u32 m0, s7, 122880
    s_mov_b32 s4, 2555904
    buffer_load_dwordx4 v9, s[16:19], s4 offen lds
    ds_read_b128 v[36:39], v12
    ds_read_b64_tr_b16 v[44:45], v16 offset:0
    ds_read_b64_tr_b16 v[46:47], v16 offset:1024
    s_waitcnt lgkmcnt(3)
    v_mfma_f32_32x32x16_bf16 v[20:35], v[48:51], v[40:43], v[20:35]
    ds_read_b128 v[40:43], v13
    ds_read_b64_tr_b16 v[48:49], v17 offset:0
    ds_read_b64_tr_b16 v[50:51], v17 offset:1024
    s_waitcnt lgkmcnt(3)
    v_mfma_f32_32x32x16_bf16 v[20:35], v[44:47], v[36:39], v[20:35]
    v_add_u32 v10, 32768, v10
    v_add_u32 v11, 32768, v11
    v_add_u32 v12, 32768, v12
    v_add_u32 v13, 32768, v13
    v_add_u32 v14, 32768, v14
    v_add_u32 v15, 32768, v15
    v_add_u32 v16, 32768, v16
    v_add_u32 v17, 32768, v17
    s_waitcnt vmcnt(8) lgkmcnt(0)
    s_barrier
    ds_read_b128 v[36:39], v10
    ds_read_b64_tr_b16 v[44:45], v14 offset:0
    ds_read_b64_tr_b16 v[46:47], v14 offset:1024
    v_mfma_f32_32x32x16_bf16 v[20:35], v[48:51], v[40:43], v[20:35]
    s_add_u32 m0, s7, 0
    s_mov_b32 s4, 163840
    buffer_load_dwordx4 v8, s[12:15], s4 offen lds
    s_add_u32 m0, s7, 8192
    s_mov_b32 s4, 425984
    buffer_load_dwordx4 v8, s[12:15], s4 offen lds
    ds_read_b128 v[40:43], v11
    ds_read_b64_tr_b16 v[48:49], v15 offset:0
    ds_read_b64_tr_b16 v[50:51], v15 offset:1024
    s_waitcnt lgkmcnt(3)
    v_mfma_f32_32x32x16_bf16 v[20:35], v[44:47], v[36:39], v[20:35]
    s_add_u32 m0, s7, 16384
    s_mov_b32 s4, 2621440
    buffer_load_dwordx4 v9, s[16:19], s4 offen lds
    s_add_u32 m0, s7, 24576
    s_mov_b32 s4, 2686976
    buffer_load_dwordx4 v9, s[16:19], s4 offen lds
    ds_read_b128 v[36:39], v12
    ds_read_b64_tr_b16 v[44:45], v16 offset:0
    ds_read_b64_tr_b16 v[46:47], v16 offset:1024
    s_waitcnt lgkmcnt(3)
    v_mfma_f32_32x32x16_bf16 v[20:35], v[48:51], v[40:43], v[20:35]
    ds_read_b128 v[40:43], v13
    ds_read_b64_tr_b16 v[48:49], v17 offset:0
    ds_read_b64_tr_b16 v[50:51], v17 offset:1024
    s_waitcnt lgkmcnt(3)
    v_mfma_f32_32x32x16_bf16 v[20:35], v[44:47], v[36:39], v[20:35]
    v_add_u32 v10, 32768, v10
    v_add_u32 v11, 32768, v11
    v_add_u32 v12, 32768, v12
    v_add_u32 v13, 32768, v13
    v_add_u32 v14, 32768, v14
    v_add_u32 v15, 32768, v15
    v_add_u32 v16, 32768, v16
    v_add_u32 v17, 32768, v17
    s_waitcnt vmcnt(8) lgkmcnt(0)
    s_barrier
    ds_read_b128 v[36:39], v10
    ds_read_b64_tr_b16 v[44:45], v14 offset:0
    ds_read_b64_tr_b16 v[46:47], v14 offset:1024
    v_mfma_f32_32x32x16_bf16 v[20:35], v[48:51], v[40:43], v[20:35]
    s_add_u32 m0, s7, 32768
    s_mov_b32 s4, 172032
    buffer_load_dwordx4 v8, s[12:15], s4 offen lds
    s_add_u32 m0, s7, 40960
    s_mov_b32 s4, 434176
    buffer_load_dwordx4 v8, s[12:15], s4 offen lds
    ds_read_b128 v[40:43], v11
    ds_read_b64_tr_b16 v[48:49], v15 offset:0
    ds_read_b64_tr_b16 v[50:51], v15 offset:1024
    s_waitcnt lgkmcnt(3)
    v_mfma_f32_32x32x16_bf16 v[20:35], v[44:47], v[36:39], v[20:35]
    s_add_u32 m0, s7, 49152
    s_mov_b32 s4, 2752512
    buffer_load_dwordx4 v9, s[16:19], s4 offen lds
    s_add_u32 m0, s7, 57344
    s_mov_b32 s4, 2818048
    buffer_load_dwordx4 v9, s[16:19], s4 offen lds
    ds_read_b128 v[36:39], v12
    ds_read_b64_tr_b16 v[44:45], v16 offset:0
    ds_read_b64_tr_b16 v[46:47], v16 offset:1024
    s_waitcnt lgkmcnt(3)
    v_mfma_f32_32x32x16_bf16 v[20:35], v[48:51], v[40:43], v[20:35]
    ds_read_b128 v[40:43], v13
    ds_read_b64_tr_b16 v[48:49], v17 offset:0
    ds_read_b64_tr_b16 v[50:51], v17 offset:1024
    s_waitcnt lgkmcnt(3)
    v_mfma_f32_32x32x16_bf16 v[20:35], v[44:47], v[36:39], v[20:35]
    v_add_u32 v10, 32768, v10
    v_add_u32 v11, 32768, v11
    v_add_u32 v12, 32768, v12
    v_add_u32 v13, 32768, v13
    v_add_u32 v14, 32768, v14
    v_add_u32 v15, 32768, v15
    v_add_u32 v16, 32768, v16
    v_add_u32 v17, 32768, v17
    s_waitcnt vmcnt(8) lgkmcnt(0)
    s_barrier
    ds_read_b128 v[36:39], v10
    ds_read_b64_tr_b16 v[44:45], v14 offset:0
    ds_read_b64_tr_b16 v[46:47], v14 offset:1024
    v_mfma_f32_32x32x16_bf16 v[20:35], v[48:51], v[40:43], v[20:35]
    s_add_u32 m0, s7, 65536
    s_mov_b32 s4, 180224
    buffer_load_dwordx4 v8, s[12:15], s4 offen lds
    s_add_u32 m0, s7, 73728
    s_mov_b32 s4, 442368
    buffer_load_dwordx4 v8, s[12:15], s4 offen lds
    ds_read_b128 v[40:43], v11
    ds_read_b64_tr_b16 v[48:49], v15 offset:0
    ds_read_b64_tr_b16 v[50:51], v15 offset:1024
    s_waitcnt lgkmcnt(3)
    v_mfma_f32_32x32x16_bf16 v[20:35], v[44:47], v[36:39], v[20:35]
    s_add_u32 m0, s7, 81920
    s_mov_b32 s4, 2883584
    buffer_load_dwordx4 v9, s[16:19], s4 offen lds
    s_add_u32 m0, s7, 90112
    s_mov_b32 s4, 2949120
    buffer_load_dwordx4 v9, s[16:19], s4 offen lds
    ds_read_b128 v[36:39], v12
    ds_read_b64_tr_b16 v[44:45], v16 offset:0
    ds_read_b64_tr_b16 v[46:47], v16 offset:1024
    s_waitcnt lgkmcnt(3)
    v_mfma_f32_32x32x16_bf16 v[20:35], v[48:51], v[40:43], v[20:35]
    ds_read_b128 v[40:43], v13
    ds_read_b64_tr_b16 v[48:49], v17 offset:0
    ds_read_b64_tr_b16 v[50:51], v17 offset:1024
    s_waitcnt lgkmcnt(3)
    v_mfma_f32_32x32x16_bf16 v[20:35], v[44:47], v[36:39], v[20:35]
    v_subrev_u32 v10, 98304, v10
    v_subrev_u32 v11, 98304, v11
    v_subrev_u32 v12, 98304, v12
    v_subrev_u32 v13, 98304, v13
    v_subrev_u32 v14, 98304, v14
    v_subrev_u32 v15, 98304, v15
    v_subrev_u32 v16, 98304, v16
    v_subrev_u32 v17, 98304, v17
    s_waitcnt vmcnt(8) lgkmcnt(0)
    s_barrier
    ds_read_b128 v[36:39], v10
    ds_read_b64_tr_b16 v[44:45], v14 offset:0
    ds_read_b64_tr_b16 v[46:47], v14 offset:1024
    v_mfma_f32_32x32x16_bf16 v[20:35], v[48:51], v[40:43], v[20:35]
    s_add_u32 m0, s7, 98304
    s_mov_b32 s4, 188416
    buffer_load_dwordx4 v8, s[12:15], s4 offen lds
    s_add_u32 m0, s7, 106496
    s_mov_b32 s4, 450560
    buffer_load_dwordx4 v8, s[12:15], s4 offen lds
    ds_read_b128 v[40:43], v11
    ds_read_b64_tr_b16 v[48:49], v15 offset:0
    ds_read_b64_tr_b16 v[50:51], v15 offset:1024
    s_waitcnt lgkmcnt(3)
    v_mfma_f32_32x32x16_bf16 v[20:35], v[44:47], v[36:39], v[20:35]
    s_add_u32 m0, s7, 114688
    s_mov_b32 s4, 3014656
    buffer_load_dwordx4 v9, s[16:19], s4 offen lds
    s_add_u32 m0, s7, 122880
    s_mov_b32 s4, 3080192
    buffer_load_dwordx4 v9, s[16:19], s4 offen lds
    ds_read_b128 v[36:39], v12
    ds_read_b64_tr_b16 v[44:45], v16 offset:0
    ds_read_b64_tr_b16 v[46:47], v16 offset:1024
    s_waitcnt lgkmcnt(3)
    v_mfma_f32_32x32x16_bf16 v[20:35], v[48:51], v[40:43], v[20:35]
    ds_read_b128 v[40:43], v13
    ds_read_b64_tr_b16 v[48:49], v17 offset:0
    ds_read_b64_tr_b16 v[50:51], v17 offset:1024
    s_waitcnt lgkmcnt(3)
    v_mfma_f32_32x32x16_bf16 v[20:35], v[44:47], v[36:39], v[20:35]
    v_add_u32 v10, 32768, v10
    v_add_u32 v11, 32768, v11
    v_add_u32 v12, 32768, v12
    v_add_u32 v13, 32768, v13
    v_add_u32 v14, 32768, v14
    v_add_u32 v15, 32768, v15
    v_add_u32 v16, 32768, v16
    v_add_u32 v17, 32768, v17
    s_waitcnt vmcnt(8) lgkmcnt(0)
    s_barrier
    ds_read_b128 v[36:39], v10
    ds_read_b64_tr_b16 v[44:45], v14 offset:0
    ds_read_b64_tr_b16 v[46:47], v14 offset:1024
    v_mfma_f32_32x32x16_bf16 v[20:35], v[48:51], v[40:43], v[20:35]
    s_add_u32 m0, s7, 0
    s_mov_b32 s4, 196608
    buffer_load_dwordx4 v8, s[12:15], s4 offen lds
    s_add_u32 m0, s7, 8192
    s_mov_b32 s4, 458752
    buffer_load_dwordx4 v8, s[12:15], s4 offen lds
    ds_read_b128 v[40:43], v11
    ds_read_b64_tr_b16 v[48:49], v15 offset:0
    ds_read_b64_tr_b16 v[50:51], v15 offset:1024
    s_waitcnt lgkmcnt(3)
    v_mfma_f32_32x32x16_bf16 v[20:35], v[44:47], v[36:39], v[20:35]
    s_add_u32 m0, s7, 16384
    s_mov_b32 s4, 3145728
    buffer_load_dwordx4 v9, s[16:19], s4 offen lds
    s_add_u32 m0, s7, 24576
    s_mov_b32 s4, 3211264
    buffer_load_dwordx4 v9, s[16:19], s4 offen lds
    ds_read_b128 v[36:39], v12
    ds_read_b64_tr_b16 v[44:45], v16 offset:0
    ds_read_b64_tr_b16 v[46:47], v16 offset:1024
    s_waitcnt lgkmcnt(3)
    v_mfma_f32_32x32x16_bf16 v[20:35], v[48:51], v[40:43], v[20:35]
    ds_read_b128 v[40:43], v13
    ds_read_b64_tr_b16 v[48:49], v17 offset:0
    ds_read_b64_tr_b16 v[50:51], v17 offset:1024
    s_waitcnt lgkmcnt(3)
    v_mfma_f32_32x32x16_bf16 v[20:35], v[44:47], v[36:39], v[20:35]
    v_add_u32 v10, 32768, v10
    v_add_u32 v11, 32768, v11
    v_add_u32 v12, 32768, v12
    v_add_u32 v13, 32768, v13
    v_add_u32 v14, 32768, v14
    v_add_u32 v15, 32768, v15
    v_add_u32 v16, 32768, v16
    v_add_u32 v17, 32768, v17
    s_waitcnt vmcnt(8) lgkmcnt(0)
    s_barrier
    ds_read_b128 v[36:39], v10
    ds_read_b64_tr_b16 v[44:45], v14 offset:0
    ds_read_b64_tr_b16 v[46:47], v14 offset:1024
    v_mfma_f32_32x32x16_bf16 v[20:35], v[48:51], v[40:43], v[20:35]
    s_add_u32 m0, s7, 32768
    s_mov_b32 s4, 204800
    buffer_load_dwordx4 v8, s[12:15], s4 offen lds
    s_add_u32 m0, s7, 40960
    s_mov_b32 s4, 466944
    buffer_load_dwordx4 v8, s[12:15], s4 offen lds
    ds_read_b128 v[40:43], v11
    ds_read_b64_tr_b16 v[48:49], v15 offset:0
    ds_read_b64_tr_b16 v[50:51], v15 offset:1024
    s_waitcnt lgkmcnt(3)
    v_mfma_f32_32x32x16_bf16 v[20:35], v[44:47], v[36:39], v[20:35]
    s_add_u32 m0, s7, 49152
    s_mov_b32 s4, 3276800
    buffer_load_dwordx4 v9, s[16:19], s4 offen lds
    s_add_u32 m0, s7, 57344
    s_mov_b32 s4, 3342336
    buffer_load_dwordx4 v9, s[16:19], s4 offen lds
    ds_read_b128 v[36:39], v12
    ds_read_b64_tr_b16 v[44:45], v16 offset:0
    ds_read_b64_tr_b16 v[46:47], v16 offset:1024
    s_waitcnt lgkmcnt(3)
    v_mfma_f32_32x32x16_bf16 v[20:35], v[48:51], v[40:43], v[20:35]
    ds_read_b128 v[40:43], v13
    ds_read_b64_tr_b16 v[48:49], v17 offset:0
    ds_read_b64_tr_b16 v[50:51], v17 offset:1024
    s_waitcnt lgkmcnt(3)
    v_mfma_f32_32x32x16_bf16 v[20:35], v[44:47], v[36:39], v[20:35]
    v_add_u32 v10, 32768, v10
    v_add_u32 v11, 32768, v11
    v_add_u32 v12, 32768, v12
    v_add_u32 v13, 32768, v13
    v_add_u32 v14, 32768, v14
    v_add_u32 v15, 32768, v15
    v_add_u32 v16, 32768, v16
    v_add_u32 v17, 32768, v17
    s_waitcnt vmcnt(8) lgkmcnt(0)
    s_barrier
    ds_read_b128 v[36:39], v10
    ds_read_b64_tr_b16 v[44:45], v14 offset:0
    ds_read_b64_tr_b16 v[46:47], v14 offset:1024
    v_mfma_f32_32x32x16_bf16 v[20:35], v[48:51], v[40:43], v[20:35]
    s_add_u32 m0, s7, 65536
    s_mov_b32 s4, 212992
    buffer_load_dwordx4 v8, s[12:15], s4 offen lds
    s_add_u32 m0, s7, 73728
    s_mov_b32 s4, 475136
    buffer_load_dwordx4 v8, s[12:15], s4 offen lds
    ds_read_b128 v[40:43], v11
    ds_read_b64_tr_b16 v[48:49], v15 offset:0
    ds_read_b64_tr_b16 v[50:51], v15 offset:1024
    s_waitcnt lgkmcnt(3)
    v_mfma_f32_32x32x16_bf16 v[20:35], v[44:47], v[36:39], v[20:35]
    s_add_u32 m0, s7, 81920
    s_mov_b32 s4, 3407872
    buffer_load_dwordx4 v9, s[16:19], s4 offen lds
    s_add_u32 m0, s7, 90112
    s_mov_b32 s4, 3473408
    buffer_load_dwordx4 v9, s[16:19], s4 offen lds
    ds_read_b128 v[36:39], v12
    ds_read_b64_tr_b16 v[44:45], v16 offset:0
    ds_read_b64_tr_b16 v[46:47], v16 offset:1024
    s_waitcnt lgkmcnt(3)
    v_mfma_f32_32x32x16_bf16 v[20:35], v[48:51], v[40:43], v[20:35]
    ds_read_b128 v[40:43], v13
    ds_read_b64_tr_b16 v[48:49], v17 offset:0
    ds_read_b64_tr_b16 v[50:51], v17 offset:1024
    s_waitcnt lgkmcnt(3)
    v_mfma_f32_32x32x16_bf16 v[20:35], v[44:47], v[36:39], v[20:35]
    v_subrev_u32 v10, 98304, v10
    v_subrev_u32 v11, 98304, v11
    v_subrev_u32 v12, 98304, v12
    v_subrev_u32 v13, 98304, v13
    v_subrev_u32 v14, 98304, v14
    v_subrev_u32 v15, 98304, v15
    v_subrev_u32 v16, 98304, v16
    v_subrev_u32 v17, 98304, v17
    s_waitcnt vmcnt(8) lgkmcnt(0)
    s_barrier
    ds_read_b128 v[36:39], v10
    ds_read_b64_tr_b16 v[44:45], v14 offset:0
    ds_read_b64_tr_b16 v[46:47], v14 offset:1024
    v_mfma_f32_32x32x16_bf16 v[20:35], v[48:51], v[40:43], v[20:35]
    s_add_u32 m0, s7, 98304
    s_mov_b32 s4, 221184
    buffer_load_dwordx4 v8, s[12:15], s4 offen lds
    s_add_u32 m0, s7, 106496
    s_mov_b32 s4, 483328
    buffer_load_dwordx4 v8, s[12:15], s4 offen lds
    ds_read_b128 v[40:43], v11
    ds_read_b64_tr_b16 v[48:49], v15 offset:0
    ds_read_b64_tr_b16 v[50:51], v15 offset:1024
    s_waitcnt lgkmcnt(3)
    v_mfma_f32_32x32x16_bf16 v[20:35], v[44:47], v[36:39], v[20:35]
    s_add_u32 m0, s7, 114688
    s_mov_b32 s4, 3538944
    buffer_load_dwordx4 v9, s[16:19], s4 offen lds
    s_add_u32 m0, s7, 122880
    s_mov_b32 s4, 3604480
    buffer_load_dwordx4 v9, s[16:19], s4 offen lds
    ds_read_b128 v[36:39], v12
    ds_read_b64_tr_b16 v[44:45], v16 offset:0
    ds_read_b64_tr_b16 v[46:47], v16 offset:1024
    s_waitcnt lgkmcnt(3)
    v_mfma_f32_32x32x16_bf16 v[20:35], v[48:51], v[40:43], v[20:35]
    ds_read_b128 v[40:43], v13
    ds_read_b64_tr_b16 v[48:49], v17 offset:0
    ds_read_b64_tr_b16 v[50:51], v17 offset:1024
    s_waitcnt lgkmcnt(3)
    v_mfma_f32_32x32x16_bf16 v[20:35], v[44:47], v[36:39], v[20:35]
    v_add_u32 v10, 32768, v10
    v_add_u32 v11, 32768, v11
    v_add_u32 v12, 32768, v12
    v_add_u32 v13, 32768, v13
    v_add_u32 v14, 32768, v14
    v_add_u32 v15, 32768, v15
    v_add_u32 v16, 32768, v16
    v_add_u32 v17, 32768, v17
    s_waitcnt vmcnt(8) lgkmcnt(0)
    s_barrier
    ds_read_b128 v[36:39], v10
    ds_read_b64_tr_b16 v[44:45], v14 offset:0
    ds_read_b64_tr_b16 v[46:47], v14 offset:1024
    v_mfma_f32_32x32x16_bf16 v[20:35], v[48:51], v[40:43], v[20:35]
    s_add_u32 m0, s7, 0
    s_mov_b32 s4, 229376
    buffer_load_dwordx4 v8, s[12:15], s4 offen lds
    s_add_u32 m0, s7, 8192
    s_mov_b32 s4, 491520
    buffer_load_dwordx4 v8, s[12:15], s4 offen lds
    ds_read_b128 v[40:43], v11
    ds_read_b64_tr_b16 v[48:49], v15 offset:0
    ds_read_b64_tr_b16 v[50:51], v15 offset:1024
    s_waitcnt lgkmcnt(3)
    v_mfma_f32_32x32x16_bf16 v[20:35], v[44:47], v[36:39], v[20:35]
    s_add_u32 m0, s7, 16384
    s_mov_b32 s4, 3670016
    buffer_load_dwordx4 v9, s[16:19], s4 offen lds
    s_add_u32 m0, s7, 24576
    s_mov_b32 s4, 3735552
    buffer_load_dwordx4 v9, s[16:19], s4 offen lds
    ds_read_b128 v[36:39], v12
    ds_read_b64_tr_b16 v[44:45], v16 offset:0
    ds_read_b64_tr_b16 v[46:47], v16 offset:1024
    s_waitcnt lgkmcnt(3)
    v_mfma_f32_32x32x16_bf16 v[20:35], v[48:51], v[40:43], v[20:35]
    ds_read_b128 v[40:43], v13
    ds_read_b64_tr_b16 v[48:49], v17 offset:0
    ds_read_b64_tr_b16 v[50:51], v17 offset:1024
    s_waitcnt lgkmcnt(3)
    v_mfma_f32_32x32x16_bf16 v[20:35], v[44:47], v[36:39], v[20:35]
    v_add_u32 v10, 32768, v10
    v_add_u32 v11, 32768, v11
    v_add_u32 v12, 32768, v12
    v_add_u32 v13, 32768, v13
    v_add_u32 v14, 32768, v14
    v_add_u32 v15, 32768, v15
    v_add_u32 v16, 32768, v16
    v_add_u32 v17, 32768, v17
    s_waitcnt vmcnt(8) lgkmcnt(0)
    s_barrier
    ds_read_b128 v[36:39], v10
    ds_read_b64_tr_b16 v[44:45], v14 offset:0
    ds_read_b64_tr_b16 v[46:47], v14 offset:1024
    v_mfma_f32_32x32x16_bf16 v[20:35], v[48:51], v[40:43], v[20:35]
    s_add_u32 m0, s7, 32768
    s_mov_b32 s4, 237568
    buffer_load_dwordx4 v8, s[12:15], s4 offen lds
    s_add_u32 m0, s7, 40960
    s_mov_b32 s4, 499712
    buffer_load_dwordx4 v8, s[12:15], s4 offen lds
    ds_read_b128 v[40:43], v11
    ds_read_b64_tr_b16 v[48:49], v15 offset:0
    ds_read_b64_tr_b16 v[50:51], v15 offset:1024
    s_waitcnt lgkmcnt(3)
    v_mfma_f32_32x32x16_bf16 v[20:35], v[44:47], v[36:39], v[20:35]
    s_add_u32 m0, s7, 49152
    s_mov_b32 s4, 3801088
    buffer_load_dwordx4 v9, s[16:19], s4 offen lds
    s_add_u32 m0, s7, 57344
    s_mov_b32 s4, 3866624
    buffer_load_dwordx4 v9, s[16:19], s4 offen lds
    ds_read_b128 v[36:39], v12
    ds_read_b64_tr_b16 v[44:45], v16 offset:0
    ds_read_b64_tr_b16 v[46:47], v16 offset:1024
    s_waitcnt lgkmcnt(3)
    v_mfma_f32_32x32x16_bf16 v[20:35], v[48:51], v[40:43], v[20:35]
    ds_read_b128 v[40:43], v13
    ds_read_b64_tr_b16 v[48:49], v17 offset:0
    ds_read_b64_tr_b16 v[50:51], v17 offset:1024
    s_waitcnt lgkmcnt(3)
    v_mfma_f32_32x32x16_bf16 v[20:35], v[44:47], v[36:39], v[20:35]
    v_add_u32 v10, 32768, v10
    v_add_u32 v11, 32768, v11
    v_add_u32 v12, 32768, v12
    v_add_u32 v13, 32768, v13
    v_add_u32 v14, 32768, v14
    v_add_u32 v15, 32768, v15
    v_add_u32 v16, 32768, v16
    v_add_u32 v17, 32768, v17
    s_waitcnt vmcnt(8) lgkmcnt(0)
    s_barrier
    ds_read_b128 v[36:39], v10
    ds_read_b64_tr_b16 v[44:45], v14 offset:0
    ds_read_b64_tr_b16 v[46:47], v14 offset:1024
    v_mfma_f32_32x32x16_bf16 v[20:35], v[48:51], v[40:43], v[20:35]
    s_add_u32 m0, s7, 65536
    s_mov_b32 s4, 245760
    buffer_load_dwordx4 v8, s[12:15], s4 offen lds
    s_add_u32 m0, s7, 73728
    s_mov_b32 s4, 507904
    buffer_load_dwordx4 v8, s[12:15], s4 offen lds
    ds_read_b128 v[40:43], v11
    ds_read_b64_tr_b16 v[48:49], v15 offset:0
    ds_read_b64_tr_b16 v[50:51], v15 offset:1024
    s_waitcnt lgkmcnt(3)
    v_mfma_f32_32x32x16_bf16 v[20:35], v[44:47], v[36:39], v[20:35]
    s_add_u32 m0, s7, 81920
    s_mov_b32 s4, 3932160
    buffer_load_dwordx4 v9, s[16:19], s4 offen lds
    s_add_u32 m0, s7, 90112
    s_mov_b32 s4, 3997696
    buffer_load_dwordx4 v9, s[16:19], s4 offen lds
    ds_read_b128 v[36:39], v12
    ds_read_b64_tr_b16 v[44:45], v16 offset:0
    ds_read_b64_tr_b16 v[46:47], v16 offset:1024
    s_waitcnt lgkmcnt(3)
    v_mfma_f32_32x32x16_bf16 v[20:35], v[48:51], v[40:43], v[20:35]
    ds_read_b128 v[40:43], v13
    ds_read_b64_tr_b16 v[48:49], v17 offset:0
    ds_read_b64_tr_b16 v[50:51], v17 offset:1024
    s_waitcnt lgkmcnt(3)
    v_mfma_f32_32x32x16_bf16 v[20:35], v[44:47], v[36:39], v[20:35]
    v_subrev_u32 v10, 98304, v10
    v_subrev_u32 v11, 98304, v11
    v_subrev_u32 v12, 98304, v12
    v_subrev_u32 v13, 98304, v13
    v_subrev_u32 v14, 98304, v14
    v_subrev_u32 v15, 98304, v15
    v_subrev_u32 v16, 98304, v16
    v_subrev_u32 v17, 98304, v17
    s_waitcnt vmcnt(8) lgkmcnt(0)
    s_barrier
    ds_read_b128 v[36:39], v10
    ds_read_b64_tr_b16 v[44:45], v14 offset:0
    ds_read_b64_tr_b16 v[46:47], v14 offset:1024
    v_mfma_f32_32x32x16_bf16 v[20:35], v[48:51], v[40:43], v[20:35]
    s_add_u32 m0, s7, 98304
    s_mov_b32 s4, 253952
    buffer_load_dwordx4 v8, s[12:15], s4 offen lds
    s_add_u32 m0, s7, 106496
    s_mov_b32 s4, 516096
    buffer_load_dwordx4 v8, s[12:15], s4 offen lds
    ds_read_b128 v[40:43], v11
    ds_read_b64_tr_b16 v[48:49], v15 offset:0
    ds_read_b64_tr_b16 v[50:51], v15 offset:1024
    s_waitcnt lgkmcnt(3)
    v_mfma_f32_32x32x16_bf16 v[20:35], v[44:47], v[36:39], v[20:35]
    s_add_u32 m0, s7, 114688
    s_mov_b32 s4, 4063232
    buffer_load_dwordx4 v9, s[16:19], s4 offen lds
    s_add_u32 m0, s7, 122880
    s_mov_b32 s4, 4128768
    buffer_load_dwordx4 v9, s[16:19], s4 offen lds
    ds_read_b128 v[36:39], v12
    ds_read_b64_tr_b16 v[44:45], v16 offset:0
    ds_read_b64_tr_b16 v[46:47], v16 offset:1024
    s_waitcnt lgkmcnt(3)
    v_mfma_f32_32x32x16_bf16 v[20:35], v[48:51], v[40:43], v[20:35]
    ds_read_b128 v[40:43], v13
    ds_read_b64_tr_b16 v[48:49], v17 offset:0
    ds_read_b64_tr_b16 v[50:51], v17 offset:1024
    s_waitcnt lgkmcnt(3)
    v_mfma_f32_32x32x16_bf16 v[20:35], v[44:47], v[36:39], v[20:35]
    v_add_u32 v10, 32768, v10
    v_add_u32 v11, 32768, v11
    v_add_u32 v12, 32768, v12
    v_add_u32 v13, 32768, v13
    v_add_u32 v14, 32768, v14
    v_add_u32 v15, 32768, v15
    v_add_u32 v16, 32768, v16
    v_add_u32 v17, 32768, v17
    s_waitcnt vmcnt(8) lgkmcnt(0)
    s_barrier
    ds_read_b128 v[36:39], v10
    ds_read_b64_tr_b16 v[44:45], v14 offset:0
    ds_read_b64_tr_b16 v[46:47], v14 offset:1024
    v_mfma_f32_32x32x16_bf16 v[20:35], v[48:51], v[40:43], v[20:35]
    ds_read_b128 v[40:43], v11
    ds_read_b64_tr_b16 v[48:49], v15 offset:0
    ds_read_b64_tr_b16 v[50:51], v15 offset:1024
    s_waitcnt lgkmcnt(3)
    v_mfma_f32_32x32x16_bf16 v[20:35], v[44:47], v[36:39], v[20:35]
    ds_read_b128 v[36:39], v12
    ds_read_b64_tr_b16 v[44:45], v16 offset:0
    ds_read_b64_tr_b16 v[46:47], v16 offset:1024
    s_waitcnt lgkmcnt(3)
    v_mfma_f32_32x32x16_bf16 v[20:35], v[48:51], v[40:43], v[20:35]
    ds_read_b128 v[40:43], v13
    ds_read_b64_tr_b16 v[48:49], v17 offset:0
    ds_read_b64_tr_b16 v[50:51], v17 offset:1024
    s_waitcnt lgkmcnt(3)
    v_mfma_f32_32x32x16_bf16 v[20:35], v[44:47], v[36:39], v[20:35]
    v_add_u32 v10, 32768, v10
    v_add_u32 v11, 32768, v11
    v_add_u32 v12, 32768, v12
    v_add_u32 v13, 32768, v13
    v_add_u32 v14, 32768, v14
    v_add_u32 v15, 32768, v15
    v_add_u32 v16, 32768, v16
    v_add_u32 v17, 32768, v17
    s_waitcnt vmcnt(4) lgkmcnt(0)
    s_barrier
    ds_read_b128 v[36:39], v10
    ds_read_b64_tr_b16 v[44:45], v14 offset:0
    ds_read_b64_tr_b16 v[46:47], v14 offset:1024
    v_mfma_f32_32x32x16_bf16 v[20:35], v[48:51], v[40:43], v[20:35]
    ds_read_b128 v[40:43], v11
    ds_read_b64_tr_b16 v[48:49], v15 offset:0
    ds_read_b64_tr_b16 v[50:51], v15 offset:1024
    s_waitcnt lgkmcnt(3)
    v_mfma_f32_32x32x16_bf16 v[20:35], v[44:47], v[36:39], v[20:35]
    ds_read_b128 v[36:39], v12
    ds_read_b64_tr_b16 v[44:45], v16 offset:0
    ds_read_b64_tr_b16 v[46:47], v16 offset:1024
    s_waitcnt lgkmcnt(3)
    v_mfma_f32_32x32x16_bf16 v[20:35], v[48:51], v[40:43], v[20:35]
    ds_read_b128 v[40:43], v13
    ds_read_b64_tr_b16 v[48:49], v17 offset:0
    ds_read_b64_tr_b16 v[50:51], v17 offset:1024
    s_waitcnt lgkmcnt(3)
    v_mfma_f32_32x32x16_bf16 v[20:35], v[44:47], v[36:39], v[20:35]
    v_add_u32 v10, 32768, v10
    v_add_u32 v11, 32768, v11
    v_add_u32 v12, 32768, v12
    v_add_u32 v13, 32768, v13
    v_add_u32 v14, 32768, v14
    v_add_u32 v15, 32768, v15
    v_add_u32 v16, 32768, v16
    v_add_u32 v17, 32768, v17
    s_waitcnt vmcnt(0) lgkmcnt(0)
    s_barrier
    ds_read_b128 v[36:39], v10
    ds_read_b64_tr_b16 v[44:45], v14 offset:0
    ds_read_b64_tr_b16 v[46:47], v14 offset:1024
    v_mfma_f32_32x32x16_bf16 v[20:35], v[48:51], v[40:43], v[20:35]
    ds_read_b128 v[40:43], v11
    ds_read_b64_tr_b16 v[48:49], v15 offset:0
    ds_read_b64_tr_b16 v[50:51], v15 offset:1024
    s_waitcnt lgkmcnt(3)
    v_mfma_f32_32x32x16_bf16 v[20:35], v[44:47], v[36:39], v[20:35]
    ds_read_b128 v[36:39], v12
    ds_read_b64_tr_b16 v[44:45], v16 offset:0
    ds_read_b64_tr_b16 v[46:47], v16 offset:1024
    s_waitcnt lgkmcnt(3)
    v_mfma_f32_32x32x16_bf16 v[20:35], v[48:51], v[40:43], v[20:35]
    ds_read_b128 v[40:43], v13
    ds_read_b64_tr_b16 v[48:49], v17 offset:0
    ds_read_b64_tr_b16 v[50:51], v17 offset:1024
    s_waitcnt lgkmcnt(3)
    v_mfma_f32_32x32x16_bf16 v[20:35], v[44:47], v[36:39], v[20:35]
    s_waitcnt lgkmcnt(0)
    v_mfma_f32_32x32x16_bf16 v[20:35], v[48:51], v[40:43], v[20:35]
    s_lshl_b32 s8, s96, 5
    s_add_u32 s8, s8, s93
    v_add_u32 v6, s8, v2
    v_lshlrev_b32 v6, 10, v6
    v_lshl_add_u32 v6, v3, 3, v6
    s_lshl_b32 s8, s97, 5
    s_add_u32 s8, s8, s6
    s_lshl_b32 s8, s8, 1
    s_lshl_b32 s9, s98, 5
    s_add_u32 s8, s8, s9
    v_add_u32 v6, s8, v6
    buffer_load_dwordx2 v[60:61], v6, s[24:27], 0 offen offset:0
    buffer_load_dwordx2 v[62:63], v6, s[24:27], 0 offen offset:16
    v_lshlrev_b32 v4, 4, v1
    s_lshl_b32 s8, s3, 11
    s_add_u32 s8, s8, 131072
    v_add_u32 v5, s8, v4
    s_xor_b32 s9, s3, 4
    s_lshl_b32 s9, s9, 11
    s_add_u32 s9, s9, 131072
    v_add_u32 v4, s9, v4
    s_cmp_eq_u32 s98, 1
    s_cbranch_scc1 red_21
    ds_write_b128 v5, v[28:31] offset:0
    ds_write_b128 v5, v[32:35] offset:1024
    s_branch red_22
red_21:
    ds_write_b128 v5, v[20:23] offset:0
    ds_write_b128 v5, v[24:27] offset:1024
    v_mov_b32 v20, v28
    v_mov_b32 v21, v29
    v_mov_b32 v22, v30
    v_mov_b32 v23, v31
    v_mov_b32 v24, v32
    v_mov_b32 v25, v33
    v_mov_b32 v26, v34
    v_mov_b32 v27, v35
    s_nop 0
red_22:
    s_waitcnt lgkmcnt(0)
    s_barrier
    ds_read_b128 v[64:67], v4 offset:0
    ds_read_b128 v[68:71], v4 offset:1024
    s_waitcnt vmcnt(0) lgkmcnt(0)
    v_lshlrev_b32 v4, 16, v60
    v_and_b32 v60, 0xffff0000, v60
    v_add_f32 v20, v20, v64
    v_add_f32 v21, v21, v65
    v_add_f32 v20, v20, v4
    v_add_f32 v21, v21, v60
    v_cvt_pk_bf16_f32 v60, v20, v21
    v_lshlrev_b32 v4, 16, v61
    v_and_b32 v61, 0xffff0000, v61
    v_add_f32 v22, v22, v66
    v_add_f32 v23, v23, v67
    v_add_f32 v22, v22, v4
    v_add_f32 v23, v23, v61
    v_cvt_pk_bf16_f32 v61, v22, v23
    buffer_store_dwordx2 v[60:61], v6, s[20:23], 0 offen offset:0
    v_lshlrev_b32 v4, 16, v62
    v_and_b32 v62, 0xffff0000, v62
    v_add_f32 v24, v24, v68
    v_add_f32 v25, v25, v69
    v_add_f32 v24, v24, v4
    v_add_f32 v25, v25, v62
    v_cvt_pk_bf16_f32 v62, v24, v25
    v_lshlrev_b32 v4, 16, v63
    v_and_b32 v63, 0xffff0000, v63
    v_add_f32 v26, v26, v70
    v_add_f32 v27, v27, v71
    v_add_f32 v26, v26, v4
    v_add_f32 v27, v27, v63
    v_cvt_pk_bf16_f32 v63, v26, v27
    buffer_store_dwordx2 v[62:63], v6, s[20:23], 0 offen offset:16
    v_lshlrev_b32 v20, 16, v60
    v_and_b32 v21, 0xffff0000, v60
    v_lshlrev_b32 v22, 16, v61
    v_and_b32 v23, 0xffff0000, v61
    v_lshlrev_b32 v24, 16, v62
    v_and_b32 v25, 0xffff0000, v62
    v_lshlrev_b32 v26, 16, v63
    v_and_b32 v27, 0xffff0000, v63
    v_add_f32 v64, v20, v21
    v_mul_f32 v65, v20, v20
    v_fma_f32 v65, v21, v21, v65
    v_add_f32 v64, v64, v22
    v_fma_f32 v65, v22, v22, v65
    v_add_f32 v64, v64, v23
    v_fma_f32 v65, v23, v23, v65
    v_add_f32 v64, v64, v24
    v_fma_f32 v65, v24, v24, v65
    v_add_f32 v64, v64, v25
    v_fma_f32 v65, v25, v25, v65
    v_add_f32 v64, v64, v26
    v_fma_f32 v65, v26, v26, v65
    v_add_f32 v64, v64, v27
    v_fma_f32 v65, v27, v27, v65
    v_mov_b32 v4, v64
    s_nop 1
    v_permlane32_swap_b32 v64, v4
    v_add_f32 v64, v64, v4
    v_mov_b32 v4, v65
    s_nop 1
    v_permlane32_swap_b32 v65, v4
    v_add_f32 v65, v65, v4
    v_lshlrev_b32 v4, 3, v2
    s_lshl_b32 s8, s3, 8
    s_add_u32 s8, s8, 147456
    v_add_u32 v5, s8, v4
    ds_write_b64 v5, v[64:65]
    s_waitcnt lgkmcnt(0)
    s_barrier
    s_and_b32 s9, s3, 5
    s_cmp_lg_u32 s9, 0
    s_cbranch_scc1 red_23
    ds_read_b64 v[66:67], v5 offset:256
    ds_read_b64 v[68:69], v5 offset:1024
    ds_read_b64 v[70:71], v5 offset:1280
    s_waitcnt lgkmcnt(0)
    v_add_f32 v64, v64, v66
    v_add_f32 v65, v65, v67
    v_add_f32 v64, v64, v68
    v_add_f32 v65, v65, v69
    v_add_f32 v64, v64, v70
    v_add_f32 v65, v65, v71
    s_lshl_b32 s8, s96, 5
    s_add_u32 s8, s8, s93
    v_add_u32 v4, s8, v2
    v_lshlrev_b32 v4, 6, v4
    s_lshr_b32 s8, s6, 3
    v_add_u32 v4, s8, v4
    buffer_store_dwordx2 v[64:65], v4, s[28:31], 0 offen
red_23:
k3_oproj_kernel_end:
    s_endpgm
.section .rodata,"a"
.p2align 6
.amdhsa_kernel k3_oproj_kernel
  .amdhsa_next_free_vgpr 72
  .amdhsa_next_free_sgpr 102
  .amdhsa_accum_offset 72
  .amdhsa_group_segment_fixed_size 0
  .amdhsa_kernarg_size 104
  .amdhsa_user_sgpr_count 2
  .amdhsa_user_sgpr_kernarg_segment_ptr 1
  .amdhsa_system_sgpr_workgroup_id_x 1
.end_amdhsa_kernel
.text
.globl k4_glu_kernel
.p2align 8
.type k4_glu_kernel,@function
k4_glu_kernel:
    s_cmp_ge_u32 s2, 224
    s_cbranch_scc1 k4_glu_kernel_end
    s_load_dwordx2 s[12:13], s[0:1], 96
    s_load_dwordx2 s[16:17], s[0:1], 56
    s_load_dwordx2 s[20:21], s[0:1], 64
    s_load_dwordx2 s[24:25], s[0:1], 96
    s_load_dwordx2 s[28:29], s[0:1], 96
    s_lshr_b32 s6, s2, 3
    s_lshl_b32 s6, s6, 6
    s_and_b32 s5, s2, 7
    s_lshl_b32 s5, s5, 8
    v_and_b32 v1, 63, v0
    v_lshrrev_b32 v4, 6, v0
    s_nop 0
    v_readfirstlane_b32 s3, v4
    v_and_b32 v2, 31, v0
    v_bfe_u32 v3, v0, 5, 1
    s_and_b32 s97, s3, 1
    s_lshr_b32 s8, s3, 1
    s_and_b32 s96, s8, 3
    s_lshr_b32 s98, s8, 2
    s_lshl_b32 s7, s3, 10
    s_mov_b32 s93, s5
    v_lshrrev_b32 v4, 3, v1
    s_mul_i32 s8, s3, 8
    v_add_u32 v4, s8, v4
    v_lshrrev_b32 v5, 1, v4
    v_and_b32 v5, 7, v5
    v_and_b32 v6, 7, v1
    v_xor_b32 v5, v5, v6
    v_lshlrev_b32 v5, 4, v5
    v_add_u32 v4, s5, v4
    s_mov_b32 s8, 1024
    v_mul_lo_u32 v4, v4, s8
    v_add_u32 v8, v4, v5
    v_lshrrev_b32 v4, 3, v1
    v_bfe_u32 v5, v4, 1, 1
    v_lshlrev_b32 v5, 2, v5
    v_and_b32 v6, 7, v1
    v_xor_b32 v5, v5, v6
    v_lshlrev_b32 v5, 4, v5
    s_mul_i32 s8, s3, 8
    v_add_u32 v4, s8, v4
    s_mov_b32 s8, 3584
    v_mul_lo_u32 v4, v4, s8
    v_add_u32 v4, v4, v5
    s_lshl_b32 s8, s6, 1
    v_add_u32 v9, s8, v4
    v_lshrrev_b32 v4, 3, v1
    v_bfe_u32 v5, v4, 1, 1
    v_lshlrev_b32 v5, 2, v5
    v_and_b32 v6, 7, v1
    v_xor_b32 v5, v5, v6
    v_lshlrev_b32 v5, 4, v5
    s_mul_i32 s8, s3, 8
    v_add_u32 v4, s8, v4
    s_mov_b32 s8, 3584
    v_mul_lo_u32 v4, v4, s8
    v_add_u32 v4, v4, v5
    s_lshl_b32 s8, s6, 1
    v_add_u32 v10, s8, v4
    s_waitcnt lgkmcnt(0)
    s_add_u32 s12, s12, 67108864
    s_addc_u32 s13, s13, 0
    s_and_b32 s13, s13, 0xffff
    s_mov_b32 s14, 2097152
    s_mov_b32 s15, 0x00020000
    s_and_b32 s17, s17, 0xffff
    s_mov_b32 s18, 1835008
    s_mov_b32 s19, 0x00020000
    s_and_b32 s21, s21, 0xffff
    s_mov_b32 s22, 1835008
    s_mov_b32 s23, 0x00020000
    s_add_u32 s24, s24, 69206016
    s_addc_u32 s25, s25, 0
    s_and_b32 s25, s25, 0xffff
    s_mov_b32 s26, 7340032
    s_mov_b32 s27, 0x00020000
    s_add_u32 s28, s28, 79691776
    s_addc_u32 s29, s29, 0
    s_and_b32 s29, s29, 0xffff
    s_mov_b32 s30, 131072
    s_mov_b32 s31, 0x00020000
    s_add_u32 m0, s7, 0
    s_mov_b32 s4, 0
    buffer_load_dwordx4 v8, s[12:15], s4 offen lds
    s_add_u32 m0, s7, 8192
    s_mov_b32 s4, 65536
    buffer_load_dwordx4 v8, s[12:15], s4 offen lds
    s_add_u32 m0, s7, 16384
    s_mov_b32 s4, 131072
    buffer_load_dwordx4 v8, s[12:15], s4 offen lds
    s_add_u32 m0, s7, 24576
    s_mov_b32 s4, 196608
    buffer_load_dwordx4 v8, s[12:15], s4 offen lds
    s_add_u32 m0, s7, 32768
    s_mov_b32 s4, 0
    buffer_load_dwordx4 v9, s[16:19], s4 offen lds
    s_add_u32 m0, s7, 40960
    s_mov_b32 s4, 0
    buffer_load_dwordx4 v10, s[20:23], s4 offen lds
    s_add_u32 m0, s7, 49152
    s_mov_b32 s4, 128
    buffer_load_dwordx4 v8, s[12:15], s4 offen lds
    s_add_u32 m0, s7, 57344
    s_mov_b32 s4, 65664
    buffer_load_dwordx4 v8, s[12:15], s4 offen lds
    s_add_u32 m0, s7, 65536
    s_mov_b32 s4, 131200
    buffer_load_dwordx4 v8, s[12:15], s4 offen lds
    s_add_u32 m0, s7, 73728
    s_mov_b32 s4, 196736
    buffer_load_dwordx4 v8, s[12:15], s4 offen lds
    s_add_u32 m0, s7, 81920
    s_mov_b32 s4, 229376
    buffer_load_dwordx4 v9, s[16:19], s4 offen lds
    s_add_u32 m0, s7, 90112
    s_mov_b32 s4, 229376
    buffer_load_dwordx4 v10, s[20:23], s4 offen lds
    s_add_u32 m0, s7, 98304
    s_mov_b32 s4, 256
    buffer_load_dwordx4 v8, s[12:15], s4 offen lds
    s_add_u32 m0, s7, 106496
    s_mov_b32 s4, 65792
    buffer_load_dwordx4 v8, s[12:15], s4 offen lds
    s_add_u32 m0, s7, 114688
    s_mov_b32 s4, 131328
    buffer_load_dwordx4 v8, s[12:15], s4 offen lds
    s_add_u32 m0, s7, 122880
    s_mov_b32 s4, 196864
    buffer_load_dwordx4 v8, s[12:15], s4 offen lds
    s_add_u32 m0, s7, 131072
    s_mov_b32 s4, 458752
    buffer_load_dwordx4 v9, s[16:19], s4 offen lds
    s_add_u32 m0, s7, 139264
    s_mov_b32 s4, 458752
    buffer_load_dwordx4 v10, s[20:23], s4 offen lds
    s_mul_i32 s92, s96, 1
    s_lshl_b32 s8, s96, 6
    v_add_u32 v4, s8, v2
    v_lshrrev_b32 v5, 1, v4
    v_and_b32 v5, 7, v5
    v_mul_u32_u24 v4, 128, v4
    s_xor_b32 s9, s92, 0
    s_mul_i32 s8, s98, 4
    s_add_u32 s8, s8, s9
    s_lshl_b32 s8, s8, 1
    v_add_u32 v7, s8, v3
    v_xor_b32 v7, v7, v5
    v_lshl_add_u32 v7, v7, 4, v4
    s_xor_b32 s8, s97, 0
    s_mul_i32 s8, s8, 4096
    v_add_u32 v11, s8, v7
    s_xor_b32 s8, s97, 1
    s_mul_i32 s8, s8, 4096
    v_add_u32 v12, s8, v7
    s_xor_b32 s9, s92, 1
    s_mul_i32 s8, s98, 4
    s_add_u32 s8, s8, s9
    s_lshl_b32 s8, s8, 1
    v_add_u32 v7, s8, v3
    v_xor_b32 v7, v7, v5
    v_lshl_add_u32 v7, v7, 4, v4
    s_xor_b32 s8, s97, 0
    s_mul_i32 s8, s8, 4096
    v_add_u32 v13, s8, v7
    s_xor_b32 s8, s97, 1
    s_mul_i32 s8, s8, 4096
    v_add_u32 v14, s8, v7
    s_xor_b32 s9, s92, 2
    s_mul_i32 s8, s98, 4
    s_add_u32 s8, s8, s9
    s_lshl_b32 s8, s8, 1
    v_add_u32 v7, s8, v3
    v_xor_b32 v7, v7, v5
    v_lshl_add_u32 v7, v7, 4, v4
    s_xor_b32 s8, s97, 0
    s_mul_i32 s8, s8, 4096
    v_add_u32 v15, s8, v7
    s_xor_b32 s8, s97, 1
    s_mul_i32 s8, s8, 4096
    v_add_u32 v16, s8, v7
    s_xor_b32 s9, s92, 3
    s_mul_i32 s8, s98, 4
    s_add_u32 s8, s8, s9
    s_lshl_b32 s8, s8, 1
    v_add_u32 v7, s8, v3
    v_xor_b32 v7, v7, v5
    v_lshl_add_u32 v7, v7, 4, v4
    s_xor_b32 s8, s97, 0
    s_mul_i32 s8, s8, 4096
    v_add_u32 v17, s8, v7
    s_xor_b32 s8, s97, 1
    s_mul_i32 s8, s8, 4096
    v_add_u32 v18, s8, v7
    v_bfe_u32 v4, v1, 2, 2
    v_lshrrev_b32 v5, 5, v1
    v_lshlrev_b32 v5, 3, v5
    v_add_u32 v5, v5, v4
    s_mul_i32 s8, s98, 64
    v_add_u32 v5, s8, v5
    v_mul_u32_u24 v5, 128, v5
    v_bfe_u32 v6, v1, 4, 1
    v_lshlrev_b32 v6, 4, v6
    v_and_b32 v7, 3, v1
    v_lshl_add_u32 v6, v7, 2, v6
    s_mul_i32 s8, s97, 32
    s_add_u32 s8, s8, 0
    v_add_u32 v6, s8, v6
    v_lshlrev_b32 v6, 1, v6
    v_bfe_u32 v7, v4, 1, 1
    v_lshlrev_b32 v7, 6, v7
    v_xor_b32 v6, v6, v7
    v_add_u32 v5, v5, v6
    s_xor_b32 s8, s92, 0
    s_mul_i32 s8, s8, 2048
    s_add_u32 s8, s8, 32768
    v_add_u32 v19, s8, v5
    s_xor_b32 s8, s92, 1
    s_mul_i32 s8, s8, 2048
    s_add_u32 s8, s8, 32768
    v_add_u32 v20, s8, v5
    s_xor_b32 s8, s92, 2
    s_mul_i32 s8, s8, 2048
    s_add_u32 s8, s8, 32768
    v_add_u32 v21, s8, v5
    s_xor_b32 s8, s92, 3
    s_mul_i32 s8, s8, 2048
    s_add_u32 s8, s8, 32768
    v_add_u32 v22, s8, v5
    v_bfe_u32 v4, v1, 2, 2
    v_lshrrev_b32 v5, 5, v1
    v_lshlrev_b32 v5, 3, v5
    v_add_u32 v5, v5, v4
    s_mul_i32 s8, s98, 64
    v_add_u32 v5, s8, v5
    v_mul_u32_u24 v5, 128, v5
    v_bfe_u32 v6, v1, 4, 1
    v_lshlrev_b32 v6, 4, v6
    v_and_b32 v7, 3, v1
    v_lshl_add_u32 v6, v7, 2, v6
    s_mul_i32 s8, s97, 32
    s_add_u32 s8, s8, 0
    v_add_u32 v6, s8, v6
    v_lshlrev_b32 v6, 1, v6
    v_bfe_u32 v7, v4, 1, 1
    v_lshlrev_b32 v7, 6, v7
    v_xor_b32 v6, v6, v7
    v_add_u32 v5, v5, v6
    s_xor_b32 s8, s92, 0
    s_mul_i32 s8, s8, 2048
    s_add_u32 s8, s8, 40960
    v_add_u32 v23, s8, v5
    s_xor_b32 s8, s92, 1
    s_mul_i32 s8, s8, 2048
    s_add_u32 s8, s8, 40960
    v_add_u32 v24, s8, v5
    s_xor_b32 s8, s92, 2
    s_mul_i32 s8, s8, 2048
    s_add_u32 s8, s8, 40960
    v_add_u32 v25, s8, v5
    s_xor_b32 s8, s92, 3
    s_mul_i32 s8, s8, 2048
    s_add_u32 s8, s8, 40960
    v_add_u32 v26, s8, v5
    v_mov_b32 v138, 0x3f803f80
    s_lshl_b32 s8, s96, 6
    s_add_u32 s8, s8, s5
    v_add_u32 v4, s8, v2
    v_lshlrev_b32 v4, 6, v4
    v_lshl_add_u32 v4, v3, 5, v4
    s_mul_i32 s8, s97, 2048
    s_sub_u32 s9, 2048, s8
    v_add_u32 v5, s9, v4
    v_add_u32 v4, s8, v4
    buffer_load_dwordx4 v[156:159], v4, s[28:31], 0 offen offset:0
    buffer_load_dwordx4 v[160:163], v4, s[28:31], 0 offen offset:16
    buffer_load_dwordx4 v[164:167], v5, s[28:31], 0 offen offset:0
    buffer_load_dwordx4 v[168:171], v5, s[28:31], 0 offen offset:16
    s_waitcnt vmcnt(16) lgkmcnt(0)
    s_barrier
    ds_read_b128 v[92:95], v11
    ds_read_b128 v[96:99], v12
    ds_read_b64_tr_b16 v[108:109], v19 offset:0
    ds_read_b64_tr_b16 v[110:111], v19 offset:512
    ds_read_b64_tr_b16 v[112:113], v23 offset:0
    ds_read_b64_tr_b16 v[114:115], v23 offset:512
    v_mov_b32 v140, 0
    v_mov_b32 v142, 0
    v_mov_b32 v141, 0
    v_mov_b32 v143, 0
    v_mov_b32 v144, 0
    v_mov_b32 v146, 0
    v_mov_b32 v145, 0
    v_mov_b32 v147, 0
    v_mov_b32 v148, 0
    v_mov_b32 v149, 0
    v_mov_b32 v150, 0
    v_mov_b32 v151, 0
    v_mov_b32 v152, 0
    v_mov_b32 v153, 0
    v_mov_b32 v154, 0
    v_mov_b32 v155, 0
    ds_read_b128 v[100:103], v13
    ds_read_b128 v[104:107], v14
    ds_read_b64_tr_b16 v[116:117], v20 offset:0
    ds_read_b64_tr_b16 v[118:119], v20 offset:512
    ds_read_b64_tr_b16 v[120:121], v24 offset:0
    ds_read_b64_tr_b16 v[122:123], v24 offset:512
    s_waitcnt lgkmcnt(6)
    v_mfma_f32_32x32x16_bf16 v[28:43], v[108:111], v[92:95], 0
    v_lshlrev_b32 v6, 16, v108
    v_and_b32 v7, 0xffff0000, v108
    v_add_f32 v148, v148, v6
    v_add_f32 v150, v150, v7
    v_lshlrev_b32 v6, 16, v112
    v_and_b32 v7, 0xffff0000, v112
    v_add_f32 v152, v152, v6
    v_add_f32 v154, v154, v7
    v_mfma_f32_32x32x16_bf16 v[44:59], v[112:115], v[92:95], 0
    v_lshlrev_b32 v6, 16, v109
    v_and_b32 v7, 0xffff0000, v109
    v_add_f32 v149, v149, v6
    v_add_f32 v151, v151, v7
    v_lshlrev_b32 v6, 16, v113
    v_and_b32 v7, 0xffff0000, v113
    v_add_f32 v153, v153, v6
    v_add_f32 v155, v155, v7
    v_mfma_f32_32x32x16_bf16 v[60:75], v[108:111], v[96:99], 0
    v_lshlrev_b32 v6, 16, v110
    v_and_b32 v7, 0xffff0000, v110
    v_add_f32 v148, v148, v6
    v_add_f32 v150, v150, v7
    v_lshlrev_b32 v6, 16, v114
    v_and_b32 v7, 0xffff0000, v114
    v_add_f32 v152, v152, v6
    v_add_f32 v154, v154, v7
    v_mfma_f32_32x32x16_bf16 v[76:91], v[112:115], v[96:99], 0
    v_lshlrev_b32 v6, 16, v111
    v_and_b32 v7, 0xffff0000, v111
    v_add_f32 v149, v149, v6
    v_add_f32 v151, v151, v7
    v_lshlrev_b32 v6, 16, v115
    v_and_b32 v7, 0xffff0000, v115
    v_add_f32 v153, v153, v6
    v_add_f32 v155, v155, v7
    ds_read_b128 v[92:95], v15
    ds_read_b128 v[96:99], v16
    ds_read_b64_tr_b16 v[108:109], v21 offset:0
    ds_read_b64_tr_b16 v[110:111], v21 offset:512
    ds_read_b64_tr_b16 v[112:113], v25 offset:0
    ds_read_b64_tr_b16 v[114:115], v25 offset:512
    s_waitcnt lgkmcnt(6)
    v_mfma_f32_32x32x16_bf16 v[28:43], v[116:119], v[100:103], v[28:43]
    v_mfma_f32_32x32x16_bf16 v[44:59], v[120:123], v[100:103], v[44:59]
    v_mfma_f32_32x32x16_bf16 v[60:75], v[116:119], v[104:107], v[60:75]
    v_mfma_f32_32x32x16_bf16 v[76:91], v[120:123], v[104:107], v[76:91]
    ds_read_b128 v[100:103], v17
    ds_read_b128 v[104:107], v18
    ds_read_b64_tr_b16 v[116:117], v22 offset:0
    ds_read_b64_tr_b16 v[118:119], v22 offset:512
    ds_read_b64_tr_b16 v[120:121], v26 offset:0
    ds_read_b64_tr_b16 v[122:123], v26 offset:512
    s_waitcnt lgkmcnt(6)
    v_mfma_f32_32x32x16_bf16 v[28:43], v[108:111], v[92:95], v[28:43]
    v_add_u32 v11, 49152, v11
    v_add_u32 v12, 49152, v12
    v_add_u32 v13, 49152, v13
    v_add_u32 v14, 49152, v14
    v_mfma_f32_32x32x16_bf16 v[44:59], v[112:115], v[92:95], v[44:59]
    v_add_u32 v15, 49152, v15
    v_add_u32 v16, 49152, v16
    v_add_u32 v17, 49152, v17
    v_add_u32 v18, 49152, v18
    v_mfma_f32_32x32x16_bf16 v[60:75], v[108:111], v[96:99], v[60:75]
    v_add_u32 v19, 49152, v19
    v_add_u32 v20, 49152, v20
    v_add_u32 v21, 49152, v21
    v_add_u32 v22, 49152, v22
    v_mfma_f32_32x32x16_bf16 v[76:91], v[112:115], v[96:99], v[76:91]
    v_add_u32 v23, 49152, v23
    v_add_u32 v24, 49152, v24
    v_add_u32 v25, 49152, v25
    v_add_u32 v26, 49152, v26
    s_waitcnt vmcnt(10) lgkmcnt(0)
    s_barrier
    ds_read_b128 v[92:95], v11
    ds_read_b128 v[96:99], v12
    ds_read_b64_tr_b16 v[108:109], v19 offset:0
    ds_read_b64_tr_b16 v[110:111], v19 offset:512
    ds_read_b64_tr_b16 v[112:113], v23 offset:0
    ds_read_b64_tr_b16 v[114:115], v23 offset:512
    v_mfma_f32_32x32x16_bf16 v[28:43], v[116:119], v[100:103], v[28:43]
    s_add_u32 m0, s7, 0
    s_mov_b32 s4, 384
    buffer_load_dwordx4 v8, s[12:15], s4 offen lds
    v_mfma_f32_32x32x16_bf16 v[44:59], v[120:123], v[100:103], v[44:59]
    s_add_u32 m0, s7, 8192
    s_mov_b32 s4, 65920
    buffer_load_dwordx4 v8, s[12:15], s4 offen lds
    v_mfma_f32_32x32x16_bf16 v[60:75], v[116:119], v[104:107], v[60:75]
    s_add_u32 m0, s7, 16384
    s_mov_b32 s4, 131456
    buffer_load_dwordx4 v8, s[12:15], s4 offen lds
    v_mfma_f32_32x32x16_bf16 v[76:91], v[120:123], v[104:107], v[76:91]
    s_add_u32 m0, s7, 24576
    s_mov_b32 s4, 196992
    buffer_load_dwordx4 v8, s[12:15], s4 offen lds
    ds_read_b128 v[100:103], v13
    ds_read_b128 v[104:107], v14
    ds_read_b64_tr_b16 v[116:117], v20 offset:0
    ds_read_b64_tr_b16 v[118:119], v20 offset:512
    ds_read_b64_tr_b16 v[120:121], v24 offset:0
    ds_read_b64_tr_b16 v[122:123], v24 offset:512
    s_waitcnt lgkmcnt(6)
    v_mfma_f32_32x32x16_bf16 v[28:43], v[108:111], v[92:95], v[28:43]
    s_add_u32 m0, s7, 32768
    s_mov_b32 s4, 688128
    buffer_load_dwordx4 v9, s[16:19], s4 offen lds
    v_lshlrev_b32 v6, 16, v108
    v_and_b32 v7, 0xffff0000, v108
    v_add_f32 v148, v148, v6
    v_add_f32 v150, v150, v7
    v_lshlrev_b32 v6, 16, v112
    v_and_b32 v7, 0xffff0000, v112
    v_add_f32 v152, v152, v6
    v_add_f32 v154, v154, v7
    v_mfma_f32_32x32x16_bf16 v[44:59], v[112:115], v[92:95], v[44:59]
    s_add_u32 m0, s7, 40960
    s_mov_b32 s4, 688128
    buffer_load_dwordx4 v10, s[20:23], s4 offen lds
    v_lshlrev_b32 v6, 16, v109
    v_and_b32 v7, 0xffff0000, v109
    v_add_f32 v149, v149, v6
    v_add_f32 v151, v151, v7
    v_lshlrev_b32 v6, 16, v113
    v_and_b32 v7, 0xffff0000, v113
    v_add_f32 v153, v153, v6
    v_add_f32 v155, v155, v7
    v_mfma_f32_32x32x16_bf16 v[60:75], v[108:111], v[96:99], v[60:75]
    v_lshlrev_b32 v6, 16, v110
    v_and_b32 v7, 0xffff0000, v110
    v_add_f32 v148, v148, v6
    v_add_f32 v150, v150, v7
    v_lshlrev_b32 v6, 16, v114
    v_and_b32 v7, 0xffff0000, v114
    v_add_f32 v152, v152, v6
    v_add_f32 v154, v154, v7
    v_mfma_f32_32x32x16_bf16 v[76:91], v[112:115], v[96:99], v[76:91]
    v_lshlrev_b32 v6, 16, v111
    v_and_b32 v7, 0xffff0000, v111
    v_add_f32 v149, v149, v6
    v_add_f32 v151, v151, v7
    v_lshlrev_b32 v6, 16, v115
    v_and_b32 v7, 0xffff0000, v115
    v_add_f32 v153, v153, v6
    v_add_f32 v155, v155, v7
    ds_read_b128 v[92:95], v15
    ds_read_b128 v[96:99], v16
    ds_read_b64_tr_b16 v[108:109], v21 offset:0
    ds_read_b64_tr_b16 v[110:111], v21 offset:512
    ds_read_b64_tr_b16 v[112:113], v25 offset:0
    ds_read_b64_tr_b16 v[114:115], v25 offset:512
    s_waitcnt lgkmcnt(6)
    v_mfma_f32_32x32x16_bf16 v[28:43], v[116:119], v[100:103], v[28:43]
    v_mfma_f32_32x32x16_bf16 v[44:59], v[120:123], v[100:103], v[44:59]
    v_mfma_f32_32x32x16_bf16 v[60:75], v[116:119], v[104:107], v[60:75]
    v_mfma_f32_32x32x16_bf16 v[76:91], v[120:123], v[104:107], v[76:91]
    ds_read_b128 v[100:103], v17
    ds_read_b128 v[104:107], v18
    ds_read_b64_tr_b16 v[116:117], v22 offset:0
    ds_read_b64_tr_b16 v[118:119], v22 offset:512
    ds_read_b64_tr_b16 v[120:121], v26 offset:0
    ds_read_b64_tr_b16 v[122:123], v26 offset:512
    s_waitcnt lgkmcnt(6)
    v_mfma_f32_32x32x16_bf16 v[28:43], v[108:111], v[92:95], v[28:43]
    v_add_u32 v11, 49152, v11
    v_add_u32 v12, 49152, v12
    v_add_u32 v13, 49152, v13
    v_add_u32 v14, 49152, v14
    v_mfma_f32_32x32x16_bf16 v[44:59], v[112:115], v[92:95], v[44:59]
    v_add_u32 v15, 49152, v15
    v_add_u32 v16, 49152, v16
    v_add_u32 v17, 49152, v17
    v_add_u32 v18, 49152, v18
    v_mfma_f32_32x32x16_bf16 v[60:75], v[108:111], v[96:99], v[60:75]
    v_add_u32 v19, 49152, v19
    v_add_u32 v20, 49152, v20
    v_add_u32 v21, 49152, v21
    v_add_u32 v22, 49152, v22
    v_mfma_f32_32x32x16_bf16 v[76:91], v[112:115], v[96:99], v[76:91]
    v_add_u32 v23, 49152, v23
    v_add_u32 v24, 49152, v24
    v_add_u32 v25, 49152, v25
    v_add_u32 v26, 49152, v26
    s_waitcnt vmcnt(10) lgkmcnt(0)
    s_barrier
    ds_read_b128 v[92:95], v11
    ds_read_b128 v[96:99], v12
    ds_read_b64_tr_b16 v[108:109], v19 offset:0
    ds_read_b64_tr_b16 v[110:111], v19 offset:512
    ds_read_b64_tr_b16 v[112:113], v23 offset:0
    ds_read_b64_tr_b16 v[114:115], v23 offset:512
    v_mfma_f32_32x32x16_bf16 v[28:43], v[116:119], v[100:103], v[28:43]
    s_add_u32 m0, s7, 49152
    s_mov_b32 s4, 512
    buffer_load_dwordx4 v8, s[12:15], s4 offen lds
    v_mfma_f32_32x32x16_bf16 v[44:59], v[120:123], v[100:103], v[44:59]
    s_add_u32 m0, s7, 57344
    s_mov_b32 s4, 66048
    buffer_load_dwordx4 v8, s[12:15], s4 offen lds
    v_mfma_f32_32x32x16_bf16 v[60:75], v[116:119], v[104:107], v[60:75]
    s_add_u32 m0, s7, 65536
    s_mov_b32 s4, 131584
    buffer_load_dwordx4 v8, s[12:15], s4 offen lds
    v_mfma_f32_32x32x16_bf16 v[76:91], v[120:123], v[104:107], v[76:91]
    s_add_u32 m0, s7, 73728
    s_mov_b32 s4, 197120
    buffer_load_dwordx4 v8, s[12:15], s4 offen lds
    ds_read_b128 v[100:103], v13
    ds_read_b128 v[104:107], v14
    ds_read_b64_tr_b16 v[116:117], v20 offset:0
    ds_read_b64_tr_b16 v[118:119], v20 offset:512
    ds_read_b64_tr_b16 v[120:121], v24 offset:0
    ds_read_b64_tr_b16 v[122:123], v24 offset:512
    s_waitcnt lgkmcnt(6)
    v_mfma_f32_32x32x16_bf16 v[28:43], v[108:111], v[92:95], v[28:43]
    s_add_u32 m0, s7, 81920
    s_mov_b32 s4, 917504
    buffer_load_dwordx4 v9, s[16:19], s4 offen lds
    v_lshlrev_b32 v6, 16, v108
    v_and_b32 v7, 0xffff0000, v108
    v_add_f32 v148, v148, v6
    v_add_f32 v150, v150, v7
    v_lshlrev_b32 v6, 16, v112
    v_and_b32 v7, 0xffff0000, v112
    v_add_f32 v152, v152, v6
    v_add_f32 v154, v154, v7
    v_mfma_f32_32x32x16_bf16 v[44:59], v[112:115], v[92:95], v[44:59]
    s_add_u32 m0, s7, 90112
    s_mov_b32 s4, 917504
    buffer_load_dwordx4 v10, s[20:23], s4 offen lds
    v_lshlrev_b32 v6, 16, v109
    v_and_b32 v7, 0xffff0000, v109
    v_add_f32 v149, v149, v6
    v_add_f32 v151, v151, v7
    v_lshlrev_b32 v6, 16, v113
    v_and_b32 v7, 0xffff0000, v113
    v_add_f32 v153, v153, v6
    v_add_f32 v155, v155, v7
    v_mfma_f32_32x32x16_bf16 v[60:75], v[108:111], v[96:99], v[60:75]
    v_lshlrev_b32 v6, 16, v110
    v_and_b32 v7, 0xffff0000, v110
    v_add_f32 v148, v148, v6
    v_add_f32 v150, v150, v7
    v_lshlrev_b32 v6, 16, v114
    v_and_b32 v7, 0xffff0000, v114
    v_add_f32 v152, v152, v6
    v_add_f32 v154, v154, v7
    v_mfma_f32_32x32x16_bf16 v[76:91], v[112:115], v[96:99], v[76:91]
    v_lshlrev_b32 v6, 16, v111
    v_and_b32 v7, 0xffff0000, v111
    v_add_f32 v149, v149, v6
    v_add_f32 v151, v151, v7
    v_lshlrev_b32 v6, 16, v115
    v_and_b32 v7, 0xffff0000, v115
    v_add_f32 v153, v153, v6
    v_add_f32 v155, v155, v7
    ds_read_b128 v[92:95], v15
    ds_read_b128 v[96:99], v16
    ds_read_b64_tr_b16 v[108:109], v21 offset:0
    ds_read_b64_tr_b16 v[110:111], v21 offset:512
    ds_read_b64_tr_b16 v[112:113], v25 offset:0
    ds_read_b64_tr_b16 v[114:115], v25 offset:512
    s_waitcnt lgkmcnt(6)
    v_mfma_f32_32x32x16_bf16 v[28:43], v[116:119], v[100:103], v[28:43]
    v_mfma_f32_32x32x16_bf16 v[44:59], v[120:123], v[100:103], v[44:59]
    v_mfma_f32_32x32x16_bf16 v[60:75], v[116:119], v[104:107], v[60:75]
    v_mfma_f32_32x32x16_bf16 v[76:91], v[120:123], v[104:107], v[76:91]
    ds_read_b128 v[100:103], v17
    ds_read_b128 v[104:107], v18
    ds_read_b64_tr_b16 v[116:117], v22 offset:0
    ds_read_b64_tr_b16 v[118:119], v22 offset:512
    ds_read_b64_tr_b16 v[120:121], v26 offset:0
    ds_read_b64_tr_b16 v[122:123], v26 offset:512
    s_waitcnt lgkmcnt(6)
    v_mfma_f32_32x32x16_bf16 v[28:43], v[108:111], v[92:95], v[28:43]
    v_subrev_u32 v11, 98304, v11
    v_subrev_u32 v12, 98304, v12
    v_subrev_u32 v13, 98304, v13
    v_subrev_u32 v14, 98304, v14
    v_mfma_f32_32x32x16_bf16 v[44:59], v[112:115], v[92:95], v[44:59]
    v_subrev_u32 v15, 98304, v15
    v_subrev_u32 v16, 98304, v16
    v_subrev_u32 v17, 98304, v17
    v_subrev_u32 v18, 98304, v18
    v_mfma_f32_32x32x16_bf16 v[60:75], v[108:111], v[96:99], v[60:75]
    v_subrev_u32 v19, 98304, v19
    v_subrev_u32 v20, 98304, v20
    v_subrev_u32 v21, 98304, v21
    v_subrev_u32 v22, 98304, v22
    v_mfma_f32_32x32x16_bf16 v[76:91], v[112:115], v[96:99], v[76:91]
    v_subrev_u32 v23, 98304, v23
    v_subrev_u32 v24, 98304, v24
    v_subrev_u32 v25, 98304, v25
    v_subrev_u32 v26, 98304, v26
    s_waitcnt vmcnt(6) lgkmcnt(0)
    s_barrier
    ds_read_b128 v[92:95], v11
    ds_read_b128 v[96:99], v12
    ds_read_b64_tr_b16 v[108:109], v19 offset:0
    ds_read_b64_tr_b16 v[110:111], v19 offset:512
    ds_read_b64_tr_b16 v[112:113], v23 offset:0
    ds_read_b64_tr_b16 v[114:115], v23 offset:512
    v_mfma_f32_32x32x16_bf16 v[28:43], v[116:119], v[100:103], v[28:43]
    s_add_u32 m0, s7, 98304
    s_mov_b32 s4, 640
    buffer_load_dwordx4 v8, s[12:15], s4 offen lds
    v_mfma_f32_32x32x16_bf16 v[44:59], v[120:123], v[100:103], v[44:59]
    s_add_u32 m0, s7, 106496
    s_mov_b32 s4, 66176
    buffer_load_dwordx4 v8, s[12:15], s4 offen lds
    v_mfma_f32_32x32x16_bf16 v[60:75], v[116:119], v[104:107], v[60:75]
    s_add_u32 m0, s7, 114688
    s_mov_b32 s4, 131712
    buffer_load_dwordx4 v8, s[12:15], s4 offen lds
    v_mfma_f32_32x32x16_bf16 v[76:91], v[120:123], v[104:107], v[76:91]
    s_add_u32 m0, s7, 122880
    s_mov_b32 s4, 197248
    buffer_load_dwordx4 v8, s[12:15], s4 offen lds
    ds_read_b128 v[100:103], v13
    ds_read_b128 v[104:107], v14
    ds_read_b64_tr_b16 v[116:117], v20 offset:0
    ds_read_b64_tr_b16 v[118:119], v20 offset:512
    ds_read_b64_tr_b16 v[120:121], v24 offset:0
    ds_read_b64_tr_b16 v[122:123], v24 offset:512
    s_waitcnt lgkmcnt(6)
    v_mfma_f32_32x32x16_bf16 v[28:43], v[108:111], v[92:95], v[28:43]
    s_add_u32 m0, s7, 131072
    s_mov_b32 s4, 1146880
    buffer_load_dwordx4 v9, s[16:19], s4 offen lds
    v_lshlrev_b32 v6, 16, v108
    v_and_b32 v7, 0xffff0000, v108
    v_add_f32 v148, v148, v6
    v_add_f32 v150, v150, v7
    v_lshlrev_b32 v6, 16, v112
    v_and_b32 v7, 0xffff0000, v112
    v_add_f32 v152, v152, v6
    v_add_f32 v154, v154, v7
    v_mfma_f32_32x32x16_bf16 v[44:59], v[112:115], v[92:95], v[44:59]
    s_add_u32 m0, s7, 139264
    s_mov_b32 s4, 1146880
    buffer_load_dwordx4 v10, s[20:23], s4 offen lds
    v_lshlrev_b32 v6, 16, v109
    v_and_b32 v7, 0xffff0000, v109
    v_add_f32 v149, v149, v6
    v_add_f32 v151, v151, v7
    v_lshlrev_b32 v6, 16, v113
    v_and_b32 v7, 0xffff0000, v113
    v_add_f32 v153, v153, v6
    v_add_f32 v155, v155, v7
    v_mfma_f32_32x32x16_bf16 v[60:75], v[108:111], v[96:99], v[60:75]
    v_lshlrev_b32 v6, 16, v110
    v_and_b32 v7, 0xffff0000, v110
    v_add_f32 v148, v148, v6
    v_add_f32 v150, v150, v7
    v_lshlrev_b32 v6, 16, v114
    v_and_b32 v7, 0xffff0000, v114
    v_add_f32 v152, v152, v6
    v_add_f32 v154, v154, v7
    v_mfma_f32_32x32x16_bf16 v[76:91], v[112:115], v[96:99], v[76:91]
    v_lshlrev_b32 v6, 16, v111
    v_and_b32 v7, 0xffff0000, v111
    v_add_f32 v149, v149, v6
    v_add_f32 v151, v151, v7
    v_lshlrev_b32 v6, 16, v115
    v_and_b32 v7, 0xffff0000, v115
    v_add_f32 v153, v153, v6
    v_add_f32 v155, v155, v7
    ds_read_b128 v[92:95], v15
    ds_read_b128 v[96:99], v16
    ds_read_b64_tr_b16 v[108:109], v21 offset:0
    ds_read_b64_tr_b16 v[110:111], v21 offset:512
    ds_read_b64_tr_b16 v[112:113], v25 offset:0
    ds_read_b64_tr_b16 v[114:115], v25 offset:512
    s_waitcnt lgkmcnt(6)
    v_mfma_f32_32x32x16_bf16 v[28:43], v[116:119], v[100:103], v[28:43]
    v_mfma_f32_32x32x16_bf16 v[44:59], v[120:123], v[100:103], v[44:59]
    v_mfma_f32_32x32x16_bf16 v[60:75], v[116:119], v[104:107], v[60:75]
    v_mfma_f32_32x32x16_bf16 v[76:91], v[120:123], v[104:107], v[76:91]
    ds_read_b128 v[100:103], v17
    ds_read_b128 v[104:107], v18
    ds_read_b64_tr_b16 v[116:117], v22 offset:0
    ds_read_b64_tr_b16 v[118:119], v22 offset:512
    ds_read_b64_tr_b16 v[120:121], v26 offset:0
    ds_read_b64_tr_b16 v[122:123], v26 offset:512
    s_waitcnt lgkmcnt(6)
    v_mfma_f32_32x32x16_bf16 v[28:43], v[108:111], v[92:95], v[28:43]
    v_add_u32 v11, 49152, v11
    v_add_u32 v12, 49152, v12
    v_add_u32 v13, 49152, v13
    v_add_u32 v14, 49152, v14
    v_mfma_f32_32x32x16_bf16 v[44:59], v[112:115], v[92:95], v[44:59]
    v_add_u32 v15, 49152, v15
    v_add_u32 v16, 49152, v16
    v_add_u32 v17, 49152, v17
    v_add_u32 v18, 49152, v18
    v_mfma_f32_32x32x16_bf16 v[60:75], v[108:111], v[96:99], v[60:75]
    v_add_u32 v19, 49152, v19
    v_add_u32 v20, 49152, v20
    v_add_u32 v21, 49152, v21
    v_add_u32 v22, 49152, v22
    v_mfma_f32_32x32x16_bf16 v[76:91], v[112:115], v[96:99], v[76:91]
    v_add_u32 v23, 49152, v23
    v_add_u32 v24, 49152, v24
    v_add_u32 v25, 49152, v25
    v_add_u32 v26, 49152, v26
    s_waitcnt vmcnt(6) lgkmcnt(0)
    s_barrier
    ds_read_b128 v[92:95], v11
    ds_read_b128 v[96:99], v12
    ds_read_b64_tr_b16 v[108:109], v19 offset:0
    ds_read_b64_tr_b16 v[110:111], v19 offset:512
    ds_read_b64_tr_b16 v[112:113], v23 offset:0
    ds_read_b64_tr_b16 v[114:115], v23 offset:512
    v_mfma_f32_32x32x16_bf16 v[28:43], v[116:119], v[100:103], v[28:43]
    s_add_u32 m0, s7, 0
    s_mov_b32 s4, 768
    buffer_load_dwordx4 v8, s[12:15], s4 offen lds
    v_mfma_f32_32x32x16_bf16 v[44:59], v[120:123], v[100:103], v[44:59]
    s_add_u32 m0, s7, 8192
    s_mov_b32 s4, 66304
    buffer_load_dwordx4 v8, s[12:15], s4 offen lds
    v_mfma_f32_32x32x16_bf16 v[60:75], v[116:119], v[104:107], v[60:75]
    s_add_u32 m0, s7, 16384
    s_mov_b32 s4, 131840
    buffer_load_dwordx4 v8, s[12:15], s4 offen lds
    v_mfma_f32_32x32x16_bf16 v[76:91], v[120:123], v[104:107], v[76:91]
    s_add_u32 m0, s7, 24576
    s_mov_b32 s4, 197376
    buffer_load_dwordx4 v8, s[12:15], s4 offen lds
    ds_read_b128 v[100:103], v13
    ds_read_b128 v[104:107], v14
    ds_read_b64_tr_b16 v[116:117], v20 offset:0
    ds_read_b64_tr_b16 v[118:119], v20 offset:512
    ds_read_b64_tr_b16 v[120:121], v24 offset:0
    ds_read_b64_tr_b16 v[122:123], v24 offset:512
    s_waitcnt lgkmcnt(6)
    v_mfma_f32_32x32x16_bf16 v[28:43], v[108:111], v[92:95], v[28:43]
    s_add_u32 m0, s7, 32768
    s_mov_b32 s4, 1376256
    buffer_load_dwordx4 v9, s[16:19], s4 offen lds
    v_lshlrev_b32 v6, 16, v108
    v_and_b32 v7, 0xffff0000, v108
    v_add_f32 v148, v148, v6
    v_add_f32 v150, v150, v7
    v_lshlrev_b32 v6, 16, v112
    v_and_b32 v7, 0xffff0000, v112
    v_add_f32 v152, v152, v6
    v_add_f32 v154, v154, v7
    v_mfma_f32_32x32x16_bf16 v[44:59], v[112:115], v[92:95], v[44:59]
    s_add_u32 m0, s7, 40960
    s_mov_b32 s4, 1376256
    buffer_load_dwordx4 v10, s[20:23], s4 offen lds
    v_lshlrev_b32 v6, 16, v109
    v_and_b32 v7, 0xffff0000, v109
    v_add_f32 v149, v149, v6
    v_add_f32 v151, v151, v7
    v_lshlrev_b32 v6, 16, v113
    v_and_b32 v7, 0xffff0000, v113
    v_add_f32 v153, v153, v6
    v_add_f32 v155, v155, v7
    v_mfma_f32_32x32x16_bf16 v[60:75], v[108:111], v[96:99], v[60:75]
    v_lshlrev_b32 v6, 16, v110
    v_and_b32 v7, 0xffff0000, v110
    v_add_f32 v148, v148, v6
    v_add_f32 v150, v150, v7
    v_lshlrev_b32 v6, 16, v114
    v_and_b32 v7, 0xffff0000, v114
    v_add_f32 v152, v152, v6
    v_add_f32 v154, v154, v7
    v_mfma_f32_32x32x16_bf16 v[76:91], v[112:115], v[96:99], v[76:91]
    v_lshlrev_b32 v6, 16, v111
    v_and_b32 v7, 0xffff0000, v111
    v_add_f32 v149, v149, v6
    v_add_f32 v151, v151, v7
    v_lshlrev_b32 v6, 16, v115
    v_and_b32 v7, 0xffff0000, v115
    v_add_f32 v153, v153, v6
    v_add_f32 v155, v155, v7
    ds_read_b128 v[92:95], v15
    ds_read_b128 v[96:99], v16
    ds_read_b64_tr_b16 v[108:109], v21 offset:0
    ds_read_b64_tr_b16 v[110:111], v21 offset:512
    ds_read_b64_tr_b16 v[112:113], v25 offset:0
    ds_read_b64_tr_b16 v[114:115], v25 offset:512
    s_waitcnt lgkmcnt(6)
    v_mfma_f32_32x32x16_bf16 v[28:43], v[116:119], v[100:103], v[28:43]
    v_mfma_f32_32x32x16_bf16 v[44:59], v[120:123], v[100:103], v[44:59]
    v_mfma_f32_32x32x16_bf16 v[60:75], v[116:119], v[104:107], v[60:75]
    v_mfma_f32_32x32x16_bf16 v[76:91], v[120:123], v[104:107], v[76:91]
    ds_read_b128 v[100:103], v17
    ds_read_b128 v[104:107], v18
    ds_read_b64_tr_b16 v[116:117], v22 offset:0
    ds_read_b64_tr_b16 v[118:119], v22 offset:512
    ds_read_b64_tr_b16 v[120:121], v26 offset:0
    ds_read_b64_tr_b16 v[122:123], v26 offset:512
    s_waitcnt lgkmcnt(6)
    v_mfma_f32_32x32x16_bf16 v[28:43], v[108:111], v[92:95], v[28:43]
    v_add_u32 v11, 49152, v11
    v_add_u32 v12, 49152, v12
    v_add_u32 v13, 49152, v13
    v_add_u32 v14, 49152, v14
    v_mfma_f32_32x32x16_bf16 v[44:59], v[112:115], v[92:95], v[44:59]
    v_add_u32 v15, 49152, v15
    v_add_u32 v16, 49152, v16
    v_add_u32 v17, 49152, v17
    v_add_u32 v18, 49152, v18
    v_mfma_f32_32x32x16_bf16 v[60:75], v[108:111], v[96:99], v[60:75]
    v_add_u32 v19, 49152, v19
    v_add_u32 v20, 49152, v20
    v_add_u32 v21, 49152, v21
    v_add_u32 v22, 49152, v22
    v_mfma_f32_32x32x16_bf16 v[76:91], v[112:115], v[96:99], v[76:91]
    v_add_u32 v23, 49152, v23
    v_add_u32 v24, 49152, v24
    v_add_u32 v25, 49152, v25
    v_add_u32 v26, 49152, v26
    s_waitcnt vmcnt(6) lgkmcnt(0)
    s_barrier
    ds_read_b128 v[92:95], v11
    ds_read_b128 v[96:99], v12
    ds_read_b64_tr_b16 v[108:109], v19 offset:0
    ds_read_b64_tr_b16 v[110:111], v19 offset:512
    ds_read_b64_tr_b16 v[112:113], v23 offset:0
    ds_read_b64_tr_b16 v[114:115], v23 offset:512
    v_mfma_f32_32x32x16_bf16 v[28:43], v[116:119], v[100:103], v[28:43]
    s_add_u32 m0, s7, 49152
    s_mov_b32 s4, 896
    buffer_load_dwordx4 v8, s[12:15], s4 offen lds
    v_mfma_f32_32x32x16_bf16 v[44:59], v[120:123], v[100:103], v[44:59]
    s_add_u32 m0, s7, 57344
    s_mov_b32 s4, 66432
    buffer_load_dwordx4 v8, s[12:15], s4 offen lds
    v_mfma_f32_32x32x16_bf16 v[60:75], v[116:119], v[104:107], v[60:75]
    s_add_u32 m0, s7, 65536
    s_mov_b32 s4, 131968
    buffer_load_dwordx4 v8, s[12:15], s4 offen lds
    v_mfma_f32_32x32x16_bf16 v[76:91], v[120:123], v[104:107], v[76:91]
    s_add_u32 m0, s7, 73728
    s_mov_b32 s4, 197504
    buffer_load_dwordx4 v8, s[12:15], s4 offen lds
    ds_read_b128 v[100:103], v13
    ds_read_b128 v[104:107], v14
    ds_read_b64_tr_b16 v[116:117], v20 offset:0
    ds_read_b64_tr_b16 v[118:119], v20 offset:512
    ds_read_b64_tr_b16 v[120:121], v24 offset:0
    ds_read_b64_tr_b16 v[122:123], v24 offset:512
    s_waitcnt lgkmcnt(6)
    v_mfma_f32_32x32x16_bf16 v[28:43], v[108:111], v[92:95], v[28:43]
    s_add_u32 m0, s7, 81920
    s_mov_b32 s4, 1605632
    buffer_load_dwordx4 v9, s[16:19], s4 offen lds
    v_lshlrev_b32 v6, 16, v108
    v_and_b32 v7, 0xffff0000, v108
    v_add_f32 v148, v148, v6
    v_add_f32 v150, v150, v7
    v_lshlrev_b32 v6, 16, v112
    v_and_b32 v7, 0xffff0000, v112
    v_add_f32 v152, v152, v6
    v_add_f32 v154, v154, v7
    v_mfma_f32_32x32x16_bf16 v[44:59], v[112:115], v[92:95], v[44:59]
    s_add_u32 m0, s7, 90112
    s_mov_b32 s4, 1605632
    buffer_load_dwordx4 v10, s[20:23], s4 offen lds
    v_lshlrev_b32 v6, 16, v109
    v_and_b32 v7, 0xffff0000, v109
    v_add_f32 v149, v149, v6
    v_add_f32 v151, v151, v7
    v_lshlrev_b32 v6, 16, v113
    v_and_b32 v7, 0xffff0000, v113
    v_add_f32 v153, v153, v6
    v_add_f32 v155, v155, v7
    v_mfma_f32_32x32x16_bf16 v[60:75], v[108:111], v[96:99], v[60:75]
    v_lshlrev_b32 v6, 16, v110
    v_and_b32 v7, 0xffff0000, v110
    v_add_f32 v148, v148, v6
    v_add_f32 v150, v150, v7
    v_lshlrev_b32 v6, 16, v114
    v_and_b32 v7, 0xffff0000, v114
    v_add_f32 v152, v152, v6
    v_add_f32 v154, v154, v7
    v_mfma_f32_32x32x16_bf16 v[76:91], v[112:115], v[96:99], v[76:91]
    v_lshlrev_b32 v6, 16, v111
    v_and_b32 v7, 0xffff0000, v111
    v_add_f32 v149, v149, v6
    v_add_f32 v151, v151, v7
    v_lshlrev_b32 v6, 16, v115
    v_and_b32 v7, 0xffff0000, v115
    v_add_f32 v153, v153, v6
    v_add_f32 v155, v155, v7
    ds_read_b128 v[92:95], v15
    ds_read_b128 v[96:99], v16
    ds_read_b64_tr_b16 v[108:109], v21 offset:0
    ds_read_b64_tr_b16 v[110:111], v21 offset:512
    ds_read_b64_tr_b16 v[112:113], v25 offset:0
    ds_read_b64_tr_b16 v[114:115], v25 offset:512
    s_waitcnt lgkmcnt(6)
    v_mfma_f32_32x32x16_bf16 v[28:43], v[116:119], v[100:103], v[28:43]
    v_mfma_f32_32x32x16_bf16 v[44:59], v[120:123], v[100:103], v[44:59]
    v_mfma_f32_32x32x16_bf16 v[60:75], v[116:119], v[104:107], v[60:75]
    v_mfma_f32_32x32x16_bf16 v[76:91], v[120:123], v[104:107], v[76:91]
    ds_read_b128 v[100:103], v17
    ds_read_b128 v[104:107], v18
    ds_read_b64_tr_b16 v[116:117], v22 offset:0
    ds_read_b64_tr_b16 v[118:119], v22 offset:512
    ds_read_b64_tr_b16 v[120:121], v26 offset:0
    ds_read_b64_tr_b16 v[122:123], v26 offset:512
    s_waitcnt lgkmcnt(6)
    v_mfma_f32_32x32x16_bf16 v[28:43], v[108:111], v[92:95], v[28:43]
    v_subrev_u32 v11, 98304, v11
    v_subrev_u32 v12, 98304, v12
    v_subrev_u32 v13, 98304, v13
    v_subrev_u32 v14, 98304, v14
    v_mfma_f32_32x32x16_bf16 v[44:59], v[112:115], v[92:95], v[44:59]
    v_subrev_u32 v15, 98304, v15
    v_subrev_u32 v16, 98304, v16
    v_subrev_u32 v17, 98304, v17
    v_subrev_u32 v18, 98304, v18
    v_mfma_f32_32x32x16_bf16 v[60:75], v[108:111], v[96:99], v[60:75]
    v_subrev_u32 v19, 98304, v19
    v_subrev_u32 v20, 98304, v20
    v_subrev_u32 v21, 98304, v21
    v_subrev_u32 v22, 98304, v22
    v_mfma_f32_32x32x16_bf16 v[76:91], v[112:115], v[96:99], v[76:91]
    v_subrev_u32 v23, 98304, v23
    v_subrev_u32 v24, 98304, v24
    v_subrev_u32 v25, 98304, v25
    v_subrev_u32 v26, 98304, v26
    s_waitcnt vmcnt(6) lgkmcnt(0)
    s_barrier
    ds_read_b128 v[92:95], v11
    ds_read_b128 v[96:99], v12
    ds_read_b64_tr_b16 v[108:109], v19 offset:0
    ds_read_b64_tr_b16 v[110:111], v19 offset:512
    ds_read_b64_tr_b16 v[112:113], v23 offset:0
    ds_read_b64_tr_b16 v[114:115], v23 offset:512
    v_mfma_f32_32x32x16_bf16 v[28:43], v[116:119], v[100:103], v[28:43]
    v_mfma_f32_32x32x16_bf16 v[44:59], v[120:123], v[100:103], v[44:59]
    v_mfma_f32_32x32x16_bf16 v[60:75], v[116:119], v[104:107], v[60:75]
    v_mfma_f32_32x32x16_bf16 v[76:91], v[120:123], v[104:107], v[76:91]
    ds_read_b128 v[100:103], v13
    ds_read_b128 v[104:107], v14
    ds_read_b64_tr_b16 v[116:117], v20 offset:0
    ds_read_b64_tr_b16 v[118:119], v20 offset:512
    ds_read_b64_tr_b16 v[120:121], v24 offset:0
    ds_read_b64_tr_b16 v[122:123], v24 offset:512
    s_waitcnt lgkmcnt(6)
    v_mfma_f32_32x32x16_bf16 v[28:43], v[108:111], v[92:95], v[28:43]
    v_lshlrev_b32 v6, 16, v108
    v_and_b32 v7, 0xffff0000, v108
    v_add_f32 v148, v148, v6
    v_add_f32 v150, v150, v7
    v_lshlrev_b32 v6, 16, v112
    v_and_b32 v7, 0xffff0000, v112
    v_add_f32 v152, v152, v6
    v_add_f32 v154, v154, v7
    v_mfma_f32_32x32x16_bf16 v[44:59], v[112:115], v[92:95], v[44:59]
    v_lshlrev_b32 v6, 16, v109
    v_and_b32 v7, 0xffff0000, v109
    v_add_f32 v149, v149, v6
    v_add_f32 v151, v151, v7
    v_lshlrev_b32 v6, 16, v113
    v_and_b32 v7, 0xffff0000, v113
    v_add_f32 v153, v153, v6
    v_add_f32 v155, v155, v7
    v_mfma_f32_32x32x16_bf16 v[60:75], v[108:111], v[96:99], v[60:75]
    v_lshlrev_b32 v6, 16, v110
    v_and_b32 v7, 0xffff0000, v110
    v_add_f32 v148, v148, v6
    v_add_f32 v150, v150, v7
    v_lshlrev_b32 v6, 16, v114
    v_and_b32 v7, 0xffff0000, v114
    v_add_f32 v152, v152, v6
    v_add_f32 v154, v154, v7
    v_mfma_f32_32x32x16_bf16 v[76:91], v[112:115], v[96:99], v[76:91]
    v_lshlrev_b32 v6, 16, v111
    v_and_b32 v7, 0xffff0000, v111
    v_add_f32 v149, v149, v6
    v_add_f32 v151, v151, v7
    v_lshlrev_b32 v6, 16, v115
    v_and_b32 v7, 0xffff0000, v115
    v_add_f32 v153, v153, v6
    v_add_f32 v155, v155, v7
    ds_read_b128 v[92:95], v15
    ds_read_b128 v[96:99], v16
    ds_read_b64_tr_b16 v[108:109], v21 offset:0
    ds_read_b64_tr_b16 v[110:111], v21 offset:512
    ds_read_b64_tr_b16 v[112:113], v25 offset:0
    ds_read_b64_tr_b16 v[114:115], v25 offset:512
    s_waitcnt lgkmcnt(6)
    v_mfma_f32_32x32x16_bf16 v[28:43], v[116:119], v[100:103], v[28:43]
    v_mfma_f32_32x32x16_bf16 v[44:59], v[120:123], v[100:103], v[44:59]
    v_mfma_f32_32x32x16_bf16 v[60:75], v[116:119], v[104:107], v[60:75]
    v_mfma_f32_32x32x16_bf16 v[76:91], v[120:123], v[104:107], v[76:91]
    ds_read_b128 v[100:103], v17
    ds_read_b128 v[104:107], v18
    ds_read_b64_tr_b16 v[116:117], v22 offset:0
    ds_read_b64_tr_b16 v[118:119], v22 offset:512
    ds_read_b64_tr_b16 v[120:121], v26 offset:0
    ds_read_b64_tr_b16 v[122:123], v26 offset:512
    s_waitcnt lgkmcnt(6)
    v_mfma_f32_32x32x16_bf16 v[28:43], v[108:111], v[92:95], v[28:43]
    v_add_u32 v11, 49152, v11
    v_add_u32 v12, 49152, v12
    v_add_u32 v13, 49152, v13
    v_add_u32 v14, 49152, v14
    v_mfma_f32_32x32x16_bf16 v[44:59], v[112:115], v[92:95], v[44:59]
    v_add_u32 v15, 49152, v15
    v_add_u32 v16, 49152, v16
    v_add_u32 v17, 49152, v17
    v_add_u32 v18, 49152, v18
    v_mfma_f32_32x32x16_bf16 v[60:75], v[108:111], v[96:99], v[60:75]
    v_add_u32 v19, 49152, v19
    v_add_u32 v20, 49152, v20
    v_add_u32 v21, 49152, v21
    v_add_u32 v22, 49152, v22
    v_mfma_f32_32x32x16_bf16 v[76:91], v[112:115], v[96:99], v[76:91]
    v_add_u32 v23, 49152, v23
    v_add_u32 v24, 49152, v24
    v_add_u32 v25, 49152, v25
    v_add_u32 v26, 49152, v26
    s_waitcnt vmcnt(0) lgkmcnt(0)
    s_barrier
    ds_read_b128 v[92:95], v11
    ds_read_b128 v[96:99], v12
    ds_read_b64_tr_b16 v[108:109], v19 offset:0
    ds_read_b64_tr_b16 v[110:111], v19 offset:512
    ds_read_b64_tr_b16 v[112:113], v23 offset:0
    ds_read_b64_tr_b16 v[114:115], v23 offset:512
    v_mfma_f32_32x32x16_bf16 v[28:43], v[116:119], v[100:103], v[28:43]
    v_mfma_f32_32x32x16_bf16 v[44:59], v[120:123], v[100:103], v[44:59]
    v_mfma_f32_32x32x16_bf16 v[60:75], v[116:119], v[104:107], v[60:75]
    v_mfma_f32_32x32x16_bf16 v[76:91], v[120:123], v[104:107], v[76:91]
    ds_read_b128 v[100:103], v13
    ds_read_b128 v[104:107], v14
    ds_read_b64_tr_b16 v[116:117], v20 offset:0
    ds_read_b64_tr_b16 v[118:119], v20 offset:512
    ds_read_b64_tr_b16 v[120:121], v24 offset:0
    ds_read_b64_tr_b16 v[122:123], v24 offset:512
    s_waitcnt lgkmcnt(6)
    v_mfma_f32_32x32x16_bf16 v[28:43], v[108:111], v[92:95], v[28:43]
    v_lshlrev_b32 v6, 16, v108
    v_and_b32 v7, 0xffff0000, v108
    v_add_f32 v148, v148, v6
    v_add_f32 v150, v150, v7
    v_lshlrev_b32 v6, 16, v112
    v_and_b32 v7, 0xffff0000, v112
    v_add_f32 v152, v152, v6
    v_add_f32 v154, v154, v7
    v_mfma_f32_32x32x16_bf16 v[44:59], v[112:115], v[92:95], v[44:59]
    v_lshlrev_b32 v6, 16, v109
    v_and_b32 v7, 0xffff0000, v109
    v_add_f32 v149, v149, v6
    v_add_f32 v151, v151, v7
    v_lshlrev_b32 v6, 16, v113
    v_and_b32 v7, 0xffff0000, v113
    v_add_f32 v153, v153, v6
    v_add_f32 v155, v155, v7
    v_mfma_f32_32x32x16_bf16 v[60:75], v[108:111], v[96:99], v[60:75]
    v_lshlrev_b32 v6, 16, v110
    v_and_b32 v7, 0xffff0000, v110
    v_add_f32 v148, v148, v6
    v_add_f32 v150, v150, v7
    v_lshlrev_b32 v6, 16, v114
    v_and_b32 v7, 0xffff0000, v114
    v_add_f32 v152, v152, v6
    v_add_f32 v154, v154, v7
    v_mfma_f32_32x32x16_bf16 v[76:91], v[112:115], v[96:99], v[76:91]
    v_lshlrev_b32 v6, 16, v111
    v_and_b32 v7, 0xffff0000, v111
    v_add_f32 v149, v149, v6
    v_add_f32 v151, v151, v7
    v_lshlrev_b32 v6, 16, v115
    v_and_b32 v7, 0xffff0000, v115
    v_add_f32 v153, v153, v6
    v_add_f32 v155, v155, v7
    ds_read_b128 v[92:95], v15
    ds_read_b128 v[96:99], v16
    ds_read_b64_tr_b16 v[108:109], v21 offset:0
    ds_read_b64_tr_b16 v[110:111], v21 offset:512
    ds_read_b64_tr_b16 v[112:113], v25 offset:0
    ds_read_b64_tr_b16 v[114:115], v25 offset:512
    s_waitcnt lgkmcnt(6)
    v_mfma_f32_32x32x16_bf16 v[28:43], v[116:119], v[100:103], v[28:43]
    v_mfma_f32_32x32x16_bf16 v[44:59], v[120:123], v[100:103], v[44:59]
    v_mfma_f32_32x32x16_bf16 v[60:75], v[116:119], v[104:107], v[60:75]
    v_mfma_f32_32x32x16_bf16 v[76:91], v[120:123], v[104:107], v[76:91]
    ds_read_b128 v[100:103], v17
    ds_read_b128 v[104:107], v18
    ds_read_b64_tr_b16 v[116:117], v22 offset:0
    ds_read_b64_tr_b16 v[118:119], v22 offset:512
    ds_read_b64_tr_b16 v[120:121], v26 offset:0
    ds_read_b64_tr_b16 v[122:123], v26 offset:512
    s_waitcnt lgkmcnt(6)
    v_mfma_f32_32x32x16_bf16 v[28:43], v[108:111], v[92:95], v[28:43]
    v_mfma_f32_32x32x16_bf16 v[44:59], v[112:115], v[92:95], v[44:59]
    v_mfma_f32_32x32x16_bf16 v[60:75], v[108:111], v[96:99], v[60:75]
    v_mfma_f32_32x32x16_bf16 v[76:91], v[112:115], v[96:99], v[76:91]
    s_waitcnt lgkmcnt(0)
    v_mfma_f32_32x32x16_bf16 v[28:43], v[116:119], v[100:103], v[28:43]
    v_mfma_f32_32x32x16_bf16 v[44:59], v[120:123], v[100:103], v[44:59]
    v_mfma_f32_32x32x16_bf16 v[60:75], v[116:119], v[104:107], v[60:75]
    v_mfma_f32_32x32x16_bf16 v[76:91], v[120:123], v[104:107], v[76:91]
    v_add_f32 v140, v140, v142
    v_add_f32 v141, v141, v143
    v_add_f32 v132, v140, v141
    v_add_f32 v144, v144, v146
    v_add_f32 v145, v145, v147
    v_add_f32 v134, v144, v145
    v_add_f32 v148, v148, v149
    v_add_f32 v150, v150, v151
    v_add_f32 v136, v148, v150
    v_add_f32 v152, v152, v153
    v_add_f32 v154, v154, v155
    v_add_f32 v137, v152, v154
    v_mov_b32 v4, v132
    s_nop 1
    v_permlane32_swap_b32 v132, v4
    v_add_f32 v132, v132, v4
    v_mov_b32 v4, v134
    s_nop 1
    v_permlane32_swap_b32 v134, v4
    v_add_f32 v134, v134, v4
    v_mov_b32 v4, v136
    s_nop 1
    v_permlane32_swap_b32 v136, v4
    v_add_f32 v136, v136, v4
    v_mov_b32 v4, v137
    s_nop 1
    v_permlane32_swap_b32 v137, v4
    v_add_f32 v137, v137, v4
    s_lshl_b32 s8, s3, 9
    s_add_u32 s8, s8, 147456
    v_lshlrev_b32 v5, 2, v2
    v_add_u32 v6, s8, v5
    ds_write_b32 v6, v132
    ds_write_b32 v6, v134 offset:128
    ds_write_b32 v6, v136 offset:256
    ds_write_b32 v6, v137 offset:384
    s_waitcnt lgkmcnt(0)
    s_barrier
    s_lshl_b32 s8, s96, 10
    s_add_u32 s8, s8, 147456
    v_add_u32 v6, s8, v5
    s_mul_i32 s8, s97, 512
    s_sub_u32 s9, 512, s8
    v_add_u32 v7, s9, v6
    v_add_u32 v6, s8, v6
    v_add_f32 v156, v156, v158
    v_add_f32 v160, v160, v162
    v_add_f32 v132, v156, v160
    v_mov_b32 v4, v132
    s_nop 1
    v_permlane32_swap_b32 v132, v4
    v_add_f32 v132, v132, v4
    v_add_f32 v157, v157, v159
    v_add_f32 v161, v161, v163
    v_add_f32 v134, v157, v161
    v_mov_b32 v4, v134
    s_nop 1
    v_permlane32_swap_b32 v134, v4
    v_add_f32 v134, v134, v4
    v_add_f32 v164, v164, v166
    v_add_f32 v168, v168, v170
    v_add_f32 v133, v164, v168
    v_mov_b32 v4, v133
    s_nop 1
    v_permlane32_swap_b32 v133, v4
    v_add_f32 v133, v133, v4
    v_add_f32 v165, v165, v167
    v_add_f32 v169, v169, v171
    v_add_f32 v135, v165, v169
    v_mov_b32 v4, v135
    s_nop 1
    v_permlane32_swap_b32 v135, v4
    v_add_f32 v135, v135, v4
    s_lshl_b32 s8, s97, 9
    s_add_u32 s8, s8, 147712
    v_lshlrev_b32 v5, 2, v1
    v_add_u32 v6, s8, v5
    ds_read_b32 v204, v6 offset:0
    ds_read_b32 v205, v6 offset:1024
    ds_read_b32 v206, v6 offset:2048
    ds_read_b32 v207, v6 offset:3072
    s_waitcnt lgkmcnt(0)
    v_add_f32 v204, v204, v205
    v_add_f32 v204, v204, v206
    v_add_f32 v204, v204, v207
    s_lshl_b32 s8, s3, 8
    s_add_u32 s8, s8, 151552
    v_add_u32 v6, s8, v5
    ds_write_b32 v6, v204
    v_lshlrev_b32 v5, 4, v3
    v_add_u32 v5, s8, v5
    s_waitcnt lgkmcnt(0)
    ds_read_b128 v[172:175], v5 offset:0
    ds_read_b128 v[176:179], v5 offset:32
    ds_read_b128 v[180:183], v5 offset:64
    ds_read_b128 v[184:187], v5 offset:96
    ds_read_b128 v[188:191], v5 offset:128
    ds_read_b128 v[192:195], v5 offset:160
    ds_read_b128 v[196:199], v5 offset:192
    ds_read_b128 v[200:203], v5 offset:224
    s_waitcnt lgkmcnt(0)
    v_mul_f32 v132, 0x3b000000, v132
    v_mul_f32 v134, 0x3b000000, v134
    v_fma_f32 v134, -v132, v132, v134
    v_max_f32 v134, 0, v134
    v_add_f32 v134, 0x3727c5ac, v134
    v_rsq_f32 v134, v134
    s_nop 0
    v_mul_f32 v132, v132, v134
    v_sub_f32 v132, 0, v132
    v_mul_f32 v133, 0x3b000000, v133
    v_mul_f32 v135, 0x3b000000, v135
    v_fma_f32 v135, -v133, v133, v135
    v_max_f32 v135, 0, v135
    v_add_f32 v135, 0x3727c5ac, v135
    v_rsq_f32 v135, v135
    s_nop 0
    v_mul_f32 v133, v133, v135
    v_sub_f32 v133, 0, v133
    v_mul_f32 v124, 0xbfb8aa3b, v134
    v_mul_f32 v125, 0xbfb8aa3b, v132
    v_mul_f32 v126, 0xbfb8aa3b, v135
    v_mul_f32 v127, 0xbfb8aa3b, v133
    v_mul_f32 v28, v28, v124
    v_mul_f32 v44, v44, v134
    v_fma_f32 v28, v125, v172, v28
    v_fma_f32 v44, v132, v188, v44
    v_exp_f32 v28, v28
    v_mul_f32 v29, v29, v124
    v_mul_f32 v45, v45, v134
    v_fma_f32 v29, v125, v173, v29
    v_fma_f32 v45, v132, v189, v45
    v_exp_f32 v29, v29
    v_mul_f32 v30, v30, v124
    v_mul_f32 v46, v46, v134
    v_fma_f32 v30, v125, v174, v30
    v_fma_f32 v46, v132, v190, v46
    v_exp_f32 v30, v30
    v_mul_f32 v31, v31, v124
    v_mul_f32 v47, v47, v134
    v_fma_f32 v31, v125, v175, v31
    v_fma_f32 v47, v132, v191, v47
    v_exp_f32 v31, v31
    v_mul_f32 v32, v32, v124
    v_mul_f32 v48, v48, v134
    v_fma_f32 v32, v125, v176, v32
    v_fma_f32 v48, v132, v192, v48
    v_exp_f32 v32, v32
    v_mul_f32 v33, v33, v124
    v_mul_f32 v49, v49, v134
    v_fma_f32 v33, v125, v177, v33
    v_fma_f32 v49, v132, v193, v49
    v_exp_f32 v33, v33
    v_mul_f32 v34, v34, v124
    v_mul_f32 v50, v50, v134
    v_fma_f32 v34, v125, v178, v34
    v_fma_f32 v50, v132, v194, v50
    v_exp_f32 v34, v34
    v_mul_f32 v35, v35, v124
    v_mul_f32 v51, v51, v134
    v_fma_f32 v35, v125, v179, v35
    v_fma_f32 v51, v132, v195, v51
    v_exp_f32 v35, v35
    v_mul_f32 v36, v36, v124
    v_mul_f32 v52, v52, v134
    v_fma_f32 v36, v125, v180, v36
    v_fma_f32 v52, v132, v196, v52
    v_exp_f32 v36, v36
    v_mul_f32 v37, v37, v124
    v_mul_f32 v53, v53, v134
    v_fma_f32 v37, v125, v181, v37
    v_fma_f32 v53, v132, v197, v53
    v_exp_f32 v37, v37
    v_mul_f32 v38, v38, v124
    v_mul_f32 v54, v54, v134
    v_fma_f32 v38, v125, v182, v38
    v_fma_f32 v54, v132, v198, v54
    v_exp_f32 v38, v38
    v_mul_f32 v39, v39, v124
    v_mul_f32 v55, v55, v134
    v_fma_f32 v39, v125, v183, v39
    v_fma_f32 v55, v132, v199, v55
    v_exp_f32 v39, v39
    v_mul_f32 v40, v40, v124
    v_mul_f32 v56, v56, v134
    v_fma_f32 v40, v125, v184, v40
    v_fma_f32 v56, v132, v200, v56
    v_exp_f32 v40, v40
    v_mul_f32 v41, v41, v124
    v_mul_f32 v57, v57, v134
    v_fma_f32 v41, v125, v185, v41
    v_fma_f32 v57, v132, v201, v57
    v_exp_f32 v41, v41
    v_mul_f32 v42, v42, v124
    v_mul_f32 v58, v58, v134
    v_fma_f32 v42, v125, v186, v42
    v_fma_f32 v58, v132, v202, v58
    v_exp_f32 v42, v42
    v_mul_f32 v43, v43, v124
    v_mul_f32 v59, v59, v134
    v_fma_f32 v43, v125, v187, v43
    v_fma_f32 v59, v132, v203, v59
    v_exp_f32 v43, v43
    v_add_f32 v28, 1.0, v28
    v_rcp_f32 v28, v28
    v_add_f32 v29, 1.0, v29
    v_rcp_f32 v29, v29
    v_add_f32 v30, 1.0, v30
    v_rcp_f32 v30, v30
    v_add_f32 v31, 1.0, v31
    v_rcp_f32 v31, v31
    v_add_f32 v32, 1.0, v32
    v_rcp_f32 v32, v32
    v_add_f32 v33, 1.0, v33
    v_rcp_f32 v33, v33
    v_add_f32 v34, 1.0, v34
    v_rcp_f32 v34, v34
    v_add_f32 v35, 1.0, v35
    v_rcp_f32 v35, v35
    v_add_f32 v36, 1.0, v36
    v_rcp_f32 v36, v36
    v_add_f32 v37, 1.0, v37
    v_rcp_f32 v37, v37
    v_add_f32 v38, 1.0, v38
    v_rcp_f32 v38, v38
    v_add_f32 v39, 1.0, v39
    v_rcp_f32 v39, v39
    v_add_f32 v40, 1.0, v40
    v_rcp_f32 v40, v40
    v_add_f32 v41, 1.0, v41
    v_rcp_f32 v41, v41
    v_add_f32 v42, 1.0, v42
    v_rcp_f32 v42, v42
    v_add_f32 v43, 1.0, v43
    v_rcp_f32 v43, v43
    v_mul_f32 v28, v28, v44
    v_mul_f32 v29, v29, v45
    v_mul_f32 v30, v30, v46
    v_mul_f32 v31, v31, v47
    v_mul_f32 v32, v32, v48
    v_mul_f32 v33, v33, v49
    v_mul_f32 v34, v34, v50
    v_mul_f32 v35, v35, v51
    v_mul_f32 v36, v36, v52
    v_mul_f32 v37, v37, v53
    v_mul_f32 v38, v38, v54
    v_mul_f32 v39, v39, v55
    v_mul_f32 v40, v40, v56
    v_mul_f32 v41, v41, v57
    v_mul_f32 v42, v42, v58
    v_mul_f32 v43, v43, v59
    v_mul_f32 v60, v60, v126
    v_mul_f32 v76, v76, v135
    v_fma_f32 v60, v127, v172, v60
    v_fma_f32 v76, v133, v188, v76
    v_exp_f32 v60, v60
    v_mul_f32 v61, v61, v126
    v_mul_f32 v77, v77, v135
    v_fma_f32 v61, v127, v173, v61
    v_fma_f32 v77, v133, v189, v77
    v_exp_f32 v61, v61
    v_mul_f32 v62, v62, v126
    v_mul_f32 v78, v78, v135
    v_fma_f32 v62, v127, v174, v62
    v_fma_f32 v78, v133, v190, v78
    v_exp_f32 v62, v62
    v_mul_f32 v63, v63, v126
    v_mul_f32 v79, v79, v135
    v_fma_f32 v63, v127, v175, v63
    v_fma_f32 v79, v133, v191, v79
    v_exp_f32 v63, v63
    v_mul_f32 v64, v64, v126
    v_mul_f32 v80, v80, v135
    v_fma_f32 v64, v127, v176, v64
    v_fma_f32 v80, v133, v192, v80
    v_exp_f32 v64, v64
    v_mul_f32 v65, v65, v126
    v_mul_f32 v81, v81, v135
    v_fma_f32 v65, v127, v177, v65
    v_fma_f32 v81, v133, v193, v81
    v_exp_f32 v65, v65
    v_mul_f32 v66, v66, v126
    v_mul_f32 v82, v82, v135
    v_fma_f32 v66, v127, v178, v66
    v_fma_f32 v82, v133, v194, v82
    v_exp_f32 v66, v66
    v_mul_f32 v67, v67, v126
    v_mul_f32 v83, v83, v135
    v_fma_f32 v67, v127, v179, v67
    v_fma_f32 v83, v133, v195, v83
    v_exp_f32 v67, v67
    v_mul_f32 v68, v68, v126
    v_mul_f32 v84, v84, v135
    v_fma_f32 v68, v127, v180, v68
    v_fma_f32 v84, v133, v196, v84
    v_exp_f32 v68, v68
    v_mul_f32 v69, v69, v126
    v_mul_f32 v85, v85, v135
    v_fma_f32 v69, v127, v181, v69
    v_fma_f32 v85, v133, v197, v85
    v_exp_f32 v69, v69
    v_mul_f32 v70, v70, v126
    v_mul_f32 v86, v86, v135
    v_fma_f32 v70, v127, v182, v70
    v_fma_f32 v86, v133, v198, v86
    v_exp_f32 v70, v70
    v_mul_f32 v71, v71, v126
    v_mul_f32 v87, v87, v135
    v_fma_f32 v71, v127, v183, v71
    v_fma_f32 v87, v133, v199, v87
    v_exp_f32 v71, v71
    v_mul_f32 v72, v72, v126
    v_mul_f32 v88, v88, v135
    v_fma_f32 v72, v127, v184, v72
    v_fma_f32 v88, v133, v200, v88
    v_exp_f32 v72, v72
    v_mul_f32 v73, v73, v126
    v_mul_f32 v89, v89, v135
    v_fma_f32 v73, v127, v185, v73
    v_fma_f32 v89, v133, v201, v89
    v_exp_f32 v73, v73
    v_mul_f32 v74, v74, v126
    v_mul_f32 v90, v90, v135
    v_fma_f32 v74, v127, v186, v74
    v_fma_f32 v90, v133, v202, v90
    v_exp_f32 v74, v74
    v_mul_f32 v75, v75, v126
    v_mul_f32 v91, v91, v135
    v_fma_f32 v75, v127, v187, v75
    v_fma_f32 v91, v133, v203, v91
    v_exp_f32 v75, v75
    v_add_f32 v60, 1.0, v60
    v_rcp_f32 v60, v60
    v_add_f32 v61, 1.0, v61
    v_rcp_f32 v61, v61
    v_add_f32 v62, 1.0, v62
    v_rcp_f32 v62, v62
    v_add_f32 v63, 1.0, v63
    v_rcp_f32 v63, v63
    v_add_f32 v64, 1.0, v64
    v_rcp_f32 v64, v64
    v_add_f32 v65, 1.0, v65
    v_rcp_f32 v65, v65
    v_add_f32 v66, 1.0, v66
    v_rcp_f32 v66, v66
    v_add_f32 v67, 1.0, v67
    v_rcp_f32 v67, v67
    v_add_f32 v68, 1.0, v68
    v_rcp_f32 v68, v68
    v_add_f32 v69, 1.0, v69
    v_rcp_f32 v69, v69
    v_add_f32 v70, 1.0, v70
    v_rcp_f32 v70, v70
    v_add_f32 v71, 1.0, v71
    v_rcp_f32 v71, v71
    v_add_f32 v72, 1.0, v72
    v_rcp_f32 v72, v72
    v_add_f32 v73, 1.0, v73
    v_rcp_f32 v73, v73
    v_add_f32 v74, 1.0, v74
    v_rcp_f32 v74, v74
    v_add_f32 v75, 1.0, v75
    v_rcp_f32 v75, v75
    v_mul_f32 v60, v60, v76
    v_mul_f32 v61, v61, v77
    v_mul_f32 v62, v62, v78
    v_mul_f32 v63, v63, v79
    v_mul_f32 v64, v64, v80
    v_mul_f32 v65, v65, v81
    v_mul_f32 v66, v66, v82
    v_mul_f32 v67, v67, v83
    v_mul_f32 v68, v68, v84
    v_mul_f32 v69, v69, v85
    v_mul_f32 v70, v70, v86
    v_mul_f32 v71, v71, v87
    v_mul_f32 v72, v72, v88
    v_mul_f32 v73, v73, v89
    v_mul_f32 v74, v74, v90
    v_mul_f32 v75, v75, v91
    v_lshlrev_b32 v4, 4, v1
    s_lshl_b32 s8, s96, 6
    s_add_u32 s8, s8, s93
    s_mul_i32 s8, s8, 3584
    s_lshl_b32 s9, s97, 5
    s_add_u32 s9, s9, s6
    s_lshl_b32 s9, s9, 6
    s_add_u32 s8, s8, s9
    v_add_u32 v4, s8, v4
    s_mul_i32 s8, s97, 114688
    s_sub_u32 s9, 114688, s8
    v_add_u32 v5, s9, v4
    v_add_u32 v4, s8, v4
    v_cvt_pk_bf16_f32 v124, v28, v29
    v_cvt_pk_bf16_f32 v125, v30, v31
    v_cvt_pk_bf16_f32 v126, v32, v33
    v_cvt_pk_bf16_f32 v127, v34, v35
    v_cvt_pk_bf16_f32 v128, v36, v37
    v_cvt_pk_bf16_f32 v129, v38, v39
    v_cvt_pk_bf16_f32 v130, v40, v41
    v_cvt_pk_bf16_f32 v131, v42, v43
    buffer_store_dwordx4 v[124:127], v4, s[24:27], 0 offen offset:0
    buffer_store_dwordx4 v[128:131], v4, s[24:27], 0 offen offset:1024
    s_nop 0
    v_cvt_pk_bf16_f32 v124, v60, v61
    v_cvt_pk_bf16_f32 v125, v62, v63
    v_cvt_pk_bf16_f32 v126, v64, v65
    v_cvt_pk_bf16_f32 v127, v66, v67
    v_cvt_pk_bf16_f32 v128, v68, v69
    v_cvt_pk_bf16_f32 v129, v70, v71
    v_cvt_pk_bf16_f32 v130, v72, v73
    v_cvt_pk_bf16_f32 v131, v74, v75
    buffer_store_dwordx4 v[124:127], v5, s[24:27], 0 offen offset:0
    buffer_store_dwordx4 v[128:131], v5, s[24:27], 0 offen offset:1024
    s_nop 0
k4_glu_kernel_end:
    s_endpgm
.section .rodata,"a"
.p2align 6
.amdhsa_kernel k4_glu_kernel
  .amdhsa_next_free_vgpr 240
  .amdhsa_next_free_sgpr 102
  .amdhsa_accum_offset 240
  .amdhsa_group_segment_fixed_size 0
  .amdhsa_kernarg_size 104
  .amdhsa_user_sgpr_count 2
  .amdhsa_user_sgpr_kernarg_segment_ptr 1
  .amdhsa_system_sgpr_workgroup_id_x 1
.end_amdhsa_kernel
.text
.globl k5_down_kernel
.p2align 8
.type k5_down_kernel,@function
k5_down_kernel:
    s_cmp_ge_u32 s2, 256
    s_cbranch_scc1 k5_down_kernel_end
    s_load_dwordx2 s[12:13], s[0:1], 96
    s_load_dwordx2 s[16:17], s[0:1], 72
    s_load_dwordx2 s[20:21], s[0:1], 80
    s_load_dwordx2 s[24:25], s[0:1], 96
    s_lshr_b32 s6, s2, 3
    s_and_b32 s6, s6, 7
    s_lshl_b32 s6, s6, 6
    s_and_b32 s5, s2, 7
    s_lshl_b32 s5, s5, 2
    s_lshr_b32 s8, s2, 6
    s_add_u32 s5, s5, s8
    s_lshl_b32 s5, s5, 6
    v_and_b32 v1, 63, v0
    v_lshrrev_b32 v4, 6, v0
    s_nop 0
    v_readfirstlane_b32 s3, v4
    v_and_b32 v2, 31, v0
    v_bfe_u32 v3, v0, 5, 1
    s_and_b32 s97, s3, 1
    s_lshr_b32 s8, s3, 1
    s_and_b32 s96, s8, 1
    s_lshr_b32 s98, s8, 1
    s_lshl_b32 s7, s3, 10
    s_mov_b32 s93, s5
    v_lshrrev_b32 v4, 4, v1
    s_mul_i32 s8, s3, 4
    v_add_u32 v4, s8, v4
    v_lshrrev_b32 v5, 0, v4
    v_and_b32 v5, 15, v5
    v_and_b32 v6, 15, v1
    v_xor_b32 v5, v5, v6
    v_lshlrev_b32 v6, 4, v1
    s_lshr_b32 s8, s5, 5
    s_mul_i32 s8, s8, 114688
    s_add_u32 s8, s8, s7
    v_add_u32 v8, s8, v6
    v_lshrrev_b32 v4, 3, v1
    v_bfe_u32 v5, v4, 1, 1
    v_lshlrev_b32 v5, 2, v5
    v_and_b32 v6, 7, v1
    v_xor_b32 v5, v5, v6
    v_lshlrev_b32 v5, 4, v5
    s_mul_i32 s8, s3, 8
    v_add_u32 v4, s8, v4
    s_mov_b32 s8, 1024
    v_mul_lo_u32 v4, v4, s8
    v_add_u32 v4, v4, v5
    s_lshl_b32 s8, s6, 1
    v_add_u32 v9, s8, v4
    s_waitcnt lgkmcnt(0)
    s_add_u32 s12, s12, 69206016
    s_addc_u32 s13, s13, 0
    s_and_b32 s13, s13, 0xffff
    s_mov_b32 s14, 7340032
    s_mov_b32 s15, 0x00020000
    s_and_b32 s17, s17, 0xffff
    s_mov_b32 s18, 1835008
    s_mov_b32 s19, 0x00020000
    s_and_b32 s21, s21, 0xffff
    s_mov_b32 s22, 2097152
    s_mov_b32 s23, 0x00020000
    s_add_u32 s24, s24, 67108864
    s_addc_u32 s25, s25, 0
    s_and_b32 s25, s25, 0xffff
    s_mov_b32 s26, 2097152
    s_mov_b32 s27, 0x00020000
    s_add_u32 m0, s7, 0
    s_mov_b32 s4, 0
    buffer_load_dwordx4 v8, s[12:15], s4 offen lds
    s_add_u32 m0, s7, 8192
    s_mov_b32 s4, 114688
    buffer_load_dwordx4 v8, s[12:15], s4 offen lds
    s_add_u32 m0, s7, 16384
    s_mov_b32 s4, 0
    buffer_load_dwordx4 v9, s[16:19], s4 offen lds
    s_add_u32 m0, s7, 24576
    s_mov_b32 s4, 65536
    buffer_load_dwordx4 v9, s[16:19], s4 offen lds
    s_add_u32 m0, s7, 32768
    s_mov_b32 s4, 8192
    buffer_load_dwordx4 v8, s[12:15], s4 offen lds
    s_add_u32 m0, s7, 40960
    s_mov_b32 s4, 122880
    buffer_load_dwordx4 v8, s[12:15], s4 offen lds
    s_add_u32 m0, s7, 49152
    s_mov_b32 s4, 131072
    buffer_load_dwordx4 v9, s[16:19], s4 offen lds
    s_add_u32 m0, s7, 57344
    s_mov_b32 s4, 196608
    buffer_load_dwordx4 v9, s[16:19], s4 offen lds
    s_add_u32 m0, s7, 65536
    s_mov_b32 s4, 16384
    buffer_load_dwordx4 v8, s[12:15], s4 offen lds
    s_add_u32 m0, s7, 73728
    s_mov_b32 s4, 131072
    buffer_load_dwordx4 v8, s[12:15], s4 offen lds
    s_add_u32 m0, s7, 81920
    s_mov_b32 s4, 262144
    buffer_load_dwordx4 v9, s[16:19], s4 offen lds
    s_add_u32 m0, s7, 90112
    s_mov_b32 s4, 327680
    buffer_load_dwordx4 v9, s[16:19], s4 offen lds
    s_add_u32 m0, s7, 98304
    s_mov_b32 s4, 24576
    buffer_load_dwordx4 v8, s[12:15], s4 offen lds
    s_add_u32 m0, s7, 106496
    s_mov_b32 s4, 139264
    buffer_load_dwordx4 v8, s[12:15], s4 offen lds
    s_add_u32 m0, s7, 114688
    s_mov_b32 s4, 393216
    buffer_load_dwordx4 v9, s[16:19], s4 offen lds
    s_add_u32 m0, s7, 122880
    s_mov_b32 s4, 458752
    buffer_load_dwordx4 v9, s[16:19], s4 offen lds
    s_mul_i32 s92, s96, 2
    s_lshl_b32 s8, s96, 6
    v_add_u32 v4, s8, v2
    v_lshrrev_b32 v5, 0, v4
    v_and_b32 v5, 15, v5
    v_mul_u32_u24 v4, 256, v4
    s_mul_i32 s8, s98, 4096
    s_mul_i32 s9, s96, 8192
    s_add_u32 s8, s8, s9
    v_lshlrev_b32 v7, 4, v1
    s_add_u32 s9, s8, 0
    v_add_u32 v10, s9, v7
    s_mul_i32 s8, s98, 4096
    s_mul_i32 s9, s96, 8192
    s_add_u32 s8, s8, s9
    v_lshlrev_b32 v7, 4, v1
    s_add_u32 s9, s8, 1024
    v_add_u32 v11, s9, v7
    s_mul_i32 s8, s98, 4096
    s_mul_i32 s9, s96, 8192
    s_add_u32 s8, s8, s9
    v_lshlrev_b32 v7, 4, v1
    s_add_u32 s9, s8, 2048
    v_add_u32 v12, s9, v7
    s_mul_i32 s8, s98, 4096
    s_mul_i32 s9, s96, 8192
    s_add_u32 s8, s8, s9
    v_lshlrev_b32 v7, 4, v1
    s_add_u32 s9, s8, 3072
    v_add_u32 v13, s9, v7
    v_bfe_u32 v4, v1, 2, 2
    v_lshrrev_b32 v5, 5, v1
    v_lshlrev_b32 v5, 2, v5
    v_add_u32 v5, v5, v4
    s_mul_i32 s8, s98, 64
    v_add_u32 v5, s8, v5
    v_mul_u32_u24 v5, 128, v5
    v_bfe_u32 v6, v1, 4, 1
    v_lshlrev_b32 v6, 4, v6
    v_and_b32 v7, 3, v1
    v_lshl_add_u32 v6, v7, 2, v6
    s_mul_i32 s8, s97, 32
    s_add_u32 s8, s8, 0
    v_add_u32 v6, s8, v6
    v_lshlrev_b32 v6, 1, v6
    v_bfe_u32 v7, v4, 1, 1
    v_lshlrev_b32 v7, 6, v7
    v_xor_b32 v6, v6, v7
    v_add_u32 v5, v5, v6
    s_mov_b32 s8, 0
    s_mul_i32 s8, s8, 2048
    s_add_u32 s8, s8, 16384
    v_add_u32 v14, s8, v5
    s_mov_b32 s8, 1
    s_mul_i32 s8, s8, 2048
    s_add_u32 s8, s8, 16384
    v_add_u32 v15, s8, v5
    s_mov_b32 s8, 2
    s_mul_i32 s8, s8, 2048
    s_add_u32 s8, s8, 16384
    v_add_u32 v16, s8, v5
    s_mov_b32 s8, 3
    s_mul_i32 s8, s8, 2048
    s_add_u32 s8, s8, 16384
    v_add_u32 v17, s8, v5
    s_waitcnt vmcnt(12) lgkmcnt(0)
    s_barrier
    ds_read_b128 v[36:39], v10
    ds_read_b64_tr_b16 v[44:45], v14 offset:0
    ds_read_b64_tr_b16 v[46:47], v14 offset:1024
    ds_read_b128 v[40:43], v11
    ds_read_b64_tr_b16 v[48:49], v15 offset:0
    ds_read_b64_tr_b16 v[50:51], v15 offset:1024
    s_waitcnt lgkmcnt(3)
    v_mfma_f32_32x32x16_bf16 v[20:35], v[44:47], v[36:39], 0
    ds_read_b128 v[36:39], v12
    ds_read_b64_tr_b16 v[44:45], v16 offset:0
    ds_read_b64_tr_b16 v[46:47], v16 offset:1024
    s_waitcnt lgkmcnt(3)
    v_mfma_f32_32x32x16_bf16 v[20:35], v[48:51], v[40:43], v[20:35]
    ds_read_b128 v[40:43], v13
    ds_read_b64_tr_b16 v[48:49], v17 offset:0
    ds_read_b64_tr_b16 v[50:51], v17 offset:1024
    s_waitcnt lgkmcnt(3)
    v_mfma_f32_32x32x16_bf16 v[20:35], v[44:47], v[36:39], v[20:35]
    v_add_u32 v10, 32768, v10
    v_add_u32 v11, 32768, v11
    v_add_u32 v12, 32768, v12
    v_add_u32 v13, 32768, v13
    v_add_u32 v14, 32768, v14
    v_add_u32 v15, 32768, v15
    v_add_u32 v16, 32768, v16
    v_add_u32 v17, 32768, v17
    s_waitcnt vmcnt(8) lgkmcnt(0)
    s_barrier
    ds_read_b128 v[36:39], v10
    ds_read_b64_tr_b16 v[44:45], v14 offset:0
    ds_read_b64_tr_b16 v[46:47], v14 offset:1024
    v_mfma_f32_32x32x16_bf16 v[20:35], v[48:51], v[40:43], v[20:35]
    s_add_u32 m0, s7, 0
    s_mov_b32 s4, 32768
    buffer_load_dwordx4 v8, s[12:15], s4 offen lds
    s_add_u32 m0, s7, 8192
    s_mov_b32 s4, 147456
    buffer_load_dwordx4 v8, s[12:15], s4 offen lds
    ds_read_b128 v[40:43], v11
    ds_read_b64_tr_b16 v[48:49], v15 offset:0
    ds_read_b64_tr_b16 v[50:51], v15 offset:1024
    s_waitcnt lgkmcnt(3)
    v_mfma_f32_32x32x16_bf16 v[20:35], v[44:47], v[36:39], v[20:35]
    s_add_u32 m0, s7, 16384
    s_mov_b32 s4, 524288
    buffer_load_dwordx4 v9, s[16:19], s4 offen lds
    s_add_u32 m0, s7, 24576
    s_mov_b32 s4, 589824
    buffer_load_dwordx4 v9, s[16:19], s4 offen lds
    ds_read_b128 v[36:39], v12
    ds_read_b64_tr_b16 v[44:45], v16 offset:0
    ds_read_b64_tr_b16 v[46:47], v16 offset:1024
    s_waitcnt lgkmcnt(3)
    v_mfma_f32_32x32x16_bf16 v[20:35], v[48:51], v[40:43], v[20:35]
    ds_read_b128 v[40:43], v13
    ds_read_b64_tr_b16 v[48:49], v17 offset:0
    ds_read_b64_tr_b16 v[50:51], v17 offset:1024
    s_waitcnt lgkmcnt(3)
    v_mfma_f32_32x32x16_bf16 v[20:35], v[44:47], v[36:39], v[20:35]
    v_add_u32 v10, 32768, v10
    v_add_u32 v11, 32768, v11
    v_add_u32 v12, 32768, v12
    v_add_u32 v13, 32768, v13
    v_add_u32 v14, 32768, v14
    v_add_u32 v15, 32768, v15
    v_add_u32 v16, 32768, v16
    v_add_u32 v17, 32768, v17
    s_waitcnt vmcnt(8) lgkmcnt(0)
    s_barrier
    ds_read_b128 v[36:39], v10
    ds_read_b64_tr_b16 v[44:45], v14 offset:0
    ds_read_b64_tr_b16 v[46:47], v14 offset:1024
    v_mfma_f32_32x32x16_bf16 v[20:35], v[48:51], v[40:43], v[20:35]
    s_add_u32 m0, s7, 32768
    s_mov_b32 s4, 40960
    buffer_load_dwordx4 v8, s[12:15], s4 offen lds
    s_add_u32 m0, s7, 40960
    s_mov_b32 s4, 155648
    buffer_load_dwordx4 v8, s[12:15], s4 offen lds
    ds_read_b128 v[40:43], v11
    ds_read_b64_tr_b16 v[48:49], v15 offset:0
    ds_read_b64_tr_b16 v[50:51], v15 offset:1024
    s_waitcnt lgkmcnt(3)
    v_mfma_f32_32x32x16_bf16 v[20:35], v[44:47], v[36:39], v[20:35]
    s_add_u32 m0, s7, 49152
    s_mov_b32 s4, 655360
    buffer_load_dwordx4 v9, s[16:19], s4 offen lds
    s_add_u32 m0, s7, 57344
    s_mov_b32 s4, 720896
    buffer_load_dwordx4 v9, s[16:19], s4 offen lds
    ds_read_b128 v[36:39], v12
    ds_read_b64_tr_b16 v[44:45], v16 offset:0
    ds_read_b64_tr_b16 v[46:47], v16 offset:1024
    s_waitcnt lgkmcnt(3)
    v_mfma_f32_32x32x16_bf16 v[20:35], v[48:51], v[40:43], v[20:35]
    ds_read_b128 v[40:43], v13
    ds_read_b64_tr_b16 v[48:49], v17 offset:0
    ds_read_b64_tr_b16 v[50:51], v17 offset:1024
    s_waitcnt lgkmcnt(3)
    v_mfma_f32_32x32x16_bf16 v[20:35], v[44:47], v[36:39], v[20:35]
    v_add_u32 v10, 32768, v10
    v_add_u32 v11, 32768, v11
    v_add_u32 v12, 32768, v12
    v_add_u32 v13, 32768, v13
    v_add_u32 v14, 32768, v14
    v_add_u32 v15, 32768, v15
    v_add_u32 v16, 32768, v16
    v_add_u32 v17, 32768, v17
    s_waitcnt vmcnt(8) lgkmcnt(0)
    s_barrier
    ds_read_b128 v[36:39], v10
    ds_read_b64_tr_b16 v[44:45], v14 offset:0
    ds_read_b64_tr_b16 v[46:47], v14 offset:1024
    v_mfma_f32_32x32x16_bf16 v[20:35], v[48:51], v[40:43], v[20:35]
    s_add_u32 m0, s7, 65536
    s_mov_b32 s4, 49152
    buffer_load_dwordx4 v8, s[12:15], s4 offen lds
    s_add_u32 m0, s7, 73728
    s_mov_b32 s4, 163840
    buffer_load_dwordx4 v8, s[12:15], s4 offen lds
    ds_read_b128 v[40:43], v11
    ds_read_b64_tr_b16 v[48:49], v15 offset:0
    ds_read_b64_tr_b16 v[50:51], v15 offset:1024
    s_waitcnt lgkmcnt(3)
    v_mfma_f32_32x32x16_bf16 v[20:35], v[44:47], v[36:39], v[20:35]
    s_add_u32 m0, s7, 81920
    s_mov_b32 s4, 786432
    buffer_load_dwordx4 v9, s[16:19], s4 offen lds
    s_add_u32 m0, s7, 90112
    s_mov_b32 s4, 851968
    buffer_load_dwordx4 v9, s[16:19], s4 offen lds
    ds_read_b128 v[36:39], v12
    ds_read_b64_tr_b16 v[44:45], v16 offset:0
    ds_read_b64_tr_b16 v[46:47], v16 offset:1024
    s_waitcnt lgkmcnt(3)
    v_mfma_f32_32x32x16_bf16 v[20:35], v[48:51], v[40:43], v[20:35]
    ds_read_b128 v[40:43], v13
    ds_read_b64_tr_b16 v[48:49], v17 offset:0
    ds_read_b64_tr_b16 v[50:51], v17 offset:1024
    s_waitcnt lgkmcnt(3)
    v_mfma_f32_32x32x16_bf16 v[20:35], v[44:47], v[36:39], v[20:35]
    v_subrev_u32 v10, 98304, v10
    v_subrev_u32 v11, 98304, v11
    v_subrev_u32 v12, 98304, v12
    v_subrev_u32 v13, 98304, v13
    v_subrev_u32 v14, 98304, v14
    v_subrev_u32 v15, 98304, v15
    v_subrev_u32 v16, 98304, v16
    v_subrev_u32 v17, 98304, v17
    s_waitcnt vmcnt(8) lgkmcnt(0)
    s_barrier
    ds_read_b128 v[36:39], v10
    ds_read_b64_tr_b16 v[44:45], v14 offset:0
    ds_read_b64_tr_b16 v[46:47], v14 offset:1024
    v_mfma_f32_32x32x16_bf16 v[20:35], v[48:51], v[40:43], v[20:35]
    s_add_u32 m0, s7, 98304
    s_mov_b32 s4, 57344
    buffer_load_dwordx4 v8, s[12:15], s4 offen lds
    s_add_u32 m0, s7, 106496
    s_mov_b32 s4, 172032
    buffer_load_dwordx4 v8, s[12:15], s4 offen lds
    ds_read_b128 v[40:43], v11
    ds_read_b64_tr_b16 v[48:49], v15 offset:0
    ds_read_b64_tr_b16 v[50:51], v15 offset:1024
    s_waitcnt lgkmcnt(3)
    v_mfma_f32_32x32x16_bf16 v[20:35], v[44:47], v[36:39], v[20:35]
    s_add_u32 m0, s7, 114688
    s_mov_b32 s4, 917504
    buffer_load_dwordx4 v9, s[16:19], s4 offen lds
    s_add_u32 m0, s7, 122880
    s_mov_b32 s4, 983040
    buffer_load_dwordx4 v9, s[16:19], s4 offen lds
    ds_read_b128 v[36:39], v12
    ds_read_b64_tr_b16 v[44:45], v16 offset:0
    ds_read_b64_tr_b16 v[46:47], v16 offset:1024
    s_waitcnt lgkmcnt(3)
    v_mfma_f32_32x32x16_bf16 v[20:35], v[48:51], v[40:43], v[20:35]
    ds_read_b128 v[40:43], v13
    ds_read_b64_tr_b16 v[48:49], v17 offset:0
    ds_read_b64_tr_b16 v[50:51], v17 offset:1024
    s_waitcnt lgkmcnt(3)
    v_mfma_f32_32x32x16_bf16 v[20:35], v[44:47], v[36:39], v[20:35]
    v_add_u32 v10, 32768, v10
    v_add_u32 v11, 32768, v11
    v_add_u32 v12, 32768, v12
    v_add_u32 v13, 32768, v13
    v_add_u32 v14, 32768, v14
    v_add_u32 v15, 32768, v15
    v_add_u32 v16, 32768, v16
    v_add_u32 v17, 32768, v17
    s_waitcnt vmcnt(8) lgkmcnt(0)
    s_barrier
    ds_read_b128 v[36:39], v10
    ds_read_b64_tr_b16 v[44:45], v14 offset:0
    ds_read_b64_tr_b16 v[46:47], v14 offset:1024
    v_mfma_f32_32x32x16_bf16 v[20:35], v[48:51], v[40:43], v[20:35]
    s_add_u32 m0, s7, 0
    s_mov_b32 s4, 65536
    buffer_load_dwordx4 v8, s[12:15], s4 offen lds
    s_add_u32 m0, s7, 8192
    s_mov_b32 s4, 180224
    buffer_load_dwordx4 v8, s[12:15], s4 offen lds
    ds_read_b128 v[40:43], v11
    ds_read_b64_tr_b16 v[48:49], v15 offset:0
    ds_read_b64_tr_b16 v[50:51], v15 offset:1024
    s_waitcnt lgkmcnt(3)
    v_mfma_f32_32x32x16_bf16 v[20:35], v[44:47], v[36:39], v[20:35]
    s_add_u32 m0, s7, 16384
    s_mov_b32 s4, 1048576
    buffer_load_dwordx4 v9, s[16:19], s4 offen lds
    s_add_u32 m0, s7, 24576
    s_mov_b32 s4, 1114112
    buffer_load_dwordx4 v9, s[16:19], s4 offen lds
    ds_read_b128 v[36:39], v12
    ds_read_b64_tr_b16 v[44:45], v16 offset:0
    ds_read_b64_tr_b16 v[46:47], v16 offset:1024
    s_waitcnt lgkmcnt(3)
    v_mfma_f32_32x32x16_bf16 v[20:35], v[48:51], v[40:43], v[20:35]
    ds_read_b128 v[40:43], v13
    ds_read_b64_tr_b16 v[48:49], v17 offset:0
    ds_read_b64_tr_b16 v[50:51], v17 offset:1024
    s_waitcnt lgkmcnt(3)
    v_mfma_f32_32x32x16_bf16 v[20:35], v[44:47], v[36:39], v[20:35]
    v_add_u32 v10, 32768, v10
    v_add_u32 v11, 32768, v11
    v_add_u32 v12, 32768, v12
    v_add_u32 v13, 32768, v13
    v_add_u32 v14, 32768, v14
    v_add_u32 v15, 32768, v15
    v_add_u32 v16, 32768, v16
    v_add_u32 v17, 32768, v17
    s_waitcnt vmcnt(8) lgkmcnt(0)
    s_barrier
    ds_read_b128 v[36:39], v10
    ds_read_b64_tr_b16 v[44:45], v14 offset:0
    ds_read_b64_tr_b16 v[46:47], v14 offset:1024
    v_mfma_f32_32x32x16_bf16 v[20:35], v[48:51], v[40:43], v[20:35]
    s_add_u32 m0, s7, 32768
    s_mov_b32 s4, 73728
    buffer_load_dwordx4 v8, s[12:15], s4 offen lds
    s_add_u32 m0, s7, 40960
    s_mov_b32 s4, 188416
    buffer_load_dwordx4 v8, s[12:15], s4 offen lds
    ds_read_b128 v[40:43], v11
    ds_read_b64_tr_b16 v[48:49], v15 offset:0
    ds_read_b64_tr_b16 v[50:51], v15 offset:1024
    s_waitcnt lgkmcnt(3)
    v_mfma_f32_32x32x16_bf16 v[20:35], v[44:47], v[36:39], v[20:35]
    s_add_u32 m0, s7, 49152
    s_mov_b32 s4, 1179648
    buffer_load_dwordx4 v9, s[16:19], s4 offen lds
    s_add_u32 m0, s7, 57344
    s_mov_b32 s4, 1245184
    buffer_load_dwordx4 v9, s[16:19], s4 offen lds
    ds_read_b128 v[36:39], v12
    ds_read_b64_tr_b16 v[44:45], v16 offset:0
    ds_read_b64_tr_b16 v[46:47], v16 offset:1024
    s_waitcnt lgkmcnt(3)
    v_mfma_f32_32x32x16_bf16 v[20:35], v[48:51], v[40:43], v[20:35]
    ds_read_b128 v[40:43], v13
    ds_read_b64_tr_b16 v[48:49], v17 offset:0
    ds_read_b64_tr_b16 v[50:51], v17 offset:1024
    s_waitcnt lgkmcnt(3)
    v_mfma_f32_32x32x16_bf16 v[20:35], v[44:47], v[36:39], v[20:35]
    v_add_u32 v10, 32768, v10
    v_add_u32 v11, 32768, v11
    v_add_u32 v12, 32768, v12
    v_add_u32 v13, 32768, v13
    v_add_u32 v14, 32768, v14
    v_add_u32 v15, 32768, v15
    v_add_u32 v16, 32768, v16
    v_add_u32 v17, 32768, v17
    s_waitcnt vmcnt(8) lgkmcnt(0)
    s_barrier
    ds_read_b128 v[36:39], v10
    ds_read_b64_tr_b16 v[44:45], v14 offset:0
    ds_read_b64_tr_b16 v[46:47], v14 offset:1024
    v_mfma_f32_32x32x16_bf16 v[20:35], v[48:51], v[40:43], v[20:35]
    s_add_u32 m0, s7, 65536
    s_mov_b32 s4, 81920
    buffer_load_dwordx4 v8, s[12:15], s4 offen lds
    s_add_u32 m0, s7, 73728
    s_mov_b32 s4, 196608
    buffer_load_dwordx4 v8, s[12:15], s4 offen lds
    ds_read_b128 v[40:43], v11
    ds_read_b64_tr_b16 v[48:49], v15 offset:0
    ds_read_b64_tr_b16 v[50:51], v15 offset:1024
    s_waitcnt lgkmcnt(3)
    v_mfma_f32_32x32x16_bf16 v[20:35], v[44:47], v[36:39], v[20:35]
    s_add_u32 m0, s7, 81920
    s_mov_b32 s4, 1310720
    buffer_load_dwordx4 v9, s[16:19], s4 offen lds
    s_add_u32 m0, s7, 90112
    s_mov_b32 s4, 1376256
    buffer_load_dwordx4 v9, s[16:19], s4 offen lds
    ds_read_b128 v[36:39], v12
    ds_read_b64_tr_b16 v[44:45], v16 offset:0
    ds_read_b64_tr_b16 v[46:47], v16 offset:1024
    s_waitcnt lgkmcnt(3)
    v_mfma_f32_32x32x16_bf16 v[20:35], v[48:51], v[40:43], v[20:35]
    ds_read_b128 v[40:43], v13
    ds_read_b64_tr_b16 v[48:49], v17 offset:0
    ds_read_b64_tr_b16 v[50:51], v17 offset:1024
    s_waitcnt lgkmcnt(3)
    v_mfma_f32_32x32x16_bf16 v[20:35], v[44:47], v[36:39], v[20:35]
    v_subrev_u32 v10, 98304, v10
    v_subrev_u32 v11, 98304, v11
    v_subrev_u32 v12, 98304, v12
    v_subrev_u32 v13, 98304, v13
    v_subrev_u32 v14, 98304, v14
    v_subrev_u32 v15, 98304, v15
    v_subrev_u32 v16, 98304, v16
    v_subrev_u32 v17, 98304, v17
    s_waitcnt vmcnt(8) lgkmcnt(0)
    s_barrier
    ds_read_b128 v[36:39], v10
    ds_read_b64_tr_b16 v[44:45], v14 offset:0
    ds_read_b64_tr_b16 v[46:47], v14 offset:1024
    v_mfma_f32_32x32x16_bf16 v[20:35], v[48:51], v[40:43], v[20:35]
    s_add_u32 m0, s7, 98304
    s_mov_b32 s4, 90112
    buffer_load_dwordx4 v8, s[12:15], s4 offen lds
    s_add_u32 m0, s7, 106496
    s_mov_b32 s4, 204800
    buffer_load_dwordx4 v8, s[12:15], s4 offen lds
    ds_read_b128 v[40:43], v11
    ds_read_b64_tr_b16 v[48:49], v15 offset:0
    ds_read_b64_tr_b16 v[50:51], v15 offset:1024
    s_waitcnt lgkmcnt(3)
    v_mfma_f32_32x32x16_bf16 v[20:35], v[44:47], v[36:39], v[20:35]
    s_add_u32 m0, s7, 114688
    s_mov_b32 s4, 1441792
    buffer_load_dwordx4 v9, s[16:19], s4 offen lds
    s_add_u32 m0, s7, 122880
    s_mov_b32 s4, 1507328
    buffer_load_dwordx4 v9, s[16:19], s4 offen lds
    ds_read_b128 v[36:39], v12
    ds_read_b64_tr_b16 v[44:45], v16 offset:0
    ds_read_b64_tr_b16 v[46:47], v16 offset:1024
    s_waitcnt lgkmcnt(3)
    v_mfma_f32_32x32x16_bf16 v[20:35], v[48:51], v[40:43], v[20:35]
    ds_read_b128 v[40:43], v13
    ds_read_b64_tr_b16 v[48:49], v17 offset:0
    ds_read_b64_tr_b16 v[50:51], v17 offset:1024
    s_waitcnt lgkmcnt(3)
    v_mfma_f32_32x32x16_bf16 v[20:35], v[44:47], v[36:39], v[20:35]
    v_add_u32 v10, 32768, v10
    v_add_u32 v11, 32768, v11
    v_add_u32 v12, 32768, v12
    v_add_u32 v13, 32768, v13
    v_add_u32 v14, 32768, v14
    v_add_u32 v15, 32768, v15
    v_add_u32 v16, 32768, v16
    v_add_u32 v17, 32768, v17
    s_waitcnt vmcnt(8) lgkmcnt(0)
    s_barrier
    ds_read_b128 v[36:39], v10
    ds_read_b64_tr_b16 v[44:45], v14 offset:0
    ds_read_b64_tr_b16 v[46:47], v14 offset:1024
    v_mfma_f32_32x32x16_bf16 v[20:35], v[48:51], v[40:43], v[20:35]
    s_add_u32 m0, s7, 0
    s_mov_b32 s4, 98304
    buffer_load_dwordx4 v8, s[12:15], s4 offen lds
    s_add_u32 m0, s7, 8192
    s_mov_b32 s4, 212992
    buffer_load_dwordx4 v8, s[12:15], s4 offen lds
    ds_read_b128 v[40:43], v11
    ds_read_b64_tr_b16 v[48:49], v15 offset:0
    ds_read_b64_tr_b16 v[50:51], v15 offset:1024
    s_waitcnt lgkmcnt(3)
    v_mfma_f32_32x32x16_bf16 v[20:35], v[44:47], v[36:39], v[20:35]
    s_add_u32 m0, s7, 16384
    s_mov_b32 s4, 1572864
    buffer_load_dwordx4 v9, s[16:19], s4 offen lds
    s_add_u32 m0, s7, 24576
    s_mov_b32 s4, 1638400
    buffer_load_dwordx4 v9, s[16:19], s4 offen lds
    ds_read_b128 v[36:39], v12
    ds_read_b64_tr_b16 v[44:45], v16 offset:0
    ds_read_b64_tr_b16 v[46:47], v16 offset:1024
    s_waitcnt lgkmcnt(3)
    v_mfma_f32_32x32x16_bf16 v[20:35], v[48:51], v[40:43], v[20:35]
    ds_read_b128 v[40:43], v13
    ds_read_b64_tr_b16 v[48:49], v17 offset:0
    ds_read_b64_tr_b16 v[50:51], v17 offset:1024
    s_waitcnt lgkmcnt(3)
    v_mfma_f32_32x32x16_bf16 v[20:35], v[44:47], v[36:39], v[20:35]
    v_add_u32 v10, 32768, v10
    v_add_u32 v11, 32768, v11
    v_add_u32 v12, 32768, v12
    v_add_u32 v13, 32768, v13
    v_add_u32 v14, 32768, v14
    v_add_u32 v15, 32768, v15
    v_add_u32 v16, 32768, v16
    v_add_u32 v17, 32768, v17
    s_waitcnt vmcnt(8) lgkmcnt(0)
    s_barrier
    ds_read_b128 v[36:39], v10
    ds_read_b64_tr_b16 v[44:45], v14 offset:0
    ds_read_b64_tr_b16 v[46:47], v14 offset:1024
    v_mfma_f32_32x32x16_bf16 v[20:35], v[48:51], v[40:43], v[20:35]
    s_add_u32 m0, s7, 32768
    s_mov_b32 s4, 106496
    buffer_load_dwordx4 v8, s[12:15], s4 offen lds
    s_add_u32 m0, s7, 40960
    s_mov_b32 s4, 221184
    buffer_load_dwordx4 v8, s[12:15], s4 offen lds
    ds_read_b128 v[40:43], v11
    ds_read_b64_tr_b16 v[48:49], v15 offset:0
    ds_read_b64_tr_b16 v[50:51], v15 offset:1024
    s_waitcnt lgkmcnt(3)
    v_mfma_f32_32x32x16_bf16 v[20:35], v[44:47], v[36:39], v[20:35]
    s_add_u32 m0, s7, 49152
    s_mov_b32 s4, 1703936
    buffer_load_dwordx4 v9, s[16:19], s4 offen lds
    s_add_u32 m0, s7, 57344
    s_mov_b32 s4, 1769472
    buffer_load_dwordx4 v9, s[16:19], s4 offen lds
    ds_read_b128 v[36:39], v12
    ds_read_b64_tr_b16 v[44:45], v16 offset:0
    ds_read_b64_tr_b16 v[46:47], v16 offset:1024
    s_waitcnt lgkmcnt(3)
    v_mfma_f32_32x32x16_bf16 v[20:35], v[48:51], v[40:43], v[20:35]
    ds_read_b128 v[40:43], v13
    ds_read_b64_tr_b16 v[48:49], v17 offset:0
    ds_read_b64_tr_b16 v[50:51], v17 offset:1024
    s_waitcnt lgkmcnt(3)
    v_mfma_f32_32x32x16_bf16 v[20:35], v[44:47], v[36:39], v[20:35]
    v_add_u32 v10, 32768, v10
    v_add_u32 v11, 32768, v11
    v_add_u32 v12, 32768, v12
    v_add_u32 v13, 32768, v13
    v_add_u32 v14, 32768, v14
    v_add_u32 v15, 32768, v15
    v_add_u32 v16, 32768, v16
    v_add_u32 v17, 32768, v17
    s_waitcnt vmcnt(8) lgkmcnt(0)
    s_barrier
    ds_read_b128 v[36:39], v10
    ds_read_b64_tr_b16 v[44:45], v14 offset:0
    ds_read_b64_tr_b16 v[46:47], v14 offset:1024
    v_mfma_f32_32x32x16_bf16 v[20:35], v[48:51], v[40:43], v[20:35]
    ds_read_b128 v[40:43], v11
    ds_read_b64_tr_b16 v[48:49], v15 offset:0
    ds_read_b64_tr_b16 v[50:51], v15 offset:1024
    s_waitcnt lgkmcnt(3)
    v_mfma_f32_32x32x16_bf16 v[20:35], v[44:47], v[36:39], v[20:35]
    ds_read_b128 v[36:39], v12
    ds_read_b64_tr_b16 v[44:45], v16 offset:0
    ds_read_b64_tr_b16 v[46:47], v16 offset:1024
    s_waitcnt lgkmcnt(3)
    v_mfma_f32_32x32x16_bf16 v[20:35], v[48:51], v[40:43], v[20:35]
    ds_read_b128 v[40:43], v13
    ds_read_b64_tr_b16 v[48:49], v17 offset:0
    ds_read_b64_tr_b16 v[50:51], v17 offset:1024
    s_waitcnt lgkmcnt(3)
    v_mfma_f32_32x32x16_bf16 v[20:35], v[44:47], v[36:39], v[20:35]
    v_subrev_u32 v10, 98304, v10
    v_subrev_u32 v11, 98304, v11
    v_subrev_u32 v12, 98304, v12
    v_subrev_u32 v13, 98304, v13
    v_subrev_u32 v14, 98304, v14
    v_subrev_u32 v15, 98304, v15
    v_subrev_u32 v16, 98304, v16
    v_subrev_u32 v17, 98304, v17
    s_waitcnt vmcnt(4) lgkmcnt(0)
    s_barrier
    ds_read_b128 v[36:39], v10
    ds_read_b64_tr_b16 v[44:45], v14 offset:0
    ds_read_b64_tr_b16 v[46:47], v14 offset:1024
    v_mfma_f32_32x32x16_bf16 v[20:35], v[48:51], v[40:43], v[20:35]
    ds_read_b128 v[40:43], v11
    ds_read_b64_tr_b16 v[48:49], v15 offset:0
    ds_read_b64_tr_b16 v[50:51], v15 offset:1024
    s_waitcnt lgkmcnt(3)
    v_mfma_f32_32x32x16_bf16 v[20:35], v[44:47], v[36:39], v[20:35]
    ds_read_b128 v[36:39], v12
    ds_read_b64_tr_b16 v[44:45], v16 offset:0
    ds_read_b64_tr_b16 v[46:47], v16 offset:1024
    s_waitcnt lgkmcnt(3)
    v_mfma_f32_32x32x16_bf16 v[20:35], v[48:51], v[40:43], v[20:35]
    ds_read_b128 v[40:43], v13
    ds_read_b64_tr_b16 v[48:49], v17 offset:0
    ds_read_b64_tr_b16 v[50:51], v17 offset:1024
    s_waitcnt lgkmcnt(3)
    v_mfma_f32_32x32x16_bf16 v[20:35], v[44:47], v[36:39], v[20:35]
    v_add_u32 v10, 32768, v10
    v_add_u32 v11, 32768, v11
    v_add_u32 v12, 32768, v12
    v_add_u32 v13, 32768, v13
    v_add_u32 v14, 32768, v14
    v_add_u32 v15, 32768, v15
    v_add_u32 v16, 32768, v16
    v_add_u32 v17, 32768, v17
    s_waitcnt vmcnt(0) lgkmcnt(0)
    s_barrier
    ds_read_b128 v[36:39], v10
    ds_read_b64_tr_b16 v[44:45], v14 offset:0
    ds_read_b64_tr_b16 v[46:47], v14 offset:1024
    v_mfma_f32_32x32x16_bf16 v[20:35], v[48:51], v[40:43], v[20:35]
    ds_read_b128 v[40:43], v11
    ds_read_b64_tr_b16 v[48:49], v15 offset:0
    ds_read_b64_tr_b16 v[50:51], v15 offset:1024
    s_waitcnt lgkmcnt(3)
    v_mfma_f32_32x32x16_bf16 v[20:35], v[44:47], v[36:39], v[20:35]
    ds_read_b128 v[36:39], v12
    ds_read_b64_tr_b16 v[44:45], v16 offset:0
    ds_read_b64_tr_b16 v[46:47], v16 offset:1024
    s_waitcnt lgkmcnt(3)
    v_mfma_f32_32x32x16_bf16 v[20:35], v[48:51], v[40:43], v[20:35]
    ds_read_b128 v[40:43], v13
    ds_read_b64_tr_b16 v[48:49], v17 offset:0
    ds_read_b64_tr_b16 v[50:51], v17 offset:1024
    s_waitcnt lgkmcnt(3)
    v_mfma_f32_32x32x16_bf16 v[20:35], v[44:47], v[36:39], v[20:35]
    s_waitcnt lgkmcnt(0)
    v_mfma_f32_32x32x16_bf16 v[20:35], v[48:51], v[40:43], v[20:35]
    s_lshl_b32 s8, s96, 5
    s_add_u32 s8, s8, s93
    v_add_u32 v6, s8, v2
    v_lshlrev_b32 v6, 10, v6
    v_lshl_add_u32 v6, v3, 3, v6
    s_lshl_b32 s8, s97, 5
    s_add_u32 s8, s8, s6
    s_lshl_b32 s8, s8, 1
    s_lshl_b32 s9, s98, 5
    s_add_u32 s8, s8, s9
    v_add_u32 v6, s8, v6
    buffer_load_dwordx2 v[60:61], v6, s[24:27], 0 offen offset:0
    buffer_load_dwordx2 v[62:63], v6, s[24:27], 0 offen offset:16
    v_lshlrev_b32 v4, 4, v1
    s_lshl_b32 s8, s3, 11
    s_add_u32 s8, s8, 131072
    v_add_u32 v5, s8, v4
    s_xor_b32 s9, s3, 4
    s_lshl_b32 s9, s9, 11
    s_add_u32 s9, s9, 131072
    v_add_u32 v4, s9, v4
    s_cmp_eq_u32 s98, 1
    s_cbranch_scc1 red_24
    ds_write_b128 v5, v[28:31] offset:0
    ds_write_b128 v5, v[32:35] offset:1024
    s_branch red_25
red_24:
    ds_write_b128 v5, v[20:23] offset:0
    ds_write_b128 v5, v[24:27] offset:1024
    v_mov_b32 v20, v28
    v_mov_b32 v21, v29
    v_mov_b32 v22, v30
    v_mov_b32 v23, v31
    v_mov_b32 v24, v32
    v_mov_b32 v25, v33
    v_mov_b32 v26, v34
    v_mov_b32 v27, v35
    s_nop 0
red_25:
    s_waitcnt lgkmcnt(0)
    s_barrier
    ds_read_b128 v[64:67], v4 offset:0
    ds_read_b128 v[68:71], v4 offset:1024
    s_waitcnt vmcnt(0) lgkmcnt(0)
    v_lshlrev_b32 v4, 16, v60
    v_and_b32 v60, 0xffff0000, v60
    v_add_f32 v20, v20, v64
    v_add_f32 v21, v21, v65
    v_add_f32 v20, v20, v4
    v_add_f32 v21, v21, v60
    v_cvt_pk_bf16_f32 v60, v20, v21
    v_lshlrev_b32 v4, 16, v61
    v_and_b32 v61, 0xffff0000, v61
    v_add_f32 v22, v22, v66
    v_add_f32 v23, v23, v67
    v_add_f32 v22, v22, v4
    v_add_f32 v23, v23, v61
    v_cvt_pk_bf16_f32 v61, v22, v23
    buffer_store_dwordx2 v[60:61], v6, s[20:23], 0 offen offset:0
    v_lshlrev_b32 v4, 16, v62
    v_and_b32 v62, 0xffff0000, v62
    v_add_f32 v24, v24, v68
    v_add_f32 v25, v25, v69
    v_add_f32 v24, v24, v4
    v_add_f32 v25, v25, v62
    v_cvt_pk_bf16_f32 v62, v24, v25
    v_lshlrev_b32 v4, 16, v63
    v_and_b32 v63, 0xffff0000, v63
    v_add_f32 v26, v26, v70
    v_add_f32 v27, v27, v71
    v_add_f32 v26, v26, v4
    v_add_f32 v27, v27, v63
    v_cvt_pk_bf16_f32 v63, v26, v27
    buffer_store_dwordx2 v[62:63], v6, s[20:23], 0 offen offset:16
k5_down_kernel_end:
    s_endpgm
.section .rodata,"a"
.p2align 6
.amdhsa_kernel k5_down_kernel
  .amdhsa_next_free_vgpr 72
  .amdhsa_next_free_sgpr 102
  .amdhsa_accum_offset 72
  .amdhsa_group_segment_fixed_size 0
  .amdhsa_kernarg_size 104
  .amdhsa_user_sgpr_count 2
  .amdhsa_user_sgpr_kernarg_segment_ptr 1
  .amdhsa_system_sgpr_workgroup_id_x 1
.end_amdhsa_kernel
```
